```python
import torch

def _softmax(x, axis=-1):
    return torch.softmax(x, dim=axis)

def _gelu(x):
    return torch.nn.functional.gelu(x, approximate='tanh')

def _silu(x):
    return torch.nn.functional.silu(x)

def _sigmoid(x):
    return torch.sigmoid(x)

def _layernorm(x, axis=-1, eps=1e-05):
    m = x.mean(dim=axis, keepdim=True)
    v = x.var(dim=axis, keepdim=True, unbiased=False)
    return (x - m) / torch.sqrt(v + eps)

def _scatter_add(tgt, idx, src, axis=0):
    return tgt.clone().index_add_(axis, idx, src)

def _segment_sum(src, seg, n):
    out = torch.zeros((n,) + src.shape[1:], dtype=src.dtype)
    return out.index_add_(0, seg, src)

def _pad(x, pw):
    flat = tuple((v for pair in reversed(pw) for v in pair))
    return torch.nn.functional.pad(x, flat)
kernel_name = 'sequential_preLN__ssm_conv_s4__mixer_gmlp__prompt'

def setup_inputs():

    _w = lambda a: (lambda t: t.to(torch.bfloat16) if t.is_floating_point() else t)(torch.as_tensor(a))

    def _A_setup():
        B, L, D, N = (1, 2048, 576, 128)
        A_re = -(lambda _x: torch.exp(torch.as_tensor(_x)))((lambda *s: torch.randn(*s, dtype=torch.bfloat16) * 6.4)(D, N))
        A_im = torch.pi * (lambda *s: torch.randn(*s, dtype=torch.bfloat16) * 0.05)(D, N)
        B_re = (lambda *s: torch.randn(*s, dtype=torch.bfloat16) * 0.05)(D, N)
        B_im = (lambda *s: torch.randn(*s, dtype=torch.bfloat16) * 0.05)(D, N)
        C_re = (lambda *s: torch.randn(*s, dtype=torch.bfloat16) * 0.05)(D, N)
        C_im = (lambda *s: torch.randn(*s, dtype=torch.bfloat16) * 0.05)(D, N)
        log_dt = (lambda *s: torch.randn(*s, dtype=torch.bfloat16) * 0.05)(D) * 0.5 - 4.0
        Dskip = (lambda *s: torch.randn(*s, dtype=torch.bfloat16) * 0.05)(D)
        return {'u': _w((lambda *s: torch.randn(*s, dtype=torch.bfloat16) * 0.05)(B, L, D)), 'A_re': _w(A_re), 'A_im': _w(A_im), 'B_re': _w(B_re), 'B_im': _w(B_im), 'C_re': _w(C_re), 'C_im': _w(C_im), 'log_dt': _w(log_dt), 'Dskip': _w(Dskip)}
    _A_in = _A_setup()

    def _B_setup():
        B, S, D, F = (1, 2048, 576, 4608)
        Fh = F // 2
        return {'x': _w((lambda *s: torch.randn(*s, dtype=torch.bfloat16) * 0.05)(B, S, D)), 'w_in': _w((lambda *s: torch.randn(*s, dtype=torch.bfloat16) * 0.4)(D, 2 * Fh)), 'w_sp': _w(0.01 * (lambda *s: torch.randn(*s, dtype=torch.bfloat16) * 0.4)(S, S)), 'b_sp': _w(1.0 + 0.01 * (lambda *s: torch.randn(*s, dtype=torch.bfloat16) * 0.05)(S)), 'w_out': _w((lambda *s: torch.randn(*s, dtype=torch.bfloat16) * 0.05)(Fh, D))}
    _B_in = _B_setup()
    return {'A_u': _A_in['u'], 'A_A_re': _A_in['A_re'], 'A_A_im': _A_in['A_im'], 'A_B_re': _A_in['B_re'], 'A_B_im': _A_in['B_im'], 'A_C_re': _A_in['C_re'], 'A_C_im': _A_in['C_im'], 'A_log_dt': _A_in['log_dt'], 'A_Dskip': _A_in['Dskip'], 'B_x': _B_in['x'], 'B_w_in': _B_in['w_in'], 'B_w_sp': _B_in['w_sp'], 'B_b_sp': _B_in['b_sp'], 'B_w_out': _B_in['w_out']}

def reference(A_u, A_A_re, A_A_im, A_B_re, A_B_im, A_C_re, A_C_im, A_log_dt, A_Dskip, B_x, B_w_in, B_w_sp, B_b_sp, B_w_out):

    def _A_ref(u, A_re, A_im, B_re, B_im, C_re, C_im, log_dt, Dskip):
        Bsz, L, D = u.shape
        dt = torch.exp(log_dt)[:, None]
        A = A_re + 1j * A_im
        Bc = B_re + 1j * B_im
        Cc = C_re + 1j * C_im
        logdA = dt * A
        dB = dt * Bc
        l = (lambda x, dt: x.to(dt))(torch.arange(L), A_re.dtype)
        P = torch.exp(logdA[:, :, None] * l[None, None, :])
        K = torch.einsum('dn,dnl,dn->dl', Cc, P, dB).real
        L2 = 2 * L
        Kp = _pad(K, ((0, 0), (0, L)))
        up = (lambda x, *d: x.permute(*d))(u, 0, 2, 1)
        up = _pad(up, ((0, 0), (0, 0), (0, L)))
        Kf = (lambda x, axes=(-2, -1): torch.fft.rfft2(x.float(), dim=axes))(Kp[:, None, :], axes=(-2, -1))
        Uf = (lambda x, axes=(-2, -1): torch.fft.rfft2(x.float(), dim=axes))(up[:, :, None, :], axes=(-2, -1))
        Yf = Uf * Kf[None, :, :, :]
        y = (lambda x, s, axes=(-2, -1): torch.fft.irfft2(x, s=s, dim=axes).to(torch.bfloat16))(Yf, (1, L2), axes=(-2, -1))[:, :, 0, :L]
        y = (lambda x, *d: x.permute(*d))(y, 0, 2, 1) + u * Dskip[None, None, :]
        return y

    def _B_ref(x, w_in, w_sp, b_sp, w_out):
        B, S, D = x.shape
        F = w_in.shape[-1]
        Fh = F // 2
        z = _gelu(torch.einsum('bsd,df->bsf', x, w_in))
        z1 = z[..., :Fh].clone()
        z2 = _layernorm(z[..., Fh:], axis=-1)
        g = torch.einsum('ts,bsf->btf', w_sp, z2) + b_sp[None, :, None]
        return torch.einsum('bsf,fd->bsd', z1 * g, w_out)
    x = A_u
    h = x + _A_ref(_layernorm(x, axis=-1), A_A_re, A_A_im, A_B_re, A_B_im, A_C_re, A_C_im, A_log_dt, A_Dskip)
    h2 = h + _B_ref(_layernorm(h, axis=-1), B_w_in, B_w_sp, B_b_sp, B_w_out)
    return h2
```

```asm
; @launch kernel=k1_kernel grid=(844,1,1) block=(256,1,1) lds=37888
; @launch kernel=k2_kernel grid=(792,1,1) block=(256,1,1) lds=40960
; @launch kernel=mega_kernel grid=(256,1,1) block=(704,1,1) lds=157696
.amdgcn_target "amdgcn-amd-amdhsa--gfx950"
.text
.globl k1_kernel
.p2align 8
.type k1_kernel,@function
k1_kernel:
    s_cmp_ge_u32 s2, 32
    s_cbranch_scc1 nocp_k1_kernel_4
    s_getpc_b64 s[4:5]
cp_k1_kernel_5:
    s_add_u32 s4, s4, k1_kernel-cp_k1_kernel_5
    s_addc_u32 s5, s5, -1
    s_mov_b32 s6, all_code_end-k1_kernel
    s_mov_b32 s7, 0x00020000
    v_lshlrev_b32 v1, 7, v0
    s_lshr_b32 s3, s2, 3
    s_lshl_b32 s3, s3, 15
    buffer_load_dword v2, v1, s[4:7], s3 offen
    s_endpgm
nocp_k1_kernel_4:
    s_sub_u32 s2, s2, 32
    s_cmp_ge_u32 s2, 812
    s_cbranch_scc1 done_k1_kernel_1
    s_load_dwordx2 s[6:7], s[0:1], 128
    s_cmp_ge_u32 s2, 704
    s_cbranch_scc1 w1_k1_kernel_3
    s_load_dwordx16 s[16:31], s[0:1], 0
    s_cmp_ge_u32 s2, 128
    s_cbranch_scc1 kg_k1_kernel_2
    s_setprio 3
    s_and_b32 s13, s2, 7
    s_lshl_b32 s13, s13, 4
    s_lshr_b32 s3, s2, 3
    s_add_u32 s13, s13, s3
    s_lshl_b32 s3, s13, 4
    v_lshrrev_b32 v1, 4, v0
    v_add_u32 v5, s3, v1
    v_and_b32 v2, 15, v0
    v_mul_u32_u24 v3, 1152, v5
    v_lshl_add_u32 v3, v2, 3, v3
    s_waitcnt lgkmcnt(0)
    s_mov_b32 s32, s16
    s_mov_b32 s33, s17
    s_mov_b32 s34, 0x240000
    s_mov_b32 s35, 0x00020000
    buffer_load_dwordx2 v[8:9], v3, s[32:35], 0 offen offset:0
    buffer_load_dwordx2 v[10:11], v3, s[32:35], 0 offen offset:128
    buffer_load_dwordx2 v[12:13], v3, s[32:35], 0 offen offset:256
    buffer_load_dwordx2 v[14:15], v3, s[32:35], 0 offen offset:384
    buffer_load_dwordx2 v[16:17], v3, s[32:35], 0 offen offset:512
    buffer_load_dwordx2 v[18:19], v3, s[32:35], 0 offen offset:640
    buffer_load_dwordx2 v[20:21], v3, s[32:35], 0 offen offset:768
    buffer_load_dwordx2 v[22:23], v3, s[32:35], 0 offen offset:896
    buffer_load_dwordx2 v[24:25], v3, s[32:35], 0 offen offset:1024
    s_add_u32 s36, s6, 0x4000000
    s_addc_u32 s37, s7, 0
    s_mov_b32 s38, 0x480000
    s_mov_b32 s39, 0x00020000
    v_mul_u32_u24 v66, 1184, v1
    v_lshl_add_u32 v66, v2, 3, v66
    v_mov_b32 v4, 0
    v_mov_b32 v7, 0
    s_waitcnt vmcnt(8)
    ds_write_b64 v66, v[8:9] offset:18944
    v_lshlrev_b32 v30, 16, v8
    v_and_b32 v31, 0xffff0000, v8
    v_add_f32 v4, v4, v30
    v_add_f32 v7, v7, v31
    v_lshlrev_b32 v32, 16, v9
    v_and_b32 v33, 0xffff0000, v9
    v_add_f32 v4, v4, v32
    v_add_f32 v7, v7, v33
    s_waitcnt vmcnt(7)
    ds_write_b64 v66, v[10:11] offset:19072
    v_lshlrev_b32 v34, 16, v10
    v_and_b32 v35, 0xffff0000, v10
    v_add_f32 v4, v4, v34
    v_add_f32 v7, v7, v35
    v_lshlrev_b32 v36, 16, v11
    v_and_b32 v37, 0xffff0000, v11
    v_add_f32 v4, v4, v36
    v_add_f32 v7, v7, v37
    s_waitcnt vmcnt(6)
    ds_write_b64 v66, v[12:13] offset:19200
    v_lshlrev_b32 v38, 16, v12
    v_and_b32 v39, 0xffff0000, v12
    v_add_f32 v4, v4, v38
    v_add_f32 v7, v7, v39
    v_lshlrev_b32 v40, 16, v13
    v_and_b32 v41, 0xffff0000, v13
    v_add_f32 v4, v4, v40
    v_add_f32 v7, v7, v41
    s_waitcnt vmcnt(5)
    ds_write_b64 v66, v[14:15] offset:19328
    v_lshlrev_b32 v42, 16, v14
    v_and_b32 v43, 0xffff0000, v14
    v_add_f32 v4, v4, v42
    v_add_f32 v7, v7, v43
    v_lshlrev_b32 v44, 16, v15
    v_and_b32 v45, 0xffff0000, v15
    v_add_f32 v4, v4, v44
    v_add_f32 v7, v7, v45
    s_waitcnt vmcnt(4)
    ds_write_b64 v66, v[16:17] offset:19456
    v_lshlrev_b32 v46, 16, v16
    v_and_b32 v47, 0xffff0000, v16
    v_add_f32 v4, v4, v46
    v_add_f32 v7, v7, v47
    v_lshlrev_b32 v48, 16, v17
    v_and_b32 v49, 0xffff0000, v17
    v_add_f32 v4, v4, v48
    v_add_f32 v7, v7, v49
    s_waitcnt vmcnt(3)
    ds_write_b64 v66, v[18:19] offset:19584
    v_lshlrev_b32 v50, 16, v18
    v_and_b32 v51, 0xffff0000, v18
    v_add_f32 v4, v4, v50
    v_add_f32 v7, v7, v51
    v_lshlrev_b32 v52, 16, v19
    v_and_b32 v53, 0xffff0000, v19
    v_add_f32 v4, v4, v52
    v_add_f32 v7, v7, v53
    s_waitcnt vmcnt(2)
    ds_write_b64 v66, v[20:21] offset:19712
    v_lshlrev_b32 v54, 16, v20
    v_and_b32 v55, 0xffff0000, v20
    v_add_f32 v4, v4, v54
    v_add_f32 v7, v7, v55
    v_lshlrev_b32 v56, 16, v21
    v_and_b32 v57, 0xffff0000, v21
    v_add_f32 v4, v4, v56
    v_add_f32 v7, v7, v57
    s_waitcnt vmcnt(1)
    ds_write_b64 v66, v[22:23] offset:19840
    v_lshlrev_b32 v58, 16, v22
    v_and_b32 v59, 0xffff0000, v22
    v_add_f32 v4, v4, v58
    v_add_f32 v7, v7, v59
    v_lshlrev_b32 v60, 16, v23
    v_and_b32 v61, 0xffff0000, v23
    v_add_f32 v4, v4, v60
    v_add_f32 v7, v7, v61
    s_waitcnt vmcnt(0)
    ds_write_b64 v66, v[24:25] offset:19968
    v_lshlrev_b32 v62, 16, v24
    v_and_b32 v63, 0xffff0000, v24
    v_add_f32 v4, v4, v62
    v_add_f32 v7, v7, v63
    v_lshlrev_b32 v64, 16, v25
    v_and_b32 v65, 0xffff0000, v25
    v_add_f32 v4, v4, v64
    v_add_f32 v7, v7, v65
    v_add_f32 v4, v4, v7
    s_nop 1
    v_add_f32_dpp v4, v4, v4 quad_perm:[1,0,3,2] row_mask:0xf bank_mask:0xf
    s_nop 1
    v_add_f32_dpp v4, v4, v4 quad_perm:[2,3,0,1] row_mask:0xf bank_mask:0xf
    s_nop 1
    v_add_f32_dpp v4, v4, v4 row_half_mirror row_mask:0xf bank_mask:0xf
    s_nop 1
    v_add_f32_dpp v4, v4, v4 row_mirror row_mask:0xf bank_mask:0xf
    v_mul_f32 v4, 0x3ae38e39, v4
    v_mov_b32 v6, 0
    v_mov_b32 v7, 0
    v_sub_f32 v68, v30, v4
    v_fmac_f32 v6, v68, v68
    v_sub_f32 v69, v31, v4
    v_fmac_f32 v7, v69, v69
    v_sub_f32 v70, v32, v4
    v_fmac_f32 v6, v70, v70
    v_sub_f32 v71, v33, v4
    v_fmac_f32 v7, v71, v71
    v_sub_f32 v68, v34, v4
    v_fmac_f32 v6, v68, v68
    v_sub_f32 v69, v35, v4
    v_fmac_f32 v7, v69, v69
    v_sub_f32 v70, v36, v4
    v_fmac_f32 v6, v70, v70
    v_sub_f32 v71, v37, v4
    v_fmac_f32 v7, v71, v71
    v_sub_f32 v68, v38, v4
    v_fmac_f32 v6, v68, v68
    v_sub_f32 v69, v39, v4
    v_fmac_f32 v7, v69, v69
    v_sub_f32 v70, v40, v4
    v_fmac_f32 v6, v70, v70
    v_sub_f32 v71, v41, v4
    v_fmac_f32 v7, v71, v71
    v_sub_f32 v68, v42, v4
    v_fmac_f32 v6, v68, v68
    v_sub_f32 v69, v43, v4
    v_fmac_f32 v7, v69, v69
    v_sub_f32 v70, v44, v4
    v_fmac_f32 v6, v70, v70
    v_sub_f32 v71, v45, v4
    v_fmac_f32 v7, v71, v71
    v_sub_f32 v68, v46, v4
    v_fmac_f32 v6, v68, v68
    v_sub_f32 v69, v47, v4
    v_fmac_f32 v7, v69, v69
    v_sub_f32 v70, v48, v4
    v_fmac_f32 v6, v70, v70
    v_sub_f32 v71, v49, v4
    v_fmac_f32 v7, v71, v71
    v_sub_f32 v68, v50, v4
    v_fmac_f32 v6, v68, v68
    v_sub_f32 v69, v51, v4
    v_fmac_f32 v7, v69, v69
    v_sub_f32 v70, v52, v4
    v_fmac_f32 v6, v70, v70
    v_sub_f32 v71, v53, v4
    v_fmac_f32 v7, v71, v71
    v_sub_f32 v68, v54, v4
    v_fmac_f32 v6, v68, v68
    v_sub_f32 v69, v55, v4
    v_fmac_f32 v7, v69, v69
    v_sub_f32 v70, v56, v4
    v_fmac_f32 v6, v70, v70
    v_sub_f32 v71, v57, v4
    v_fmac_f32 v7, v71, v71
    v_sub_f32 v68, v58, v4
    v_fmac_f32 v6, v68, v68
    v_sub_f32 v69, v59, v4
    v_fmac_f32 v7, v69, v69
    v_sub_f32 v70, v60, v4
    v_fmac_f32 v6, v70, v70
    v_sub_f32 v71, v61, v4
    v_fmac_f32 v7, v71, v71
    v_sub_f32 v68, v62, v4
    v_fmac_f32 v6, v68, v68
    v_sub_f32 v69, v63, v4
    v_fmac_f32 v7, v69, v69
    v_sub_f32 v70, v64, v4
    v_fmac_f32 v6, v70, v70
    v_sub_f32 v71, v65, v4
    v_fmac_f32 v7, v71, v71
    v_add_f32 v6, v6, v7
    s_nop 1
    v_add_f32_dpp v6, v6, v6 quad_perm:[1,0,3,2] row_mask:0xf bank_mask:0xf
    s_nop 1
    v_add_f32_dpp v6, v6, v6 quad_perm:[2,3,0,1] row_mask:0xf bank_mask:0xf
    s_nop 1
    v_add_f32_dpp v6, v6, v6 row_half_mirror row_mask:0xf bank_mask:0xf
    s_nop 1
    v_add_f32_dpp v6, v6, v6 row_mirror row_mask:0xf bank_mask:0xf
    v_mul_f32 v6, 0x3ae38e39, v6
    v_cvt_pk_bf16_f32 v4, v4, v4
    v_lshlrev_b32 v4, 16, v4
    v_cvt_pk_bf16_f32 v6, v6, v6
    v_lshlrev_b32 v6, 16, v6
    v_add_f32 v6, 0x3727c5ac, v6
    v_cvt_pk_bf16_f32 v6, v6, v6
    v_lshlrev_b32 v6, 16, v6
    v_sqrt_f32 v6, v6
    s_nop 0
    v_cvt_pk_bf16_f32 v6, v6, v6
    v_lshlrev_b32 v6, 16, v6
    v_rcp_f32 v5, v6
    v_sub_f32 v30, v30, v4
    v_sub_f32 v31, v31, v4
    v_sub_f32 v32, v32, v4
    v_sub_f32 v33, v33, v4
    v_sub_f32 v34, v34, v4
    v_sub_f32 v35, v35, v4
    v_sub_f32 v36, v36, v4
    v_sub_f32 v37, v37, v4
    v_sub_f32 v38, v38, v4
    v_sub_f32 v39, v39, v4
    v_sub_f32 v40, v40, v4
    v_sub_f32 v41, v41, v4
    v_sub_f32 v42, v42, v4
    v_sub_f32 v43, v43, v4
    v_sub_f32 v44, v44, v4
    v_sub_f32 v45, v45, v4
    v_sub_f32 v46, v46, v4
    v_sub_f32 v47, v47, v4
    v_sub_f32 v48, v48, v4
    v_sub_f32 v49, v49, v4
    v_sub_f32 v50, v50, v4
    v_sub_f32 v51, v51, v4
    v_sub_f32 v52, v52, v4
    v_sub_f32 v53, v53, v4
    v_sub_f32 v54, v54, v4
    v_sub_f32 v55, v55, v4
    v_sub_f32 v56, v56, v4
    v_sub_f32 v57, v57, v4
    v_sub_f32 v58, v58, v4
    v_sub_f32 v59, v59, v4
    v_sub_f32 v60, v60, v4
    v_sub_f32 v61, v61, v4
    v_sub_f32 v62, v62, v4
    v_sub_f32 v63, v63, v4
    v_sub_f32 v64, v64, v4
    v_sub_f32 v65, v65, v4
    v_cvt_pk_bf16_f32 v8, v30, v31
    v_cvt_pk_bf16_f32 v9, v32, v33
    v_cvt_pk_bf16_f32 v10, v34, v35
    v_cvt_pk_bf16_f32 v11, v36, v37
    v_cvt_pk_bf16_f32 v12, v38, v39
    v_cvt_pk_bf16_f32 v13, v40, v41
    v_cvt_pk_bf16_f32 v14, v42, v43
    v_cvt_pk_bf16_f32 v15, v44, v45
    v_cvt_pk_bf16_f32 v16, v46, v47
    v_cvt_pk_bf16_f32 v17, v48, v49
    v_cvt_pk_bf16_f32 v18, v50, v51
    v_cvt_pk_bf16_f32 v19, v52, v53
    v_cvt_pk_bf16_f32 v20, v54, v55
    v_cvt_pk_bf16_f32 v21, v56, v57
    v_cvt_pk_bf16_f32 v22, v58, v59
    v_cvt_pk_bf16_f32 v23, v60, v61
    v_cvt_pk_bf16_f32 v24, v62, v63
    v_cvt_pk_bf16_f32 v25, v64, v65
    v_lshlrev_b32 v30, 16, v8
    v_and_b32 v31, 0xffff0000, v8
    v_lshlrev_b32 v32, 16, v9
    v_and_b32 v33, 0xffff0000, v9
    v_lshlrev_b32 v34, 16, v10
    v_and_b32 v35, 0xffff0000, v10
    v_lshlrev_b32 v36, 16, v11
    v_and_b32 v37, 0xffff0000, v11
    v_lshlrev_b32 v38, 16, v12
    v_and_b32 v39, 0xffff0000, v12
    v_lshlrev_b32 v40, 16, v13
    v_and_b32 v41, 0xffff0000, v13
    v_lshlrev_b32 v42, 16, v14
    v_and_b32 v43, 0xffff0000, v14
    v_lshlrev_b32 v44, 16, v15
    v_and_b32 v45, 0xffff0000, v15
    v_lshlrev_b32 v46, 16, v16
    v_and_b32 v47, 0xffff0000, v16
    v_lshlrev_b32 v48, 16, v17
    v_and_b32 v49, 0xffff0000, v17
    v_lshlrev_b32 v50, 16, v18
    v_and_b32 v51, 0xffff0000, v18
    v_lshlrev_b32 v52, 16, v19
    v_and_b32 v53, 0xffff0000, v19
    v_lshlrev_b32 v54, 16, v20
    v_and_b32 v55, 0xffff0000, v20
    v_lshlrev_b32 v56, 16, v21
    v_and_b32 v57, 0xffff0000, v21
    v_lshlrev_b32 v58, 16, v22
    v_and_b32 v59, 0xffff0000, v22
    v_lshlrev_b32 v60, 16, v23
    v_and_b32 v61, 0xffff0000, v23
    v_lshlrev_b32 v62, 16, v24
    v_and_b32 v63, 0xffff0000, v24
    v_lshlrev_b32 v64, 16, v25
    v_and_b32 v65, 0xffff0000, v25
    v_mul_f32 v30, v30, v5
    v_mul_f32 v31, v31, v5
    v_mul_f32 v32, v32, v5
    v_mul_f32 v33, v33, v5
    v_mul_f32 v34, v34, v5
    v_mul_f32 v35, v35, v5
    v_mul_f32 v36, v36, v5
    v_mul_f32 v37, v37, v5
    v_mul_f32 v38, v38, v5
    v_mul_f32 v39, v39, v5
    v_mul_f32 v40, v40, v5
    v_mul_f32 v41, v41, v5
    v_mul_f32 v42, v42, v5
    v_mul_f32 v43, v43, v5
    v_mul_f32 v44, v44, v5
    v_mul_f32 v45, v45, v5
    v_mul_f32 v46, v46, v5
    v_mul_f32 v47, v47, v5
    v_mul_f32 v48, v48, v5
    v_mul_f32 v49, v49, v5
    v_mul_f32 v50, v50, v5
    v_mul_f32 v51, v51, v5
    v_mul_f32 v52, v52, v5
    v_mul_f32 v53, v53, v5
    v_mul_f32 v54, v54, v5
    v_mul_f32 v55, v55, v5
    v_mul_f32 v56, v56, v5
    v_mul_f32 v57, v57, v5
    v_mul_f32 v58, v58, v5
    v_mul_f32 v59, v59, v5
    v_mul_f32 v60, v60, v5
    v_mul_f32 v61, v61, v5
    v_mul_f32 v62, v62, v5
    v_mul_f32 v63, v63, v5
    v_mul_f32 v64, v64, v5
    v_mul_f32 v65, v65, v5
    v_cvt_pk_bf16_f32 v8, v30, v31
    v_cvt_pk_bf16_f32 v9, v32, v33
    v_cvt_pk_bf16_f32 v10, v34, v35
    v_cvt_pk_bf16_f32 v11, v36, v37
    v_cvt_pk_bf16_f32 v12, v38, v39
    v_cvt_pk_bf16_f32 v13, v40, v41
    v_cvt_pk_bf16_f32 v14, v42, v43
    v_cvt_pk_bf16_f32 v15, v44, v45
    v_cvt_pk_bf16_f32 v16, v46, v47
    v_cvt_pk_bf16_f32 v17, v48, v49
    v_cvt_pk_bf16_f32 v18, v50, v51
    v_cvt_pk_bf16_f32 v19, v52, v53
    v_cvt_pk_bf16_f32 v20, v54, v55
    v_cvt_pk_bf16_f32 v21, v56, v57
    v_cvt_pk_bf16_f32 v22, v58, v59
    v_cvt_pk_bf16_f32 v23, v60, v61
    v_cvt_pk_bf16_f32 v24, v62, v63
    v_cvt_pk_bf16_f32 v25, v64, v65
    ds_write_b64 v66, v[8:9] offset:0
    ds_write_b64 v66, v[10:11] offset:128
    ds_write_b64 v66, v[12:13] offset:256
    ds_write_b64 v66, v[14:15] offset:384
    ds_write_b64 v66, v[16:17] offset:512
    ds_write_b64 v66, v[18:19] offset:640
    ds_write_b64 v66, v[20:21] offset:768
    ds_write_b64 v66, v[22:23] offset:896
    ds_write_b64 v66, v[24:25] offset:1024
    v_and_b32 v2, 63, v0
    v_lshrrev_b32 v1, 6, v0
    v_and_b32 v3, 15, v2
    v_lshrrev_b32 v4, 4, v2
    v_lshrrev_b32 v5, 2, v3
    v_lshl_add_u32 v5, v4, 3, v5
    v_mul_u32_u24 v5, 1184, v5
    v_and_b32 v6, 3, v3
    v_lshl_add_u32 v5, v6, 3, v5
    v_mul_u32_u24 v6, 288, v1
    v_add_u32 v5, v5, v6
    v_mul_u32_u24 v6, 144, v1
    v_add_u32 v6, v6, v3
    v_lshlrev_b32 v6, 6, v6
    v_lshl_add_u32 v6, v4, 4, v6
    s_mul_i32 s3, s13, 36864
    s_waitcnt lgkmcnt(0)
    s_barrier
    ds_read_b64_tr_b16 v[8:9], v5 offset:0
    ds_read_b64_tr_b16 v[10:11], v5 offset:4736
    ds_read_b64_tr_b16 v[12:13], v5 offset:32
    ds_read_b64_tr_b16 v[14:15], v5 offset:4768
    ds_read_b64_tr_b16 v[16:17], v5 offset:64
    ds_read_b64_tr_b16 v[18:19], v5 offset:4800
    ds_read_b64_tr_b16 v[20:21], v5 offset:96
    ds_read_b64_tr_b16 v[22:23], v5 offset:4832
    ds_read_b64_tr_b16 v[24:25], v5 offset:128
    ds_read_b64_tr_b16 v[26:27], v5 offset:4864
    ds_read_b64_tr_b16 v[28:29], v5 offset:160
    ds_read_b64_tr_b16 v[30:31], v5 offset:4896
    ds_read_b64_tr_b16 v[32:33], v5 offset:192
    ds_read_b64_tr_b16 v[34:35], v5 offset:4928
    ds_read_b64_tr_b16 v[36:37], v5 offset:224
    ds_read_b64_tr_b16 v[38:39], v5 offset:4960
    ds_read_b64_tr_b16 v[40:41], v5 offset:256
    ds_read_b64_tr_b16 v[42:43], v5 offset:4992
    s_waitcnt lgkmcnt(15)
    buffer_store_dwordx4 v[8:11], v6, s[36:39], s3 offen
    s_add_u32 s3, s3, 1024
    s_waitcnt lgkmcnt(14)
    buffer_store_dwordx4 v[12:15], v6, s[36:39], s3 offen
    s_add_u32 s3, s3, 1024
    s_waitcnt lgkmcnt(12)
    buffer_store_dwordx4 v[16:19], v6, s[36:39], s3 offen
    s_add_u32 s3, s3, 1024
    s_waitcnt lgkmcnt(10)
    buffer_store_dwordx4 v[20:23], v6, s[36:39], s3 offen
    s_add_u32 s3, s3, 1024
    s_waitcnt lgkmcnt(8)
    buffer_store_dwordx4 v[24:27], v6, s[36:39], s3 offen
    s_add_u32 s3, s3, 1024
    s_waitcnt lgkmcnt(6)
    buffer_store_dwordx4 v[28:31], v6, s[36:39], s3 offen
    s_add_u32 s3, s3, 1024
    s_waitcnt lgkmcnt(4)
    buffer_store_dwordx4 v[32:35], v6, s[36:39], s3 offen
    s_add_u32 s3, s3, 1024
    s_waitcnt lgkmcnt(2)
    buffer_store_dwordx4 v[36:39], v6, s[36:39], s3 offen
    s_add_u32 s3, s3, 1024
    s_waitcnt lgkmcnt(0)
    buffer_store_dwordx4 v[40:43], v6, s[36:39], s3 offen
    s_add_u32 s3, s3, 1024
    s_endpgm
kg_k1_kernel_2:
    s_sub_u32 s14, s2, 128
    v_and_b32 v1, 127, v0
    v_lshlrev_b32 v2, 1, v1
    s_lshl_b32 s3, s14, 8
    v_add_u32 v2, s3, v2
    s_lshl_b32 s3, s14, 1
    v_mov_b32 v3, s3
    v_lshrrev_b32 v4, 6, v0
    s_waitcnt lgkmcnt(0)
    v_readfirstlane_b32 s15, v4
    s_mov_b32 s56, s30
    s_mov_b32 s57, s31
    s_mov_b32 s58, 0x480
    s_mov_b32 s59, 0x00020000
    buffer_load_ushort v16, v3, s[56:59], 0 offen
    s_mov_b32 s32, s18
    s_mov_b32 s33, s19
    s_mov_b32 s34, 0x24000
    s_mov_b32 s35, 0x00020000
    buffer_load_ushort v10, v2, s[32:35], 0 offen
    s_mov_b32 s36, s20
    s_mov_b32 s37, s21
    s_mov_b32 s38, 0x24000
    s_mov_b32 s39, 0x00020000
    buffer_load_ushort v11, v2, s[36:39], 0 offen
    s_mov_b32 s40, s22
    s_mov_b32 s41, s23
    s_mov_b32 s42, 0x24000
    s_mov_b32 s43, 0x00020000
    buffer_load_ushort v12, v2, s[40:43], 0 offen
    s_mov_b32 s44, s24
    s_mov_b32 s45, s25
    s_mov_b32 s46, 0x24000
    s_mov_b32 s47, 0x00020000
    buffer_load_ushort v13, v2, s[44:47], 0 offen
    s_mov_b32 s48, s26
    s_mov_b32 s49, s27
    s_mov_b32 s50, 0x24000
    s_mov_b32 s51, 0x00020000
    buffer_load_ushort v14, v2, s[48:51], 0 offen
    s_mov_b32 s52, s28
    s_mov_b32 s53, s29
    s_mov_b32 s54, 0x24000
    s_mov_b32 s55, 0x00020000
    buffer_load_ushort v15, v2, s[52:55], 0 offen
    s_getpc_b64 s[60:61]
pc_k1_kernel_8:
    s_add_u32 s60, s60, gtab_k1_kernel-pc_k1_kernel_8
    s_addc_u32 s61, s61, 0
    s_mov_b32 s62, 4096
    s_mov_b32 s63, 0x00020000
    v_lshlrev_b32 v5, 4, v0
    buffer_load_dwordx4 v[56:59], v5, s[60:63], 0 offen
    v_and_b32 v64, 15, v0
    v_bfe_u32 v65, v0, 4, 2
    v_mul_u32_u24 v4, 528, v64
    v_lshl_add_u32 v4, v65, 4, v4
    s_lshr_b32 s3, s15, 1
    s_mul_i32 s3, s3, 8448
    v_add_u32 v66, s3, v4
    s_and_b32 s10, s15, 1
    s_mul_i32 s11, s10, 8448
    s_add_u32 s11, s11, 11088
    v_add_u32 v67, s11, v4
    s_lshr_b32 s3, s15, 1
    s_lshl_b32 s3, s3, 4
    v_add_u32 v7, s3, v64
    v_mov_b32 v68, v7
    v_lshlrev_b32 v8, 1, v7
    v_subrev_u32 v8, 8, v8
    v_max_i32 v68, v68, v8
    v_lshlrev_b32 v8, 2, v7
    v_subrev_u32 v8, 32, v8
    v_max_i32 v68, v68, v8
    v_lshlrev_b32 v8, 3, v7
    v_subrev_u32 v8, 96, v8
    v_max_i32 v68, v68, v8
    v_min_i32 v68, 71, v68
    v_lshlrev_b32 v68, 6, v68
    v_lshl_add_u32 v68, v65, 3, v68
    s_lshl_b32 s10, s10, 5
    v_add_u32 v68, s10, v68
    v_lshlrev_b32 v9, 2, v1
    s_mov_b32 s8, 0x3fb8aa3b
    s_mov_b32 s9, 0x32a57060
    s_waitcnt vmcnt(5)
    v_lshlrev_b32 v16, 16, v16
    v_lshlrev_b32 v10, 16, v10
    v_lshlrev_b32 v11, 16, v11
    v_mul_f32 v17, s8, v16
    v_fma_f32 v18, v16, s8, -v17
    v_fma_f32 v18, v16, s9, v18
    v_exp_f32 v17, v17
    v_mul_f32 v18, 0x3f317218, v18
    v_fma_f32 v17, v17, v18, v17
    v_cvt_pk_bf16_f32 v17, v17, v17
    v_lshlrev_b32 v17, 16, v17
    v_mul_f32 v20, v17, v10
    v_mul_f32 v21, v17, v11
    v_mul_f32 v20, 0x3fb8aa3b, v20
    v_mul_f32 v21, 0x3e22f983, v21
    s_cmp_ge_u32 s15, 2
    s_cbranch_scc1 xw_k1_kernel_6
    v_mul_f32 v24, 0x41000000, v20
    v_mul_f32 v23, 0x41000000, v21
    v_exp_f32 v24, v24
    v_fract_f32 v23, v23
    v_cos_f32 v22, v23
    v_sin_f32 v23, v23
    s_nop 0
    v_mul_f32 v22, v22, v24
    v_mul_f32 v23, v23, v24
    v_mov_b32 v30, 0x00003f80
    ds_write_b32 v9, v30 offset:11088
    v_cvt_pk_bf16_f32 v31, v22, v23
    ds_write_b32 v9, v31 offset:11616
    v_pk_mul_f32 v[24:25], v[22:23], v[22:23] op_sel:[0,0] op_sel_hi:[0,1]
    v_pk_fma_f32 v[24:25], v[22:23], v[22:23], v[24:25] op_sel:[1,1,0] op_sel_hi:[1,0,1] neg_lo:[0,1,0]
    v_cvt_pk_bf16_f32 v30, v24, v25
    ds_write_b32 v9, v30 offset:12144
    v_pk_mul_f32 v[26:27], v[22:23], v[24:25] op_sel:[0,0] op_sel_hi:[0,1]
    v_pk_fma_f32 v[26:27], v[22:23], v[24:25], v[26:27] op_sel:[1,1,0] op_sel_hi:[1,0,1] neg_lo:[0,1,0]
    v_cvt_pk_bf16_f32 v31, v26, v27
    ds_write_b32 v9, v31 offset:12672
    v_pk_mul_f32 v[28:29], v[24:25], v[24:25] op_sel:[0,0] op_sel_hi:[0,1]
    v_pk_fma_f32 v[28:29], v[24:25], v[24:25], v[28:29] op_sel:[1,1,0] op_sel_hi:[1,0,1] neg_lo:[0,1,0]
    v_cvt_pk_bf16_f32 v30, v28, v29
    ds_write_b32 v9, v30 offset:13200
    v_pk_mul_f32 v[32:33], v[26:27], v[24:25] op_sel:[0,0] op_sel_hi:[0,1]
    v_pk_fma_f32 v[32:33], v[26:27], v[24:25], v[32:33] op_sel:[1,1,0] op_sel_hi:[1,0,1] neg_lo:[0,1,0]
    v_cvt_pk_bf16_f32 v31, v32, v33
    ds_write_b32 v9, v31 offset:13728
    v_pk_mul_f32 v[34:35], v[28:29], v[24:25] op_sel:[0,0] op_sel_hi:[0,1]
    v_pk_fma_f32 v[34:35], v[28:29], v[24:25], v[34:35] op_sel:[1,1,0] op_sel_hi:[1,0,1] neg_lo:[0,1,0]
    v_cvt_pk_bf16_f32 v30, v34, v35
    ds_write_b32 v9, v30 offset:14256
    v_pk_mul_f32 v[26:27], v[32:33], v[24:25] op_sel:[0,0] op_sel_hi:[0,1]
    v_pk_fma_f32 v[26:27], v[32:33], v[24:25], v[26:27] op_sel:[1,1,0] op_sel_hi:[1,0,1] neg_lo:[0,1,0]
    v_cvt_pk_bf16_f32 v31, v26, v27
    ds_write_b32 v9, v31 offset:14784
    v_pk_mul_f32 v[28:29], v[34:35], v[24:25] op_sel:[0,0] op_sel_hi:[0,1]
    v_pk_fma_f32 v[28:29], v[34:35], v[24:25], v[28:29] op_sel:[1,1,0] op_sel_hi:[1,0,1] neg_lo:[0,1,0]
    v_cvt_pk_bf16_f32 v30, v28, v29
    ds_write_b32 v9, v30 offset:15312
    v_pk_mul_f32 v[32:33], v[26:27], v[24:25] op_sel:[0,0] op_sel_hi:[0,1]
    v_pk_fma_f32 v[32:33], v[26:27], v[24:25], v[32:33] op_sel:[1,1,0] op_sel_hi:[1,0,1] neg_lo:[0,1,0]
    v_cvt_pk_bf16_f32 v31, v32, v33
    ds_write_b32 v9, v31 offset:15840
    v_pk_mul_f32 v[34:35], v[28:29], v[24:25] op_sel:[0,0] op_sel_hi:[0,1]
    v_pk_fma_f32 v[34:35], v[28:29], v[24:25], v[34:35] op_sel:[1,1,0] op_sel_hi:[1,0,1] neg_lo:[0,1,0]
    v_cvt_pk_bf16_f32 v30, v34, v35
    ds_write_b32 v9, v30 offset:16368
    v_pk_mul_f32 v[26:27], v[32:33], v[24:25] op_sel:[0,0] op_sel_hi:[0,1]
    v_pk_fma_f32 v[26:27], v[32:33], v[24:25], v[26:27] op_sel:[1,1,0] op_sel_hi:[1,0,1] neg_lo:[0,1,0]
    v_cvt_pk_bf16_f32 v31, v26, v27
    ds_write_b32 v9, v31 offset:16896
    v_pk_mul_f32 v[28:29], v[34:35], v[24:25] op_sel:[0,0] op_sel_hi:[0,1]
    v_pk_fma_f32 v[28:29], v[34:35], v[24:25], v[28:29] op_sel:[1,1,0] op_sel_hi:[1,0,1] neg_lo:[0,1,0]
    v_cvt_pk_bf16_f32 v30, v28, v29
    ds_write_b32 v9, v30 offset:17424
    v_pk_mul_f32 v[32:33], v[26:27], v[24:25] op_sel:[0,0] op_sel_hi:[0,1]
    v_pk_fma_f32 v[32:33], v[26:27], v[24:25], v[32:33] op_sel:[1,1,0] op_sel_hi:[1,0,1] neg_lo:[0,1,0]
    v_cvt_pk_bf16_f32 v31, v32, v33
    ds_write_b32 v9, v31 offset:17952
    v_pk_mul_f32 v[34:35], v[28:29], v[24:25] op_sel:[0,0] op_sel_hi:[0,1]
    v_pk_fma_f32 v[34:35], v[28:29], v[24:25], v[34:35] op_sel:[1,1,0] op_sel_hi:[1,0,1] neg_lo:[0,1,0]
    v_cvt_pk_bf16_f32 v30, v34, v35
    ds_write_b32 v9, v30 offset:18480
    v_pk_mul_f32 v[26:27], v[32:33], v[24:25] op_sel:[0,0] op_sel_hi:[0,1]
    v_pk_fma_f32 v[26:27], v[32:33], v[24:25], v[26:27] op_sel:[1,1,0] op_sel_hi:[1,0,1] neg_lo:[0,1,0]
    v_cvt_pk_bf16_f32 v31, v26, v27
    ds_write_b32 v9, v31 offset:19008
    v_pk_mul_f32 v[28:29], v[34:35], v[24:25] op_sel:[0,0] op_sel_hi:[0,1]
    v_pk_fma_f32 v[28:29], v[34:35], v[24:25], v[28:29] op_sel:[1,1,0] op_sel_hi:[1,0,1] neg_lo:[0,1,0]
    v_cvt_pk_bf16_f32 v30, v28, v29
    ds_write_b32 v9, v30 offset:19536
    v_pk_mul_f32 v[32:33], v[26:27], v[24:25] op_sel:[0,0] op_sel_hi:[0,1]
    v_pk_fma_f32 v[32:33], v[26:27], v[24:25], v[32:33] op_sel:[1,1,0] op_sel_hi:[1,0,1] neg_lo:[0,1,0]
    v_cvt_pk_bf16_f32 v31, v32, v33
    ds_write_b32 v9, v31 offset:20064
    v_pk_mul_f32 v[34:35], v[28:29], v[24:25] op_sel:[0,0] op_sel_hi:[0,1]
    v_pk_fma_f32 v[34:35], v[28:29], v[24:25], v[34:35] op_sel:[1,1,0] op_sel_hi:[1,0,1] neg_lo:[0,1,0]
    v_cvt_pk_bf16_f32 v30, v34, v35
    ds_write_b32 v9, v30 offset:20592
    v_pk_mul_f32 v[26:27], v[32:33], v[24:25] op_sel:[0,0] op_sel_hi:[0,1]
    v_pk_fma_f32 v[26:27], v[32:33], v[24:25], v[26:27] op_sel:[1,1,0] op_sel_hi:[1,0,1] neg_lo:[0,1,0]
    v_cvt_pk_bf16_f32 v31, v26, v27
    ds_write_b32 v9, v31 offset:21120
    v_pk_mul_f32 v[28:29], v[34:35], v[24:25] op_sel:[0,0] op_sel_hi:[0,1]
    v_pk_fma_f32 v[28:29], v[34:35], v[24:25], v[28:29] op_sel:[1,1,0] op_sel_hi:[1,0,1] neg_lo:[0,1,0]
    v_cvt_pk_bf16_f32 v30, v28, v29
    ds_write_b32 v9, v30 offset:21648
    v_pk_mul_f32 v[32:33], v[26:27], v[24:25] op_sel:[0,0] op_sel_hi:[0,1]
    v_pk_fma_f32 v[32:33], v[26:27], v[24:25], v[32:33] op_sel:[1,1,0] op_sel_hi:[1,0,1] neg_lo:[0,1,0]
    v_cvt_pk_bf16_f32 v31, v32, v33
    ds_write_b32 v9, v31 offset:22176
    v_pk_mul_f32 v[34:35], v[28:29], v[24:25] op_sel:[0,0] op_sel_hi:[0,1]
    v_pk_fma_f32 v[34:35], v[28:29], v[24:25], v[34:35] op_sel:[1,1,0] op_sel_hi:[1,0,1] neg_lo:[0,1,0]
    v_cvt_pk_bf16_f32 v30, v34, v35
    ds_write_b32 v9, v30 offset:22704
    v_pk_mul_f32 v[26:27], v[32:33], v[24:25] op_sel:[0,0] op_sel_hi:[0,1]
    v_pk_fma_f32 v[26:27], v[32:33], v[24:25], v[26:27] op_sel:[1,1,0] op_sel_hi:[1,0,1] neg_lo:[0,1,0]
    v_cvt_pk_bf16_f32 v31, v26, v27
    ds_write_b32 v9, v31 offset:23232
    v_pk_mul_f32 v[28:29], v[34:35], v[24:25] op_sel:[0,0] op_sel_hi:[0,1]
    v_pk_fma_f32 v[28:29], v[34:35], v[24:25], v[28:29] op_sel:[1,1,0] op_sel_hi:[1,0,1] neg_lo:[0,1,0]
    v_cvt_pk_bf16_f32 v30, v28, v29
    ds_write_b32 v9, v30 offset:23760
    v_pk_mul_f32 v[32:33], v[26:27], v[24:25] op_sel:[0,0] op_sel_hi:[0,1]
    v_pk_fma_f32 v[32:33], v[26:27], v[24:25], v[32:33] op_sel:[1,1,0] op_sel_hi:[1,0,1] neg_lo:[0,1,0]
    v_cvt_pk_bf16_f32 v31, v32, v33
    ds_write_b32 v9, v31 offset:24288
    v_pk_mul_f32 v[34:35], v[28:29], v[24:25] op_sel:[0,0] op_sel_hi:[0,1]
    v_pk_fma_f32 v[34:35], v[28:29], v[24:25], v[34:35] op_sel:[1,1,0] op_sel_hi:[1,0,1] neg_lo:[0,1,0]
    v_cvt_pk_bf16_f32 v30, v34, v35
    ds_write_b32 v9, v30 offset:24816
    v_pk_mul_f32 v[26:27], v[32:33], v[24:25] op_sel:[0,0] op_sel_hi:[0,1]
    v_pk_fma_f32 v[26:27], v[32:33], v[24:25], v[26:27] op_sel:[1,1,0] op_sel_hi:[1,0,1] neg_lo:[0,1,0]
    v_cvt_pk_bf16_f32 v31, v26, v27
    ds_write_b32 v9, v31 offset:25344
    v_pk_mul_f32 v[28:29], v[34:35], v[24:25] op_sel:[0,0] op_sel_hi:[0,1]
    v_pk_fma_f32 v[28:29], v[34:35], v[24:25], v[28:29] op_sel:[1,1,0] op_sel_hi:[1,0,1] neg_lo:[0,1,0]
    v_cvt_pk_bf16_f32 v30, v28, v29
    ds_write_b32 v9, v30 offset:25872
    v_pk_mul_f32 v[32:33], v[26:27], v[24:25] op_sel:[0,0] op_sel_hi:[0,1]
    v_pk_fma_f32 v[32:33], v[26:27], v[24:25], v[32:33] op_sel:[1,1,0] op_sel_hi:[1,0,1] neg_lo:[0,1,0]
    v_cvt_pk_bf16_f32 v31, v32, v33
    ds_write_b32 v9, v31 offset:26400
    v_pk_mul_f32 v[34:35], v[28:29], v[24:25] op_sel:[0,0] op_sel_hi:[0,1]
    v_pk_fma_f32 v[34:35], v[28:29], v[24:25], v[34:35] op_sel:[1,1,0] op_sel_hi:[1,0,1] neg_lo:[0,1,0]
    v_cvt_pk_bf16_f32 v30, v34, v35
    ds_write_b32 v9, v30 offset:26928
    v_pk_mul_f32 v[26:27], v[32:33], v[24:25] op_sel:[0,0] op_sel_hi:[0,1]
    v_pk_fma_f32 v[26:27], v[32:33], v[24:25], v[26:27] op_sel:[1,1,0] op_sel_hi:[1,0,1] neg_lo:[0,1,0]
    v_cvt_pk_bf16_f32 v31, v26, v27
    ds_write_b32 v9, v31 offset:27456
    s_branch join_k1_kernel_7
xw_k1_kernel_6:
    v_mul_f32 v40, 0x3f800000, v20
    v_mul_f32 v23, 0x3f800000, v21
    v_exp_f32 v40, v40
    v_fract_f32 v23, v23
    v_cos_f32 v22, v23
    v_sin_f32 v23, v23
    s_nop 0
    v_mul_f32 v22, v22, v40
    v_mul_f32 v23, v23, v40
    v_mul_f32 v40, 0x43800000, v20
    v_mul_f32 v43, 0x43800000, v21
    v_exp_f32 v40, v40
    v_fract_f32 v43, v43
    v_cos_f32 v42, v43
    v_sin_f32 v43, v43
    s_nop 0
    v_mul_f32 v42, v42, v40
    v_mul_f32 v43, v43, v40
    v_mul_f32 v40, 0x44000000, v20
    v_mul_f32 v45, 0x44000000, v21
    v_exp_f32 v40, v40
    v_fract_f32 v45, v45
    v_cos_f32 v44, v45
    v_sin_f32 v45, v45
    s_nop 0
    v_mul_f32 v44, v44, v40
    v_mul_f32 v45, v45, v40
    v_mul_f32 v40, 0x44800000, v20
    v_mul_f32 v47, 0x44800000, v21
    v_exp_f32 v40, v40
    v_fract_f32 v47, v47
    v_cos_f32 v46, v47
    v_sin_f32 v47, v47
    s_nop 0
    v_mul_f32 v46, v46, v40
    v_mul_f32 v47, v47, v40
    s_waitcnt vmcnt(0)
    v_lshlrev_b32 v12, 16, v12
    v_lshlrev_b32 v13, 16, v13
    v_lshlrev_b32 v14, 16, v14
    v_lshlrev_b32 v15, 16, v15
    v_mul_f32 v12, v17, v12
    v_mul_f32 v13, v17, v13
    v_pk_mul_f32 v[24:25], v[14:15], v[12:13] op_sel:[0,0] op_sel_hi:[0,1]
    v_pk_fma_f32 v[24:25], v[14:15], v[12:13], v[24:25] op_sel:[1,1,0] op_sel_hi:[1,0,1] neg_lo:[0,1,0]
    v_cvt_pk_bf16_f32 v40, v24, -v25
    ds_write_b32 v9, v40 offset:0
    v_pk_mul_f32 v[26:27], v[24:25], v[22:23] op_sel:[0,0] op_sel_hi:[0,1]
    v_pk_fma_f32 v[26:27], v[24:25], v[22:23], v[26:27] op_sel:[1,1,0] op_sel_hi:[1,0,1] neg_lo:[0,1,0]
    v_cvt_pk_bf16_f32 v41, v26, -v27
    ds_write_b32 v9, v41 offset:528
    v_pk_mul_f32 v[28:29], v[26:27], v[22:23] op_sel:[0,0] op_sel_hi:[0,1]
    v_pk_fma_f32 v[28:29], v[26:27], v[22:23], v[28:29] op_sel:[1,1,0] op_sel_hi:[1,0,1] neg_lo:[0,1,0]
    v_cvt_pk_bf16_f32 v40, v28, -v29
    ds_write_b32 v9, v40 offset:1056
    v_pk_mul_f32 v[30:31], v[28:29], v[22:23] op_sel:[0,0] op_sel_hi:[0,1]
    v_pk_fma_f32 v[30:31], v[28:29], v[22:23], v[30:31] op_sel:[1,1,0] op_sel_hi:[1,0,1] neg_lo:[0,1,0]
    v_cvt_pk_bf16_f32 v41, v30, -v31
    ds_write_b32 v9, v41 offset:1584
    v_pk_mul_f32 v[32:33], v[30:31], v[22:23] op_sel:[0,0] op_sel_hi:[0,1]
    v_pk_fma_f32 v[32:33], v[30:31], v[22:23], v[32:33] op_sel:[1,1,0] op_sel_hi:[1,0,1] neg_lo:[0,1,0]
    v_cvt_pk_bf16_f32 v40, v32, -v33
    ds_write_b32 v9, v40 offset:2112
    v_pk_mul_f32 v[34:35], v[32:33], v[22:23] op_sel:[0,0] op_sel_hi:[0,1]
    v_pk_fma_f32 v[34:35], v[32:33], v[22:23], v[34:35] op_sel:[1,1,0] op_sel_hi:[1,0,1] neg_lo:[0,1,0]
    v_cvt_pk_bf16_f32 v41, v34, -v35
    ds_write_b32 v9, v41 offset:2640
    v_pk_mul_f32 v[36:37], v[34:35], v[22:23] op_sel:[0,0] op_sel_hi:[0,1]
    v_pk_fma_f32 v[36:37], v[34:35], v[22:23], v[36:37] op_sel:[1,1,0] op_sel_hi:[1,0,1] neg_lo:[0,1,0]
    v_cvt_pk_bf16_f32 v40, v36, -v37
    ds_write_b32 v9, v40 offset:3168
    v_pk_mul_f32 v[38:39], v[36:37], v[22:23] op_sel:[0,0] op_sel_hi:[0,1]
    v_pk_fma_f32 v[38:39], v[36:37], v[22:23], v[38:39] op_sel:[1,1,0] op_sel_hi:[1,0,1] neg_lo:[0,1,0]
    v_cvt_pk_bf16_f32 v41, v38, -v39
    ds_write_b32 v9, v41 offset:3696
    v_pk_mul_f32 v[48:49], v[24:25], v[42:43] op_sel:[0,0] op_sel_hi:[0,1]
    v_pk_fma_f32 v[48:49], v[24:25], v[42:43], v[48:49] op_sel:[1,1,0] op_sel_hi:[1,0,1] neg_lo:[0,1,0]
    v_cvt_pk_bf16_f32 v40, v48, -v49
    ds_write_b32 v9, v40 offset:4224
    v_pk_mul_f32 v[48:49], v[28:29], v[42:43] op_sel:[0,0] op_sel_hi:[0,1]
    v_pk_fma_f32 v[48:49], v[28:29], v[42:43], v[48:49] op_sel:[1,1,0] op_sel_hi:[1,0,1] neg_lo:[0,1,0]
    v_cvt_pk_bf16_f32 v41, v48, -v49
    ds_write_b32 v9, v41 offset:4752
    v_pk_mul_f32 v[48:49], v[32:33], v[42:43] op_sel:[0,0] op_sel_hi:[0,1]
    v_pk_fma_f32 v[48:49], v[32:33], v[42:43], v[48:49] op_sel:[1,1,0] op_sel_hi:[1,0,1] neg_lo:[0,1,0]
    v_cvt_pk_bf16_f32 v40, v48, -v49
    ds_write_b32 v9, v40 offset:5280
    v_pk_mul_f32 v[48:49], v[36:37], v[42:43] op_sel:[0,0] op_sel_hi:[0,1]
    v_pk_fma_f32 v[48:49], v[36:37], v[42:43], v[48:49] op_sel:[1,1,0] op_sel_hi:[1,0,1] neg_lo:[0,1,0]
    v_cvt_pk_bf16_f32 v41, v48, -v49
    ds_write_b32 v9, v41 offset:5808
    v_pk_mul_f32 v[48:49], v[24:25], v[44:45] op_sel:[0,0] op_sel_hi:[0,1]
    v_pk_fma_f32 v[48:49], v[24:25], v[44:45], v[48:49] op_sel:[1,1,0] op_sel_hi:[1,0,1] neg_lo:[0,1,0]
    v_cvt_pk_bf16_f32 v40, v48, -v49
    ds_write_b32 v9, v40 offset:6336
    v_pk_mul_f32 v[50:51], v[48:49], v[42:43] op_sel:[0,0] op_sel_hi:[0,1]
    v_pk_fma_f32 v[50:51], v[48:49], v[42:43], v[50:51] op_sel:[1,1,0] op_sel_hi:[1,0,1] neg_lo:[0,1,0]
    v_cvt_pk_bf16_f32 v40, v50, -v51
    ds_write_b32 v9, v40 offset:7392
    v_pk_mul_f32 v[48:49], v[32:33], v[44:45] op_sel:[0,0] op_sel_hi:[0,1]
    v_pk_fma_f32 v[48:49], v[32:33], v[44:45], v[48:49] op_sel:[1,1,0] op_sel_hi:[1,0,1] neg_lo:[0,1,0]
    v_cvt_pk_bf16_f32 v41, v48, -v49
    ds_write_b32 v9, v41 offset:6864
    v_pk_mul_f32 v[50:51], v[48:49], v[42:43] op_sel:[0,0] op_sel_hi:[0,1]
    v_pk_fma_f32 v[50:51], v[48:49], v[42:43], v[50:51] op_sel:[1,1,0] op_sel_hi:[1,0,1] neg_lo:[0,1,0]
    v_cvt_pk_bf16_f32 v41, v50, -v51
    ds_write_b32 v9, v41 offset:7920
    v_pk_mul_f32 v[48:49], v[24:25], v[46:47] op_sel:[0,0] op_sel_hi:[0,1]
    v_pk_fma_f32 v[48:49], v[24:25], v[46:47], v[48:49] op_sel:[1,1,0] op_sel_hi:[1,0,1] neg_lo:[0,1,0]
    v_cvt_pk_bf16_f32 v40, v48, -v49
    ds_write_b32 v9, v40 offset:8448
    v_pk_mul_f32 v[50:51], v[48:49], v[42:43] op_sel:[0,0] op_sel_hi:[0,1]
    v_pk_fma_f32 v[50:51], v[48:49], v[42:43], v[50:51] op_sel:[1,1,0] op_sel_hi:[1,0,1] neg_lo:[0,1,0]
    v_cvt_pk_bf16_f32 v41, v50, -v51
    ds_write_b32 v9, v41 offset:8976
    v_pk_mul_f32 v[50:51], v[48:49], v[44:45] op_sel:[0,0] op_sel_hi:[0,1]
    v_pk_fma_f32 v[50:51], v[48:49], v[44:45], v[50:51] op_sel:[1,1,0] op_sel_hi:[1,0,1] neg_lo:[0,1,0]
    v_cvt_pk_bf16_f32 v40, v50, -v51
    ds_write_b32 v9, v40 offset:9504
    v_pk_mul_f32 v[52:53], v[50:51], v[42:43] op_sel:[0,0] op_sel_hi:[0,1]
    v_pk_fma_f32 v[52:53], v[50:51], v[42:43], v[52:53] op_sel:[1,1,0] op_sel_hi:[1,0,1] neg_lo:[0,1,0]
    v_cvt_pk_bf16_f32 v41, v52, -v53
    ds_write_b32 v9, v41 offset:10032
    v_pk_mul_f32 v[52:53], v[48:49], v[46:47] op_sel:[0,0] op_sel_hi:[0,1]
    v_pk_fma_f32 v[52:53], v[48:49], v[46:47], v[52:53] op_sel:[1,1,0] op_sel_hi:[1,0,1] neg_lo:[0,1,0]
    v_cvt_pk_bf16_f32 v40, v52, -v53
    ds_write_b32 v9, v40 offset:10560
join_k1_kernel_7:
    s_waitcnt vmcnt(0) lgkmcnt(0)
    s_barrier
    ds_read_b128 v[8:11], v67 offset:0
    ds_read_b128 v[12:15], v66 offset:0
    ds_read_b128 v[16:19], v67 offset:64
    ds_read_b128 v[20:23], v66 offset:64
    ds_read_b128 v[24:27], v67 offset:128
    ds_read_b128 v[28:31], v66 offset:128
    ds_read_b128 v[32:35], v67 offset:192
    ds_read_b128 v[36:39], v66 offset:192
    s_waitcnt lgkmcnt(6)
    v_mfma_f32_16x16x32_bf16 v[40:43], v[8:11], v[12:15], 0
    ds_read_b128 v[8:11], v67 offset:256
    ds_read_b128 v[12:15], v66 offset:256
    s_waitcnt lgkmcnt(6)
    v_mfma_f32_16x16x32_bf16 v[40:43], v[16:19], v[20:23], v[40:43]
    ds_read_b128 v[16:19], v67 offset:320
    ds_read_b128 v[20:23], v66 offset:320
    s_waitcnt lgkmcnt(6)
    v_mfma_f32_16x16x32_bf16 v[40:43], v[24:27], v[28:31], v[40:43]
    ds_read_b128 v[24:27], v67 offset:384
    ds_read_b128 v[28:31], v66 offset:384
    s_waitcnt lgkmcnt(6)
    v_mfma_f32_16x16x32_bf16 v[40:43], v[32:35], v[36:39], v[40:43]
    ds_read_b128 v[32:35], v67 offset:448
    ds_read_b128 v[36:39], v66 offset:448
    s_waitcnt lgkmcnt(6)
    v_mfma_f32_16x16x32_bf16 v[40:43], v[8:11], v[12:15], v[40:43]
    s_waitcnt lgkmcnt(4)
    v_mfma_f32_16x16x32_bf16 v[40:43], v[16:19], v[20:23], v[40:43]
    s_waitcnt lgkmcnt(2)
    v_mfma_f32_16x16x32_bf16 v[40:43], v[24:27], v[28:31], v[40:43]
    s_waitcnt lgkmcnt(0)
    v_mfma_f32_16x16x32_bf16 v[40:43], v[32:35], v[36:39], v[40:43]
    s_add_u32 s32, s6, 0x5000000
    s_addc_u32 s33, s7, 0
    s_mov_b32 s34, 0x252000
    s_mov_b32 s35, 0x00020000
    s_mul_i32 s3, s14, 4224
    v_and_b32 v48, 0xffff, v56
    v_lshrrev_b32 v49, 16, v56
    v_and_b32 v50, 0xffff, v57
    v_lshrrev_b32 v51, 16, v57
    v_and_b32 v52, 0xffff, v58
    v_lshrrev_b32 v53, 16, v58
    v_and_b32 v54, 0xffff, v59
    v_lshrrev_b32 v55, 16, v59
    v_mov_b32 v20, 0
    v_mov_b32 v21, 0
    v_mov_b32 v22, 0
    v_mov_b32 v23, 0
    v_cvt_pk_bf16_f32 v46, v40, v41
    v_cvt_pk_bf16_f32 v47, v42, v43
    ds_write_b64 v68, v[46:47] offset:27984
    s_waitcnt lgkmcnt(0)
    s_barrier
    ds_read_u16 v8, v48 offset:27984
    ds_read_u16 v9, v49 offset:27984
    ds_read_u16 v10, v50 offset:27984
    ds_read_u16 v11, v51 offset:27984
    ds_read_u16 v12, v52 offset:27984
    ds_read_u16 v13, v53 offset:27984
    ds_read_u16 v14, v54 offset:27984
    ds_read_u16 v15, v55 offset:27984
    s_waitcnt lgkmcnt(0)
    v_lshl_or_b32 v16, v9, 16, v8
    v_lshl_or_b32 v17, v11, 16, v10
    v_lshl_or_b32 v18, v13, 16, v12
    v_lshl_or_b32 v19, v15, 16, v14
    buffer_store_dwordx4 v[16:19], v5, s[32:35], s3 offen
    v_cmp_gt_u32 vcc, 8, v0
    s_and_saveexec_b64 s[4:5], vcc
    s_cbranch_execz done_k1_kernel_1
    s_add_u32 s3, s3, 4096
    buffer_store_dwordx4 v[20:23], v5, s[32:35], s3 offen
    s_endpgm
w1_k1_kernel_3:
    s_load_dwordx8 s[64:71], s[0:1], 80
    s_sub_u32 s3, s2, 704
    s_waitcnt lgkmcnt(0)
    s_add_u32 s32, s6, 0x1e00000
    s_addc_u32 s33, s7, 0
    s_mov_b32 s34, 0x74000
    s_mov_b32 s35, 0x00020000
    v_mov_b32 v20, -1
    v_mov_b32 v21, -1
    v_mov_b32 v22, -1
    v_mov_b32 v23, -1
    v_lshlrev_b32 v24, 4, v0
    s_lshl_b32 s13, s3, 13
    buffer_store_dwordx4 v[20:23], v24, s[32:35], s13 offen
    s_add_u32 s13, s13, 4096
    buffer_store_dwordx4 v[20:23], v24, s[32:35], s13 offen
    s_cmp_ge_u32 s3, 36
    s_cselect_b32 s13, 36, 0
    s_cmp_ge_u32 s3, 72
    s_cselect_b32 s13, 72, s13
    s_add_u32 s3, s3, s13
    s_add_u32 s3, s3, 36
    s_mov_b32 s10, 59652324
    s_mul_hi_u32 s11, s3, s10
    s_mul_i32 s12, s11, 72
    s_sub_u32 s12, s3, s12
    s_mov_b32 s16, s64
    s_mov_b32 s17, s65
    s_mov_b32 s18, 0x510000
    s_mov_b32 s19, 0x00020000
    s_add_u32 s20, s6, 0x1400000
    s_addc_u32 s21, s7, 0
    s_mov_b32 s22, 0x510000
    s_mov_b32 s23, 0x00020000
    v_and_b32 v2, 63, v0
    v_lshrrev_b32 v1, 6, v0
    s_nop 0
    v_readfirstlane_b32 s15, v1
    v_lshrrev_b32 v3, 3, v2
    v_and_b32 v4, 7, v2
    v_bfe_u32 v5, v2, 4, 1
    v_lshlrev_b32 v5, 1, v5
    v_xor_b32 v4, v4, v5
    v_lshlrev_b32 v4, 4, v4
    v_mul_u32_u24 v3, 9216, v3
    v_add_u32 v4, v4, v3
    v_xor_b32 v5, 64, v4
    s_mul_i32 s13, s11, 1769472
    s_lshl_b32 s14, s12, 7
    s_add_u32 s13, s13, s14
    s_mul_i32 s14, s15, 442368
    s_add_u32 s13, s13, s14
    s_mul_i32 s14, s15, 6144
    s_add_u32 m0, s14, 0
    s_nop 0
    buffer_load_dwordx4 v4, s[16:19], s13 offen lds
    s_add_u32 s13, s13, 73728
    s_add_u32 m0, s14, 1024
    s_nop 0
    buffer_load_dwordx4 v5, s[16:19], s13 offen lds
    s_add_u32 s13, s13, 73728
    s_add_u32 m0, s14, 2048
    s_nop 0
    buffer_load_dwordx4 v4, s[16:19], s13 offen lds
    s_add_u32 s13, s13, 73728
    s_add_u32 m0, s14, 3072
    s_nop 0
    buffer_load_dwordx4 v5, s[16:19], s13 offen lds
    s_add_u32 s13, s13, 73728
    s_add_u32 m0, s14, 4096
    s_nop 0
    buffer_load_dwordx4 v4, s[16:19], s13 offen lds
    s_add_u32 s13, s13, 73728
    s_add_u32 m0, s14, 5120
    s_nop 0
    buffer_load_dwordx4 v5, s[16:19], s13 offen lds
    s_add_u32 s13, s13, 73728
    v_and_b32 v3, 15, v2
    v_lshrrev_b32 v6, 4, v2
    v_lshrrev_b32 v7, 2, v3
    v_bfe_u32 v8, v3, 1, 1
    s_lshl_b32 s13, s15, 1
    v_add_u32 v8, s13, v8
    v_and_b32 v9, 2, v7
    v_xor_b32 v8, v8, v9
    v_and_b32 v9, 1, v6
    v_lshlrev_b32 v9, 2, v9
    v_xor_b32 v8, v8, v9
    v_lshlrev_b32 v8, 4, v8
    v_and_b32 v9, 1, v3
    v_lshl_add_u32 v8, v9, 3, v8
    v_lshl_add_u32 v7, v6, 3, v7
    v_lshl_add_u32 v8, v7, 7, v8
    s_lshl_b32 s13, s12, 6
    s_lshl_b32 s14, s15, 4
    s_add_u32 s13, s13, s14
    v_add_u32 v9, s13, v3
    v_mul_u32_u24 v9, 1152, v9
    v_lshl_add_u32 v9, v6, 4, v9
    s_mul_i32 s13, s11, 384
    v_lshlrev_b32 v9, 6, v3
    v_lshl_add_u32 v9, v6, 4, v9
    s_lshl_b32 s13, s12, 2
    s_add_u32 s13, s13, s15
    s_mul_i32 s13, s13, 18432
    s_mul_i32 s14, s11, 6144
    s_add_u32 s13, s13, s14
    v_add_u32 v10, 4096, v9
    s_waitcnt vmcnt(0)
    s_barrier
    ds_read_b64_tr_b16 v[16:17], v8 offset:0
    ds_read_b64_tr_b16 v[18:19], v8 offset:512
    ds_read_b64_tr_b16 v[20:21], v8 offset:4096
    ds_read_b64_tr_b16 v[22:23], v8 offset:4608
    ds_read_b64_tr_b16 v[24:25], v8 offset:8192
    ds_read_b64_tr_b16 v[26:27], v8 offset:8704
    ds_read_b64_tr_b16 v[28:29], v8 offset:12288
    ds_read_b64_tr_b16 v[30:31], v8 offset:12800
    ds_read_b64_tr_b16 v[32:33], v8 offset:16384
    ds_read_b64_tr_b16 v[34:35], v8 offset:16896
    ds_read_b64_tr_b16 v[36:37], v8 offset:20480
    ds_read_b64_tr_b16 v[38:39], v8 offset:20992
    s_waitcnt lgkmcnt(10)
    buffer_store_dwordx4 v[16:19], v9, s[20:23], s13 offen offset:0 sc1
    s_waitcnt lgkmcnt(8)
    buffer_store_dwordx4 v[20:23], v9, s[20:23], s13 offen offset:1024 sc1
    s_waitcnt lgkmcnt(6)
    buffer_store_dwordx4 v[24:27], v9, s[20:23], s13 offen offset:2048 sc1
    s_waitcnt lgkmcnt(4)
    buffer_store_dwordx4 v[28:31], v9, s[20:23], s13 offen offset:3072 sc1
    s_waitcnt lgkmcnt(2)
    buffer_store_dwordx4 v[32:35], v10, s[20:23], s13 offen offset:0 sc1
    s_waitcnt lgkmcnt(0)
    buffer_store_dwordx4 v[36:39], v10, s[20:23], s13 offen offset:1024 sc1
    s_add_u32 s24, s6, 0x2000000
    s_addc_u32 s25, s7, 0
    s_mov_b32 s26, 0xd800
    s_mov_b32 s27, 0x00020000
    v_mov_b32 v10, 0
    v_mov_b32 v11, 0
    s_mov_b32 s14, 0x3f803f80
    v_dot2_f32_bf16 v10, v16, s14, v10
    v_dot2_f32_bf16 v11, v17, s14, v11
    v_dot2_f32_bf16 v10, v18, s14, v10
    v_dot2_f32_bf16 v11, v19, s14, v11
    v_dot2_f32_bf16 v10, v20, s14, v10
    v_dot2_f32_bf16 v11, v21, s14, v11
    v_dot2_f32_bf16 v10, v22, s14, v10
    v_dot2_f32_bf16 v11, v23, s14, v11
    v_dot2_f32_bf16 v10, v24, s14, v10
    v_dot2_f32_bf16 v11, v25, s14, v11
    v_dot2_f32_bf16 v10, v26, s14, v10
    v_dot2_f32_bf16 v11, v27, s14, v11
    v_dot2_f32_bf16 v10, v28, s14, v10
    v_dot2_f32_bf16 v11, v29, s14, v11
    v_dot2_f32_bf16 v10, v30, s14, v10
    v_dot2_f32_bf16 v11, v31, s14, v11
    v_dot2_f32_bf16 v10, v32, s14, v10
    v_dot2_f32_bf16 v11, v33, s14, v11
    v_dot2_f32_bf16 v10, v34, s14, v10
    v_dot2_f32_bf16 v11, v35, s14, v11
    v_dot2_f32_bf16 v10, v36, s14, v10
    v_dot2_f32_bf16 v11, v37, s14, v11
    v_dot2_f32_bf16 v10, v38, s14, v10
    v_dot2_f32_bf16 v11, v39, s14, v11
    s_nop 2
    v_add_f32 v10, v10, v11
    v_mov_b32 v11, v10
    s_nop 1
    v_permlane32_swap_b32 v10, v11
    v_add_f32 v10, v10, v11
    v_mov_b32 v11, v10
    s_nop 1
    v_permlane16_swap_b32 v10, v11
    v_add_f32 v10, v10, v11
    s_mul_i32 s13, s11, 18432
    s_lshl_b32 s14, s12, 8
    s_add_u32 s13, s13, s14
    s_lshl_b32 s14, s15, 6
    s_add_u32 s13, s13, s14
    v_lshlrev_b32 v11, 2, v3
    s_mov_b64 exec, 0xffff
    buffer_store_dword v10, v11, s[24:27], s13 offen
    s_endpgm
done_k1_kernel_1:
    s_endpgm
.p2align 6
.type gtab_k1_kernel,@object
gtab_k1_kernel:
    .short 4096, 4096, 4096, 4096, 3646, 3646, 3646, 3646, 3646, 3646, 3646, 3644, 3644, 3644, 3644, 3644
    .short 3644, 3644, 3644, 3644, 3642, 3642, 3642, 3642, 3642, 3642, 3642, 3640, 3640, 3640, 3640, 3640
    .short 3640, 3640, 3640, 3640, 3638, 3638, 3638, 3638, 3638, 3638, 3638, 3636, 3636, 3636, 3636, 3636
    .short 3636, 3636, 3636, 3636, 3634, 3634, 3634, 3634, 3634, 3634, 3634, 3632, 3632, 3632, 3632, 3632
    .short 3632, 3632, 3632, 3632, 3630, 3630, 3630, 3630, 3630, 3630, 3630, 3628, 3628, 3628, 3628, 3628
    .short 3628, 3628, 3628, 3628, 3626, 3626, 3626, 3626, 3626, 3626, 3626, 3624, 3624, 3624, 3624, 3624
    .short 3624, 3624, 3624, 3624, 3622, 3622, 3622, 3622, 3622, 3622, 3622, 3620, 3620, 3620, 3620, 3620
    .short 3620, 3620, 3620, 3620, 3618, 3618, 3618, 3618, 3618, 3618, 3618, 3616, 3616, 3616, 3616, 3616
    .short 3616, 3616, 3616, 3616, 3614, 3614, 3614, 3614, 3614, 3614, 3614, 3612, 3612, 3612, 3612, 3612
    .short 3612, 3612, 3612, 3612, 3610, 3610, 3610, 3610, 3610, 3610, 3610, 3608, 3608, 3608, 3608, 3608
    .short 3608, 3608, 3608, 3608, 3606, 3606, 3606, 3606, 3606, 3606, 3606, 3604, 3604, 3604, 3604, 3604
    .short 3604, 3604, 3604, 3604, 3602, 3602, 3602, 3602, 3602, 3602, 3602, 3600, 3600, 3600, 3600, 3600
    .short 3600, 3600, 3600, 3600, 3598, 3598, 3598, 3598, 3598, 3598, 3598, 3596, 3596, 3596, 3596, 3596
    .short 3596, 3596, 3596, 3596, 3594, 3594, 3594, 3594, 3594, 3594, 3594, 3592, 3592, 3592, 3592, 3592
    .short 3592, 3592, 3592, 3592, 3590, 3590, 3590, 3590, 3590, 3590, 3590, 3588, 3588, 3588, 3588, 3588
    .short 3588, 3588, 3588, 3588, 3586, 3586, 3586, 3586, 3586, 3586, 3586, 3584, 3584, 3584, 3584, 3584
    .short 3584, 3584, 3584, 3584, 3134, 3134, 3134, 3134, 3134, 3134, 3134, 3132, 3132, 3132, 3132, 3132
    .short 3132, 3132, 3132, 3132, 3130, 3130, 3130, 3130, 3130, 3130, 3130, 3128, 3128, 3128, 3128, 3128
    .short 3128, 3128, 3128, 3128, 3126, 3126, 3126, 3126, 3126, 3126, 3126, 3124, 3124, 3124, 3124, 3124
    .short 3124, 3124, 3124, 3124, 3122, 3122, 3122, 3122, 3122, 3122, 3122, 3120, 3120, 3120, 3120, 3120
    .short 3120, 3120, 3120, 3120, 3118, 3118, 3118, 3118, 3118, 3118, 3118, 3116, 3116, 3116, 3116, 3116
    .short 3116, 3116, 3116, 3116, 3114, 3114, 3114, 3114, 3114, 3114, 3114, 3112, 3112, 3112, 3112, 3112
    .short 3112, 3112, 3112, 3112, 3110, 3110, 3110, 3110, 3110, 3110, 3110, 3108, 3108, 3108, 3108, 3108
    .short 3108, 3108, 3108, 3108, 3106, 3106, 3106, 3106, 3106, 3106, 3106, 3104, 3104, 3104, 3104, 3104
    .short 3104, 3104, 3104, 3104, 3102, 3102, 3102, 3102, 3102, 3102, 3102, 3100, 3100, 3100, 3100, 3100
    .short 3100, 3100, 3100, 3100, 3098, 3098, 3098, 3098, 3098, 3098, 3098, 3096, 3096, 3096, 3096, 3096
    .short 3096, 3096, 3096, 3096, 3094, 3094, 3094, 3094, 3094, 3094, 3094, 3092, 3092, 3092, 3092, 3092
    .short 3092, 3092, 3092, 3092, 3090, 3090, 3090, 3090, 3090, 3090, 3090, 3088, 3088, 3088, 3088, 3088
    .short 3088, 3088, 3088, 3088, 3086, 3086, 3086, 3086, 3086, 3086, 3086, 3084, 3084, 3084, 3084, 3084
    .short 3084, 3084, 3084, 3084, 3082, 3082, 3082, 3082, 3082, 3082, 3082, 3080, 3080, 3080, 3080, 3080
    .short 3080, 3080, 3080, 3080, 3078, 3078, 3078, 3078, 3078, 3078, 3078, 3076, 3076, 3076, 3076, 3076
    .short 3076, 3076, 3076, 3076, 3074, 3074, 3074, 3074, 3074, 3074, 3074, 3072, 3072, 3072, 3072, 3072
    .short 3072, 3072, 3072, 3072, 2622, 2622, 2622, 2622, 2622, 2622, 2622, 2620, 2620, 2620, 2620, 2620
    .short 2620, 2620, 2620, 2620, 2618, 2618, 2618, 2618, 2618, 2618, 2618, 2616, 2616, 2616, 2616, 2616
    .short 2616, 2616, 2616, 2616, 2614, 2614, 2614, 2614, 2614, 2614, 2614, 2612, 2612, 2612, 2612, 2612
    .short 2612, 2612, 2612, 2612, 2610, 2610, 2610, 2610, 2610, 2610, 2610, 2608, 2608, 2608, 2608, 2608
    .short 2608, 2608, 2608, 2608, 2606, 2606, 2606, 2606, 2606, 2606, 2606, 2604, 2604, 2604, 2604, 2604
    .short 2604, 2604, 2604, 2604, 2602, 2602, 2602, 2602, 2602, 2602, 2602, 2600, 2600, 2600, 2600, 2600
    .short 2600, 2600, 2600, 2600, 2598, 2598, 2598, 2598, 2598, 2598, 2598, 2596, 2596, 2596, 2596, 2596
    .short 2596, 2596, 2596, 2596, 2594, 2594, 2594, 2594, 2594, 2594, 2594, 2592, 2592, 2592, 2592, 2592
    .short 2592, 2592, 2592, 2592, 2590, 2590, 2590, 2590, 2590, 2590, 2590, 2588, 2588, 2588, 2588, 2588
    .short 2588, 2588, 2588, 2588, 2586, 2586, 2586, 2586, 2586, 2586, 2586, 2584, 2584, 2584, 2584, 2584
    .short 2584, 2584, 2584, 2584, 2582, 2582, 2582, 2582, 2582, 2582, 2582, 2580, 2580, 2580, 2580, 2580
    .short 2580, 2580, 2580, 2580, 2578, 2578, 2578, 2578, 2578, 2578, 2578, 2576, 2576, 2576, 2576, 2576
    .short 2576, 2576, 2576, 2576, 2574, 2574, 2574, 2574, 2574, 2574, 2574, 2572, 2572, 2572, 2572, 2572
    .short 2572, 2572, 2572, 2572, 2570, 2570, 2570, 2570, 2570, 2570, 2570, 2568, 2568, 2568, 2568, 2568
    .short 2568, 2568, 2568, 2568, 2566, 2566, 2566, 2566, 2566, 2566, 2566, 2564, 2564, 2564, 2564, 2564
    .short 2564, 2564, 2564, 2564, 2562, 2562, 2562, 2562, 2562, 2562, 2562, 2560, 2560, 2560, 2560, 2560
    .short 2560, 2560, 2560, 2560, 2110, 2110, 2110, 2110, 2110, 2110, 2110, 2108, 2108, 2108, 2108, 2108
    .short 2108, 2108, 2108, 2108, 2106, 2106, 2106, 2106, 2106, 2106, 2106, 2104, 2104, 2104, 2104, 2104
    .short 2104, 2104, 2104, 2104, 2102, 2102, 2102, 2102, 2102, 2102, 2102, 2100, 2100, 2100, 2100, 2100
    .short 2100, 2100, 2100, 2100, 2098, 2098, 2098, 2098, 2098, 2098, 2098, 2096, 2096, 2096, 2096, 2096
    .short 2096, 2096, 2096, 2096, 2094, 2094, 2094, 2094, 2094, 2094, 2094, 2092, 2092, 2092, 2092, 2092
    .short 2092, 2092, 2092, 2092, 2090, 2090, 2090, 2090, 2090, 2090, 2090, 2088, 2088, 2088, 2088, 2088
    .short 2088, 2088, 2088, 2088, 2086, 2086, 2086, 2086, 2086, 2086, 2086, 2084, 2084, 2084, 2084, 2084
    .short 2084, 2084, 2084, 2084, 2082, 2082, 2082, 2082, 2082, 2082, 2082, 2080, 2080, 2080, 2080, 2080
    .short 2080, 2080, 2080, 2080, 2078, 2078, 2078, 2078, 2078, 2078, 2078, 2076, 2076, 2076, 2076, 2076
    .short 2076, 2076, 2076, 2076, 2074, 2074, 2074, 2074, 2074, 2074, 2074, 2072, 2072, 2072, 2072, 2072
    .short 2072, 2072, 2072, 2072, 2070, 2070, 2070, 2070, 2070, 2070, 2070, 2068, 2068, 2068, 2068, 2068
    .short 2068, 2068, 2068, 2068, 2066, 2066, 2066, 2066, 2066, 2066, 2066, 2064, 2064, 2064, 2064, 2064
    .short 2064, 2064, 2064, 2064, 2062, 2062, 2062, 2062, 2062, 2062, 2062, 2060, 2060, 2060, 2060, 2060
    .short 2060, 2060, 2060, 2060, 2058, 2058, 2058, 2058, 2058, 2058, 2058, 2056, 2056, 2056, 2056, 2056
    .short 2056, 2056, 2056, 2056, 2054, 2054, 2054, 2054, 2054, 2054, 2054, 2052, 2052, 2052, 2052, 2052
    .short 2052, 2052, 2052, 2052, 2050, 2050, 2050, 2050, 2050, 2050, 2050, 2048, 2048, 2048, 2048, 2048
    .short 2048, 2048, 1854, 1854, 1854, 1598, 1598, 1598, 1598, 1598, 1852, 1852, 1852, 1596, 1596, 1596
    .short 1596, 1596, 1850, 1850, 1850, 1594, 1594, 1594, 1594, 1594, 1848, 1848, 1848, 1592, 1592, 1592
    .short 1592, 1592, 1846, 1846, 1846, 1590, 1590, 1590, 1590, 1590, 1844, 1844, 1844, 1588, 1588, 1588
    .short 1588, 1588, 1842, 1842, 1842, 1586, 1586, 1586, 1586, 1586, 1840, 1840, 1840, 1584, 1584, 1584
    .short 1584, 1584, 1838, 1838, 1838, 1582, 1582, 1582, 1582, 1582, 1836, 1836, 1836, 1580, 1580, 1580
    .short 1580, 1580, 1834, 1834, 1834, 1578, 1578, 1578, 1578, 1578, 1832, 1832, 1832, 1576, 1576, 1576
    .short 1576, 1576, 1830, 1830, 1830, 1574, 1574, 1574, 1574, 1574, 1828, 1828, 1828, 1572, 1572, 1572
    .short 1572, 1572, 1826, 1826, 1826, 1570, 1570, 1570, 1570, 1570, 1824, 1824, 1824, 1568, 1568, 1568
    .short 1568, 1568, 1822, 1822, 1822, 1566, 1566, 1566, 1566, 1566, 1820, 1820, 1820, 1564, 1564, 1564
    .short 1564, 1564, 1818, 1818, 1818, 1562, 1562, 1562, 1562, 1562, 1816, 1816, 1816, 1560, 1560, 1560
    .short 1560, 1560, 1814, 1814, 1814, 1558, 1558, 1558, 1558, 1558, 1812, 1812, 1812, 1556, 1556, 1556
    .short 1556, 1556, 1810, 1810, 1810, 1554, 1554, 1554, 1554, 1554, 1808, 1808, 1808, 1552, 1552, 1552
    .short 1552, 1552, 1806, 1806, 1806, 1550, 1550, 1550, 1550, 1550, 1804, 1804, 1804, 1548, 1548, 1548
    .short 1548, 1548, 1802, 1802, 1802, 1546, 1546, 1546, 1546, 1546, 1800, 1800, 1800, 1544, 1544, 1544
    .short 1544, 1544, 1798, 1798, 1798, 1542, 1542, 1542, 1542, 1542, 1796, 1796, 1796, 1540, 1540, 1540
    .short 1540, 1540, 1794, 1794, 1794, 1538, 1538, 1538, 1538, 1538, 1792, 1792, 1792, 1536, 1536, 1536
    .short 1536, 1536, 1342, 1342, 1342, 1086, 1086, 1086, 1086, 1086, 1340, 1340, 1340, 1084, 1084, 1084
    .short 1084, 1084, 1338, 1338, 1338, 1082, 1082, 1082, 1082, 1082, 1336, 1336, 1336, 1080, 1080, 1080
    .short 1080, 1080, 1334, 1334, 1334, 1078, 1078, 1078, 1078, 1078, 1332, 1332, 1332, 1076, 1076, 1076
    .short 1076, 1076, 1330, 1330, 1330, 1074, 1074, 1074, 1074, 1074, 1328, 1328, 1328, 1072, 1072, 1072
    .short 1072, 1072, 1326, 1326, 1326, 1070, 1070, 1070, 1070, 1070, 1324, 1324, 1324, 1068, 1068, 1068
    .short 1068, 1068, 1322, 1322, 1322, 1066, 1066, 1066, 1066, 1066, 1320, 1320, 1320, 1064, 1064, 1064
    .short 1064, 1064, 1318, 1318, 1318, 1062, 1062, 1062, 1062, 1062, 1316, 1316, 1316, 1060, 1060, 1060
    .short 1060, 1060, 1314, 1314, 1314, 1058, 1058, 1058, 1058, 1058, 1312, 1312, 1312, 1056, 1056, 1056
    .short 1056, 1056, 1310, 1310, 1310, 1054, 1054, 1054, 1054, 1054, 1308, 1308, 1308, 1052, 1052, 1052
    .short 1052, 1052, 1306, 1306, 1306, 1050, 1050, 1050, 1050, 1050, 1304, 1304, 1304, 1048, 1048, 1048
    .short 1048, 1048, 1302, 1302, 1302, 1046, 1046, 1046, 1046, 1046, 1300, 1300, 1300, 1044, 1044, 1044
    .short 1044, 1044, 1298, 1298, 1298, 1042, 1042, 1042, 1042, 1042, 1296, 1296, 1296, 1040, 1040, 1040
    .short 1040, 1040, 1294, 1294, 1294, 1038, 1038, 1038, 1038, 1038, 1292, 1292, 1292, 1036, 1036, 1036
    .short 1036, 1036, 1290, 1290, 1290, 1034, 1034, 1034, 1034, 1034, 1288, 1288, 1288, 1032, 1032, 1032
    .short 1032, 1032, 1286, 1286, 1286, 1030, 1030, 1030, 1030, 1030, 1284, 1284, 1284, 1028, 1028, 1028
    .short 1028, 1028, 1282, 1282, 1282, 1026, 1026, 1026, 1026, 1026, 1280, 1280, 1280, 1024, 1024, 1024
    .short 1024, 958, 830, 830, 830, 702, 574, 574, 574, 956, 828, 828, 828, 700, 572, 572
    .short 572, 954, 826, 826, 826, 698, 570, 570, 570, 952, 824, 824, 824, 696, 568, 568
    .short 568, 950, 822, 822, 822, 694, 566, 566, 566, 948, 820, 820, 820, 692, 564, 564
    .short 564, 946, 818, 818, 818, 690, 562, 562, 562, 944, 816, 816, 816, 688, 560, 560
    .short 560, 942, 814, 814, 814, 686, 558, 558, 558, 940, 812, 812, 812, 684, 556, 556
    .short 556, 938, 810, 810, 810, 682, 554, 554, 554, 936, 808, 808, 808, 680, 552, 552
    .short 552, 934, 806, 806, 806, 678, 550, 550, 550, 932, 804, 804, 804, 676, 548, 548
    .short 548, 930, 802, 802, 802, 674, 546, 546, 546, 928, 800, 800, 800, 672, 544, 544
    .short 544, 926, 798, 798, 798, 670, 542, 542, 542, 924, 796, 796, 796, 668, 540, 540
    .short 540, 922, 794, 794, 794, 666, 538, 538, 538, 920, 792, 792, 792, 664, 536, 536
    .short 536, 918, 790, 790, 790, 662, 534, 534, 534, 916, 788, 788, 788, 660, 532, 532
    .short 532, 914, 786, 786, 786, 658, 530, 530, 530, 912, 784, 784, 784, 656, 528, 528
    .short 528, 910, 782, 782, 782, 654, 526, 526, 526, 908, 780, 780, 780, 652, 524, 524
    .short 524, 906, 778, 778, 778, 650, 522, 522, 522, 904, 776, 776, 776, 648, 520, 520
    .short 520, 902, 774, 774, 774, 646, 518, 518, 518, 900, 772, 772, 772, 644, 516, 516
    .short 516, 898, 770, 770, 770, 642, 514, 514, 514, 896, 768, 768, 768, 640, 512, 512
    .short 510, 446, 382, 318, 254, 190, 126, 62, 508, 444, 380, 316, 252, 188, 124, 60
    .short 506, 442, 378, 314, 250, 186, 122, 58, 504, 440, 376, 312, 248, 184, 120, 56
    .short 502, 438, 374, 310, 246, 182, 118, 54, 500, 436, 372, 308, 244, 180, 116, 52
    .short 498, 434, 370, 306, 242, 178, 114, 50, 496, 432, 368, 304, 240, 176, 112, 48
    .short 494, 430, 366, 302, 238, 174, 110, 46, 492, 428, 364, 300, 236, 172, 108, 44
    .short 490, 426, 362, 298, 234, 170, 106, 42, 488, 424, 360, 296, 232, 168, 104, 40
    .short 486, 422, 358, 294, 230, 166, 102, 38, 484, 420, 356, 292, 228, 164, 100, 36
    .short 482, 418, 354, 290, 226, 162, 98, 34, 480, 416, 352, 288, 224, 160, 96, 32
    .short 478, 414, 350, 286, 222, 158, 94, 30, 476, 412, 348, 284, 220, 156, 92, 28
    .short 474, 410, 346, 282, 218, 154, 90, 26, 472, 408, 344, 280, 216, 152, 88, 24
    .short 470, 406, 342, 278, 214, 150, 86, 22, 468, 404, 340, 276, 212, 148, 84, 20
    .short 466, 402, 338, 274, 210, 146, 82, 18, 464, 400, 336, 272, 208, 144, 80, 16
    .short 462, 398, 334, 270, 206, 142, 78, 14, 460, 396, 332, 268, 204, 140, 76, 12
    .short 458, 394, 330, 266, 202, 138, 74, 10, 456, 392, 328, 264, 200, 136, 72, 8
    .short 454, 390, 326, 262, 198, 134, 70, 6, 452, 388, 324, 260, 196, 132, 68, 4
    .short 450, 386, 322, 258, 194, 130, 66, 2, 448, 384, 320, 256, 192, 128, 64, 0
.size gtab_k1_kernel, 4096
.globl k2_kernel
.p2align 8
.type k2_kernel,@function
k2_kernel:
    s_cmp_ge_u32 s2, 792
    s_cbranch_scc1 done_k2_kernel_1
    s_load_dwordx2 s[6:7], s[0:1], 128
    s_cmp_ge_u32 s2, 576
    s_cbranch_scc1 side_k2_kernel_2
    s_load_dwordx2 s[8:9], s[0:1], 64
    s_load_dwordx2 s[56:57], s[0:1], 88
    s_mov_b32 s16, 4
    s_mov_b32 s17, s2
    s_mov_b32 s79, 0
    s_and_b32 s14, s17, 0xfffffff0
    s_and_b32 s3, s17, 7
    s_lshl_b32 s3, s3, 1
    s_add_u32 s14, s14, s3
    s_bfe_u32 s3, s17, 0x10003
    s_add_u32 s14, s14, s3
    v_lshlrev_b32 v1, 4, v0
    v_add_u32 v22, s79, v1
    v_lshrrev_b32 v3, 6, v0
    v_lshrrev_b32 v20, 1, v0
    v_mul_u32_u24 v20, 36864, v20
    v_and_b32 v21, 1, v0
    v_lshl_add_u32 v20, v21, 4, v20
    s_lshl_b32 s3, s14, 6
    s_mul_i32 s4, s14, 4224
    s_lshl_b32 s5, s14, 1
    v_mov_b32 v4, s5
    v_readfirstlane_b32 s15, v3
    s_waitcnt lgkmcnt(0)
    s_add_u32 s28, s6, 0x5000000
    s_addc_u32 s29, s7, 0
    s_mov_b32 s30, 0x252000
    s_mov_b32 s31, 0x00020000
    buffer_load_dwordx4 v[8:11], v1, s[28:31], s4 offen
    buffer_load_dwordx4 v[12:15], v1, s[28:31], s4 offen offset:16
    s_add_u32 s32, s6, 0x4000000
    s_addc_u32 s33, s7, 0
    s_mov_b32 s34, 0x480000
    s_mov_b32 s35, 0x00020000
    buffer_load_dwordx4 v[24:27], v20, s[32:35], s3 offen
    buffer_load_dwordx4 v[16:19], v20, s[32:35], s3 offen offset:32
    s_mov_b32 s40, s8
    s_mov_b32 s41, s9
    s_mov_b32 s42, 0x480
    s_mov_b32 s43, 0x00020000
    buffer_load_ushort v36, v4, s[40:43], 0 offen
    s_add_u32 s44, s6, 0x4800000
    s_addc_u32 s45, s7, 0
    s_mov_b32 s46, 0x240000
    s_mov_b32 s47, 0x00020000
    v_mov_b32 v40, 0
    v_mov_b32 v41, 0
    v_mov_b32 v42, 0
    v_mov_b32 v43, 0
    v_cmp_gt_u32 vcc, 160, v0
    s_and_saveexec_b64 s[10:11], vcc
    ds_write_b128 v22, v[40:43] offset:33280
    s_mov_b64 exec, s[10:11]
    v_lshrrev_b32 v5, 2, v0
    v_mul_u32_u24 v5, 4160, v5
    v_and_b32 v6, 3, v0
    v_lshl_add_u32 v5, v6, 4, v5
    v_add_u32 v5, s79, v5
    v_cmp_gt_u32 vcc, 32, v0
    s_and_saveexec_b64 s[10:11], vcc
    ds_write_b128 v5, v[40:43] offset:4096
    s_mov_b64 exec, s[10:11]
    v_and_b32 v2, 15, v0
    v_bfe_u32 v3, v0, 4, 2
    v_and_b32 v5, 7, v2
    v_sub_u32 v5, 7, v5
    v_mul_u32_u24 v5, 4160, v5
    v_lshrrev_b32 v6, 3, v2
    v_sub_u32 v6, v3, v6
    v_add_u32 v6, 1, v6
    v_lshl_add_u32 v5, v6, 4, v5
    v_add_u32 v5, s79, v5
    v_mul_u32_u24 v6, 160, v2
    v_lshl_add_u32 v6, v3, 4, v6
    v_add_u32 v6, 33280, v6
    v_add_u32 v6, s79, v6
    v_lshrrev_b32 v7, 3, v0
    v_mul_u32_u24 v7, 160, v7
    v_and_b32 v21, 7, v0
    v_lshl_add_u32 v7, v21, 4, v7
    v_add_u32 v7, s79, v7
    s_waitcnt vmcnt(3)
    ds_write_b128 v22, v[8:11]
    ds_write_b128 v22, v[10:13] offset:16640
    v_mov_b32 v44, v9
    v_mov_b32 v45, v10
    v_mov_b32 v46, v11
    v_mov_b32 v47, v12
    v_mov_b32 v48, v13
    v_mov_b32 v49, v14
    ds_write_b128 v22, v[44:47] offset:8320
    ds_write_b128 v22, v[46:49] offset:24960
    v_alignbit_b32 v52, v9, v8, 16
    v_alignbit_b32 v53, v10, v9, 16
    v_alignbit_b32 v54, v11, v10, 16
    v_alignbit_b32 v55, v12, v11, 16
    v_alignbit_b32 v56, v13, v12, 16
    v_alignbit_b32 v57, v14, v13, 16
    ds_write_b128 v22, v[52:55] offset:4160
    ds_write_b128 v22, v[54:57] offset:20800
    v_alignbit_b32 v60, v10, v9, 16
    v_alignbit_b32 v61, v11, v10, 16
    v_alignbit_b32 v62, v12, v11, 16
    v_alignbit_b32 v63, v13, v12, 16
    v_alignbit_b32 v64, v14, v13, 16
    v_alignbit_b32 v65, v15, v14, 16
    ds_write_b128 v22, v[60:63] offset:12480
    ds_write_b128 v22, v[62:65] offset:29120
    s_waitcnt vmcnt(2)
    ds_write_b128 v7, v[24:27] offset:35840
    s_waitcnt vmcnt(0)
    s_add_u32 s48, s6, 0x1400000
    s_addc_u32 s49, s7, 0
    s_mov_b32 s50, 0x510000
    s_mov_b32 s51, 0x00020000
    s_lshr_b32 s10, s2, 3
    s_mul_i32 s10, s10, 9216
    s_add_u32 s10, s10, 2654208
    s_and_b32 s11, s2, 3
    s_mul_i32 s11, s11, 663552
    s_add_u32 s10, s10, s11
    v_lshlrev_b32 v109, 7, v0
    s_cmp_lt_u32 s2, 576
    s_cselect_b32 s11, 72, 0
    v_cmp_gt_u32 vcc, s11, v0
    s_and_saveexec_b64 s[12:13], vcc
    s_cbranch_execz nw_k2_kernel_3
    buffer_load_dword v110, v109, s[48:51], s10 offen
nw_k2_kernel_3:
    s_mov_b64 exec, s[12:13]
    v_lshlrev_b32 v36, 16, v36
    v_lshlrev_b32 v68, 16, v24
    v_and_b32 v69, 0xffff0000, v24
    v_lshlrev_b32 v70, 16, v25
    v_and_b32 v71, 0xffff0000, v25
    v_lshlrev_b32 v72, 16, v26
    v_and_b32 v73, 0xffff0000, v26
    v_lshlrev_b32 v74, 16, v27
    v_and_b32 v75, 0xffff0000, v27
    v_mul_f32 v68, v68, v36
    v_mul_f32 v69, v69, v36
    v_mul_f32 v70, v70, v36
    v_mul_f32 v71, v71, v36
    v_mul_f32 v72, v72, v36
    v_mul_f32 v73, v73, v36
    v_mul_f32 v74, v74, v36
    v_mul_f32 v75, v75, v36
    v_cvt_pk_bf16_f32 v104, v68, v69
    v_cvt_pk_bf16_f32 v105, v70, v71
    v_cvt_pk_bf16_f32 v106, v72, v73
    v_cvt_pk_bf16_f32 v107, v74, v75
    v_lshlrev_b32 v96, 16, v16
    v_and_b32 v97, 0xffff0000, v16
    v_lshlrev_b32 v98, 16, v17
    v_and_b32 v99, 0xffff0000, v17
    v_lshlrev_b32 v100, 16, v18
    v_and_b32 v101, 0xffff0000, v18
    v_lshlrev_b32 v102, 16, v19
    v_and_b32 v103, 0xffff0000, v19
    s_waitcnt lgkmcnt(0)
    s_barrier
    s_cmp_eq_u32 s15, 1
    s_cbranch_scc1 cw_k2_kernel_5
    s_cmp_eq_u32 s15, 2
    s_cbranch_scc1 cw_k2_kernel_6
    s_cmp_eq_u32 s15, 3
    s_cbranch_scc1 cw_k2_kernel_7
cw_k2_kernel_4:
    ds_read_b128 v[72:75], v6 offset:2624
    ds_read_b128 v[76:79], v6 offset:5184
    ds_read_b128 v[40:43], v5 offset:4064
    ds_read_b128 v[44:47], v5 offset:4032
    ds_read_b128 v[80:83], v6 offset:2560
    ds_read_b128 v[84:87], v6 offset:5120
    ds_read_b128 v[48:51], v5 offset:4000
    ds_read_b128 v[52:55], v5 offset:3968
    s_waitcnt lgkmcnt(4)
    v_mfma_f32_16x16x32_bf16 v[24:27], v[40:43], v[72:75], 0
    ds_read_b128 v[88:91], v6 offset:2464
    v_mfma_f32_16x16x32_bf16 v[28:31], v[40:43], v[76:79], 0
    ds_read_b128 v[92:95], v6 offset:5024
    v_mfma_f32_16x16x32_bf16 v[32:35], v[44:47], v[72:75], 0
    ds_read_b128 v[56:59], v5 offset:3936
    v_mfma_f32_16x16x32_bf16 v[36:39], v[44:47], v[76:79], 0
    ds_read_b128 v[60:63], v5 offset:3904
    s_waitcnt lgkmcnt(4)
    v_mfma_f32_16x16x32_bf16 v[8:11], v[40:43], v[80:83], 0
    ds_read_b128 v[72:75], v6 offset:2400
    v_mfma_f32_16x16x32_bf16 v[12:15], v[40:43], v[84:87], 0
    ds_read_b128 v[76:79], v6 offset:4960
    v_mfma_f32_16x16x32_bf16 v[16:19], v[44:47], v[80:83], 0
    ds_read_b128 v[64:67], v5 offset:3872
    v_mfma_f32_16x16x32_bf16 v[20:23], v[44:47], v[84:87], 0
    ds_read_b128 v[68:71], v5 offset:3840
    v_mfma_f32_16x16x32_bf16 v[24:27], v[48:51], v[80:83], v[24:27]
    v_mfma_f32_16x16x32_bf16 v[28:31], v[48:51], v[84:87], v[28:31]
    v_mfma_f32_16x16x32_bf16 v[32:35], v[52:55], v[80:83], v[32:35]
    v_mfma_f32_16x16x32_bf16 v[36:39], v[52:55], v[84:87], v[36:39]
    s_waitcnt lgkmcnt(4)
    v_mfma_f32_16x16x32_bf16 v[8:11], v[48:51], v[88:91], v[8:11]
    ds_read_b128 v[80:83], v6 offset:2304
    v_mfma_f32_16x16x32_bf16 v[12:15], v[48:51], v[92:95], v[12:15]
    ds_read_b128 v[84:87], v6 offset:4864
    v_mfma_f32_16x16x32_bf16 v[16:19], v[52:55], v[88:91], v[16:19]
    ds_read_b128 v[40:43], v5 offset:3808
    v_mfma_f32_16x16x32_bf16 v[20:23], v[52:55], v[92:95], v[20:23]
    ds_read_b128 v[44:47], v5 offset:3776
    v_mfma_f32_16x16x32_bf16 v[24:27], v[56:59], v[88:91], v[24:27]
    v_mfma_f32_16x16x32_bf16 v[28:31], v[56:59], v[92:95], v[28:31]
    v_mfma_f32_16x16x32_bf16 v[32:35], v[60:63], v[88:91], v[32:35]
    v_mfma_f32_16x16x32_bf16 v[36:39], v[60:63], v[92:95], v[36:39]
    s_waitcnt lgkmcnt(4)
    v_mfma_f32_16x16x32_bf16 v[8:11], v[56:59], v[72:75], v[8:11]
    ds_read_b128 v[88:91], v6 offset:2240
    v_mfma_f32_16x16x32_bf16 v[12:15], v[56:59], v[76:79], v[12:15]
    ds_read_b128 v[92:95], v6 offset:4800
    v_mfma_f32_16x16x32_bf16 v[16:19], v[60:63], v[72:75], v[16:19]
    ds_read_b128 v[48:51], v5 offset:3744
    v_mfma_f32_16x16x32_bf16 v[20:23], v[60:63], v[76:79], v[20:23]
    ds_read_b128 v[52:55], v5 offset:3712
    v_mfma_f32_16x16x32_bf16 v[24:27], v[64:67], v[72:75], v[24:27]
    v_mfma_f32_16x16x32_bf16 v[28:31], v[64:67], v[76:79], v[28:31]
    v_mfma_f32_16x16x32_bf16 v[32:35], v[68:71], v[72:75], v[32:35]
    v_mfma_f32_16x16x32_bf16 v[36:39], v[68:71], v[76:79], v[36:39]
    s_waitcnt lgkmcnt(4)
    v_mfma_f32_16x16x32_bf16 v[8:11], v[64:67], v[80:83], v[8:11]
    ds_read_b128 v[72:75], v6 offset:2144
    v_mfma_f32_16x16x32_bf16 v[12:15], v[64:67], v[84:87], v[12:15]
    ds_read_b128 v[76:79], v6 offset:4704
    v_mfma_f32_16x16x32_bf16 v[16:19], v[68:71], v[80:83], v[16:19]
    ds_read_b128 v[56:59], v5 offset:3680
    v_mfma_f32_16x16x32_bf16 v[20:23], v[68:71], v[84:87], v[20:23]
    ds_read_b128 v[60:63], v5 offset:3648
    v_mfma_f32_16x16x32_bf16 v[24:27], v[40:43], v[80:83], v[24:27]
    v_mfma_f32_16x16x32_bf16 v[28:31], v[40:43], v[84:87], v[28:31]
    v_mfma_f32_16x16x32_bf16 v[32:35], v[44:47], v[80:83], v[32:35]
    v_mfma_f32_16x16x32_bf16 v[36:39], v[44:47], v[84:87], v[36:39]
    s_waitcnt lgkmcnt(4)
    v_mfma_f32_16x16x32_bf16 v[8:11], v[40:43], v[88:91], v[8:11]
    ds_read_b128 v[80:83], v6 offset:2080
    v_mfma_f32_16x16x32_bf16 v[12:15], v[40:43], v[92:95], v[12:15]
    ds_read_b128 v[84:87], v6 offset:4640
    v_mfma_f32_16x16x32_bf16 v[16:19], v[44:47], v[88:91], v[16:19]
    ds_read_b128 v[64:67], v5 offset:3616
    v_mfma_f32_16x16x32_bf16 v[20:23], v[44:47], v[92:95], v[20:23]
    ds_read_b128 v[68:71], v5 offset:3584
    v_mfma_f32_16x16x32_bf16 v[24:27], v[48:51], v[88:91], v[24:27]
    v_mfma_f32_16x16x32_bf16 v[28:31], v[48:51], v[92:95], v[28:31]
    v_mfma_f32_16x16x32_bf16 v[32:35], v[52:55], v[88:91], v[32:35]
    v_mfma_f32_16x16x32_bf16 v[36:39], v[52:55], v[92:95], v[36:39]
    s_waitcnt lgkmcnt(4)
    v_mfma_f32_16x16x32_bf16 v[8:11], v[48:51], v[72:75], v[8:11]
    ds_read_b128 v[88:91], v6 offset:1984
    v_mfma_f32_16x16x32_bf16 v[12:15], v[48:51], v[76:79], v[12:15]
    ds_read_b128 v[92:95], v6 offset:4544
    v_mfma_f32_16x16x32_bf16 v[16:19], v[52:55], v[72:75], v[16:19]
    ds_read_b128 v[40:43], v5 offset:3552
    v_mfma_f32_16x16x32_bf16 v[20:23], v[52:55], v[76:79], v[20:23]
    ds_read_b128 v[44:47], v5 offset:3520
    v_mfma_f32_16x16x32_bf16 v[24:27], v[56:59], v[72:75], v[24:27]
    v_mfma_f32_16x16x32_bf16 v[28:31], v[56:59], v[76:79], v[28:31]
    v_mfma_f32_16x16x32_bf16 v[32:35], v[60:63], v[72:75], v[32:35]
    v_mfma_f32_16x16x32_bf16 v[36:39], v[60:63], v[76:79], v[36:39]
    s_waitcnt lgkmcnt(4)
    v_mfma_f32_16x16x32_bf16 v[8:11], v[56:59], v[80:83], v[8:11]
    ds_read_b128 v[72:75], v6 offset:1920
    v_mfma_f32_16x16x32_bf16 v[12:15], v[56:59], v[84:87], v[12:15]
    ds_read_b128 v[76:79], v6 offset:4480
    v_mfma_f32_16x16x32_bf16 v[16:19], v[60:63], v[80:83], v[16:19]
    ds_read_b128 v[48:51], v5 offset:3488
    v_mfma_f32_16x16x32_bf16 v[20:23], v[60:63], v[84:87], v[20:23]
    ds_read_b128 v[52:55], v5 offset:3456
    v_mfma_f32_16x16x32_bf16 v[24:27], v[64:67], v[80:83], v[24:27]
    v_mfma_f32_16x16x32_bf16 v[28:31], v[64:67], v[84:87], v[28:31]
    v_mfma_f32_16x16x32_bf16 v[32:35], v[68:71], v[80:83], v[32:35]
    v_mfma_f32_16x16x32_bf16 v[36:39], v[68:71], v[84:87], v[36:39]
    s_waitcnt lgkmcnt(4)
    v_mfma_f32_16x16x32_bf16 v[8:11], v[64:67], v[88:91], v[8:11]
    ds_read_b128 v[80:83], v6 offset:1824
    v_mfma_f32_16x16x32_bf16 v[12:15], v[64:67], v[92:95], v[12:15]
    ds_read_b128 v[84:87], v6 offset:4384
    v_mfma_f32_16x16x32_bf16 v[16:19], v[68:71], v[88:91], v[16:19]
    ds_read_b128 v[56:59], v5 offset:3424
    v_mfma_f32_16x16x32_bf16 v[20:23], v[68:71], v[92:95], v[20:23]
    ds_read_b128 v[60:63], v5 offset:3392
    v_mfma_f32_16x16x32_bf16 v[24:27], v[40:43], v[88:91], v[24:27]
    v_mfma_f32_16x16x32_bf16 v[28:31], v[40:43], v[92:95], v[28:31]
    v_mfma_f32_16x16x32_bf16 v[32:35], v[44:47], v[88:91], v[32:35]
    v_mfma_f32_16x16x32_bf16 v[36:39], v[44:47], v[92:95], v[36:39]
    s_waitcnt lgkmcnt(4)
    v_mfma_f32_16x16x32_bf16 v[8:11], v[40:43], v[72:75], v[8:11]
    ds_read_b128 v[88:91], v6 offset:1760
    v_mfma_f32_16x16x32_bf16 v[12:15], v[40:43], v[76:79], v[12:15]
    ds_read_b128 v[92:95], v6 offset:4320
    v_mfma_f32_16x16x32_bf16 v[16:19], v[44:47], v[72:75], v[16:19]
    ds_read_b128 v[64:67], v5 offset:3360
    v_mfma_f32_16x16x32_bf16 v[20:23], v[44:47], v[76:79], v[20:23]
    ds_read_b128 v[68:71], v5 offset:3328
    v_mfma_f32_16x16x32_bf16 v[24:27], v[48:51], v[72:75], v[24:27]
    v_mfma_f32_16x16x32_bf16 v[28:31], v[48:51], v[76:79], v[28:31]
    v_mfma_f32_16x16x32_bf16 v[32:35], v[52:55], v[72:75], v[32:35]
    v_mfma_f32_16x16x32_bf16 v[36:39], v[52:55], v[76:79], v[36:39]
    s_waitcnt lgkmcnt(4)
    v_mfma_f32_16x16x32_bf16 v[8:11], v[48:51], v[80:83], v[8:11]
    v_mfma_f32_16x16x32_bf16 v[12:15], v[48:51], v[84:87], v[12:15]
    v_mfma_f32_16x16x32_bf16 v[16:19], v[52:55], v[80:83], v[16:19]
    v_mfma_f32_16x16x32_bf16 v[20:23], v[52:55], v[84:87], v[20:23]
    v_mfma_f32_16x16x32_bf16 v[24:27], v[56:59], v[80:83], v[24:27]
    v_mfma_f32_16x16x32_bf16 v[28:31], v[56:59], v[84:87], v[28:31]
    v_mfma_f32_16x16x32_bf16 v[32:35], v[60:63], v[80:83], v[32:35]
    v_mfma_f32_16x16x32_bf16 v[36:39], v[60:63], v[84:87], v[36:39]
    s_waitcnt lgkmcnt(0)
    v_mfma_f32_16x16x32_bf16 v[8:11], v[56:59], v[88:91], v[8:11]
    v_mfma_f32_16x16x32_bf16 v[12:15], v[56:59], v[92:95], v[12:15]
    v_mfma_f32_16x16x32_bf16 v[16:19], v[60:63], v[88:91], v[16:19]
    v_mfma_f32_16x16x32_bf16 v[20:23], v[60:63], v[92:95], v[20:23]
    v_mfma_f32_16x16x32_bf16 v[24:27], v[64:67], v[88:91], v[24:27]
    v_mfma_f32_16x16x32_bf16 v[28:31], v[64:67], v[92:95], v[28:31]
    v_mfma_f32_16x16x32_bf16 v[32:35], v[68:71], v[88:91], v[32:35]
    v_mfma_f32_16x16x32_bf16 v[36:39], v[68:71], v[92:95], v[36:39]
    v_mul_u32_u24 v7, 272, v2
    v_lshl_add_u32 v7, v3, 4, v7
    v_add_u32 v7, s79, v7
    s_barrier
    s_nop 7
    ds_write_b128 v7, v[8:11] offset:0
    ds_write_b128 v7, v[12:15] offset:4352
    ds_write_b128 v7, v[16:19] offset:64
    ds_write_b128 v7, v[20:23] offset:4416
    ds_write_b128 v7, v[24:27] offset:128
    ds_write_b128 v7, v[28:31] offset:4480
    ds_write_b128 v7, v[32:35] offset:192
    ds_write_b128 v7, v[36:39] offset:4544
    s_branch cj_k2_kernel_8
cw_k2_kernel_5:
    ds_read_b128 v[72:75], v6 offset:1664
    ds_read_b128 v[76:79], v6 offset:4224
    ds_read_b128 v[64:67], v5 offset:3360
    ds_read_b128 v[68:71], v5 offset:3328
    ds_read_b128 v[40:43], v5 offset:3296
    ds_read_b128 v[44:47], v5 offset:3264
    ds_read_b128 v[80:83], v6 offset:1600
    ds_read_b128 v[84:87], v6 offset:4160
    ds_read_b128 v[48:51], v5 offset:3232
    ds_read_b128 v[52:55], v5 offset:3200
    s_waitcnt lgkmcnt(4)
    v_mfma_f32_16x16x32_bf16 v[8:11], v[64:67], v[72:75], 0
    ds_read_b128 v[88:91], v6 offset:1504
    v_mfma_f32_16x16x32_bf16 v[12:15], v[64:67], v[76:79], 0
    ds_read_b128 v[92:95], v6 offset:4064
    v_mfma_f32_16x16x32_bf16 v[16:19], v[68:71], v[72:75], 0
    ds_read_b128 v[56:59], v5 offset:3168
    v_mfma_f32_16x16x32_bf16 v[20:23], v[68:71], v[76:79], 0
    ds_read_b128 v[60:63], v5 offset:3136
    v_mfma_f32_16x16x32_bf16 v[24:27], v[40:43], v[72:75], 0
    v_mfma_f32_16x16x32_bf16 v[28:31], v[40:43], v[76:79], 0
    v_mfma_f32_16x16x32_bf16 v[32:35], v[44:47], v[72:75], 0
    v_mfma_f32_16x16x32_bf16 v[36:39], v[44:47], v[76:79], 0
    s_waitcnt lgkmcnt(4)
    v_mfma_f32_16x16x32_bf16 v[8:11], v[40:43], v[80:83], v[8:11]
    ds_read_b128 v[72:75], v6 offset:1440
    v_mfma_f32_16x16x32_bf16 v[12:15], v[40:43], v[84:87], v[12:15]
    ds_read_b128 v[76:79], v6 offset:4000
    v_mfma_f32_16x16x32_bf16 v[16:19], v[44:47], v[80:83], v[16:19]
    ds_read_b128 v[64:67], v5 offset:3104
    v_mfma_f32_16x16x32_bf16 v[20:23], v[44:47], v[84:87], v[20:23]
    ds_read_b128 v[68:71], v5 offset:3072
    v_mfma_f32_16x16x32_bf16 v[24:27], v[48:51], v[80:83], v[24:27]
    v_mfma_f32_16x16x32_bf16 v[28:31], v[48:51], v[84:87], v[28:31]
    v_mfma_f32_16x16x32_bf16 v[32:35], v[52:55], v[80:83], v[32:35]
    v_mfma_f32_16x16x32_bf16 v[36:39], v[52:55], v[84:87], v[36:39]
    s_waitcnt lgkmcnt(4)
    v_mfma_f32_16x16x32_bf16 v[8:11], v[48:51], v[88:91], v[8:11]
    ds_read_b128 v[80:83], v6 offset:1344
    v_mfma_f32_16x16x32_bf16 v[12:15], v[48:51], v[92:95], v[12:15]
    ds_read_b128 v[84:87], v6 offset:3904
    v_mfma_f32_16x16x32_bf16 v[16:19], v[52:55], v[88:91], v[16:19]
    ds_read_b128 v[40:43], v5 offset:3040
    v_mfma_f32_16x16x32_bf16 v[20:23], v[52:55], v[92:95], v[20:23]
    ds_read_b128 v[44:47], v5 offset:3008
    v_mfma_f32_16x16x32_bf16 v[24:27], v[56:59], v[88:91], v[24:27]
    v_mfma_f32_16x16x32_bf16 v[28:31], v[56:59], v[92:95], v[28:31]
    v_mfma_f32_16x16x32_bf16 v[32:35], v[60:63], v[88:91], v[32:35]
    v_mfma_f32_16x16x32_bf16 v[36:39], v[60:63], v[92:95], v[36:39]
    s_waitcnt lgkmcnt(4)
    v_mfma_f32_16x16x32_bf16 v[8:11], v[56:59], v[72:75], v[8:11]
    ds_read_b128 v[88:91], v6 offset:1280
    v_mfma_f32_16x16x32_bf16 v[12:15], v[56:59], v[76:79], v[12:15]
    ds_read_b128 v[92:95], v6 offset:3840
    v_mfma_f32_16x16x32_bf16 v[16:19], v[60:63], v[72:75], v[16:19]
    ds_read_b128 v[48:51], v5 offset:2976
    v_mfma_f32_16x16x32_bf16 v[20:23], v[60:63], v[76:79], v[20:23]
    ds_read_b128 v[52:55], v5 offset:2944
    v_mfma_f32_16x16x32_bf16 v[24:27], v[64:67], v[72:75], v[24:27]
    v_mfma_f32_16x16x32_bf16 v[28:31], v[64:67], v[76:79], v[28:31]
    v_mfma_f32_16x16x32_bf16 v[32:35], v[68:71], v[72:75], v[32:35]
    v_mfma_f32_16x16x32_bf16 v[36:39], v[68:71], v[76:79], v[36:39]
    s_waitcnt lgkmcnt(4)
    v_mfma_f32_16x16x32_bf16 v[8:11], v[64:67], v[80:83], v[8:11]
    ds_read_b128 v[72:75], v6 offset:1184
    v_mfma_f32_16x16x32_bf16 v[12:15], v[64:67], v[84:87], v[12:15]
    ds_read_b128 v[76:79], v6 offset:3744
    v_mfma_f32_16x16x32_bf16 v[16:19], v[68:71], v[80:83], v[16:19]
    ds_read_b128 v[56:59], v5 offset:2912
    v_mfma_f32_16x16x32_bf16 v[20:23], v[68:71], v[84:87], v[20:23]
    ds_read_b128 v[60:63], v5 offset:2880
    v_mfma_f32_16x16x32_bf16 v[24:27], v[40:43], v[80:83], v[24:27]
    v_mfma_f32_16x16x32_bf16 v[28:31], v[40:43], v[84:87], v[28:31]
    v_mfma_f32_16x16x32_bf16 v[32:35], v[44:47], v[80:83], v[32:35]
    v_mfma_f32_16x16x32_bf16 v[36:39], v[44:47], v[84:87], v[36:39]
    s_waitcnt lgkmcnt(4)
    v_mfma_f32_16x16x32_bf16 v[8:11], v[40:43], v[88:91], v[8:11]
    ds_read_b128 v[80:83], v6 offset:1120
    v_mfma_f32_16x16x32_bf16 v[12:15], v[40:43], v[92:95], v[12:15]
    ds_read_b128 v[84:87], v6 offset:3680
    v_mfma_f32_16x16x32_bf16 v[16:19], v[44:47], v[88:91], v[16:19]
    ds_read_b128 v[64:67], v5 offset:2848
    v_mfma_f32_16x16x32_bf16 v[20:23], v[44:47], v[92:95], v[20:23]
    ds_read_b128 v[68:71], v5 offset:2816
    v_mfma_f32_16x16x32_bf16 v[24:27], v[48:51], v[88:91], v[24:27]
    v_mfma_f32_16x16x32_bf16 v[28:31], v[48:51], v[92:95], v[28:31]
    v_mfma_f32_16x16x32_bf16 v[32:35], v[52:55], v[88:91], v[32:35]
    v_mfma_f32_16x16x32_bf16 v[36:39], v[52:55], v[92:95], v[36:39]
    s_waitcnt lgkmcnt(4)
    v_mfma_f32_16x16x32_bf16 v[8:11], v[48:51], v[72:75], v[8:11]
    ds_read_b128 v[88:91], v6 offset:1024
    v_mfma_f32_16x16x32_bf16 v[12:15], v[48:51], v[76:79], v[12:15]
    ds_read_b128 v[92:95], v6 offset:3584
    v_mfma_f32_16x16x32_bf16 v[16:19], v[52:55], v[72:75], v[16:19]
    ds_read_b128 v[40:43], v5 offset:2784
    v_mfma_f32_16x16x32_bf16 v[20:23], v[52:55], v[76:79], v[20:23]
    ds_read_b128 v[44:47], v5 offset:2752
    v_mfma_f32_16x16x32_bf16 v[24:27], v[56:59], v[72:75], v[24:27]
    v_mfma_f32_16x16x32_bf16 v[28:31], v[56:59], v[76:79], v[28:31]
    v_mfma_f32_16x16x32_bf16 v[32:35], v[60:63], v[72:75], v[32:35]
    v_mfma_f32_16x16x32_bf16 v[36:39], v[60:63], v[76:79], v[36:39]
    s_waitcnt lgkmcnt(4)
    v_mfma_f32_16x16x32_bf16 v[8:11], v[56:59], v[80:83], v[8:11]
    ds_read_b128 v[72:75], v6 offset:960
    v_mfma_f32_16x16x32_bf16 v[12:15], v[56:59], v[84:87], v[12:15]
    ds_read_b128 v[76:79], v6 offset:3520
    v_mfma_f32_16x16x32_bf16 v[16:19], v[60:63], v[80:83], v[16:19]
    ds_read_b128 v[48:51], v5 offset:2720
    v_mfma_f32_16x16x32_bf16 v[20:23], v[60:63], v[84:87], v[20:23]
    ds_read_b128 v[52:55], v5 offset:2688
    v_mfma_f32_16x16x32_bf16 v[24:27], v[64:67], v[80:83], v[24:27]
    v_mfma_f32_16x16x32_bf16 v[28:31], v[64:67], v[84:87], v[28:31]
    v_mfma_f32_16x16x32_bf16 v[32:35], v[68:71], v[80:83], v[32:35]
    v_mfma_f32_16x16x32_bf16 v[36:39], v[68:71], v[84:87], v[36:39]
    s_waitcnt lgkmcnt(4)
    v_mfma_f32_16x16x32_bf16 v[8:11], v[64:67], v[88:91], v[8:11]
    ds_read_b128 v[80:83], v6 offset:864
    v_mfma_f32_16x16x32_bf16 v[12:15], v[64:67], v[92:95], v[12:15]
    ds_read_b128 v[84:87], v6 offset:3424
    v_mfma_f32_16x16x32_bf16 v[16:19], v[68:71], v[88:91], v[16:19]
    ds_read_b128 v[56:59], v5 offset:2656
    v_mfma_f32_16x16x32_bf16 v[20:23], v[68:71], v[92:95], v[20:23]
    ds_read_b128 v[60:63], v5 offset:2624
    v_mfma_f32_16x16x32_bf16 v[24:27], v[40:43], v[88:91], v[24:27]
    v_mfma_f32_16x16x32_bf16 v[28:31], v[40:43], v[92:95], v[28:31]
    v_mfma_f32_16x16x32_bf16 v[32:35], v[44:47], v[88:91], v[32:35]
    v_mfma_f32_16x16x32_bf16 v[36:39], v[44:47], v[92:95], v[36:39]
    s_waitcnt lgkmcnt(4)
    v_mfma_f32_16x16x32_bf16 v[8:11], v[40:43], v[72:75], v[8:11]
    ds_read_b128 v[88:91], v6 offset:800
    v_mfma_f32_16x16x32_bf16 v[12:15], v[40:43], v[76:79], v[12:15]
    ds_read_b128 v[92:95], v6 offset:3360
    v_mfma_f32_16x16x32_bf16 v[16:19], v[44:47], v[72:75], v[16:19]
    ds_read_b128 v[64:67], v5 offset:2592
    v_mfma_f32_16x16x32_bf16 v[20:23], v[44:47], v[76:79], v[20:23]
    ds_read_b128 v[68:71], v5 offset:2560
    v_mfma_f32_16x16x32_bf16 v[24:27], v[48:51], v[72:75], v[24:27]
    v_mfma_f32_16x16x32_bf16 v[28:31], v[48:51], v[76:79], v[28:31]
    v_mfma_f32_16x16x32_bf16 v[32:35], v[52:55], v[72:75], v[32:35]
    v_mfma_f32_16x16x32_bf16 v[36:39], v[52:55], v[76:79], v[36:39]
    s_waitcnt lgkmcnt(4)
    v_mfma_f32_16x16x32_bf16 v[8:11], v[48:51], v[80:83], v[8:11]
    v_mfma_f32_16x16x32_bf16 v[12:15], v[48:51], v[84:87], v[12:15]
    v_mfma_f32_16x16x32_bf16 v[16:19], v[52:55], v[80:83], v[16:19]
    v_mfma_f32_16x16x32_bf16 v[20:23], v[52:55], v[84:87], v[20:23]
    v_mfma_f32_16x16x32_bf16 v[24:27], v[56:59], v[80:83], v[24:27]
    v_mfma_f32_16x16x32_bf16 v[28:31], v[56:59], v[84:87], v[28:31]
    v_mfma_f32_16x16x32_bf16 v[32:35], v[60:63], v[80:83], v[32:35]
    v_mfma_f32_16x16x32_bf16 v[36:39], v[60:63], v[84:87], v[36:39]
    s_waitcnt lgkmcnt(0)
    v_mfma_f32_16x16x32_bf16 v[8:11], v[56:59], v[88:91], v[8:11]
    v_mfma_f32_16x16x32_bf16 v[12:15], v[56:59], v[92:95], v[12:15]
    v_mfma_f32_16x16x32_bf16 v[16:19], v[60:63], v[88:91], v[16:19]
    v_mfma_f32_16x16x32_bf16 v[20:23], v[60:63], v[92:95], v[20:23]
    v_mfma_f32_16x16x32_bf16 v[24:27], v[64:67], v[88:91], v[24:27]
    v_mfma_f32_16x16x32_bf16 v[28:31], v[64:67], v[92:95], v[28:31]
    v_mfma_f32_16x16x32_bf16 v[32:35], v[68:71], v[88:91], v[32:35]
    v_mfma_f32_16x16x32_bf16 v[36:39], v[68:71], v[92:95], v[36:39]
    v_mul_u32_u24 v7, 272, v2
    v_lshl_add_u32 v7, v3, 4, v7
    v_add_u32 v7, s79, v7
    s_barrier
    s_nop 7
    ds_write_b128 v7, v[8:11] offset:8704
    ds_write_b128 v7, v[12:15] offset:13056
    ds_write_b128 v7, v[16:19] offset:8768
    ds_write_b128 v7, v[20:23] offset:13120
    ds_write_b128 v7, v[24:27] offset:8832
    ds_write_b128 v7, v[28:31] offset:13184
    ds_write_b128 v7, v[32:35] offset:8896
    ds_write_b128 v7, v[36:39] offset:13248
    s_branch cj_k2_kernel_8
cw_k2_kernel_6:
    ds_read_b128 v[72:75], v6 offset:704
    ds_read_b128 v[76:79], v6 offset:3264
    ds_read_b128 v[64:67], v5 offset:2592
    ds_read_b128 v[68:71], v5 offset:2560
    ds_read_b128 v[40:43], v5 offset:2528
    ds_read_b128 v[44:47], v5 offset:2496
    ds_read_b128 v[80:83], v6 offset:640
    ds_read_b128 v[84:87], v6 offset:3200
    ds_read_b128 v[48:51], v5 offset:2464
    ds_read_b128 v[52:55], v5 offset:2432
    s_waitcnt lgkmcnt(4)
    v_mfma_f32_16x16x32_bf16 v[8:11], v[64:67], v[72:75], 0
    ds_read_b128 v[88:91], v6 offset:544
    v_mfma_f32_16x16x32_bf16 v[12:15], v[64:67], v[76:79], 0
    ds_read_b128 v[92:95], v6 offset:3104
    v_mfma_f32_16x16x32_bf16 v[16:19], v[68:71], v[72:75], 0
    ds_read_b128 v[56:59], v5 offset:2400
    v_mfma_f32_16x16x32_bf16 v[20:23], v[68:71], v[76:79], 0
    ds_read_b128 v[60:63], v5 offset:2368
    v_mfma_f32_16x16x32_bf16 v[24:27], v[40:43], v[72:75], 0
    v_mfma_f32_16x16x32_bf16 v[28:31], v[40:43], v[76:79], 0
    v_mfma_f32_16x16x32_bf16 v[32:35], v[44:47], v[72:75], 0
    v_mfma_f32_16x16x32_bf16 v[36:39], v[44:47], v[76:79], 0
    s_waitcnt lgkmcnt(4)
    v_mfma_f32_16x16x32_bf16 v[8:11], v[40:43], v[80:83], v[8:11]
    ds_read_b128 v[72:75], v6 offset:480
    v_mfma_f32_16x16x32_bf16 v[12:15], v[40:43], v[84:87], v[12:15]
    ds_read_b128 v[76:79], v6 offset:3040
    v_mfma_f32_16x16x32_bf16 v[16:19], v[44:47], v[80:83], v[16:19]
    ds_read_b128 v[64:67], v5 offset:2336
    v_mfma_f32_16x16x32_bf16 v[20:23], v[44:47], v[84:87], v[20:23]
    ds_read_b128 v[68:71], v5 offset:2304
    v_mfma_f32_16x16x32_bf16 v[24:27], v[48:51], v[80:83], v[24:27]
    v_mfma_f32_16x16x32_bf16 v[28:31], v[48:51], v[84:87], v[28:31]
    v_mfma_f32_16x16x32_bf16 v[32:35], v[52:55], v[80:83], v[32:35]
    v_mfma_f32_16x16x32_bf16 v[36:39], v[52:55], v[84:87], v[36:39]
    s_waitcnt lgkmcnt(4)
    v_mfma_f32_16x16x32_bf16 v[8:11], v[48:51], v[88:91], v[8:11]
    ds_read_b128 v[80:83], v6 offset:384
    v_mfma_f32_16x16x32_bf16 v[12:15], v[48:51], v[92:95], v[12:15]
    ds_read_b128 v[84:87], v6 offset:2944
    v_mfma_f32_16x16x32_bf16 v[16:19], v[52:55], v[88:91], v[16:19]
    ds_read_b128 v[40:43], v5 offset:2272
    v_mfma_f32_16x16x32_bf16 v[20:23], v[52:55], v[92:95], v[20:23]
    ds_read_b128 v[44:47], v5 offset:2240
    v_mfma_f32_16x16x32_bf16 v[24:27], v[56:59], v[88:91], v[24:27]
    v_mfma_f32_16x16x32_bf16 v[28:31], v[56:59], v[92:95], v[28:31]
    v_mfma_f32_16x16x32_bf16 v[32:35], v[60:63], v[88:91], v[32:35]
    v_mfma_f32_16x16x32_bf16 v[36:39], v[60:63], v[92:95], v[36:39]
    s_waitcnt lgkmcnt(4)
    v_mfma_f32_16x16x32_bf16 v[8:11], v[56:59], v[72:75], v[8:11]
    ds_read_b128 v[88:91], v6 offset:320
    v_mfma_f32_16x16x32_bf16 v[12:15], v[56:59], v[76:79], v[12:15]
    ds_read_b128 v[92:95], v6 offset:2880
    v_mfma_f32_16x16x32_bf16 v[16:19], v[60:63], v[72:75], v[16:19]
    ds_read_b128 v[48:51], v5 offset:2208
    v_mfma_f32_16x16x32_bf16 v[20:23], v[60:63], v[76:79], v[20:23]
    ds_read_b128 v[52:55], v5 offset:2176
    v_mfma_f32_16x16x32_bf16 v[24:27], v[64:67], v[72:75], v[24:27]
    v_mfma_f32_16x16x32_bf16 v[28:31], v[64:67], v[76:79], v[28:31]
    v_mfma_f32_16x16x32_bf16 v[32:35], v[68:71], v[72:75], v[32:35]
    v_mfma_f32_16x16x32_bf16 v[36:39], v[68:71], v[76:79], v[36:39]
    s_waitcnt lgkmcnt(4)
    v_mfma_f32_16x16x32_bf16 v[8:11], v[64:67], v[80:83], v[8:11]
    ds_read_b128 v[72:75], v6 offset:224
    v_mfma_f32_16x16x32_bf16 v[12:15], v[64:67], v[84:87], v[12:15]
    ds_read_b128 v[76:79], v6 offset:2784
    v_mfma_f32_16x16x32_bf16 v[16:19], v[68:71], v[80:83], v[16:19]
    ds_read_b128 v[56:59], v5 offset:2144
    v_mfma_f32_16x16x32_bf16 v[20:23], v[68:71], v[84:87], v[20:23]
    ds_read_b128 v[60:63], v5 offset:2112
    v_mfma_f32_16x16x32_bf16 v[24:27], v[40:43], v[80:83], v[24:27]
    v_mfma_f32_16x16x32_bf16 v[28:31], v[40:43], v[84:87], v[28:31]
    v_mfma_f32_16x16x32_bf16 v[32:35], v[44:47], v[80:83], v[32:35]
    v_mfma_f32_16x16x32_bf16 v[36:39], v[44:47], v[84:87], v[36:39]
    s_waitcnt lgkmcnt(4)
    v_mfma_f32_16x16x32_bf16 v[8:11], v[40:43], v[88:91], v[8:11]
    ds_read_b128 v[80:83], v6 offset:160
    v_mfma_f32_16x16x32_bf16 v[12:15], v[40:43], v[92:95], v[12:15]
    ds_read_b128 v[84:87], v6 offset:2720
    v_mfma_f32_16x16x32_bf16 v[16:19], v[44:47], v[88:91], v[16:19]
    ds_read_b128 v[64:67], v5 offset:2080
    v_mfma_f32_16x16x32_bf16 v[20:23], v[44:47], v[92:95], v[20:23]
    ds_read_b128 v[68:71], v5 offset:2048
    v_mfma_f32_16x16x32_bf16 v[24:27], v[48:51], v[88:91], v[24:27]
    v_mfma_f32_16x16x32_bf16 v[28:31], v[48:51], v[92:95], v[28:31]
    v_mfma_f32_16x16x32_bf16 v[32:35], v[52:55], v[88:91], v[32:35]
    v_mfma_f32_16x16x32_bf16 v[36:39], v[52:55], v[92:95], v[36:39]
    s_waitcnt lgkmcnt(4)
    v_mfma_f32_16x16x32_bf16 v[8:11], v[48:51], v[72:75], v[8:11]
    ds_read_b128 v[92:95], v6 offset:2624
    v_mfma_f32_16x16x32_bf16 v[12:15], v[48:51], v[76:79], v[12:15]
    ds_read_b128 v[40:43], v5 offset:2016
    v_mfma_f32_16x16x32_bf16 v[16:19], v[52:55], v[72:75], v[16:19]
    ds_read_b128 v[44:47], v5 offset:1984
    v_mfma_f32_16x16x32_bf16 v[20:23], v[52:55], v[76:79], v[20:23]
    v_mfma_f32_16x16x32_bf16 v[24:27], v[56:59], v[72:75], v[24:27]
    v_mfma_f32_16x16x32_bf16 v[28:31], v[56:59], v[76:79], v[28:31]
    v_mfma_f32_16x16x32_bf16 v[32:35], v[60:63], v[72:75], v[32:35]
    v_mfma_f32_16x16x32_bf16 v[36:39], v[60:63], v[76:79], v[36:39]
    s_waitcnt lgkmcnt(3)
    v_mfma_f32_16x16x32_bf16 v[8:11], v[56:59], v[80:83], v[8:11]
    ds_read_b128 v[76:79], v6 offset:2560
    v_mfma_f32_16x16x32_bf16 v[12:15], v[56:59], v[84:87], v[12:15]
    ds_read_b128 v[48:51], v5 offset:1952
    v_mfma_f32_16x16x32_bf16 v[16:19], v[60:63], v[80:83], v[16:19]
    ds_read_b128 v[52:55], v5 offset:1920
    v_mfma_f32_16x16x32_bf16 v[20:23], v[60:63], v[84:87], v[20:23]
    v_mfma_f32_16x16x32_bf16 v[24:27], v[64:67], v[80:83], v[24:27]
    v_mfma_f32_16x16x32_bf16 v[28:31], v[64:67], v[84:87], v[28:31]
    v_mfma_f32_16x16x32_bf16 v[32:35], v[68:71], v[80:83], v[32:35]
    v_mfma_f32_16x16x32_bf16 v[36:39], v[68:71], v[84:87], v[36:39]
    s_waitcnt lgkmcnt(3)
    v_mfma_f32_16x16x32_bf16 v[12:15], v[64:67], v[92:95], v[12:15]
    ds_read_b128 v[84:87], v6 offset:2464
    v_mfma_f32_16x16x32_bf16 v[20:23], v[68:71], v[92:95], v[20:23]
    ds_read_b128 v[56:59], v5 offset:1888
    v_mfma_f32_16x16x32_bf16 v[28:31], v[40:43], v[92:95], v[28:31]
    ds_read_b128 v[60:63], v5 offset:1856
    v_mfma_f32_16x16x32_bf16 v[36:39], v[44:47], v[92:95], v[36:39]
    s_waitcnt lgkmcnt(3)
    v_mfma_f32_16x16x32_bf16 v[12:15], v[40:43], v[76:79], v[12:15]
    ds_read_b128 v[92:95], v6 offset:2400
    v_mfma_f32_16x16x32_bf16 v[20:23], v[44:47], v[76:79], v[20:23]
    ds_read_b128 v[64:67], v5 offset:1824
    v_mfma_f32_16x16x32_bf16 v[28:31], v[48:51], v[76:79], v[28:31]
    ds_read_b128 v[68:71], v5 offset:1792
    v_mfma_f32_16x16x32_bf16 v[36:39], v[52:55], v[76:79], v[36:39]
    s_waitcnt lgkmcnt(3)
    v_mfma_f32_16x16x32_bf16 v[12:15], v[48:51], v[84:87], v[12:15]
    ds_read_b128 v[76:79], v6 offset:2304
    v_mfma_f32_16x16x32_bf16 v[20:23], v[52:55], v[84:87], v[20:23]
    ds_read_b128 v[40:43], v5 offset:1760
    v_mfma_f32_16x16x32_bf16 v[28:31], v[56:59], v[84:87], v[28:31]
    ds_read_b128 v[44:47], v5 offset:1728
    v_mfma_f32_16x16x32_bf16 v[36:39], v[60:63], v[84:87], v[36:39]
    s_waitcnt lgkmcnt(3)
    v_mfma_f32_16x16x32_bf16 v[12:15], v[56:59], v[92:95], v[12:15]
    ds_read_b128 v[84:87], v6 offset:2240
    v_mfma_f32_16x16x32_bf16 v[20:23], v[60:63], v[92:95], v[20:23]
    ds_read_b128 v[48:51], v5 offset:1696
    v_mfma_f32_16x16x32_bf16 v[28:31], v[64:67], v[92:95], v[28:31]
    ds_read_b128 v[52:55], v5 offset:1664
    v_mfma_f32_16x16x32_bf16 v[36:39], v[68:71], v[92:95], v[36:39]
    s_waitcnt lgkmcnt(3)
    v_mfma_f32_16x16x32_bf16 v[12:15], v[64:67], v[76:79], v[12:15]
    ds_read_b128 v[92:95], v6 offset:2144
    v_mfma_f32_16x16x32_bf16 v[20:23], v[68:71], v[76:79], v[20:23]
    ds_read_b128 v[56:59], v5 offset:1632
    v_mfma_f32_16x16x32_bf16 v[28:31], v[40:43], v[76:79], v[28:31]
    ds_read_b128 v[60:63], v5 offset:1600
    v_mfma_f32_16x16x32_bf16 v[36:39], v[44:47], v[76:79], v[36:39]
    s_waitcnt lgkmcnt(3)
    v_mfma_f32_16x16x32_bf16 v[12:15], v[40:43], v[84:87], v[12:15]
    ds_read_b128 v[76:79], v6 offset:2080
    v_mfma_f32_16x16x32_bf16 v[20:23], v[44:47], v[84:87], v[20:23]
    ds_read_b128 v[64:67], v5 offset:1568
    v_mfma_f32_16x16x32_bf16 v[28:31], v[48:51], v[84:87], v[28:31]
    ds_read_b128 v[68:71], v5 offset:1536
    v_mfma_f32_16x16x32_bf16 v[36:39], v[52:55], v[84:87], v[36:39]
    s_waitcnt lgkmcnt(3)
    v_mfma_f32_16x16x32_bf16 v[12:15], v[48:51], v[92:95], v[12:15]
    v_mfma_f32_16x16x32_bf16 v[20:23], v[52:55], v[92:95], v[20:23]
    v_mfma_f32_16x16x32_bf16 v[28:31], v[56:59], v[92:95], v[28:31]
    v_mfma_f32_16x16x32_bf16 v[36:39], v[60:63], v[92:95], v[36:39]
    s_waitcnt lgkmcnt(0)
    v_mfma_f32_16x16x32_bf16 v[12:15], v[56:59], v[76:79], v[12:15]
    v_mfma_f32_16x16x32_bf16 v[20:23], v[60:63], v[76:79], v[20:23]
    v_mfma_f32_16x16x32_bf16 v[28:31], v[64:67], v[76:79], v[28:31]
    v_mfma_f32_16x16x32_bf16 v[36:39], v[68:71], v[76:79], v[36:39]
    v_mul_u32_u24 v7, 272, v2
    v_lshl_add_u32 v7, v3, 4, v7
    v_add_u32 v7, s79, v7
    s_barrier
    s_nop 7
    ds_write_b128 v7, v[8:11] offset:17408
    ds_write_b128 v7, v[12:15] offset:21760
    ds_write_b128 v7, v[16:19] offset:17472
    ds_write_b128 v7, v[20:23] offset:21824
    ds_write_b128 v7, v[24:27] offset:17536
    ds_write_b128 v7, v[28:31] offset:21888
    ds_write_b128 v7, v[32:35] offset:17600
    ds_write_b128 v7, v[36:39] offset:21952
    s_branch cj_k2_kernel_8
cw_k2_kernel_7:
    ds_read_b128 v[84:87], v6 offset:1984
    ds_read_b128 v[64:67], v5 offset:1568
    ds_read_b128 v[68:71], v5 offset:1536
    ds_read_b128 v[40:43], v5 offset:1504
    ds_read_b128 v[44:47], v5 offset:1472
    ds_read_b128 v[92:95], v6 offset:1920
    ds_read_b128 v[48:51], v5 offset:1440
    ds_read_b128 v[52:55], v5 offset:1408
    s_waitcnt lgkmcnt(3)
    v_mfma_f32_16x16x32_bf16 v[12:15], v[64:67], v[84:87], 0
    ds_read_b128 v[76:79], v6 offset:1824
    v_mfma_f32_16x16x32_bf16 v[20:23], v[68:71], v[84:87], 0
    ds_read_b128 v[56:59], v5 offset:1376
    v_mfma_f32_16x16x32_bf16 v[28:31], v[40:43], v[84:87], 0
    ds_read_b128 v[60:63], v5 offset:1344
    v_mfma_f32_16x16x32_bf16 v[36:39], v[44:47], v[84:87], 0
    s_waitcnt lgkmcnt(3)
    v_mfma_f32_16x16x32_bf16 v[12:15], v[40:43], v[92:95], v[12:15]
    ds_read_b128 v[84:87], v6 offset:1760
    v_mfma_f32_16x16x32_bf16 v[20:23], v[44:47], v[92:95], v[20:23]
    ds_read_b128 v[64:67], v5 offset:1312
    v_mfma_f32_16x16x32_bf16 v[28:31], v[48:51], v[92:95], v[28:31]
    ds_read_b128 v[68:71], v5 offset:1280
    v_mfma_f32_16x16x32_bf16 v[36:39], v[52:55], v[92:95], v[36:39]
    s_waitcnt lgkmcnt(3)
    v_mfma_f32_16x16x32_bf16 v[12:15], v[48:51], v[76:79], v[12:15]
    ds_read_b128 v[92:95], v6 offset:1664
    v_mfma_f32_16x16x32_bf16 v[20:23], v[52:55], v[76:79], v[20:23]
    ds_read_b128 v[40:43], v5 offset:1248
    v_mfma_f32_16x16x32_bf16 v[28:31], v[56:59], v[76:79], v[28:31]
    ds_read_b128 v[44:47], v5 offset:1216
    v_mfma_f32_16x16x32_bf16 v[36:39], v[60:63], v[76:79], v[36:39]
    s_waitcnt lgkmcnt(3)
    v_mfma_f32_16x16x32_bf16 v[12:15], v[56:59], v[84:87], v[12:15]
    ds_read_b128 v[76:79], v6 offset:1600
    v_mfma_f32_16x16x32_bf16 v[20:23], v[60:63], v[84:87], v[20:23]
    ds_read_b128 v[48:51], v5 offset:1184
    v_mfma_f32_16x16x32_bf16 v[28:31], v[64:67], v[84:87], v[28:31]
    ds_read_b128 v[52:55], v5 offset:1152
    v_mfma_f32_16x16x32_bf16 v[36:39], v[68:71], v[84:87], v[36:39]
    s_waitcnt lgkmcnt(3)
    v_mfma_f32_16x16x32_bf16 v[12:15], v[64:67], v[92:95], v[12:15]
    ds_read_b128 v[84:87], v6 offset:1504
    v_mfma_f32_16x16x32_bf16 v[20:23], v[68:71], v[92:95], v[20:23]
    ds_read_b128 v[56:59], v5 offset:1120
    v_mfma_f32_16x16x32_bf16 v[28:31], v[40:43], v[92:95], v[28:31]
    ds_read_b128 v[60:63], v5 offset:1088
    v_mfma_f32_16x16x32_bf16 v[36:39], v[44:47], v[92:95], v[36:39]
    s_waitcnt lgkmcnt(3)
    v_mfma_f32_16x16x32_bf16 v[12:15], v[40:43], v[76:79], v[12:15]
    ds_read_b128 v[92:95], v6 offset:1440
    v_mfma_f32_16x16x32_bf16 v[20:23], v[44:47], v[76:79], v[20:23]
    ds_read_b128 v[64:67], v5 offset:1056
    v_mfma_f32_16x16x32_bf16 v[28:31], v[48:51], v[76:79], v[28:31]
    ds_read_b128 v[68:71], v5 offset:1024
    v_mfma_f32_16x16x32_bf16 v[36:39], v[52:55], v[76:79], v[36:39]
    s_waitcnt lgkmcnt(3)
    v_mfma_f32_16x16x32_bf16 v[12:15], v[48:51], v[84:87], v[12:15]
    ds_read_b128 v[76:79], v6 offset:1344
    v_mfma_f32_16x16x32_bf16 v[20:23], v[52:55], v[84:87], v[20:23]
    ds_read_b128 v[40:43], v5 offset:992
    v_mfma_f32_16x16x32_bf16 v[28:31], v[56:59], v[84:87], v[28:31]
    ds_read_b128 v[44:47], v5 offset:960
    v_mfma_f32_16x16x32_bf16 v[36:39], v[60:63], v[84:87], v[36:39]
    s_waitcnt lgkmcnt(3)
    v_mfma_f32_16x16x32_bf16 v[12:15], v[56:59], v[92:95], v[12:15]
    ds_read_b128 v[84:87], v6 offset:1280
    v_mfma_f32_16x16x32_bf16 v[20:23], v[60:63], v[92:95], v[20:23]
    ds_read_b128 v[48:51], v5 offset:928
    v_mfma_f32_16x16x32_bf16 v[28:31], v[64:67], v[92:95], v[28:31]
    ds_read_b128 v[52:55], v5 offset:896
    v_mfma_f32_16x16x32_bf16 v[36:39], v[68:71], v[92:95], v[36:39]
    s_waitcnt lgkmcnt(3)
    v_mfma_f32_16x16x32_bf16 v[12:15], v[64:67], v[76:79], v[12:15]
    ds_read_b128 v[92:95], v6 offset:1184
    v_mfma_f32_16x16x32_bf16 v[20:23], v[68:71], v[76:79], v[20:23]
    ds_read_b128 v[56:59], v5 offset:864
    v_mfma_f32_16x16x32_bf16 v[28:31], v[40:43], v[76:79], v[28:31]
    ds_read_b128 v[60:63], v5 offset:832
    v_mfma_f32_16x16x32_bf16 v[36:39], v[44:47], v[76:79], v[36:39]
    s_waitcnt lgkmcnt(3)
    v_mfma_f32_16x16x32_bf16 v[12:15], v[40:43], v[84:87], v[12:15]
    ds_read_b128 v[76:79], v6 offset:1120
    v_mfma_f32_16x16x32_bf16 v[20:23], v[44:47], v[84:87], v[20:23]
    ds_read_b128 v[64:67], v5 offset:800
    v_mfma_f32_16x16x32_bf16 v[28:31], v[48:51], v[84:87], v[28:31]
    ds_read_b128 v[68:71], v5 offset:768
    v_mfma_f32_16x16x32_bf16 v[36:39], v[52:55], v[84:87], v[36:39]
    s_waitcnt lgkmcnt(3)
    v_mfma_f32_16x16x32_bf16 v[12:15], v[48:51], v[92:95], v[12:15]
    ds_read_b128 v[84:87], v6 offset:1024
    v_mfma_f32_16x16x32_bf16 v[20:23], v[52:55], v[92:95], v[20:23]
    ds_read_b128 v[40:43], v5 offset:736
    v_mfma_f32_16x16x32_bf16 v[28:31], v[56:59], v[92:95], v[28:31]
    ds_read_b128 v[44:47], v5 offset:704
    v_mfma_f32_16x16x32_bf16 v[36:39], v[60:63], v[92:95], v[36:39]
    s_waitcnt lgkmcnt(3)
    v_mfma_f32_16x16x32_bf16 v[12:15], v[56:59], v[76:79], v[12:15]
    ds_read_b128 v[92:95], v6 offset:960
    v_mfma_f32_16x16x32_bf16 v[20:23], v[60:63], v[76:79], v[20:23]
    ds_read_b128 v[48:51], v5 offset:672
    v_mfma_f32_16x16x32_bf16 v[28:31], v[64:67], v[76:79], v[28:31]
    ds_read_b128 v[52:55], v5 offset:640
    v_mfma_f32_16x16x32_bf16 v[36:39], v[68:71], v[76:79], v[36:39]
    s_waitcnt lgkmcnt(3)
    v_mfma_f32_16x16x32_bf16 v[12:15], v[64:67], v[84:87], v[12:15]
    ds_read_b128 v[76:79], v6 offset:864
    v_mfma_f32_16x16x32_bf16 v[20:23], v[68:71], v[84:87], v[20:23]
    ds_read_b128 v[56:59], v5 offset:608
    v_mfma_f32_16x16x32_bf16 v[28:31], v[40:43], v[84:87], v[28:31]
    ds_read_b128 v[60:63], v5 offset:576
    v_mfma_f32_16x16x32_bf16 v[36:39], v[44:47], v[84:87], v[36:39]
    s_waitcnt lgkmcnt(3)
    v_mfma_f32_16x16x32_bf16 v[12:15], v[40:43], v[92:95], v[12:15]
    ds_read_b128 v[84:87], v6 offset:800
    v_mfma_f32_16x16x32_bf16 v[20:23], v[44:47], v[92:95], v[20:23]
    ds_read_b128 v[64:67], v5 offset:544
    v_mfma_f32_16x16x32_bf16 v[28:31], v[48:51], v[92:95], v[28:31]
    ds_read_b128 v[68:71], v5 offset:512
    v_mfma_f32_16x16x32_bf16 v[36:39], v[52:55], v[92:95], v[36:39]
    s_waitcnt lgkmcnt(3)
    v_mfma_f32_16x16x32_bf16 v[12:15], v[48:51], v[76:79], v[12:15]
    ds_read_b128 v[92:95], v6 offset:704
    v_mfma_f32_16x16x32_bf16 v[20:23], v[52:55], v[76:79], v[20:23]
    ds_read_b128 v[40:43], v5 offset:480
    v_mfma_f32_16x16x32_bf16 v[28:31], v[56:59], v[76:79], v[28:31]
    ds_read_b128 v[44:47], v5 offset:448
    v_mfma_f32_16x16x32_bf16 v[36:39], v[60:63], v[76:79], v[36:39]
    s_waitcnt lgkmcnt(3)
    v_mfma_f32_16x16x32_bf16 v[12:15], v[56:59], v[84:87], v[12:15]
    ds_read_b128 v[76:79], v6 offset:640
    v_mfma_f32_16x16x32_bf16 v[20:23], v[60:63], v[84:87], v[20:23]
    ds_read_b128 v[48:51], v5 offset:416
    v_mfma_f32_16x16x32_bf16 v[28:31], v[64:67], v[84:87], v[28:31]
    ds_read_b128 v[52:55], v5 offset:384
    v_mfma_f32_16x16x32_bf16 v[36:39], v[68:71], v[84:87], v[36:39]
    s_waitcnt lgkmcnt(3)
    v_mfma_f32_16x16x32_bf16 v[12:15], v[64:67], v[92:95], v[12:15]
    ds_read_b128 v[84:87], v6 offset:544
    v_mfma_f32_16x16x32_bf16 v[20:23], v[68:71], v[92:95], v[20:23]
    ds_read_b128 v[56:59], v5 offset:352
    v_mfma_f32_16x16x32_bf16 v[28:31], v[40:43], v[92:95], v[28:31]
    ds_read_b128 v[60:63], v5 offset:320
    v_mfma_f32_16x16x32_bf16 v[36:39], v[44:47], v[92:95], v[36:39]
    s_waitcnt lgkmcnt(3)
    v_mfma_f32_16x16x32_bf16 v[12:15], v[40:43], v[76:79], v[12:15]
    ds_read_b128 v[92:95], v6 offset:480
    v_mfma_f32_16x16x32_bf16 v[20:23], v[44:47], v[76:79], v[20:23]
    ds_read_b128 v[64:67], v5 offset:288
    v_mfma_f32_16x16x32_bf16 v[28:31], v[48:51], v[76:79], v[28:31]
    ds_read_b128 v[68:71], v5 offset:256
    v_mfma_f32_16x16x32_bf16 v[36:39], v[52:55], v[76:79], v[36:39]
    s_waitcnt lgkmcnt(3)
    v_mfma_f32_16x16x32_bf16 v[12:15], v[48:51], v[84:87], v[12:15]
    ds_read_b128 v[76:79], v6 offset:384
    v_mfma_f32_16x16x32_bf16 v[20:23], v[52:55], v[84:87], v[20:23]
    ds_read_b128 v[40:43], v5 offset:224
    v_mfma_f32_16x16x32_bf16 v[28:31], v[56:59], v[84:87], v[28:31]
    ds_read_b128 v[44:47], v5 offset:192
    v_mfma_f32_16x16x32_bf16 v[36:39], v[60:63], v[84:87], v[36:39]
    s_waitcnt lgkmcnt(3)
    v_mfma_f32_16x16x32_bf16 v[12:15], v[56:59], v[92:95], v[12:15]
    ds_read_b128 v[84:87], v6 offset:320
    v_mfma_f32_16x16x32_bf16 v[20:23], v[60:63], v[92:95], v[20:23]
    ds_read_b128 v[48:51], v5 offset:160
    v_mfma_f32_16x16x32_bf16 v[28:31], v[64:67], v[92:95], v[28:31]
    ds_read_b128 v[52:55], v5 offset:128
    v_mfma_f32_16x16x32_bf16 v[36:39], v[68:71], v[92:95], v[36:39]
    s_waitcnt lgkmcnt(3)
    v_mfma_f32_16x16x32_bf16 v[12:15], v[64:67], v[76:79], v[12:15]
    ds_read_b128 v[92:95], v6 offset:224
    v_mfma_f32_16x16x32_bf16 v[20:23], v[68:71], v[76:79], v[20:23]
    ds_read_b128 v[56:59], v5 offset:96
    v_mfma_f32_16x16x32_bf16 v[28:31], v[40:43], v[76:79], v[28:31]
    ds_read_b128 v[60:63], v5 offset:64
    v_mfma_f32_16x16x32_bf16 v[36:39], v[44:47], v[76:79], v[36:39]
    s_waitcnt lgkmcnt(3)
    v_mfma_f32_16x16x32_bf16 v[12:15], v[40:43], v[84:87], v[12:15]
    ds_read_b128 v[76:79], v6 offset:160
    v_mfma_f32_16x16x32_bf16 v[20:23], v[44:47], v[84:87], v[20:23]
    ds_read_b128 v[64:67], v5 offset:32
    v_mfma_f32_16x16x32_bf16 v[28:31], v[48:51], v[84:87], v[28:31]
    ds_read_b128 v[68:71], v5 offset:0
    v_mfma_f32_16x16x32_bf16 v[36:39], v[52:55], v[84:87], v[36:39]
    s_waitcnt lgkmcnt(3)
    v_mfma_f32_16x16x32_bf16 v[12:15], v[48:51], v[92:95], v[12:15]
    v_mfma_f32_16x16x32_bf16 v[20:23], v[52:55], v[92:95], v[20:23]
    v_mfma_f32_16x16x32_bf16 v[28:31], v[56:59], v[92:95], v[28:31]
    v_mfma_f32_16x16x32_bf16 v[36:39], v[60:63], v[92:95], v[36:39]
    s_waitcnt lgkmcnt(0)
    v_mfma_f32_16x16x32_bf16 v[12:15], v[56:59], v[76:79], v[12:15]
    v_mfma_f32_16x16x32_bf16 v[20:23], v[60:63], v[76:79], v[20:23]
    v_mfma_f32_16x16x32_bf16 v[28:31], v[64:67], v[76:79], v[28:31]
    v_mfma_f32_16x16x32_bf16 v[36:39], v[68:71], v[76:79], v[36:39]
    v_mul_u32_u24 v7, 272, v2
    v_lshl_add_u32 v7, v3, 4, v7
    v_add_u32 v7, s79, v7
    s_barrier
    s_nop 7
    ds_write_b128 v7, v[12:15] offset:26112
    ds_write_b128 v7, v[20:23] offset:26176
    ds_write_b128 v7, v[28:31] offset:26240
    ds_write_b128 v7, v[36:39] offset:26304
cj_k2_kernel_8:
    v_lshrrev_b32 v5, 3, v0
    v_mul_u32_u24 v5, 272, v5
    v_and_b32 v6, 7, v0
    v_lshl_add_u32 v5, v6, 5, v5
    v_add_u32 v5, s79, v5
    s_lshl_b32 s3, s14, 12
    s_waitcnt lgkmcnt(0)
    s_barrier
    ds_read_b128 v[8:11], v5 offset:0
    ds_read_b128 v[12:15], v5 offset:16
    ds_read_b128 v[16:19], v5 offset:8704
    ds_read_b128 v[20:23], v5 offset:8720
    ds_read_b128 v[24:27], v5 offset:17408
    ds_read_b128 v[28:31], v5 offset:17424
    v_mov_b32 v32, 0
    v_mov_b32 v33, 0
    v_mov_b32 v34, 0
    v_mov_b32 v35, 0
    v_mov_b32 v36, 0
    v_mov_b32 v37, 0
    v_mov_b32 v38, 0
    v_mov_b32 v39, 0
    s_cmp_lt_u32 s15, 2
    s_cbranch_scc1 sk_k2_kernel_13
    ds_read_b128 v[32:35], v5 offset:21760
    ds_read_b128 v[36:39], v5 offset:21776
sk_k2_kernel_13:
    v_lshlrev_b32 v40, 16, v104
    v_and_b32 v41, 0xffff0000, v104
    v_lshlrev_b32 v42, 16, v105
    v_and_b32 v43, 0xffff0000, v105
    v_lshlrev_b32 v44, 16, v106
    v_and_b32 v45, 0xffff0000, v106
    v_lshlrev_b32 v46, 16, v107
    v_and_b32 v47, 0xffff0000, v107
    s_waitcnt lgkmcnt(0)
    v_add_f32 v8, v8, v16
    v_add_f32 v24, v24, v32
    v_add_f32 v9, v9, v17
    v_add_f32 v25, v25, v33
    v_add_f32 v10, v10, v18
    v_add_f32 v26, v26, v34
    v_add_f32 v11, v11, v19
    v_add_f32 v27, v27, v35
    v_add_f32 v12, v12, v20
    v_add_f32 v28, v28, v36
    v_add_f32 v13, v13, v21
    v_add_f32 v29, v29, v37
    v_add_f32 v14, v14, v22
    v_add_f32 v30, v30, v38
    v_add_f32 v15, v15, v23
    v_add_f32 v31, v31, v39
    v_add_f32 v8, v8, v24
    v_add_f32 v9, v9, v25
    v_add_f32 v10, v10, v26
    v_add_f32 v11, v11, v27
    v_add_f32 v12, v12, v28
    v_add_f32 v13, v13, v29
    v_add_f32 v14, v14, v30
    v_add_f32 v15, v15, v31
    v_cvt_pk_bf16_f32 v16, v8, v9
    v_cvt_pk_bf16_f32 v17, v10, v11
    v_cvt_pk_bf16_f32 v18, v12, v13
    v_cvt_pk_bf16_f32 v19, v14, v15
    v_lshlrev_b32 v8, 16, v16
    v_and_b32 v9, 0xffff0000, v16
    v_lshlrev_b32 v10, 16, v17
    v_and_b32 v11, 0xffff0000, v17
    v_lshlrev_b32 v12, 16, v18
    v_and_b32 v13, 0xffff0000, v18
    v_lshlrev_b32 v14, 16, v19
    v_and_b32 v15, 0xffff0000, v19
    v_add_f32 v8, v8, v40
    v_add_f32 v9, v9, v41
    v_add_f32 v10, v10, v42
    v_add_f32 v11, v11, v43
    v_add_f32 v12, v12, v44
    v_add_f32 v13, v13, v45
    v_add_f32 v14, v14, v46
    v_add_f32 v15, v15, v47
    v_cvt_pk_bf16_f32 v16, v8, v9
    v_cvt_pk_bf16_f32 v17, v10, v11
    v_cvt_pk_bf16_f32 v18, v12, v13
    v_cvt_pk_bf16_f32 v19, v14, v15
    v_lshlrev_b32 v8, 16, v16
    v_and_b32 v9, 0xffff0000, v16
    v_lshlrev_b32 v10, 16, v17
    v_and_b32 v11, 0xffff0000, v17
    v_lshlrev_b32 v12, 16, v18
    v_and_b32 v13, 0xffff0000, v18
    v_lshlrev_b32 v14, 16, v19
    v_and_b32 v15, 0xffff0000, v19
    v_add_f32 v8, v8, v96
    v_add_f32 v9, v9, v97
    v_add_f32 v10, v10, v98
    v_add_f32 v11, v11, v99
    v_add_f32 v12, v12, v100
    v_add_f32 v13, v13, v101
    v_add_f32 v14, v14, v102
    v_add_f32 v15, v15, v103
    v_cvt_pk_bf16_f32 v16, v8, v9
    v_cvt_pk_bf16_f32 v17, v10, v11
    v_cvt_pk_bf16_f32 v18, v12, v13
    v_cvt_pk_bf16_f32 v19, v14, v15
    buffer_store_dwordx4 v[16:19], v1, s[44:47], s3 offen sc1
    s_endpgm
side_k2_kernel_2:
    s_load_dwordx8 s[64:71], s[0:1], 80
    s_cmp_ge_u32 s2, 684
    s_cbranch_scc1 w2_k2_kernel_15
w1b_k2_kernel_14:
    s_sub_u32 s3, s2, 576
    s_waitcnt lgkmcnt(0)
    s_cmp_ge_u32 s3, 36
    s_cselect_b32 s13, 36, 0
    s_cmp_ge_u32 s3, 72
    s_cselect_b32 s13, 72, s13
    s_add_u32 s3, s3, s13
    s_mov_b32 s10, 59652324
    s_mul_hi_u32 s11, s3, s10
    s_mul_i32 s12, s11, 72
    s_sub_u32 s12, s3, s12
    s_mov_b32 s16, s64
    s_mov_b32 s17, s65
    s_mov_b32 s18, 0x510000
    s_mov_b32 s19, 0x00020000
    s_add_u32 s20, s6, 0x1400000
    s_addc_u32 s21, s7, 0
    s_mov_b32 s22, 0x510000
    s_mov_b32 s23, 0x00020000
    v_and_b32 v2, 63, v0
    v_lshrrev_b32 v1, 6, v0
    s_nop 0
    v_readfirstlane_b32 s15, v1
    v_lshrrev_b32 v3, 3, v2
    v_and_b32 v4, 7, v2
    v_bfe_u32 v5, v2, 4, 1
    v_lshlrev_b32 v5, 1, v5
    v_xor_b32 v4, v4, v5
    v_lshlrev_b32 v4, 4, v4
    v_mul_u32_u24 v3, 9216, v3
    v_add_u32 v4, v4, v3
    v_xor_b32 v5, 64, v4
    s_mul_i32 s13, s11, 1769472
    s_lshl_b32 s14, s12, 7
    s_add_u32 s13, s13, s14
    s_mul_i32 s14, s15, 442368
    s_add_u32 s13, s13, s14
    s_mul_i32 s14, s15, 6144
    s_add_u32 m0, s14, 0
    s_nop 0
    buffer_load_dwordx4 v4, s[16:19], s13 offen lds
    s_add_u32 s13, s13, 73728
    s_add_u32 m0, s14, 1024
    s_nop 0
    buffer_load_dwordx4 v5, s[16:19], s13 offen lds
    s_add_u32 s13, s13, 73728
    s_add_u32 m0, s14, 2048
    s_nop 0
    buffer_load_dwordx4 v4, s[16:19], s13 offen lds
    s_add_u32 s13, s13, 73728
    s_add_u32 m0, s14, 3072
    s_nop 0
    buffer_load_dwordx4 v5, s[16:19], s13 offen lds
    s_add_u32 s13, s13, 73728
    s_add_u32 m0, s14, 4096
    s_nop 0
    buffer_load_dwordx4 v4, s[16:19], s13 offen lds
    s_add_u32 s13, s13, 73728
    s_add_u32 m0, s14, 5120
    s_nop 0
    buffer_load_dwordx4 v5, s[16:19], s13 offen lds
    s_add_u32 s13, s13, 73728
    v_and_b32 v3, 15, v2
    v_lshrrev_b32 v6, 4, v2
    v_lshrrev_b32 v7, 2, v3
    v_bfe_u32 v8, v3, 1, 1
    s_lshl_b32 s13, s15, 1
    v_add_u32 v8, s13, v8
    v_and_b32 v9, 2, v7
    v_xor_b32 v8, v8, v9
    v_and_b32 v9, 1, v6
    v_lshlrev_b32 v9, 2, v9
    v_xor_b32 v8, v8, v9
    v_lshlrev_b32 v8, 4, v8
    v_and_b32 v9, 1, v3
    v_lshl_add_u32 v8, v9, 3, v8
    v_lshl_add_u32 v7, v6, 3, v7
    v_lshl_add_u32 v8, v7, 7, v8
    s_lshl_b32 s13, s12, 6
    s_lshl_b32 s14, s15, 4
    s_add_u32 s13, s13, s14
    v_add_u32 v9, s13, v3
    v_mul_u32_u24 v9, 1152, v9
    v_lshl_add_u32 v9, v6, 4, v9
    s_mul_i32 s13, s11, 384
    v_lshlrev_b32 v9, 6, v3
    v_lshl_add_u32 v9, v6, 4, v9
    s_lshl_b32 s13, s12, 2
    s_add_u32 s13, s13, s15
    s_mul_i32 s13, s13, 18432
    s_mul_i32 s14, s11, 6144
    s_add_u32 s13, s13, s14
    v_add_u32 v10, 4096, v9
    s_waitcnt vmcnt(0)
    s_barrier
    ds_read_b64_tr_b16 v[16:17], v8 offset:0
    ds_read_b64_tr_b16 v[18:19], v8 offset:512
    ds_read_b64_tr_b16 v[20:21], v8 offset:4096
    ds_read_b64_tr_b16 v[22:23], v8 offset:4608
    ds_read_b64_tr_b16 v[24:25], v8 offset:8192
    ds_read_b64_tr_b16 v[26:27], v8 offset:8704
    ds_read_b64_tr_b16 v[28:29], v8 offset:12288
    ds_read_b64_tr_b16 v[30:31], v8 offset:12800
    ds_read_b64_tr_b16 v[32:33], v8 offset:16384
    ds_read_b64_tr_b16 v[34:35], v8 offset:16896
    ds_read_b64_tr_b16 v[36:37], v8 offset:20480
    ds_read_b64_tr_b16 v[38:39], v8 offset:20992
    s_waitcnt lgkmcnt(10)
    buffer_store_dwordx4 v[16:19], v9, s[20:23], s13 offen offset:0 sc1
    s_waitcnt lgkmcnt(8)
    buffer_store_dwordx4 v[20:23], v9, s[20:23], s13 offen offset:1024 sc1
    s_waitcnt lgkmcnt(6)
    buffer_store_dwordx4 v[24:27], v9, s[20:23], s13 offen offset:2048 sc1
    s_waitcnt lgkmcnt(4)
    buffer_store_dwordx4 v[28:31], v9, s[20:23], s13 offen offset:3072 sc1
    s_waitcnt lgkmcnt(2)
    buffer_store_dwordx4 v[32:35], v10, s[20:23], s13 offen offset:0 sc1
    s_waitcnt lgkmcnt(0)
    buffer_store_dwordx4 v[36:39], v10, s[20:23], s13 offen offset:1024 sc1
    s_add_u32 s24, s6, 0x2000000
    s_addc_u32 s25, s7, 0
    s_mov_b32 s26, 0xd800
    s_mov_b32 s27, 0x00020000
    v_mov_b32 v10, 0
    v_mov_b32 v11, 0
    s_mov_b32 s14, 0x3f803f80
    v_dot2_f32_bf16 v10, v16, s14, v10
    v_dot2_f32_bf16 v11, v17, s14, v11
    v_dot2_f32_bf16 v10, v18, s14, v10
    v_dot2_f32_bf16 v11, v19, s14, v11
    v_dot2_f32_bf16 v10, v20, s14, v10
    v_dot2_f32_bf16 v11, v21, s14, v11
    v_dot2_f32_bf16 v10, v22, s14, v10
    v_dot2_f32_bf16 v11, v23, s14, v11
    v_dot2_f32_bf16 v10, v24, s14, v10
    v_dot2_f32_bf16 v11, v25, s14, v11
    v_dot2_f32_bf16 v10, v26, s14, v10
    v_dot2_f32_bf16 v11, v27, s14, v11
    v_dot2_f32_bf16 v10, v28, s14, v10
    v_dot2_f32_bf16 v11, v29, s14, v11
    v_dot2_f32_bf16 v10, v30, s14, v10
    v_dot2_f32_bf16 v11, v31, s14, v11
    v_dot2_f32_bf16 v10, v32, s14, v10
    v_dot2_f32_bf16 v11, v33, s14, v11
    v_dot2_f32_bf16 v10, v34, s14, v10
    v_dot2_f32_bf16 v11, v35, s14, v11
    v_dot2_f32_bf16 v10, v36, s14, v10
    v_dot2_f32_bf16 v11, v37, s14, v11
    v_dot2_f32_bf16 v10, v38, s14, v10
    v_dot2_f32_bf16 v11, v39, s14, v11
    s_nop 2
    v_add_f32 v10, v10, v11
    v_mov_b32 v11, v10
    s_nop 1
    v_permlane32_swap_b32 v10, v11
    v_add_f32 v10, v10, v11
    v_mov_b32 v11, v10
    s_nop 1
    v_permlane16_swap_b32 v10, v11
    v_add_f32 v10, v10, v11
    s_mul_i32 s13, s11, 18432
    s_lshl_b32 s14, s12, 8
    s_add_u32 s13, s13, s14
    s_lshl_b32 s14, s15, 6
    s_add_u32 s13, s13, s14
    v_lshlrev_b32 v11, 2, v3
    s_mov_b64 exec, 0xffff
    buffer_store_dword v10, v11, s[24:27], s13 offen
    s_endpgm
w2_k2_kernel_15:
    s_sub_u32 s3, s2, 684
    s_waitcnt lgkmcnt(0)
    s_mov_b32 s10, 477218589
    s_mul_hi_u32 s11, s3, s10
    s_mul_i32 s12, s11, 9
    s_sub_u32 s12, s3, s12
    s_mov_b32 s16, s70
    s_mov_b32 s17, s71
    s_mov_b32 s18, 0x288000
    s_mov_b32 s19, 0x00020000
    s_add_u32 s20, s6, 0x1a00000
    s_addc_u32 s21, s7, 0
    s_mov_b32 s22, 0x288000
    s_mov_b32 s23, 0x00020000
    v_and_b32 v2, 63, v0
    v_lshrrev_b32 v1, 6, v0
    s_nop 0
    v_readfirstlane_b32 s15, v1
    v_lshrrev_b32 v3, 3, v2
    v_and_b32 v4, 7, v2
    v_bfe_u32 v5, v2, 4, 1
    v_lshlrev_b32 v5, 1, v5
    v_xor_b32 v4, v4, v5
    v_lshlrev_b32 v4, 4, v4
    v_mul_u32_u24 v3, 1152, v3
    v_add_u32 v4, v4, v3
    v_xor_b32 v5, 64, v4
    s_mul_i32 s13, s11, 221184
    s_lshl_b32 s14, s12, 7
    s_add_u32 s13, s13, s14
    s_mul_i32 s14, s15, 55296
    s_add_u32 s13, s13, s14
    s_mul_i32 s14, s15, 6144
    s_add_u32 m0, s14, 0
    s_nop 0
    buffer_load_dwordx4 v4, s[16:19], s13 offen lds
    s_add_u32 s13, s13, 9216
    s_add_u32 m0, s14, 1024
    s_nop 0
    buffer_load_dwordx4 v5, s[16:19], s13 offen lds
    s_add_u32 s13, s13, 9216
    s_add_u32 m0, s14, 2048
    s_nop 0
    buffer_load_dwordx4 v4, s[16:19], s13 offen lds
    s_add_u32 s13, s13, 9216
    s_add_u32 m0, s14, 3072
    s_nop 0
    buffer_load_dwordx4 v5, s[16:19], s13 offen lds
    s_add_u32 s13, s13, 9216
    s_add_u32 m0, s14, 4096
    s_nop 0
    buffer_load_dwordx4 v4, s[16:19], s13 offen lds
    s_add_u32 s13, s13, 9216
    s_add_u32 m0, s14, 5120
    s_nop 0
    buffer_load_dwordx4 v5, s[16:19], s13 offen lds
    s_add_u32 s13, s13, 9216
    v_and_b32 v3, 15, v2
    v_lshrrev_b32 v6, 4, v2
    v_lshrrev_b32 v7, 2, v3
    v_bfe_u32 v8, v3, 1, 1
    s_lshl_b32 s13, s15, 1
    v_add_u32 v8, s13, v8
    v_and_b32 v9, 2, v7
    v_xor_b32 v8, v8, v9
    v_and_b32 v9, 1, v6
    v_lshlrev_b32 v9, 2, v9
    v_xor_b32 v8, v8, v9
    v_lshlrev_b32 v8, 4, v8
    v_and_b32 v9, 1, v3
    v_lshl_add_u32 v8, v9, 3, v8
    v_lshl_add_u32 v7, v6, 3, v7
    v_lshl_add_u32 v8, v7, 7, v8
    s_lshl_b32 s13, s12, 6
    s_lshl_b32 s14, s15, 4
    s_add_u32 s13, s13, s14
    v_add_u32 v9, s13, v3
    v_mul_u32_u24 v9, 4608, v9
    v_lshl_add_u32 v9, v6, 4, v9
    s_mul_i32 s13, s11, 384
    v_lshlrev_b32 v10, 4, v6
    v_sub_u32 v9, v9, v10
    s_mul_i32 s14, s11, 43
    s_lshr_b32 s14, s14, 7
    s_mul_i32 s13, s14, 3
    s_sub_u32 s13, s11, s13
    s_mul_i32 s13, s13, 24
    s_add_u32 s10, s13, 0
    v_add_u32 v10, s10, v6
    v_mul_u32_u24 v11, 57, v10
    v_lshrrev_b32 v11, 10, v11
    v_mul_u32_u24 v12, 18, v11
    v_sub_u32 v10, v10, v12
    v_cmp_lt_u32 vcc, 9, v10
    v_subrev_u32 v12, 2, v10
    v_lshlrev_b32 v13, 1, v11
    v_cndmask_b32 v12, v10, v12, vcc
    v_lshl_add_u32 v12, v11, 4, v12
    v_add3_u32 v13, v13, v10, 56
    v_and_b32 v14, 0x1e, v10
    v_cmp_eq_u32 vcc, 8, v14
    s_nop 1
    v_cndmask_b32 v12, v12, v13, vcc
    v_lshl_add_u32 v40, v12, 4, v9
    s_add_u32 s10, s13, 4
    v_add_u32 v10, s10, v6
    v_mul_u32_u24 v11, 57, v10
    v_lshrrev_b32 v11, 10, v11
    v_mul_u32_u24 v12, 18, v11
    v_sub_u32 v10, v10, v12
    v_cmp_lt_u32 vcc, 9, v10
    v_subrev_u32 v12, 2, v10
    v_lshlrev_b32 v13, 1, v11
    v_cndmask_b32 v12, v10, v12, vcc
    v_lshl_add_u32 v12, v11, 4, v12
    v_add3_u32 v13, v13, v10, 56
    v_and_b32 v14, 0x1e, v10
    v_cmp_eq_u32 vcc, 8, v14
    s_nop 1
    v_cndmask_b32 v12, v12, v13, vcc
    v_lshl_add_u32 v41, v12, 4, v9
    s_add_u32 s10, s13, 8
    v_add_u32 v10, s10, v6
    v_mul_u32_u24 v11, 57, v10
    v_lshrrev_b32 v11, 10, v11
    v_mul_u32_u24 v12, 18, v11
    v_sub_u32 v10, v10, v12
    v_cmp_lt_u32 vcc, 9, v10
    v_subrev_u32 v12, 2, v10
    v_lshlrev_b32 v13, 1, v11
    v_cndmask_b32 v12, v10, v12, vcc
    v_lshl_add_u32 v12, v11, 4, v12
    v_add3_u32 v13, v13, v10, 56
    v_and_b32 v14, 0x1e, v10
    v_cmp_eq_u32 vcc, 8, v14
    s_nop 1
    v_cndmask_b32 v12, v12, v13, vcc
    v_lshl_add_u32 v42, v12, 4, v9
    s_add_u32 s10, s13, 12
    v_add_u32 v10, s10, v6
    v_mul_u32_u24 v11, 57, v10
    v_lshrrev_b32 v11, 10, v11
    v_mul_u32_u24 v12, 18, v11
    v_sub_u32 v10, v10, v12
    v_cmp_lt_u32 vcc, 9, v10
    v_subrev_u32 v12, 2, v10
    v_lshlrev_b32 v13, 1, v11
    v_cndmask_b32 v12, v10, v12, vcc
    v_lshl_add_u32 v12, v11, 4, v12
    v_add3_u32 v13, v13, v10, 56
    v_and_b32 v14, 0x1e, v10
    v_cmp_eq_u32 vcc, 8, v14
    s_nop 1
    v_cndmask_b32 v12, v12, v13, vcc
    v_lshl_add_u32 v43, v12, 4, v9
    s_add_u32 s10, s13, 16
    v_add_u32 v10, s10, v6
    v_mul_u32_u24 v11, 57, v10
    v_lshrrev_b32 v11, 10, v11
    v_mul_u32_u24 v12, 18, v11
    v_sub_u32 v10, v10, v12
    v_cmp_lt_u32 vcc, 9, v10
    v_subrev_u32 v12, 2, v10
    v_lshlrev_b32 v13, 1, v11
    v_cndmask_b32 v12, v10, v12, vcc
    v_lshl_add_u32 v12, v11, 4, v12
    v_add3_u32 v13, v13, v10, 56
    v_and_b32 v14, 0x1e, v10
    v_cmp_eq_u32 vcc, 8, v14
    s_nop 1
    v_cndmask_b32 v12, v12, v13, vcc
    v_lshl_add_u32 v44, v12, 4, v9
    s_add_u32 s10, s13, 20
    v_add_u32 v10, s10, v6
    v_mul_u32_u24 v11, 57, v10
    v_lshrrev_b32 v11, 10, v11
    v_mul_u32_u24 v12, 18, v11
    v_sub_u32 v10, v10, v12
    v_cmp_lt_u32 vcc, 9, v10
    v_subrev_u32 v12, 2, v10
    v_lshlrev_b32 v13, 1, v11
    v_cndmask_b32 v12, v10, v12, vcc
    v_lshl_add_u32 v12, v11, 4, v12
    v_add3_u32 v13, v13, v10, 56
    v_and_b32 v14, 0x1e, v10
    v_cmp_eq_u32 vcc, 8, v14
    s_nop 1
    v_cndmask_b32 v12, v12, v13, vcc
    v_lshl_add_u32 v45, v12, 4, v9
    s_mul_i32 s13, s14, 1152
    s_waitcnt vmcnt(0)
    s_barrier
    ds_read_b64_tr_b16 v[16:17], v8 offset:0
    ds_read_b64_tr_b16 v[18:19], v8 offset:512
    ds_read_b64_tr_b16 v[20:21], v8 offset:4096
    ds_read_b64_tr_b16 v[22:23], v8 offset:4608
    ds_read_b64_tr_b16 v[24:25], v8 offset:8192
    ds_read_b64_tr_b16 v[26:27], v8 offset:8704
    ds_read_b64_tr_b16 v[28:29], v8 offset:12288
    ds_read_b64_tr_b16 v[30:31], v8 offset:12800
    ds_read_b64_tr_b16 v[32:33], v8 offset:16384
    ds_read_b64_tr_b16 v[34:35], v8 offset:16896
    ds_read_b64_tr_b16 v[36:37], v8 offset:20480
    ds_read_b64_tr_b16 v[38:39], v8 offset:20992
    s_waitcnt lgkmcnt(10)
    buffer_store_dwordx4 v[16:19], v40, s[20:23], s13 offen
    s_waitcnt lgkmcnt(8)
    buffer_store_dwordx4 v[20:23], v41, s[20:23], s13 offen
    s_waitcnt lgkmcnt(6)
    buffer_store_dwordx4 v[24:27], v42, s[20:23], s13 offen
    s_waitcnt lgkmcnt(4)
    buffer_store_dwordx4 v[28:31], v43, s[20:23], s13 offen
    s_waitcnt lgkmcnt(2)
    buffer_store_dwordx4 v[32:35], v44, s[20:23], s13 offen
    s_waitcnt lgkmcnt(0)
    buffer_store_dwordx4 v[36:39], v45, s[20:23], s13 offen
    s_endpgm
done_k2_kernel_1:
    s_endpgm
.globl mega_kernel
.p2align 8
.type mega_kernel,@function
mega_kernel:
    s_cmp_ge_u32 s2, 256
    s_cbranch_scc1 done_mega_kernel_1
    s_load_dwordx2 s[6:7], s[0:1], 128
    s_load_dwordx4 s[72:75], s[0:1], 88
    s_load_dwordx2 s[4:5], s[0:1], 112
    v_lshrrev_b32 v1, 6, v0
    v_and_b32 v2, 63, v0
    s_and_b32 s10, s2, 7
    s_lshr_b32 s11, s2, 3
    s_and_b32 s12, s10, 3
    s_lshl_b32 s12, s12, 2
    s_and_b32 s13, s11, 3
    s_add_u32 s12, s12, s13
    s_lshr_b32 s13, s10, 2
    s_lshl_b32 s13, s13, 3
    s_lshr_b32 s14, s11, 2
    s_add_u32 s13, s13, s14
    s_mov_b32 s10, s12
    s_mov_b32 s11, s13
    s_mul_i32 s12, s12, 144
    s_lshl_b32 s13, s13, 7
    v_readfirstlane_b32 s15, v1
    s_and_b32 s76, s10, 7
    s_mul_i32 s76, s76, 72
    s_lshr_b32 s77, s10, 3
    s_lshl_b32 s77, s77, 6
    s_add_u32 s77, s77, s13
    s_add_u32 s15, s15, 8
    s_cmp_ge_u32 s15, 11
    s_cselect_b32 s14, 11, 0
    s_sub_u32 s15, s15, s14
    s_cmp_eq_u32 s15, 8
    s_cbranch_scc1 ldP_mega_kernel_2
    s_cmp_eq_u32 s15, 9
    s_cbranch_scc1 ldQ_mega_kernel_3
    s_cmp_eq_u32 s15, 10
    s_cbranch_scc1 aux_mega_kernel_4
    v_and_b32 v3, 15, v2
    v_lshrrev_b32 v4, 4, v2
    v_lshrrev_b32 v5, 1, v3
    v_xor_b32 v5, v5, v4
    v_lshlrev_b32 v5, 4, v5
    v_lshl_add_u32 v5, v3, 7, v5
    s_and_b32 s40, s15, 3
    s_lshr_b32 s41, s15, 2
    s_mul_i32 s42, s41, 10240
    v_add_u32 v6, s42, v5
    v_xor_b32 v7, 64, v6
    s_mul_i32 s42, s40, 4096
    s_add_u32 s42, s42, 73728
    v_add_u32 v8, s42, v5
    v_xor_b32 v9, 64, v8
    v_lshrrev_b32 v12, 2, v3
    v_and_b32 v13, 3, v3
    v_and_b32 v14, 1, v4
    v_lshl_or_b32 v14, v14, 2, v12
    v_lshlrev_b32 v14, 1, v14
    v_lshrrev_b32 v15, 1, v13
    s_lshl_b32 s42, s40, 2
    v_add_u32 v15, s42, v15
    v_xor_b32 v15, v15, v14
    v_lshlrev_b32 v15, 4, v15
    v_and_b32 v13, 1, v13
    v_lshl_add_u32 v15, v13, 3, v15
    v_lshl_add_u32 v12, v4, 3, v12
    v_lshl_add_u32 v10, v12, 8, v15
    v_add_u32 v10, 73728, v10
    v_xor_b32 v11, 32, v10
    v_and_b32 v12, 8, v3
    v_cmp_ne_u32 s[64:65], 0, v12
    v_and_b32 v12, 4, v3
    v_cmp_ne_u32 s[66:67], 0, v12
    v_and_b32 v12, 2, v3
    v_cmp_ne_u32 s[68:69], 0, v12
    v_and_b32 v12, 1, v3
    v_cmp_ne_u32 s[70:71], 0, v12
    s_mov_b32 s78, 0xbdd2d3e8
    s_mov_b32 s79, 0xc0135761
    s_waitcnt lgkmcnt(0)
    s_add_u32 s20, s6, 0x4800000
    s_addc_u32 s21, s7, 0
    s_mov_b32 s22, 0x240000
    s_mov_b32 s23, 0x00020000
    s_add_u32 s24, s6, 0x2800000
    s_addc_u32 s25, s7, 0
    s_mov_b32 s26, 0x900000
    s_mov_b32 s27, 0x00020000
    s_add_u32 s28, s6, 0x3400000
    s_addc_u32 s29, s7, 0
    s_mov_b32 s30, 0x900000
    s_mov_b32 s31, 0x00020000
    s_mov_b32 s32, s74
    s_mov_b32 s33, s75
    s_mov_b32 s34, 0x1000
    s_mov_b32 s35, 0x00020000
    s_mov_b32 s80, s4
    s_mov_b32 s81, s5
    s_mov_b32 s82, 0x240000
    s_mov_b32 s83, 0x00020000
    s_cmp_eq_u32 s41, 1
    s_cbranch_scc1 c1_mega_kernel_5
    s_barrier
    ds_read_b64_tr_b16 v[96:97], v10 offset:0
    ds_read_b64_tr_b16 v[98:99], v10 offset:1024
    ds_read_b64_tr_b16 v[100:101], v11 offset:0
    ds_read_b64_tr_b16 v[102:103], v11 offset:1024
    ds_read_b128 v[104:107], v6 offset:0
    ds_read_b128 v[108:111], v6 offset:2048
    ds_read_b128 v[112:115], v6 offset:4096
    ds_read_b128 v[116:119], v6 offset:6144
    ds_read_b128 v[120:123], v6 offset:8192
    s_waitcnt lgkmcnt(0)
    v_mfma_f32_16x16x32_bf16 v[56:59], v[96:99], v[104:107], 0
    ds_read_b64_tr_b16 v[124:125], v10 offset:8192
    v_mfma_f32_16x16x32_bf16 v[60:63], v[100:103], v[104:107], 0
    ds_read_b64_tr_b16 v[126:127], v10 offset:9216
    v_mfma_f32_16x16x32_bf16 v[64:67], v[96:99], v[108:111], 0
    ds_read_b64_tr_b16 v[128:129], v11 offset:8192
    v_mfma_f32_16x16x32_bf16 v[68:71], v[100:103], v[108:111], 0
    ds_read_b64_tr_b16 v[130:131], v11 offset:9216
    v_mfma_f32_16x16x32_bf16 v[72:75], v[96:99], v[112:115], 0
    ds_read_b128 v[132:135], v7 offset:0
    v_mfma_f32_16x16x32_bf16 v[76:79], v[100:103], v[112:115], 0
    ds_read_b128 v[136:139], v7 offset:2048
    v_mfma_f32_16x16x32_bf16 v[80:83], v[96:99], v[116:119], 0
    ds_read_b128 v[140:143], v7 offset:4096
    v_mfma_f32_16x16x32_bf16 v[84:87], v[100:103], v[116:119], 0
    ds_read_b128 v[144:147], v7 offset:6144
    v_mfma_f32_16x16x32_bf16 v[88:91], v[96:99], v[120:123], 0
    ds_read_b128 v[148:151], v7 offset:8192
    v_mfma_f32_16x16x32_bf16 v[92:95], v[100:103], v[120:123], 0
    s_waitcnt lgkmcnt(0)
    s_barrier
    v_mfma_f32_16x16x32_bf16 v[56:59], v[124:127], v[132:135], v[56:59]
    ds_read_b64_tr_b16 v[96:97], v10 offset:16384
    v_mfma_f32_16x16x32_bf16 v[60:63], v[128:131], v[132:135], v[60:63]
    ds_read_b64_tr_b16 v[98:99], v10 offset:17408
    v_mfma_f32_16x16x32_bf16 v[64:67], v[124:127], v[136:139], v[64:67]
    ds_read_b64_tr_b16 v[100:101], v11 offset:16384
    v_mfma_f32_16x16x32_bf16 v[68:71], v[128:131], v[136:139], v[68:71]
    ds_read_b64_tr_b16 v[102:103], v11 offset:17408
    v_mfma_f32_16x16x32_bf16 v[72:75], v[124:127], v[140:143], v[72:75]
    ds_read_b128 v[104:107], v6 offset:18432
    v_mfma_f32_16x16x32_bf16 v[76:79], v[128:131], v[140:143], v[76:79]
    ds_read_b128 v[108:111], v6 offset:20480
    v_mfma_f32_16x16x32_bf16 v[80:83], v[124:127], v[144:147], v[80:83]
    ds_read_b128 v[112:115], v6 offset:22528
    v_mfma_f32_16x16x32_bf16 v[84:87], v[128:131], v[144:147], v[84:87]
    ds_read_b128 v[116:119], v6 offset:24576
    v_mfma_f32_16x16x32_bf16 v[88:91], v[124:127], v[148:151], v[88:91]
    ds_read_b128 v[120:123], v6 offset:26624
    v_mfma_f32_16x16x32_bf16 v[92:95], v[128:131], v[148:151], v[92:95]
    s_waitcnt lgkmcnt(0)
    s_mov_b32 s43, 2
lp_mega_kernel_6:
    v_mfma_f32_16x16x32_bf16 v[56:59], v[96:99], v[104:107], v[56:59]
    ds_read_b64_tr_b16 v[124:125], v10 offset:24576
    v_mfma_f32_16x16x32_bf16 v[60:63], v[100:103], v[104:107], v[60:63]
    ds_read_b64_tr_b16 v[126:127], v10 offset:25600
    v_mfma_f32_16x16x32_bf16 v[64:67], v[96:99], v[108:111], v[64:67]
    ds_read_b64_tr_b16 v[128:129], v11 offset:24576
    v_mfma_f32_16x16x32_bf16 v[68:71], v[100:103], v[108:111], v[68:71]
    ds_read_b64_tr_b16 v[130:131], v11 offset:25600
    v_mfma_f32_16x16x32_bf16 v[72:75], v[96:99], v[112:115], v[72:75]
    ds_read_b128 v[132:135], v7 offset:18432
    v_mfma_f32_16x16x32_bf16 v[76:79], v[100:103], v[112:115], v[76:79]
    ds_read_b128 v[136:139], v7 offset:20480
    v_mfma_f32_16x16x32_bf16 v[80:83], v[96:99], v[116:119], v[80:83]
    ds_read_b128 v[140:143], v7 offset:22528
    v_mfma_f32_16x16x32_bf16 v[84:87], v[100:103], v[116:119], v[84:87]
    ds_read_b128 v[144:147], v7 offset:24576
    v_mfma_f32_16x16x32_bf16 v[88:91], v[96:99], v[120:123], v[88:91]
    ds_read_b128 v[148:151], v7 offset:26624
    v_mfma_f32_16x16x32_bf16 v[92:95], v[100:103], v[120:123], v[92:95]
    s_waitcnt lgkmcnt(0)
    s_barrier
    v_mfma_f32_16x16x32_bf16 v[56:59], v[124:127], v[132:135], v[56:59]
    ds_read_b64_tr_b16 v[96:97], v10 offset:32768
    v_mfma_f32_16x16x32_bf16 v[60:63], v[128:131], v[132:135], v[60:63]
    ds_read_b64_tr_b16 v[98:99], v10 offset:33792
    v_mfma_f32_16x16x32_bf16 v[64:67], v[124:127], v[136:139], v[64:67]
    ds_read_b64_tr_b16 v[100:101], v11 offset:32768
    v_mfma_f32_16x16x32_bf16 v[68:71], v[128:131], v[136:139], v[68:71]
    ds_read_b64_tr_b16 v[102:103], v11 offset:33792
    v_mfma_f32_16x16x32_bf16 v[72:75], v[124:127], v[140:143], v[72:75]
    ds_read_b128 v[104:107], v6 offset:36864
    v_mfma_f32_16x16x32_bf16 v[76:79], v[128:131], v[140:143], v[76:79]
    ds_read_b128 v[108:111], v6 offset:38912
    v_mfma_f32_16x16x32_bf16 v[80:83], v[124:127], v[144:147], v[80:83]
    ds_read_b128 v[112:115], v6 offset:40960
    v_mfma_f32_16x16x32_bf16 v[84:87], v[128:131], v[144:147], v[84:87]
    ds_read_b128 v[116:119], v6 offset:43008
    v_mfma_f32_16x16x32_bf16 v[88:91], v[124:127], v[148:151], v[88:91]
    ds_read_b128 v[120:123], v6 offset:45056
    v_mfma_f32_16x16x32_bf16 v[92:95], v[128:131], v[148:151], v[92:95]
    s_waitcnt lgkmcnt(0)
    v_mfma_f32_16x16x32_bf16 v[56:59], v[96:99], v[104:107], v[56:59]
    ds_read_b64_tr_b16 v[124:125], v10 offset:40960
    v_mfma_f32_16x16x32_bf16 v[60:63], v[100:103], v[104:107], v[60:63]
    ds_read_b64_tr_b16 v[126:127], v10 offset:41984
    v_mfma_f32_16x16x32_bf16 v[64:67], v[96:99], v[108:111], v[64:67]
    ds_read_b64_tr_b16 v[128:129], v11 offset:40960
    v_mfma_f32_16x16x32_bf16 v[68:71], v[100:103], v[108:111], v[68:71]
    ds_read_b64_tr_b16 v[130:131], v11 offset:41984
    v_mfma_f32_16x16x32_bf16 v[72:75], v[96:99], v[112:115], v[72:75]
    ds_read_b128 v[132:135], v7 offset:36864
    v_mfma_f32_16x16x32_bf16 v[76:79], v[100:103], v[112:115], v[76:79]
    ds_read_b128 v[136:139], v7 offset:38912
    v_mfma_f32_16x16x32_bf16 v[80:83], v[96:99], v[116:119], v[80:83]
    ds_read_b128 v[140:143], v7 offset:40960
    v_mfma_f32_16x16x32_bf16 v[84:87], v[100:103], v[116:119], v[84:87]
    ds_read_b128 v[144:147], v7 offset:43008
    v_mfma_f32_16x16x32_bf16 v[88:91], v[96:99], v[120:123], v[88:91]
    ds_read_b128 v[148:151], v7 offset:45056
    v_mfma_f32_16x16x32_bf16 v[92:95], v[100:103], v[120:123], v[92:95]
    s_waitcnt lgkmcnt(0)
    s_barrier
    v_mfma_f32_16x16x32_bf16 v[56:59], v[124:127], v[132:135], v[56:59]
    ds_read_b64_tr_b16 v[96:97], v10 offset:49152
    v_mfma_f32_16x16x32_bf16 v[60:63], v[128:131], v[132:135], v[60:63]
    ds_read_b64_tr_b16 v[98:99], v10 offset:50176
    v_mfma_f32_16x16x32_bf16 v[64:67], v[124:127], v[136:139], v[64:67]
    ds_read_b64_tr_b16 v[100:101], v11 offset:49152
    v_mfma_f32_16x16x32_bf16 v[68:71], v[128:131], v[136:139], v[68:71]
    ds_read_b64_tr_b16 v[102:103], v11 offset:50176
    v_mfma_f32_16x16x32_bf16 v[72:75], v[124:127], v[140:143], v[72:75]
    ds_read_b128 v[104:107], v6 offset:55296
    v_mfma_f32_16x16x32_bf16 v[76:79], v[128:131], v[140:143], v[76:79]
    ds_read_b128 v[108:111], v6 offset:57344
    v_mfma_f32_16x16x32_bf16 v[80:83], v[124:127], v[144:147], v[80:83]
    ds_read_b128 v[112:115], v6 offset:59392
    v_mfma_f32_16x16x32_bf16 v[84:87], v[128:131], v[144:147], v[84:87]
    ds_read_b128 v[116:119], v6 offset:61440
    v_mfma_f32_16x16x32_bf16 v[88:91], v[124:127], v[148:151], v[88:91]
    ds_read_b128 v[120:123], v6 offset:63488
    v_mfma_f32_16x16x32_bf16 v[92:95], v[128:131], v[148:151], v[92:95]
    s_waitcnt lgkmcnt(0)
    v_mfma_f32_16x16x32_bf16 v[56:59], v[96:99], v[104:107], v[56:59]
    ds_read_b64_tr_b16 v[124:125], v10 offset:57344
    v_mfma_f32_16x16x32_bf16 v[60:63], v[100:103], v[104:107], v[60:63]
    ds_read_b64_tr_b16 v[126:127], v10 offset:58368
    v_mfma_f32_16x16x32_bf16 v[64:67], v[96:99], v[108:111], v[64:67]
    ds_read_b64_tr_b16 v[128:129], v11 offset:57344
    v_mfma_f32_16x16x32_bf16 v[68:71], v[100:103], v[108:111], v[68:71]
    ds_read_b64_tr_b16 v[130:131], v11 offset:58368
    v_mfma_f32_16x16x32_bf16 v[72:75], v[96:99], v[112:115], v[72:75]
    ds_read_b128 v[132:135], v7 offset:55296
    v_mfma_f32_16x16x32_bf16 v[76:79], v[100:103], v[112:115], v[76:79]
    ds_read_b128 v[136:139], v7 offset:57344
    v_mfma_f32_16x16x32_bf16 v[80:83], v[96:99], v[116:119], v[80:83]
    ds_read_b128 v[140:143], v7 offset:59392
    v_mfma_f32_16x16x32_bf16 v[84:87], v[100:103], v[116:119], v[84:87]
    ds_read_b128 v[144:147], v7 offset:61440
    v_mfma_f32_16x16x32_bf16 v[88:91], v[96:99], v[120:123], v[88:91]
    ds_read_b128 v[148:151], v7 offset:63488
    v_mfma_f32_16x16x32_bf16 v[92:95], v[100:103], v[120:123], v[92:95]
    s_waitcnt lgkmcnt(0)
    s_barrier
    v_mfma_f32_16x16x32_bf16 v[56:59], v[124:127], v[132:135], v[56:59]
    ds_read_b64_tr_b16 v[96:97], v10 offset:0
    v_mfma_f32_16x16x32_bf16 v[60:63], v[128:131], v[132:135], v[60:63]
    ds_read_b64_tr_b16 v[98:99], v10 offset:1024
    v_mfma_f32_16x16x32_bf16 v[64:67], v[124:127], v[136:139], v[64:67]
    ds_read_b64_tr_b16 v[100:101], v11 offset:0
    v_mfma_f32_16x16x32_bf16 v[68:71], v[128:131], v[136:139], v[68:71]
    ds_read_b64_tr_b16 v[102:103], v11 offset:1024
    v_mfma_f32_16x16x32_bf16 v[72:75], v[124:127], v[140:143], v[72:75]
    ds_read_b128 v[104:107], v6 offset:0
    v_mfma_f32_16x16x32_bf16 v[76:79], v[128:131], v[140:143], v[76:79]
    ds_read_b128 v[108:111], v6 offset:2048
    v_mfma_f32_16x16x32_bf16 v[80:83], v[124:127], v[144:147], v[80:83]
    ds_read_b128 v[112:115], v6 offset:4096
    v_mfma_f32_16x16x32_bf16 v[84:87], v[128:131], v[144:147], v[84:87]
    ds_read_b128 v[116:119], v6 offset:6144
    v_mfma_f32_16x16x32_bf16 v[88:91], v[124:127], v[148:151], v[88:91]
    ds_read_b128 v[120:123], v6 offset:8192
    v_mfma_f32_16x16x32_bf16 v[92:95], v[128:131], v[148:151], v[92:95]
    s_waitcnt lgkmcnt(0)
    v_mfma_f32_16x16x32_bf16 v[56:59], v[96:99], v[104:107], v[56:59]
    ds_read_b64_tr_b16 v[124:125], v10 offset:8192
    v_mfma_f32_16x16x32_bf16 v[60:63], v[100:103], v[104:107], v[60:63]
    ds_read_b64_tr_b16 v[126:127], v10 offset:9216
    v_mfma_f32_16x16x32_bf16 v[64:67], v[96:99], v[108:111], v[64:67]
    ds_read_b64_tr_b16 v[128:129], v11 offset:8192
    v_mfma_f32_16x16x32_bf16 v[68:71], v[100:103], v[108:111], v[68:71]
    ds_read_b64_tr_b16 v[130:131], v11 offset:9216
    v_mfma_f32_16x16x32_bf16 v[72:75], v[96:99], v[112:115], v[72:75]
    ds_read_b128 v[132:135], v7 offset:0
    v_mfma_f32_16x16x32_bf16 v[76:79], v[100:103], v[112:115], v[76:79]
    ds_read_b128 v[136:139], v7 offset:2048
    v_mfma_f32_16x16x32_bf16 v[80:83], v[96:99], v[116:119], v[80:83]
    ds_read_b128 v[140:143], v7 offset:4096
    v_mfma_f32_16x16x32_bf16 v[84:87], v[100:103], v[116:119], v[84:87]
    ds_read_b128 v[144:147], v7 offset:6144
    v_mfma_f32_16x16x32_bf16 v[88:91], v[96:99], v[120:123], v[88:91]
    ds_read_b128 v[148:151], v7 offset:8192
    v_mfma_f32_16x16x32_bf16 v[92:95], v[100:103], v[120:123], v[92:95]
    s_waitcnt lgkmcnt(0)
    s_barrier
    v_mfma_f32_16x16x32_bf16 v[56:59], v[124:127], v[132:135], v[56:59]
    ds_read_b64_tr_b16 v[96:97], v10 offset:16384
    v_mfma_f32_16x16x32_bf16 v[60:63], v[128:131], v[132:135], v[60:63]
    ds_read_b64_tr_b16 v[98:99], v10 offset:17408
    v_mfma_f32_16x16x32_bf16 v[64:67], v[124:127], v[136:139], v[64:67]
    ds_read_b64_tr_b16 v[100:101], v11 offset:16384
    v_mfma_f32_16x16x32_bf16 v[68:71], v[128:131], v[136:139], v[68:71]
    ds_read_b64_tr_b16 v[102:103], v11 offset:17408
    v_mfma_f32_16x16x32_bf16 v[72:75], v[124:127], v[140:143], v[72:75]
    ds_read_b128 v[104:107], v6 offset:18432
    v_mfma_f32_16x16x32_bf16 v[76:79], v[128:131], v[140:143], v[76:79]
    ds_read_b128 v[108:111], v6 offset:20480
    v_mfma_f32_16x16x32_bf16 v[80:83], v[124:127], v[144:147], v[80:83]
    ds_read_b128 v[112:115], v6 offset:22528
    v_mfma_f32_16x16x32_bf16 v[84:87], v[128:131], v[144:147], v[84:87]
    ds_read_b128 v[116:119], v6 offset:24576
    v_mfma_f32_16x16x32_bf16 v[88:91], v[124:127], v[148:151], v[88:91]
    ds_read_b128 v[120:123], v6 offset:26624
    v_mfma_f32_16x16x32_bf16 v[92:95], v[128:131], v[148:151], v[92:95]
    s_waitcnt lgkmcnt(0)
    s_sub_u32 s43, s43, 1
    s_cmp_lg_u32 s43, 0
    s_cbranch_scc1 lp_mega_kernel_6
    v_lshlrev_b32 v14, 4, v4
    s_lshl_b32 s42, s40, 7
    v_add_u32 v14, s42, v14
    v_add_u32 v15, 139264, v14
    ds_read_b128 v[140:143], v15
    ds_read_b128 v[144:147], v15 offset:64
    v_lshlrev_b32 v12, 2, v3
    s_lshl_b32 s42, s40, 7
    s_add_u32 s42, s42, 139776
    v_add_u32 v13, s42, v12
    ds_read_b32 v124, v13
    ds_read_b32 v126, v13 offset:64
    v_add_u32 v12, 144128, v12
    ds_read_b32 v128, v12 offset:0
    v_mov_b32 v129, 0
    ds_read_b32 v130, v12 offset:64
    v_mov_b32 v131, 0
    ds_read_b32 v132, v12 offset:128
    v_mov_b32 v133, 0
    ds_read_b32 v134, v12 offset:192
    v_mov_b32 v135, 0
    ds_read_b32 v136, v12 offset:256
    v_mov_b32 v137, 0
    v_mov_b32 v125, 0
    v_mov_b32 v127, 0
    v_cmp_eq_u32 vcc, 0, v4
    s_nop 0
    s_waitcnt lgkmcnt(0)
    v_cndmask_b32 v124, 0, v124, vcc
    v_cndmask_b32 v126, 0, v126, vcc
    s_nop 1
    v_mfma_f32_16x16x16_bf16 v[56:59], v[124:125], v[128:129], v[56:59]
    v_mfma_f32_16x16x16_bf16 v[60:63], v[126:127], v[128:129], v[60:63]
    v_mfma_f32_16x16x16_bf16 v[64:67], v[124:125], v[130:131], v[64:67]
    v_mfma_f32_16x16x16_bf16 v[68:71], v[126:127], v[130:131], v[68:71]
    v_mfma_f32_16x16x16_bf16 v[72:75], v[124:125], v[132:133], v[72:75]
    v_mfma_f32_16x16x16_bf16 v[76:79], v[126:127], v[132:133], v[76:79]
    v_mfma_f32_16x16x16_bf16 v[80:83], v[124:125], v[134:135], v[80:83]
    v_mfma_f32_16x16x16_bf16 v[84:87], v[126:127], v[134:135], v[84:87]
    v_mfma_f32_16x16x16_bf16 v[88:91], v[124:125], v[136:137], v[88:91]
    v_mfma_f32_16x16x16_bf16 v[92:95], v[126:127], v[136:137], v[92:95]
    v_bfe_u32 v12, v3, 2, 1
    v_lshlrev_b32 v12, 4, v12
    v_lshl_add_u32 v12, v4, 2, v12
    v_and_b32 v13, 3, v3
    v_add_u32 v12, v12, v13
    v_lshrrev_b32 v13, 3, v3
    v_lshl_add_u32 v12, v12, 1, v13
    v_lshlrev_b32 v12, 2, v12
    s_lshl_b32 s42, s40, 8
    s_add_u32 s42, s42, 140288
    v_add_u32 v12, s42, v12
    v_pk_mul_f32 v[56:57], v[56:57], v[140:141]
    v_pk_mul_f32 v[58:59], v[58:59], v[142:143]
    v_pk_mul_f32 v[60:61], v[60:61], v[144:145]
    v_pk_mul_f32 v[62:63], v[62:63], v[146:147]
    v_pk_mul_f32 v[152:153], v[56:57], v[56:57]
    v_pk_mul_f32 v[154:155], v[58:59], v[58:59]
    v_pk_mul_f32 v[156:157], v[60:61], v[60:61]
    v_pk_mul_f32 v[158:159], v[62:63], v[62:63]
    v_pk_fma_f32 v[152:153], v[152:153], s[78:79], s[78:79] op_sel:[0,0,1] op_sel_hi:[1,0,1]
    v_pk_fma_f32 v[154:155], v[154:155], s[78:79], s[78:79] op_sel:[0,0,1] op_sel_hi:[1,0,1]
    v_pk_fma_f32 v[156:157], v[156:157], s[78:79], s[78:79] op_sel:[0,0,1] op_sel_hi:[1,0,1]
    v_pk_fma_f32 v[158:159], v[158:159], s[78:79], s[78:79] op_sel:[0,0,1] op_sel_hi:[1,0,1]
    v_pk_mul_f32 v[152:153], v[152:153], v[56:57]
    v_pk_mul_f32 v[154:155], v[154:155], v[58:59]
    v_pk_mul_f32 v[156:157], v[156:157], v[60:61]
    v_pk_mul_f32 v[158:159], v[158:159], v[62:63]
    v_exp_f32 v152, v152
    v_exp_f32 v153, v153
    v_exp_f32 v154, v154
    v_exp_f32 v155, v155
    v_exp_f32 v156, v156
    v_exp_f32 v157, v157
    v_exp_f32 v158, v158
    v_exp_f32 v159, v159
    v_pk_add_f32 v[152:153], v[152:153], 1.0 op_sel_hi:[1,0]
    v_pk_add_f32 v[154:155], v[154:155], 1.0 op_sel_hi:[1,0]
    v_pk_add_f32 v[156:157], v[156:157], 1.0 op_sel_hi:[1,0]
    v_pk_add_f32 v[158:159], v[158:159], 1.0 op_sel_hi:[1,0]
    v_rcp_f32 v152, v152
    v_rcp_f32 v153, v153
    v_rcp_f32 v154, v154
    v_rcp_f32 v155, v155
    v_rcp_f32 v156, v156
    v_rcp_f32 v157, v157
    v_rcp_f32 v158, v158
    v_rcp_f32 v159, v159
    v_pk_mul_f32 v[56:57], v[56:57], v[152:153]
    v_pk_mul_f32 v[58:59], v[58:59], v[154:155]
    v_pk_mul_f32 v[60:61], v[60:61], v[156:157]
    v_pk_mul_f32 v[62:63], v[62:63], v[158:159]
    v_pk_mov_b32 v[124:125], v[56:57], v[56:57] op_sel:[0,1]
    v_pk_mul_f32 v[132:133], v[56:57], v[56:57]
    v_pk_mov_b32 v[126:127], v[58:59], v[58:59] op_sel:[0,1]
    v_pk_mul_f32 v[134:135], v[58:59], v[58:59]
    v_pk_mov_b32 v[128:129], v[60:61], v[60:61] op_sel:[0,1]
    v_pk_mul_f32 v[136:137], v[60:61], v[60:61]
    v_pk_mov_b32 v[130:131], v[62:63], v[62:63] op_sel:[0,1]
    v_pk_mul_f32 v[138:139], v[62:63], v[62:63]
    v_pk_mul_f32 v[64:65], v[64:65], v[140:141]
    v_pk_mul_f32 v[66:67], v[66:67], v[142:143]
    v_pk_mul_f32 v[68:69], v[68:69], v[144:145]
    v_pk_mul_f32 v[70:71], v[70:71], v[146:147]
    v_pk_mul_f32 v[152:153], v[64:65], v[64:65]
    v_pk_mul_f32 v[154:155], v[66:67], v[66:67]
    v_pk_mul_f32 v[156:157], v[68:69], v[68:69]
    v_pk_mul_f32 v[158:159], v[70:71], v[70:71]
    v_pk_fma_f32 v[152:153], v[152:153], s[78:79], s[78:79] op_sel:[0,0,1] op_sel_hi:[1,0,1]
    v_pk_fma_f32 v[154:155], v[154:155], s[78:79], s[78:79] op_sel:[0,0,1] op_sel_hi:[1,0,1]
    v_pk_fma_f32 v[156:157], v[156:157], s[78:79], s[78:79] op_sel:[0,0,1] op_sel_hi:[1,0,1]
    v_pk_fma_f32 v[158:159], v[158:159], s[78:79], s[78:79] op_sel:[0,0,1] op_sel_hi:[1,0,1]
    v_pk_mul_f32 v[152:153], v[152:153], v[64:65]
    v_pk_mul_f32 v[154:155], v[154:155], v[66:67]
    v_pk_mul_f32 v[156:157], v[156:157], v[68:69]
    v_pk_mul_f32 v[158:159], v[158:159], v[70:71]
    v_exp_f32 v152, v152
    v_exp_f32 v153, v153
    v_exp_f32 v154, v154
    v_exp_f32 v155, v155
    v_exp_f32 v156, v156
    v_exp_f32 v157, v157
    v_exp_f32 v158, v158
    v_exp_f32 v159, v159
    v_pk_add_f32 v[152:153], v[152:153], 1.0 op_sel_hi:[1,0]
    v_pk_add_f32 v[154:155], v[154:155], 1.0 op_sel_hi:[1,0]
    v_pk_add_f32 v[156:157], v[156:157], 1.0 op_sel_hi:[1,0]
    v_pk_add_f32 v[158:159], v[158:159], 1.0 op_sel_hi:[1,0]
    v_rcp_f32 v152, v152
    v_rcp_f32 v153, v153
    v_rcp_f32 v154, v154
    v_rcp_f32 v155, v155
    v_rcp_f32 v156, v156
    v_rcp_f32 v157, v157
    v_rcp_f32 v158, v158
    v_rcp_f32 v159, v159
    v_pk_mul_f32 v[64:65], v[64:65], v[152:153]
    v_pk_mul_f32 v[66:67], v[66:67], v[154:155]
    v_pk_mul_f32 v[68:69], v[68:69], v[156:157]
    v_pk_mul_f32 v[70:71], v[70:71], v[158:159]
    v_pk_add_f32 v[124:125], v[124:125], v[64:65]
    v_pk_fma_f32 v[132:133], v[64:65], v[64:65], v[132:133]
    v_pk_add_f32 v[126:127], v[126:127], v[66:67]
    v_pk_fma_f32 v[134:135], v[66:67], v[66:67], v[134:135]
    v_pk_add_f32 v[128:129], v[128:129], v[68:69]
    v_pk_fma_f32 v[136:137], v[68:69], v[68:69], v[136:137]
    v_pk_add_f32 v[130:131], v[130:131], v[70:71]
    v_pk_fma_f32 v[138:139], v[70:71], v[70:71], v[138:139]
    v_pk_mul_f32 v[72:73], v[72:73], v[140:141]
    v_pk_mul_f32 v[74:75], v[74:75], v[142:143]
    v_pk_mul_f32 v[76:77], v[76:77], v[144:145]
    v_pk_mul_f32 v[78:79], v[78:79], v[146:147]
    v_pk_mul_f32 v[152:153], v[72:73], v[72:73]
    v_pk_mul_f32 v[154:155], v[74:75], v[74:75]
    v_pk_mul_f32 v[156:157], v[76:77], v[76:77]
    v_pk_mul_f32 v[158:159], v[78:79], v[78:79]
    v_pk_fma_f32 v[152:153], v[152:153], s[78:79], s[78:79] op_sel:[0,0,1] op_sel_hi:[1,0,1]
    v_pk_fma_f32 v[154:155], v[154:155], s[78:79], s[78:79] op_sel:[0,0,1] op_sel_hi:[1,0,1]
    v_pk_fma_f32 v[156:157], v[156:157], s[78:79], s[78:79] op_sel:[0,0,1] op_sel_hi:[1,0,1]
    v_pk_fma_f32 v[158:159], v[158:159], s[78:79], s[78:79] op_sel:[0,0,1] op_sel_hi:[1,0,1]
    v_pk_mul_f32 v[152:153], v[152:153], v[72:73]
    v_pk_mul_f32 v[154:155], v[154:155], v[74:75]
    v_pk_mul_f32 v[156:157], v[156:157], v[76:77]
    v_pk_mul_f32 v[158:159], v[158:159], v[78:79]
    v_exp_f32 v152, v152
    v_exp_f32 v153, v153
    v_exp_f32 v154, v154
    v_exp_f32 v155, v155
    v_exp_f32 v156, v156
    v_exp_f32 v157, v157
    v_exp_f32 v158, v158
    v_exp_f32 v159, v159
    v_pk_add_f32 v[152:153], v[152:153], 1.0 op_sel_hi:[1,0]
    v_pk_add_f32 v[154:155], v[154:155], 1.0 op_sel_hi:[1,0]
    v_pk_add_f32 v[156:157], v[156:157], 1.0 op_sel_hi:[1,0]
    v_pk_add_f32 v[158:159], v[158:159], 1.0 op_sel_hi:[1,0]
    v_rcp_f32 v152, v152
    v_rcp_f32 v153, v153
    v_rcp_f32 v154, v154
    v_rcp_f32 v155, v155
    v_rcp_f32 v156, v156
    v_rcp_f32 v157, v157
    v_rcp_f32 v158, v158
    v_rcp_f32 v159, v159
    v_pk_mul_f32 v[72:73], v[72:73], v[152:153]
    v_pk_mul_f32 v[74:75], v[74:75], v[154:155]
    v_pk_mul_f32 v[76:77], v[76:77], v[156:157]
    v_pk_mul_f32 v[78:79], v[78:79], v[158:159]
    v_pk_add_f32 v[124:125], v[124:125], v[72:73]
    v_pk_fma_f32 v[132:133], v[72:73], v[72:73], v[132:133]
    v_pk_add_f32 v[126:127], v[126:127], v[74:75]
    v_pk_fma_f32 v[134:135], v[74:75], v[74:75], v[134:135]
    v_pk_add_f32 v[128:129], v[128:129], v[76:77]
    v_pk_fma_f32 v[136:137], v[76:77], v[76:77], v[136:137]
    v_pk_add_f32 v[130:131], v[130:131], v[78:79]
    v_pk_fma_f32 v[138:139], v[78:79], v[78:79], v[138:139]
    v_pk_mul_f32 v[80:81], v[80:81], v[140:141]
    v_pk_mul_f32 v[82:83], v[82:83], v[142:143]
    v_pk_mul_f32 v[84:85], v[84:85], v[144:145]
    v_pk_mul_f32 v[86:87], v[86:87], v[146:147]
    v_pk_mul_f32 v[152:153], v[80:81], v[80:81]
    v_pk_mul_f32 v[154:155], v[82:83], v[82:83]
    v_pk_mul_f32 v[156:157], v[84:85], v[84:85]
    v_pk_mul_f32 v[158:159], v[86:87], v[86:87]
    v_pk_fma_f32 v[152:153], v[152:153], s[78:79], s[78:79] op_sel:[0,0,1] op_sel_hi:[1,0,1]
    v_pk_fma_f32 v[154:155], v[154:155], s[78:79], s[78:79] op_sel:[0,0,1] op_sel_hi:[1,0,1]
    v_pk_fma_f32 v[156:157], v[156:157], s[78:79], s[78:79] op_sel:[0,0,1] op_sel_hi:[1,0,1]
    v_pk_fma_f32 v[158:159], v[158:159], s[78:79], s[78:79] op_sel:[0,0,1] op_sel_hi:[1,0,1]
    v_pk_mul_f32 v[152:153], v[152:153], v[80:81]
    v_pk_mul_f32 v[154:155], v[154:155], v[82:83]
    v_pk_mul_f32 v[156:157], v[156:157], v[84:85]
    v_pk_mul_f32 v[158:159], v[158:159], v[86:87]
    v_exp_f32 v152, v152
    v_exp_f32 v153, v153
    v_exp_f32 v154, v154
    v_exp_f32 v155, v155
    v_exp_f32 v156, v156
    v_exp_f32 v157, v157
    v_exp_f32 v158, v158
    v_exp_f32 v159, v159
    v_pk_add_f32 v[152:153], v[152:153], 1.0 op_sel_hi:[1,0]
    v_pk_add_f32 v[154:155], v[154:155], 1.0 op_sel_hi:[1,0]
    v_pk_add_f32 v[156:157], v[156:157], 1.0 op_sel_hi:[1,0]
    v_pk_add_f32 v[158:159], v[158:159], 1.0 op_sel_hi:[1,0]
    v_rcp_f32 v152, v152
    v_rcp_f32 v153, v153
    v_rcp_f32 v154, v154
    v_rcp_f32 v155, v155
    v_rcp_f32 v156, v156
    v_rcp_f32 v157, v157
    v_rcp_f32 v158, v158
    v_rcp_f32 v159, v159
    v_pk_mul_f32 v[80:81], v[80:81], v[152:153]
    v_pk_mul_f32 v[82:83], v[82:83], v[154:155]
    v_pk_mul_f32 v[84:85], v[84:85], v[156:157]
    v_pk_mul_f32 v[86:87], v[86:87], v[158:159]
    v_pk_add_f32 v[124:125], v[124:125], v[80:81]
    v_pk_fma_f32 v[132:133], v[80:81], v[80:81], v[132:133]
    v_pk_add_f32 v[126:127], v[126:127], v[82:83]
    v_pk_fma_f32 v[134:135], v[82:83], v[82:83], v[134:135]
    v_pk_add_f32 v[128:129], v[128:129], v[84:85]
    v_pk_fma_f32 v[136:137], v[84:85], v[84:85], v[136:137]
    v_pk_add_f32 v[130:131], v[130:131], v[86:87]
    v_pk_fma_f32 v[138:139], v[86:87], v[86:87], v[138:139]
    v_pk_mul_f32 v[88:89], v[88:89], v[140:141]
    v_pk_mul_f32 v[90:91], v[90:91], v[142:143]
    v_pk_mul_f32 v[92:93], v[92:93], v[144:145]
    v_pk_mul_f32 v[94:95], v[94:95], v[146:147]
    v_pk_mul_f32 v[152:153], v[88:89], v[88:89]
    v_pk_mul_f32 v[154:155], v[90:91], v[90:91]
    v_pk_mul_f32 v[156:157], v[92:93], v[92:93]
    v_pk_mul_f32 v[158:159], v[94:95], v[94:95]
    v_pk_fma_f32 v[152:153], v[152:153], s[78:79], s[78:79] op_sel:[0,0,1] op_sel_hi:[1,0,1]
    v_pk_fma_f32 v[154:155], v[154:155], s[78:79], s[78:79] op_sel:[0,0,1] op_sel_hi:[1,0,1]
    v_pk_fma_f32 v[156:157], v[156:157], s[78:79], s[78:79] op_sel:[0,0,1] op_sel_hi:[1,0,1]
    v_pk_fma_f32 v[158:159], v[158:159], s[78:79], s[78:79] op_sel:[0,0,1] op_sel_hi:[1,0,1]
    v_pk_mul_f32 v[152:153], v[152:153], v[88:89]
    v_pk_mul_f32 v[154:155], v[154:155], v[90:91]
    v_pk_mul_f32 v[156:157], v[156:157], v[92:93]
    v_pk_mul_f32 v[158:159], v[158:159], v[94:95]
    v_exp_f32 v152, v152
    v_exp_f32 v153, v153
    v_exp_f32 v154, v154
    v_exp_f32 v155, v155
    v_exp_f32 v156, v156
    v_exp_f32 v157, v157
    v_exp_f32 v158, v158
    v_exp_f32 v159, v159
    v_pk_add_f32 v[152:153], v[152:153], 1.0 op_sel_hi:[1,0]
    v_pk_add_f32 v[154:155], v[154:155], 1.0 op_sel_hi:[1,0]
    v_pk_add_f32 v[156:157], v[156:157], 1.0 op_sel_hi:[1,0]
    v_pk_add_f32 v[158:159], v[158:159], 1.0 op_sel_hi:[1,0]
    v_rcp_f32 v152, v152
    v_rcp_f32 v153, v153
    v_rcp_f32 v154, v154
    v_rcp_f32 v155, v155
    v_rcp_f32 v156, v156
    v_rcp_f32 v157, v157
    v_rcp_f32 v158, v158
    v_rcp_f32 v159, v159
    v_pk_mul_f32 v[88:89], v[88:89], v[152:153]
    v_pk_mul_f32 v[90:91], v[90:91], v[154:155]
    v_pk_mul_f32 v[92:93], v[92:93], v[156:157]
    v_pk_mul_f32 v[94:95], v[94:95], v[158:159]
    v_pk_add_f32 v[124:125], v[124:125], v[88:89]
    v_pk_fma_f32 v[132:133], v[88:89], v[88:89], v[132:133]
    v_pk_add_f32 v[126:127], v[126:127], v[90:91]
    v_pk_fma_f32 v[134:135], v[90:91], v[90:91], v[134:135]
    v_pk_add_f32 v[128:129], v[128:129], v[92:93]
    v_pk_fma_f32 v[136:137], v[92:93], v[92:93], v[136:137]
    v_pk_add_f32 v[130:131], v[130:131], v[94:95]
    v_pk_fma_f32 v[138:139], v[94:95], v[94:95], v[138:139]
    v_cndmask_b32 v140, v132, v124, s[64:65]
    v_cndmask_b32 v124, v124, v132, s[64:65]
    v_cndmask_b32 v141, v133, v125, s[64:65]
    v_cndmask_b32 v125, v125, v133, s[64:65]
    v_cndmask_b32 v142, v134, v126, s[64:65]
    v_cndmask_b32 v126, v126, v134, s[64:65]
    v_cndmask_b32 v143, v135, v127, s[64:65]
    v_cndmask_b32 v127, v127, v135, s[64:65]
    v_cndmask_b32 v144, v136, v128, s[64:65]
    v_cndmask_b32 v128, v128, v136, s[64:65]
    v_cndmask_b32 v145, v137, v129, s[64:65]
    v_cndmask_b32 v129, v129, v137, s[64:65]
    v_cndmask_b32 v146, v138, v130, s[64:65]
    v_cndmask_b32 v130, v130, v138, s[64:65]
    v_cndmask_b32 v147, v139, v131, s[64:65]
    v_cndmask_b32 v131, v131, v139, s[64:65]
    s_nop 1
    v_add_f32_dpp v124, v140, v124 row_ror:8 row_mask:0xf bank_mask:0xf
    v_add_f32_dpp v125, v141, v125 row_ror:8 row_mask:0xf bank_mask:0xf
    v_add_f32_dpp v126, v142, v126 row_ror:8 row_mask:0xf bank_mask:0xf
    v_add_f32_dpp v127, v143, v127 row_ror:8 row_mask:0xf bank_mask:0xf
    v_add_f32_dpp v128, v144, v128 row_ror:8 row_mask:0xf bank_mask:0xf
    v_add_f32_dpp v129, v145, v129 row_ror:8 row_mask:0xf bank_mask:0xf
    v_add_f32_dpp v130, v146, v130 row_ror:8 row_mask:0xf bank_mask:0xf
    v_add_f32_dpp v131, v147, v131 row_ror:8 row_mask:0xf bank_mask:0xf
    v_cndmask_b32 v140, v128, v124, s[66:67]
    v_cndmask_b32 v124, v124, v128, s[66:67]
    v_cndmask_b32 v141, v129, v125, s[66:67]
    v_cndmask_b32 v125, v125, v129, s[66:67]
    v_cndmask_b32 v142, v130, v126, s[66:67]
    v_cndmask_b32 v126, v126, v130, s[66:67]
    v_cndmask_b32 v143, v131, v127, s[66:67]
    v_cndmask_b32 v127, v127, v131, s[66:67]
    s_nop 1
    v_add_f32_dpp v124, v140, v124 row_half_mirror row_mask:0xf bank_mask:0xf
    v_add_f32_dpp v125, v141, v125 row_half_mirror row_mask:0xf bank_mask:0xf
    v_add_f32_dpp v126, v142, v126 row_half_mirror row_mask:0xf bank_mask:0xf
    v_add_f32_dpp v127, v143, v127 row_half_mirror row_mask:0xf bank_mask:0xf
    v_cndmask_b32 v140, v126, v124, s[68:69]
    v_cndmask_b32 v124, v124, v126, s[68:69]
    v_cndmask_b32 v141, v127, v125, s[68:69]
    v_cndmask_b32 v125, v125, v127, s[68:69]
    s_nop 1
    v_add_f32_dpp v124, v140, v124 quad_perm:[2,3,0,1] row_mask:0xf bank_mask:0xf
    v_add_f32_dpp v125, v141, v125 quad_perm:[2,3,0,1] row_mask:0xf bank_mask:0xf
    v_cndmask_b32 v140, v125, v124, s[70:71]
    v_cndmask_b32 v124, v124, v125, s[70:71]
    s_nop 1
    v_add_f32_dpp v124, v140, v124 quad_perm:[1,0,3,2] row_mask:0xf bank_mask:0xf
    ds_write_b32 v12, v124
    s_waitcnt lgkmcnt(0)
    s_barrier
    v_mfma_f32_16x16x32_bf16 v[16:19], v[104:107], v[96:99], 0
    ds_read_b64_tr_b16 v[124:125], v10 offset:24576
    v_mfma_f32_16x16x32_bf16 v[20:23], v[104:107], v[100:103], 0
    ds_read_b64_tr_b16 v[126:127], v10 offset:25600
    v_mfma_f32_16x16x32_bf16 v[24:27], v[108:111], v[96:99], 0
    ds_read_b64_tr_b16 v[128:129], v11 offset:24576
    v_mfma_f32_16x16x32_bf16 v[28:31], v[108:111], v[100:103], 0
    ds_read_b64_tr_b16 v[130:131], v11 offset:25600
    v_mfma_f32_16x16x32_bf16 v[32:35], v[112:115], v[96:99], 0
    ds_read_b128 v[132:135], v7 offset:18432
    v_mfma_f32_16x16x32_bf16 v[36:39], v[112:115], v[100:103], 0
    ds_read_b128 v[136:139], v7 offset:20480
    v_mfma_f32_16x16x32_bf16 v[40:43], v[116:119], v[96:99], 0
    ds_read_b128 v[140:143], v7 offset:22528
    v_mfma_f32_16x16x32_bf16 v[44:47], v[116:119], v[100:103], 0
    ds_read_b128 v[144:147], v7 offset:24576
    v_mfma_f32_16x16x32_bf16 v[48:51], v[120:123], v[96:99], 0
    ds_read_b128 v[148:151], v7 offset:26624
    v_mfma_f32_16x16x32_bf16 v[52:55], v[120:123], v[100:103], 0
    s_waitcnt lgkmcnt(0)
    s_barrier
    v_mfma_f32_16x16x32_bf16 v[16:19], v[132:135], v[124:127], v[16:19]
    ds_read_b64_tr_b16 v[96:97], v10 offset:32768
    v_mfma_f32_16x16x32_bf16 v[20:23], v[132:135], v[128:131], v[20:23]
    ds_read_b64_tr_b16 v[98:99], v10 offset:33792
    v_mfma_f32_16x16x32_bf16 v[24:27], v[136:139], v[124:127], v[24:27]
    ds_read_b64_tr_b16 v[100:101], v11 offset:32768
    v_mfma_f32_16x16x32_bf16 v[28:31], v[136:139], v[128:131], v[28:31]
    ds_read_b64_tr_b16 v[102:103], v11 offset:33792
    v_mfma_f32_16x16x32_bf16 v[32:35], v[140:143], v[124:127], v[32:35]
    ds_read_b128 v[104:107], v6 offset:36864
    v_mfma_f32_16x16x32_bf16 v[36:39], v[140:143], v[128:131], v[36:39]
    ds_read_b128 v[108:111], v6 offset:38912
    v_mfma_f32_16x16x32_bf16 v[40:43], v[144:147], v[124:127], v[40:43]
    ds_read_b128 v[112:115], v6 offset:40960
    v_mfma_f32_16x16x32_bf16 v[44:47], v[144:147], v[128:131], v[44:47]
    ds_read_b128 v[116:119], v6 offset:43008
    v_mfma_f32_16x16x32_bf16 v[48:51], v[148:151], v[124:127], v[48:51]
    ds_read_b128 v[120:123], v6 offset:45056
    v_mfma_f32_16x16x32_bf16 v[52:55], v[148:151], v[128:131], v[52:55]
    s_waitcnt lgkmcnt(0)
    v_mfma_f32_16x16x32_bf16 v[16:19], v[104:107], v[96:99], v[16:19]
    ds_read_b64_tr_b16 v[124:125], v10 offset:40960
    v_mfma_f32_16x16x32_bf16 v[20:23], v[104:107], v[100:103], v[20:23]
    ds_read_b64_tr_b16 v[126:127], v10 offset:41984
    v_mfma_f32_16x16x32_bf16 v[24:27], v[108:111], v[96:99], v[24:27]
    ds_read_b64_tr_b16 v[128:129], v11 offset:40960
    v_mfma_f32_16x16x32_bf16 v[28:31], v[108:111], v[100:103], v[28:31]
    ds_read_b64_tr_b16 v[130:131], v11 offset:41984
    v_mfma_f32_16x16x32_bf16 v[32:35], v[112:115], v[96:99], v[32:35]
    ds_read_b128 v[132:135], v7 offset:36864
    v_mfma_f32_16x16x32_bf16 v[36:39], v[112:115], v[100:103], v[36:39]
    ds_read_b128 v[136:139], v7 offset:38912
    v_mfma_f32_16x16x32_bf16 v[40:43], v[116:119], v[96:99], v[40:43]
    ds_read_b128 v[140:143], v7 offset:40960
    v_mfma_f32_16x16x32_bf16 v[44:47], v[116:119], v[100:103], v[44:47]
    ds_read_b128 v[144:147], v7 offset:43008
    v_mfma_f32_16x16x32_bf16 v[48:51], v[120:123], v[96:99], v[48:51]
    ds_read_b128 v[148:151], v7 offset:45056
    v_mfma_f32_16x16x32_bf16 v[52:55], v[120:123], v[100:103], v[52:55]
    s_waitcnt lgkmcnt(0)
    s_barrier
    v_mfma_f32_16x16x32_bf16 v[16:19], v[132:135], v[124:127], v[16:19]
    ds_read_b64_tr_b16 v[96:97], v10 offset:49152
    v_mfma_f32_16x16x32_bf16 v[20:23], v[132:135], v[128:131], v[20:23]
    ds_read_b64_tr_b16 v[98:99], v10 offset:50176
    v_mfma_f32_16x16x32_bf16 v[24:27], v[136:139], v[124:127], v[24:27]
    ds_read_b64_tr_b16 v[100:101], v11 offset:49152
    v_mfma_f32_16x16x32_bf16 v[28:31], v[136:139], v[128:131], v[28:31]
    ds_read_b64_tr_b16 v[102:103], v11 offset:50176
    v_mfma_f32_16x16x32_bf16 v[32:35], v[140:143], v[124:127], v[32:35]
    ds_read_b128 v[104:107], v6 offset:55296
    v_mfma_f32_16x16x32_bf16 v[36:39], v[140:143], v[128:131], v[36:39]
    ds_read_b128 v[108:111], v6 offset:57344
    v_mfma_f32_16x16x32_bf16 v[40:43], v[144:147], v[124:127], v[40:43]
    ds_read_b128 v[112:115], v6 offset:59392
    v_mfma_f32_16x16x32_bf16 v[44:47], v[144:147], v[128:131], v[44:47]
    ds_read_b128 v[116:119], v6 offset:61440
    v_mfma_f32_16x16x32_bf16 v[48:51], v[148:151], v[124:127], v[48:51]
    ds_read_b128 v[120:123], v6 offset:63488
    v_mfma_f32_16x16x32_bf16 v[52:55], v[148:151], v[128:131], v[52:55]
    s_waitcnt lgkmcnt(0)
    v_mfma_f32_16x16x32_bf16 v[16:19], v[104:107], v[96:99], v[16:19]
    ds_read_b64_tr_b16 v[124:125], v10 offset:57344
    v_mfma_f32_16x16x32_bf16 v[20:23], v[104:107], v[100:103], v[20:23]
    ds_read_b64_tr_b16 v[126:127], v10 offset:58368
    v_mfma_f32_16x16x32_bf16 v[24:27], v[108:111], v[96:99], v[24:27]
    ds_read_b64_tr_b16 v[128:129], v11 offset:57344
    v_mfma_f32_16x16x32_bf16 v[28:31], v[108:111], v[100:103], v[28:31]
    ds_read_b64_tr_b16 v[130:131], v11 offset:58368
    v_mfma_f32_16x16x32_bf16 v[32:35], v[112:115], v[96:99], v[32:35]
    ds_read_b128 v[132:135], v7 offset:55296
    v_mfma_f32_16x16x32_bf16 v[36:39], v[112:115], v[100:103], v[36:39]
    ds_read_b128 v[136:139], v7 offset:57344
    v_mfma_f32_16x16x32_bf16 v[40:43], v[116:119], v[96:99], v[40:43]
    ds_read_b128 v[140:143], v7 offset:59392
    v_mfma_f32_16x16x32_bf16 v[44:47], v[116:119], v[100:103], v[44:47]
    ds_read_b128 v[144:147], v7 offset:61440
    v_mfma_f32_16x16x32_bf16 v[48:51], v[120:123], v[96:99], v[48:51]
    ds_read_b128 v[148:151], v7 offset:63488
    v_mfma_f32_16x16x32_bf16 v[52:55], v[120:123], v[100:103], v[52:55]
    s_waitcnt lgkmcnt(0)
    s_barrier
    v_mfma_f32_16x16x32_bf16 v[16:19], v[132:135], v[124:127], v[16:19]
    ds_read_b64_tr_b16 v[96:97], v10 offset:0
    v_mfma_f32_16x16x32_bf16 v[20:23], v[132:135], v[128:131], v[20:23]
    ds_read_b64_tr_b16 v[98:99], v10 offset:1024
    v_mfma_f32_16x16x32_bf16 v[24:27], v[136:139], v[124:127], v[24:27]
    ds_read_b64_tr_b16 v[100:101], v11 offset:0
    v_mfma_f32_16x16x32_bf16 v[28:31], v[136:139], v[128:131], v[28:31]
    ds_read_b64_tr_b16 v[102:103], v11 offset:1024
    v_mfma_f32_16x16x32_bf16 v[32:35], v[140:143], v[124:127], v[32:35]
    ds_read_b128 v[104:107], v6 offset:0
    v_mfma_f32_16x16x32_bf16 v[36:39], v[140:143], v[128:131], v[36:39]
    ds_read_b128 v[108:111], v6 offset:2048
    v_mfma_f32_16x16x32_bf16 v[40:43], v[144:147], v[124:127], v[40:43]
    ds_read_b128 v[112:115], v6 offset:4096
    v_mfma_f32_16x16x32_bf16 v[44:47], v[144:147], v[128:131], v[44:47]
    ds_read_b128 v[116:119], v6 offset:6144
    v_mfma_f32_16x16x32_bf16 v[48:51], v[148:151], v[124:127], v[48:51]
    ds_read_b128 v[120:123], v6 offset:8192
    v_mfma_f32_16x16x32_bf16 v[52:55], v[148:151], v[128:131], v[52:55]
    s_waitcnt lgkmcnt(0)
    v_mfma_f32_16x16x32_bf16 v[16:19], v[104:107], v[96:99], v[16:19]
    ds_read_b64_tr_b16 v[124:125], v10 offset:8192
    v_mfma_f32_16x16x32_bf16 v[20:23], v[104:107], v[100:103], v[20:23]
    ds_read_b64_tr_b16 v[126:127], v10 offset:9216
    v_mfma_f32_16x16x32_bf16 v[24:27], v[108:111], v[96:99], v[24:27]
    ds_read_b64_tr_b16 v[128:129], v11 offset:8192
    v_mfma_f32_16x16x32_bf16 v[28:31], v[108:111], v[100:103], v[28:31]
    ds_read_b64_tr_b16 v[130:131], v11 offset:9216
    v_mfma_f32_16x16x32_bf16 v[32:35], v[112:115], v[96:99], v[32:35]
    ds_read_b128 v[132:135], v7 offset:0
    v_mfma_f32_16x16x32_bf16 v[36:39], v[112:115], v[100:103], v[36:39]
    ds_read_b128 v[136:139], v7 offset:2048
    v_mfma_f32_16x16x32_bf16 v[40:43], v[116:119], v[96:99], v[40:43]
    ds_read_b128 v[140:143], v7 offset:4096
    v_mfma_f32_16x16x32_bf16 v[44:47], v[116:119], v[100:103], v[44:47]
    ds_read_b128 v[144:147], v7 offset:6144
    v_mfma_f32_16x16x32_bf16 v[48:51], v[120:123], v[96:99], v[48:51]
    ds_read_b128 v[148:151], v7 offset:8192
    v_mfma_f32_16x16x32_bf16 v[52:55], v[120:123], v[100:103], v[52:55]
    s_waitcnt lgkmcnt(0)
    s_barrier
    v_mfma_f32_16x16x32_bf16 v[16:19], v[132:135], v[124:127], v[16:19]
    ds_read_b64_tr_b16 v[96:97], v10 offset:16384
    v_mfma_f32_16x16x32_bf16 v[20:23], v[132:135], v[128:131], v[20:23]
    ds_read_b64_tr_b16 v[98:99], v10 offset:17408
    v_mfma_f32_16x16x32_bf16 v[24:27], v[136:139], v[124:127], v[24:27]
    ds_read_b64_tr_b16 v[100:101], v11 offset:16384
    v_mfma_f32_16x16x32_bf16 v[28:31], v[136:139], v[128:131], v[28:31]
    ds_read_b64_tr_b16 v[102:103], v11 offset:17408
    v_mfma_f32_16x16x32_bf16 v[32:35], v[140:143], v[124:127], v[32:35]
    ds_read_b128 v[104:107], v6 offset:18432
    v_mfma_f32_16x16x32_bf16 v[36:39], v[140:143], v[128:131], v[36:39]
    ds_read_b128 v[108:111], v6 offset:20480
    v_mfma_f32_16x16x32_bf16 v[40:43], v[144:147], v[124:127], v[40:43]
    ds_read_b128 v[112:115], v6 offset:22528
    v_mfma_f32_16x16x32_bf16 v[44:47], v[144:147], v[128:131], v[44:47]
    ds_read_b128 v[116:119], v6 offset:24576
    v_mfma_f32_16x16x32_bf16 v[48:51], v[148:151], v[124:127], v[48:51]
    ds_read_b128 v[120:123], v6 offset:26624
    v_mfma_f32_16x16x32_bf16 v[52:55], v[148:151], v[128:131], v[52:55]
    s_waitcnt lgkmcnt(0)
    v_mfma_f32_16x16x32_bf16 v[16:19], v[104:107], v[96:99], v[16:19]
    ds_read_b64_tr_b16 v[124:125], v10 offset:24576
    v_mfma_f32_16x16x32_bf16 v[20:23], v[104:107], v[100:103], v[20:23]
    ds_read_b64_tr_b16 v[126:127], v10 offset:25600
    v_mfma_f32_16x16x32_bf16 v[24:27], v[108:111], v[96:99], v[24:27]
    ds_read_b64_tr_b16 v[128:129], v11 offset:24576
    v_mfma_f32_16x16x32_bf16 v[28:31], v[108:111], v[100:103], v[28:31]
    ds_read_b64_tr_b16 v[130:131], v11 offset:25600
    v_mfma_f32_16x16x32_bf16 v[32:35], v[112:115], v[96:99], v[32:35]
    ds_read_b128 v[132:135], v7 offset:18432
    v_mfma_f32_16x16x32_bf16 v[36:39], v[112:115], v[100:103], v[36:39]
    ds_read_b128 v[136:139], v7 offset:20480
    v_mfma_f32_16x16x32_bf16 v[40:43], v[116:119], v[96:99], v[40:43]
    ds_read_b128 v[140:143], v7 offset:22528
    v_mfma_f32_16x16x32_bf16 v[44:47], v[116:119], v[100:103], v[44:47]
    ds_read_b128 v[144:147], v7 offset:24576
    v_mfma_f32_16x16x32_bf16 v[48:51], v[120:123], v[96:99], v[48:51]
    ds_read_b128 v[148:151], v7 offset:26624
    v_mfma_f32_16x16x32_bf16 v[52:55], v[120:123], v[100:103], v[52:55]
    s_waitcnt lgkmcnt(0)
    s_barrier
    v_mfma_f32_16x16x32_bf16 v[16:19], v[132:135], v[124:127], v[16:19]
    ds_read_b64_tr_b16 v[96:97], v10 offset:32768
    v_mfma_f32_16x16x32_bf16 v[20:23], v[132:135], v[128:131], v[20:23]
    ds_read_b64_tr_b16 v[98:99], v10 offset:33792
    v_mfma_f32_16x16x32_bf16 v[24:27], v[136:139], v[124:127], v[24:27]
    ds_read_b64_tr_b16 v[100:101], v11 offset:32768
    v_mfma_f32_16x16x32_bf16 v[28:31], v[136:139], v[128:131], v[28:31]
    ds_read_b64_tr_b16 v[102:103], v11 offset:33792
    v_mfma_f32_16x16x32_bf16 v[32:35], v[140:143], v[124:127], v[32:35]
    ds_read_b128 v[104:107], v6 offset:36864
    v_mfma_f32_16x16x32_bf16 v[36:39], v[140:143], v[128:131], v[36:39]
    ds_read_b128 v[108:111], v6 offset:38912
    v_mfma_f32_16x16x32_bf16 v[40:43], v[144:147], v[124:127], v[40:43]
    ds_read_b128 v[112:115], v6 offset:40960
    v_mfma_f32_16x16x32_bf16 v[44:47], v[144:147], v[128:131], v[44:47]
    ds_read_b128 v[116:119], v6 offset:43008
    v_mfma_f32_16x16x32_bf16 v[48:51], v[148:151], v[124:127], v[48:51]
    ds_read_b128 v[120:123], v6 offset:45056
    v_mfma_f32_16x16x32_bf16 v[52:55], v[148:151], v[128:131], v[52:55]
    s_waitcnt lgkmcnt(0)
    v_add_u32 v15, 142336, v14
    ds_read_b128 v[124:127], v15 offset:0
    ds_read_b128 v[132:135], v15 offset:512
    ds_read_b128 v[128:131], v15 offset:64
    ds_read_b128 v[136:139], v15 offset:576
    v_lshlrev_b32 v13, 6, v3
    v_lshl_add_u32 v13, v4, 4, v13
    s_lshl_b32 s42, s10, 6
    s_lshl_b32 s44, s11, 2
    s_add_u32 s42, s42, s44
    s_add_u32 s42, s42, s40
    s_mul_i32 s42, s42, 9216
    v_add_u32 v13, s42, v13
    s_waitcnt lgkmcnt(0)
    v_pk_fma_f32 v[56:57], v[56:57], v[124:125], v[132:133] neg_lo:[0,0,1] neg_hi:[0,0,1]
    v_pk_fma_f32 v[58:59], v[58:59], v[126:127], v[134:135] neg_lo:[0,0,1] neg_hi:[0,0,1]
    v_pk_fma_f32 v[60:61], v[60:61], v[128:129], v[136:137] neg_lo:[0,0,1] neg_hi:[0,0,1]
    v_pk_fma_f32 v[62:63], v[62:63], v[130:131], v[138:139] neg_lo:[0,0,1] neg_hi:[0,0,1]
    v_cvt_pk_bf16_f32 v56, v56, v57
    v_cvt_pk_bf16_f32 v57, v58, v59
    v_cvt_pk_bf16_f32 v58, v60, v61
    v_cvt_pk_bf16_f32 v59, v62, v63
    s_mov_b32 s44, 0
    s_nop 0
    v_permlane32_swap_b32 v56, v58
    v_permlane32_swap_b32 v57, v59
    s_nop 0
    v_permlane16_swap_b32 v56, v58
    v_permlane16_swap_b32 v57, v59
    buffer_store_dwordx4 v[56:59], v13, s[24:27], s44 offen sc1
    v_pk_fma_f32 v[64:65], v[64:65], v[124:125], v[132:133] neg_lo:[0,0,1] neg_hi:[0,0,1]
    v_pk_fma_f32 v[66:67], v[66:67], v[126:127], v[134:135] neg_lo:[0,0,1] neg_hi:[0,0,1]
    v_pk_fma_f32 v[68:69], v[68:69], v[128:129], v[136:137] neg_lo:[0,0,1] neg_hi:[0,0,1]
    v_pk_fma_f32 v[70:71], v[70:71], v[130:131], v[138:139] neg_lo:[0,0,1] neg_hi:[0,0,1]
    v_cvt_pk_bf16_f32 v64, v64, v65
    v_cvt_pk_bf16_f32 v65, v66, v67
    v_cvt_pk_bf16_f32 v66, v68, v69
    v_cvt_pk_bf16_f32 v67, v70, v71
    s_mov_b32 s44, 1024
    s_nop 0
    v_permlane32_swap_b32 v64, v66
    v_permlane32_swap_b32 v65, v67
    s_nop 0
    v_permlane16_swap_b32 v64, v66
    v_permlane16_swap_b32 v65, v67
    buffer_store_dwordx4 v[64:67], v13, s[24:27], s44 offen sc1
    v_pk_fma_f32 v[72:73], v[72:73], v[124:125], v[132:133] neg_lo:[0,0,1] neg_hi:[0,0,1]
    v_pk_fma_f32 v[74:75], v[74:75], v[126:127], v[134:135] neg_lo:[0,0,1] neg_hi:[0,0,1]
    v_pk_fma_f32 v[76:77], v[76:77], v[128:129], v[136:137] neg_lo:[0,0,1] neg_hi:[0,0,1]
    v_pk_fma_f32 v[78:79], v[78:79], v[130:131], v[138:139] neg_lo:[0,0,1] neg_hi:[0,0,1]
    v_cvt_pk_bf16_f32 v72, v72, v73
    v_cvt_pk_bf16_f32 v73, v74, v75
    v_cvt_pk_bf16_f32 v74, v76, v77
    v_cvt_pk_bf16_f32 v75, v78, v79
    s_mov_b32 s44, 2048
    s_nop 0
    v_permlane32_swap_b32 v72, v74
    v_permlane32_swap_b32 v73, v75
    s_nop 0
    v_permlane16_swap_b32 v72, v74
    v_permlane16_swap_b32 v73, v75
    buffer_store_dwordx4 v[72:75], v13, s[24:27], s44 offen sc1
    v_pk_fma_f32 v[80:81], v[80:81], v[124:125], v[132:133] neg_lo:[0,0,1] neg_hi:[0,0,1]
    v_pk_fma_f32 v[82:83], v[82:83], v[126:127], v[134:135] neg_lo:[0,0,1] neg_hi:[0,0,1]
    v_pk_fma_f32 v[84:85], v[84:85], v[128:129], v[136:137] neg_lo:[0,0,1] neg_hi:[0,0,1]
    v_pk_fma_f32 v[86:87], v[86:87], v[130:131], v[138:139] neg_lo:[0,0,1] neg_hi:[0,0,1]
    v_cvt_pk_bf16_f32 v80, v80, v81
    v_cvt_pk_bf16_f32 v81, v82, v83
    v_cvt_pk_bf16_f32 v82, v84, v85
    v_cvt_pk_bf16_f32 v83, v86, v87
    s_mov_b32 s44, 3072
    s_nop 0
    v_permlane32_swap_b32 v80, v82
    v_permlane32_swap_b32 v81, v83
    s_nop 0
    v_permlane16_swap_b32 v80, v82
    v_permlane16_swap_b32 v81, v83
    buffer_store_dwordx4 v[80:83], v13, s[24:27], s44 offen sc1
    v_pk_fma_f32 v[88:89], v[88:89], v[124:125], v[132:133] neg_lo:[0,0,1] neg_hi:[0,0,1]
    v_pk_fma_f32 v[90:91], v[90:91], v[126:127], v[134:135] neg_lo:[0,0,1] neg_hi:[0,0,1]
    v_pk_fma_f32 v[92:93], v[92:93], v[128:129], v[136:137] neg_lo:[0,0,1] neg_hi:[0,0,1]
    v_pk_fma_f32 v[94:95], v[94:95], v[130:131], v[138:139] neg_lo:[0,0,1] neg_hi:[0,0,1]
    v_cvt_pk_bf16_f32 v88, v88, v89
    v_cvt_pk_bf16_f32 v89, v90, v91
    v_cvt_pk_bf16_f32 v90, v92, v93
    v_cvt_pk_bf16_f32 v91, v94, v95
    s_mov_b32 s44, 4096
    s_nop 0
    v_permlane32_swap_b32 v88, v90
    v_permlane32_swap_b32 v89, v91
    s_nop 0
    v_permlane16_swap_b32 v88, v90
    v_permlane16_swap_b32 v89, v91
    buffer_store_dwordx4 v[88:91], v13, s[24:27], s44 offen sc1
    v_mfma_f32_16x16x32_bf16 v[16:19], v[104:107], v[96:99], v[16:19]
    ds_read_b64_tr_b16 v[124:125], v10 offset:40960
    v_mfma_f32_16x16x32_bf16 v[20:23], v[104:107], v[100:103], v[20:23]
    ds_read_b64_tr_b16 v[126:127], v10 offset:41984
    v_mfma_f32_16x16x32_bf16 v[24:27], v[108:111], v[96:99], v[24:27]
    ds_read_b64_tr_b16 v[128:129], v11 offset:40960
    v_mfma_f32_16x16x32_bf16 v[28:31], v[108:111], v[100:103], v[28:31]
    ds_read_b64_tr_b16 v[130:131], v11 offset:41984
    v_mfma_f32_16x16x32_bf16 v[32:35], v[112:115], v[96:99], v[32:35]
    ds_read_b128 v[132:135], v7 offset:36864
    v_mfma_f32_16x16x32_bf16 v[36:39], v[112:115], v[100:103], v[36:39]
    ds_read_b128 v[136:139], v7 offset:38912
    v_mfma_f32_16x16x32_bf16 v[40:43], v[116:119], v[96:99], v[40:43]
    ds_read_b128 v[140:143], v7 offset:40960
    v_mfma_f32_16x16x32_bf16 v[44:47], v[116:119], v[100:103], v[44:47]
    ds_read_b128 v[144:147], v7 offset:43008
    v_mfma_f32_16x16x32_bf16 v[48:51], v[120:123], v[96:99], v[48:51]
    ds_read_b128 v[148:151], v7 offset:45056
    v_mfma_f32_16x16x32_bf16 v[52:55], v[120:123], v[100:103], v[52:55]
    s_waitcnt lgkmcnt(0)
    s_barrier
    v_mfma_f32_16x16x32_bf16 v[16:19], v[132:135], v[124:127], v[16:19]
    ds_read_b64_tr_b16 v[96:97], v10 offset:49152
    v_mfma_f32_16x16x32_bf16 v[20:23], v[132:135], v[128:131], v[20:23]
    ds_read_b64_tr_b16 v[98:99], v10 offset:50176
    v_mfma_f32_16x16x32_bf16 v[24:27], v[136:139], v[124:127], v[24:27]
    ds_read_b64_tr_b16 v[100:101], v11 offset:49152
    v_mfma_f32_16x16x32_bf16 v[28:31], v[136:139], v[128:131], v[28:31]
    ds_read_b64_tr_b16 v[102:103], v11 offset:50176
    v_mfma_f32_16x16x32_bf16 v[32:35], v[140:143], v[124:127], v[32:35]
    ds_read_b128 v[104:107], v6 offset:55296
    v_mfma_f32_16x16x32_bf16 v[36:39], v[140:143], v[128:131], v[36:39]
    ds_read_b128 v[108:111], v6 offset:57344
    v_mfma_f32_16x16x32_bf16 v[40:43], v[144:147], v[124:127], v[40:43]
    ds_read_b128 v[112:115], v6 offset:59392
    v_mfma_f32_16x16x32_bf16 v[44:47], v[144:147], v[128:131], v[44:47]
    ds_read_b128 v[116:119], v6 offset:61440
    v_mfma_f32_16x16x32_bf16 v[48:51], v[148:151], v[124:127], v[48:51]
    ds_read_b128 v[120:123], v6 offset:63488
    v_mfma_f32_16x16x32_bf16 v[52:55], v[148:151], v[128:131], v[52:55]
    s_waitcnt lgkmcnt(0)
    v_mfma_f32_16x16x32_bf16 v[16:19], v[104:107], v[96:99], v[16:19]
    ds_read_b64_tr_b16 v[124:125], v10 offset:57344
    v_mfma_f32_16x16x32_bf16 v[20:23], v[104:107], v[100:103], v[20:23]
    ds_read_b64_tr_b16 v[126:127], v10 offset:58368
    v_mfma_f32_16x16x32_bf16 v[24:27], v[108:111], v[96:99], v[24:27]
    ds_read_b64_tr_b16 v[128:129], v11 offset:57344
    v_mfma_f32_16x16x32_bf16 v[28:31], v[108:111], v[100:103], v[28:31]
    ds_read_b64_tr_b16 v[130:131], v11 offset:58368
    v_mfma_f32_16x16x32_bf16 v[32:35], v[112:115], v[96:99], v[32:35]
    ds_read_b128 v[132:135], v7 offset:55296
    v_mfma_f32_16x16x32_bf16 v[36:39], v[112:115], v[100:103], v[36:39]
    ds_read_b128 v[136:139], v7 offset:57344
    v_mfma_f32_16x16x32_bf16 v[40:43], v[116:119], v[96:99], v[40:43]
    ds_read_b128 v[140:143], v7 offset:59392
    v_mfma_f32_16x16x32_bf16 v[44:47], v[116:119], v[100:103], v[44:47]
    ds_read_b128 v[144:147], v7 offset:61440
    v_mfma_f32_16x16x32_bf16 v[48:51], v[120:123], v[96:99], v[48:51]
    ds_read_b128 v[148:151], v7 offset:63488
    v_mfma_f32_16x16x32_bf16 v[52:55], v[120:123], v[100:103], v[52:55]
    s_waitcnt lgkmcnt(0)
    s_waitcnt vmcnt(0)
    s_barrier
    v_mfma_f32_16x16x32_bf16 v[16:19], v[132:135], v[124:127], v[16:19]
    ds_read_b64_tr_b16 v[96:97], v10 offset:0
    v_mfma_f32_16x16x32_bf16 v[20:23], v[132:135], v[128:131], v[20:23]
    ds_read_b64_tr_b16 v[98:99], v10 offset:1024
    v_mfma_f32_16x16x32_bf16 v[24:27], v[136:139], v[124:127], v[24:27]
    ds_read_b64_tr_b16 v[100:101], v11 offset:0
    v_mfma_f32_16x16x32_bf16 v[28:31], v[136:139], v[128:131], v[28:31]
    ds_read_b64_tr_b16 v[102:103], v11 offset:1024
    v_mfma_f32_16x16x32_bf16 v[32:35], v[140:143], v[124:127], v[32:35]
    ds_read_b128 v[104:107], v6 offset:0
    v_mfma_f32_16x16x32_bf16 v[36:39], v[140:143], v[128:131], v[36:39]
    ds_read_b128 v[108:111], v6 offset:2048
    v_mfma_f32_16x16x32_bf16 v[40:43], v[144:147], v[124:127], v[40:43]
    ds_read_b128 v[112:115], v6 offset:4096
    v_mfma_f32_16x16x32_bf16 v[44:47], v[144:147], v[128:131], v[44:47]
    ds_read_b128 v[116:119], v6 offset:6144
    v_mfma_f32_16x16x32_bf16 v[48:51], v[148:151], v[124:127], v[48:51]
    ds_read_b128 v[120:123], v6 offset:8192
    v_mfma_f32_16x16x32_bf16 v[52:55], v[148:151], v[128:131], v[52:55]
    s_waitcnt lgkmcnt(0)
    v_mfma_f32_16x16x32_bf16 v[16:19], v[104:107], v[96:99], v[16:19]
    ds_read_b64_tr_b16 v[124:125], v10 offset:8192
    v_mfma_f32_16x16x32_bf16 v[20:23], v[104:107], v[100:103], v[20:23]
    ds_read_b64_tr_b16 v[126:127], v10 offset:9216
    v_mfma_f32_16x16x32_bf16 v[24:27], v[108:111], v[96:99], v[24:27]
    ds_read_b64_tr_b16 v[128:129], v11 offset:8192
    v_mfma_f32_16x16x32_bf16 v[28:31], v[108:111], v[100:103], v[28:31]
    ds_read_b64_tr_b16 v[130:131], v11 offset:9216
    v_mfma_f32_16x16x32_bf16 v[32:35], v[112:115], v[96:99], v[32:35]
    ds_read_b128 v[132:135], v7 offset:0
    v_mfma_f32_16x16x32_bf16 v[36:39], v[112:115], v[100:103], v[36:39]
    ds_read_b128 v[136:139], v7 offset:2048
    v_mfma_f32_16x16x32_bf16 v[40:43], v[116:119], v[96:99], v[40:43]
    ds_read_b128 v[140:143], v7 offset:4096
    v_mfma_f32_16x16x32_bf16 v[44:47], v[116:119], v[100:103], v[44:47]
    ds_read_b128 v[144:147], v7 offset:6144
    v_mfma_f32_16x16x32_bf16 v[48:51], v[120:123], v[96:99], v[48:51]
    ds_read_b128 v[148:151], v7 offset:8192
    v_mfma_f32_16x16x32_bf16 v[52:55], v[120:123], v[100:103], v[52:55]
    s_waitcnt lgkmcnt(0)
    s_barrier
    v_mfma_f32_16x16x32_bf16 v[16:19], v[132:135], v[124:127], v[16:19]
    ds_read_b64_tr_b16 v[96:97], v10 offset:16384
    v_mfma_f32_16x16x32_bf16 v[20:23], v[132:135], v[128:131], v[20:23]
    ds_read_b64_tr_b16 v[98:99], v10 offset:17408
    v_mfma_f32_16x16x32_bf16 v[24:27], v[136:139], v[124:127], v[24:27]
    ds_read_b64_tr_b16 v[100:101], v11 offset:16384
    v_mfma_f32_16x16x32_bf16 v[28:31], v[136:139], v[128:131], v[28:31]
    ds_read_b64_tr_b16 v[102:103], v11 offset:17408
    v_mfma_f32_16x16x32_bf16 v[32:35], v[140:143], v[124:127], v[32:35]
    ds_read_b128 v[104:107], v6 offset:18432
    v_mfma_f32_16x16x32_bf16 v[36:39], v[140:143], v[128:131], v[36:39]
    ds_read_b128 v[108:111], v6 offset:20480
    v_mfma_f32_16x16x32_bf16 v[40:43], v[144:147], v[124:127], v[40:43]
    ds_read_b128 v[112:115], v6 offset:22528
    v_mfma_f32_16x16x32_bf16 v[44:47], v[144:147], v[128:131], v[44:47]
    ds_read_b128 v[116:119], v6 offset:24576
    v_mfma_f32_16x16x32_bf16 v[48:51], v[148:151], v[124:127], v[48:51]
    ds_read_b128 v[120:123], v6 offset:26624
    v_mfma_f32_16x16x32_bf16 v[52:55], v[148:151], v[128:131], v[52:55]
    s_waitcnt lgkmcnt(0)
    v_mfma_f32_16x16x32_bf16 v[16:19], v[104:107], v[96:99], v[16:19]
    ds_read_b64_tr_b16 v[124:125], v10 offset:24576
    v_mfma_f32_16x16x32_bf16 v[20:23], v[104:107], v[100:103], v[20:23]
    ds_read_b64_tr_b16 v[126:127], v10 offset:25600
    v_mfma_f32_16x16x32_bf16 v[24:27], v[108:111], v[96:99], v[24:27]
    ds_read_b64_tr_b16 v[128:129], v11 offset:24576
    v_mfma_f32_16x16x32_bf16 v[28:31], v[108:111], v[100:103], v[28:31]
    ds_read_b64_tr_b16 v[130:131], v11 offset:25600
    v_mfma_f32_16x16x32_bf16 v[32:35], v[112:115], v[96:99], v[32:35]
    ds_read_b128 v[132:135], v7 offset:18432
    v_mfma_f32_16x16x32_bf16 v[36:39], v[112:115], v[100:103], v[36:39]
    ds_read_b128 v[136:139], v7 offset:20480
    v_mfma_f32_16x16x32_bf16 v[40:43], v[116:119], v[96:99], v[40:43]
    ds_read_b128 v[140:143], v7 offset:22528
    v_mfma_f32_16x16x32_bf16 v[44:47], v[116:119], v[100:103], v[44:47]
    ds_read_b128 v[144:147], v7 offset:24576
    v_mfma_f32_16x16x32_bf16 v[48:51], v[120:123], v[96:99], v[48:51]
    ds_read_b128 v[148:151], v7 offset:26624
    v_mfma_f32_16x16x32_bf16 v[52:55], v[120:123], v[100:103], v[52:55]
    s_waitcnt lgkmcnt(0)
    s_barrier
    v_mfma_f32_16x16x32_bf16 v[16:19], v[132:135], v[124:127], v[16:19]
    v_mfma_f32_16x16x32_bf16 v[20:23], v[132:135], v[128:131], v[20:23]
    v_mfma_f32_16x16x32_bf16 v[24:27], v[136:139], v[124:127], v[24:27]
    v_mfma_f32_16x16x32_bf16 v[28:31], v[136:139], v[128:131], v[28:31]
    v_mfma_f32_16x16x32_bf16 v[32:35], v[140:143], v[124:127], v[32:35]
    v_mfma_f32_16x16x32_bf16 v[36:39], v[140:143], v[128:131], v[36:39]
    v_mfma_f32_16x16x32_bf16 v[40:43], v[144:147], v[124:127], v[40:43]
    v_mfma_f32_16x16x32_bf16 v[44:47], v[144:147], v[128:131], v[44:47]
    v_mfma_f32_16x16x32_bf16 v[48:51], v[148:151], v[124:127], v[48:51]
    v_mfma_f32_16x16x32_bf16 v[52:55], v[148:151], v[128:131], v[52:55]
    v_lshlrev_b32 v12, 2, v3
    s_lshl_b32 s42, s40, 7
    s_add_u32 s42, s42, 139264
    v_add_u32 v12, s42, v12
    ds_read_b32 v142, v12
    ds_read_b32 v146, v12 offset:64
    s_lshl_b32 s42, s40, 5
    s_add_u32 s42, s42, s13
    v_add_u32 v14, s42, v3
    v_lshlrev_b32 v15, 1, v14
    buffer_load_ushort v160, v15, s[32:35], 0 offen
    buffer_load_ushort v162, v15, s[32:35], 0 offen offset:32
    v_lshlrev_b32 v12, 2, v3
    s_lshl_b32 s42, s40, 7
    s_add_u32 s42, s42, 139776
    v_add_u32 v13, s42, v12
    ds_read_b32 v124, v13
    ds_read_b32 v126, v13 offset:64
    v_add_u32 v12, 143360, v12
    v_lshrrev_b32 v13, 2, v3
    v_lshlrev_b32 v13, 4, v13
    v_add_u32 v13, v13, v12
    ds_read_b32 v128, v13 offset:0
    v_mov_b32 v129, 0
    ds_read_b32 v130, v13 offset:16
    v_mov_b32 v131, 0
    ds_read_b32 v132, v13 offset:128
    v_mov_b32 v133, 0
    ds_read_b32 v134, v13 offset:144
    v_mov_b32 v135, 0
    ds_read_b32 v136, v12 offset:256
    v_mov_b32 v137, 0
    v_mov_b32 v125, 0
    v_mov_b32 v127, 0
    v_cmp_eq_u32 vcc, 0, v4
    s_nop 0
    s_waitcnt lgkmcnt(0)
    v_cndmask_b32 v124, 0, v124, vcc
    v_cndmask_b32 v126, 0, v126, vcc
    s_nop 1
    v_mfma_f32_16x16x16_bf16 v[16:19], v[128:129], v[124:125], v[16:19]
    v_mfma_f32_16x16x16_bf16 v[20:23], v[128:129], v[126:127], v[20:23]
    v_mfma_f32_16x16x16_bf16 v[24:27], v[130:131], v[124:125], v[24:27]
    v_mfma_f32_16x16x16_bf16 v[28:31], v[130:131], v[126:127], v[28:31]
    v_mfma_f32_16x16x16_bf16 v[32:35], v[132:133], v[124:125], v[32:35]
    v_mfma_f32_16x16x16_bf16 v[36:39], v[132:133], v[126:127], v[36:39]
    v_mfma_f32_16x16x16_bf16 v[40:43], v[134:135], v[124:125], v[40:43]
    v_mfma_f32_16x16x16_bf16 v[44:47], v[134:135], v[126:127], v[44:47]
    v_mfma_f32_16x16x16_bf16 v[48:51], v[136:137], v[124:125], v[48:51]
    v_mfma_f32_16x16x16_bf16 v[52:55], v[136:137], v[126:127], v[52:55]
    v_mul_f32 v141, 0xc0135761, v142
    v_mul_f32 v140, v142, v142
    v_mul_f32 v140, v140, v142
    v_mul_f32 v140, 0xbdd2d3e8, v140
    v_rcp_f32 v142, v142
    v_mul_f32 v145, 0xc0135761, v146
    v_mul_f32 v144, v146, v146
    v_mul_f32 v144, v144, v146
    v_mul_f32 v144, 0xbdd2d3e8, v144
    v_rcp_f32 v146, v146
    s_nop 1
    v_mov_b32 v156, v140
    v_mov_b32 v157, v141
    v_mov_b32 v158, v142
    v_mov_b32 v159, v144
    v_mov_b32 v161, v145
    v_mov_b32 v163, v146
    s_barrier
    ds_read_b128 v[96:99], v8 offset:32768
    ds_read_b128 v[100:103], v8 offset:34816
    ds_read_b128 v[104:107], v6 offset:36864
    ds_read_b128 v[108:111], v6 offset:38912
    ds_read_b128 v[112:115], v6 offset:40960
    ds_read_b128 v[116:119], v6 offset:43008
    ds_read_b128 v[120:123], v6 offset:45056
    s_waitcnt lgkmcnt(0)
    v_mfma_f32_16x16x32_bf16 v[56:59], v[104:107], v[96:99], 0
    ds_read_b128 v[124:127], v9 offset:32768
    v_mul_f32 v152, v16, v16
    v_mfma_f32_16x16x32_bf16 v[60:63], v[104:107], v[100:103], 0
    ds_read_b128 v[128:131], v9 offset:34816
    v_mul_f32 v153, v17, v17
    v_mfma_f32_16x16x32_bf16 v[64:67], v[108:111], v[96:99], 0
    ds_read_b128 v[132:135], v7 offset:36864
    v_mul_f32 v154, v18, v18
    v_mfma_f32_16x16x32_bf16 v[68:71], v[108:111], v[100:103], 0
    ds_read_b128 v[136:139], v7 offset:38912
    v_mul_f32 v155, v19, v19
    v_mfma_f32_16x16x32_bf16 v[72:75], v[112:115], v[96:99], 0
    ds_read_b128 v[140:143], v7 offset:40960
    v_fma_f32 v152, v152, v156, v157
    v_mfma_f32_16x16x32_bf16 v[76:79], v[112:115], v[100:103], 0
    ds_read_b128 v[144:147], v7 offset:43008
    v_fma_f32 v153, v153, v156, v157
    v_mfma_f32_16x16x32_bf16 v[80:83], v[116:119], v[96:99], 0
    ds_read_b128 v[148:151], v7 offset:45056
    v_fma_f32 v154, v154, v156, v157
    v_mfma_f32_16x16x32_bf16 v[84:87], v[116:119], v[100:103], 0
    v_fma_f32 v155, v155, v156, v157
    v_mfma_f32_16x16x32_bf16 v[88:91], v[120:123], v[96:99], 0
    v_mul_f32 v152, v152, v16
    v_mfma_f32_16x16x32_bf16 v[92:95], v[120:123], v[100:103], 0
    v_mul_f32 v153, v153, v17
    s_waitcnt lgkmcnt(0)
    s_barrier
    v_mfma_f32_16x16x32_bf16 v[56:59], v[132:135], v[124:127], v[56:59]
    ds_read_b128 v[96:99], v8 offset:49152
    v_mul_f32 v154, v154, v18
    v_mul_f32 v155, v155, v19
    v_mfma_f32_16x16x32_bf16 v[60:63], v[132:135], v[128:131], v[60:63]
    ds_read_b128 v[100:103], v8 offset:51200
    v_exp_f32 v152, v152
    v_exp_f32 v153, v153
    v_mfma_f32_16x16x32_bf16 v[64:67], v[136:139], v[124:127], v[64:67]
    ds_read_b128 v[104:107], v6 offset:55296
    v_exp_f32 v154, v154
    v_exp_f32 v155, v155
    v_mfma_f32_16x16x32_bf16 v[68:71], v[136:139], v[128:131], v[68:71]
    ds_read_b128 v[108:111], v6 offset:57344
    v_fma_f32 v152, v152, v158, v158
    v_fma_f32 v153, v153, v158, v158
    v_mfma_f32_16x16x32_bf16 v[72:75], v[140:143], v[124:127], v[72:75]
    ds_read_b128 v[112:115], v6 offset:59392
    v_fma_f32 v154, v154, v158, v158
    v_fma_f32 v155, v155, v158, v158
    v_mfma_f32_16x16x32_bf16 v[76:79], v[140:143], v[128:131], v[76:79]
    ds_read_b128 v[116:119], v6 offset:61440
    v_rcp_f32 v152, v152
    v_rcp_f32 v153, v153
    v_mfma_f32_16x16x32_bf16 v[80:83], v[144:147], v[124:127], v[80:83]
    ds_read_b128 v[120:123], v6 offset:63488
    v_rcp_f32 v154, v154
    v_rcp_f32 v155, v155
    v_mfma_f32_16x16x32_bf16 v[84:87], v[144:147], v[128:131], v[84:87]
    v_mul_f32 v16, v16, v152
    v_mul_f32 v17, v17, v153
    v_mfma_f32_16x16x32_bf16 v[88:91], v[148:151], v[124:127], v[88:91]
    v_mul_f32 v18, v18, v154
    v_mul_f32 v19, v19, v155
    v_mfma_f32_16x16x32_bf16 v[92:95], v[148:151], v[128:131], v[92:95]
    v_mul_f32 v152, v20, v20
    v_mul_f32 v153, v21, v21
    s_waitcnt lgkmcnt(0)
    v_mfma_f32_16x16x32_bf16 v[56:59], v[104:107], v[96:99], v[56:59]
    ds_read_b128 v[124:127], v9 offset:49152
    v_mul_f32 v154, v22, v22
    v_mfma_f32_16x16x32_bf16 v[60:63], v[104:107], v[100:103], v[60:63]
    ds_read_b128 v[128:131], v9 offset:51200
    v_mul_f32 v155, v23, v23
    v_mfma_f32_16x16x32_bf16 v[64:67], v[108:111], v[96:99], v[64:67]
    ds_read_b128 v[132:135], v7 offset:55296
    v_fma_f32 v152, v152, v159, v161
    v_mfma_f32_16x16x32_bf16 v[68:71], v[108:111], v[100:103], v[68:71]
    ds_read_b128 v[136:139], v7 offset:57344
    v_fma_f32 v153, v153, v159, v161
    v_mfma_f32_16x16x32_bf16 v[72:75], v[112:115], v[96:99], v[72:75]
    ds_read_b128 v[140:143], v7 offset:59392
    v_fma_f32 v154, v154, v159, v161
    v_mfma_f32_16x16x32_bf16 v[76:79], v[112:115], v[100:103], v[76:79]
    ds_read_b128 v[144:147], v7 offset:61440
    v_fma_f32 v155, v155, v159, v161
    v_mfma_f32_16x16x32_bf16 v[80:83], v[116:119], v[96:99], v[80:83]
    ds_read_b128 v[148:151], v7 offset:63488
    v_mul_f32 v152, v152, v20
    v_mfma_f32_16x16x32_bf16 v[84:87], v[116:119], v[100:103], v[84:87]
    v_mul_f32 v153, v153, v21
    v_mfma_f32_16x16x32_bf16 v[88:91], v[120:123], v[96:99], v[88:91]
    v_mul_f32 v154, v154, v22
    v_mfma_f32_16x16x32_bf16 v[92:95], v[120:123], v[100:103], v[92:95]
    v_mul_f32 v155, v155, v23
    s_waitcnt lgkmcnt(0)
    s_barrier
    v_mfma_f32_16x16x32_bf16 v[56:59], v[132:135], v[124:127], v[56:59]
    ds_read_b128 v[96:99], v8 offset:0
    v_exp_f32 v152, v152
    v_mfma_f32_16x16x32_bf16 v[60:63], v[132:135], v[128:131], v[60:63]
    ds_read_b128 v[100:103], v8 offset:2048
    v_exp_f32 v153, v153
    v_mfma_f32_16x16x32_bf16 v[64:67], v[136:139], v[124:127], v[64:67]
    ds_read_b128 v[104:107], v6 offset:0
    v_exp_f32 v154, v154
    v_mfma_f32_16x16x32_bf16 v[68:71], v[136:139], v[128:131], v[68:71]
    ds_read_b128 v[108:111], v6 offset:2048
    v_exp_f32 v155, v155
    v_mfma_f32_16x16x32_bf16 v[72:75], v[140:143], v[124:127], v[72:75]
    ds_read_b128 v[112:115], v6 offset:4096
    v_fma_f32 v152, v152, v163, v163
    v_mfma_f32_16x16x32_bf16 v[76:79], v[140:143], v[128:131], v[76:79]
    ds_read_b128 v[116:119], v6 offset:6144
    v_fma_f32 v153, v153, v163, v163
    v_mfma_f32_16x16x32_bf16 v[80:83], v[144:147], v[124:127], v[80:83]
    ds_read_b128 v[120:123], v6 offset:8192
    v_fma_f32 v154, v154, v163, v163
    v_mfma_f32_16x16x32_bf16 v[84:87], v[144:147], v[128:131], v[84:87]
    v_fma_f32 v155, v155, v163, v163
    v_mfma_f32_16x16x32_bf16 v[88:91], v[148:151], v[124:127], v[88:91]
    v_rcp_f32 v152, v152
    v_mfma_f32_16x16x32_bf16 v[92:95], v[148:151], v[128:131], v[92:95]
    v_rcp_f32 v153, v153
    s_waitcnt lgkmcnt(0)
    v_mfma_f32_16x16x32_bf16 v[56:59], v[104:107], v[96:99], v[56:59]
    ds_read_b128 v[124:127], v9 offset:0
    v_rcp_f32 v154, v154
    v_mfma_f32_16x16x32_bf16 v[60:63], v[104:107], v[100:103], v[60:63]
    ds_read_b128 v[128:131], v9 offset:2048
    v_rcp_f32 v155, v155
    v_mfma_f32_16x16x32_bf16 v[64:67], v[108:111], v[96:99], v[64:67]
    ds_read_b128 v[132:135], v7 offset:0
    v_mul_f32 v20, v20, v152
    v_mfma_f32_16x16x32_bf16 v[68:71], v[108:111], v[100:103], v[68:71]
    ds_read_b128 v[136:139], v7 offset:2048
    v_mul_f32 v21, v21, v153
    v_mfma_f32_16x16x32_bf16 v[72:75], v[112:115], v[96:99], v[72:75]
    ds_read_b128 v[140:143], v7 offset:4096
    v_mul_f32 v22, v22, v154
    v_mfma_f32_16x16x32_bf16 v[76:79], v[112:115], v[100:103], v[76:79]
    ds_read_b128 v[144:147], v7 offset:6144
    v_mul_f32 v23, v23, v155
    v_mfma_f32_16x16x32_bf16 v[80:83], v[116:119], v[96:99], v[80:83]
    ds_read_b128 v[148:151], v7 offset:8192
    v_mul_f32 v152, v24, v24
    v_mfma_f32_16x16x32_bf16 v[84:87], v[116:119], v[100:103], v[84:87]
    v_mul_f32 v153, v25, v25
    v_mfma_f32_16x16x32_bf16 v[88:91], v[120:123], v[96:99], v[88:91]
    v_mul_f32 v154, v26, v26
    v_mfma_f32_16x16x32_bf16 v[92:95], v[120:123], v[100:103], v[92:95]
    v_mul_f32 v155, v27, v27
    s_waitcnt lgkmcnt(0)
    s_barrier
    v_mfma_f32_16x16x32_bf16 v[56:59], v[132:135], v[124:127], v[56:59]
    ds_read_b128 v[96:99], v8 offset:16384
    v_fma_f32 v152, v152, v156, v157
    v_fma_f32 v153, v153, v156, v157
    v_mfma_f32_16x16x32_bf16 v[60:63], v[132:135], v[128:131], v[60:63]
    ds_read_b128 v[100:103], v8 offset:18432
    v_fma_f32 v154, v154, v156, v157
    v_fma_f32 v155, v155, v156, v157
    v_mfma_f32_16x16x32_bf16 v[64:67], v[136:139], v[124:127], v[64:67]
    ds_read_b128 v[104:107], v6 offset:18432
    v_mul_f32 v152, v152, v24
    v_mul_f32 v153, v153, v25
    v_mfma_f32_16x16x32_bf16 v[68:71], v[136:139], v[128:131], v[68:71]
    ds_read_b128 v[108:111], v6 offset:20480
    v_mul_f32 v154, v154, v26
    v_mul_f32 v155, v155, v27
    v_mfma_f32_16x16x32_bf16 v[72:75], v[140:143], v[124:127], v[72:75]
    ds_read_b128 v[112:115], v6 offset:22528
    v_exp_f32 v152, v152
    v_exp_f32 v153, v153
    v_mfma_f32_16x16x32_bf16 v[76:79], v[140:143], v[128:131], v[76:79]
    ds_read_b128 v[116:119], v6 offset:24576
    v_exp_f32 v154, v154
    v_exp_f32 v155, v155
    v_mfma_f32_16x16x32_bf16 v[80:83], v[144:147], v[124:127], v[80:83]
    ds_read_b128 v[120:123], v6 offset:26624
    v_fma_f32 v152, v152, v158, v158
    v_fma_f32 v153, v153, v158, v158
    v_mfma_f32_16x16x32_bf16 v[84:87], v[144:147], v[128:131], v[84:87]
    v_fma_f32 v154, v154, v158, v158
    v_fma_f32 v155, v155, v158, v158
    v_mfma_f32_16x16x32_bf16 v[88:91], v[148:151], v[124:127], v[88:91]
    v_rcp_f32 v152, v152
    v_rcp_f32 v153, v153
    v_mfma_f32_16x16x32_bf16 v[92:95], v[148:151], v[128:131], v[92:95]
    v_rcp_f32 v154, v154
    v_rcp_f32 v155, v155
    s_waitcnt lgkmcnt(0)
    v_mfma_f32_16x16x32_bf16 v[56:59], v[104:107], v[96:99], v[56:59]
    ds_read_b128 v[124:127], v9 offset:16384
    v_mul_f32 v24, v24, v152
    v_mfma_f32_16x16x32_bf16 v[60:63], v[104:107], v[100:103], v[60:63]
    ds_read_b128 v[128:131], v9 offset:18432
    v_mul_f32 v25, v25, v153
    v_mfma_f32_16x16x32_bf16 v[64:67], v[108:111], v[96:99], v[64:67]
    ds_read_b128 v[132:135], v7 offset:18432
    v_mul_f32 v26, v26, v154
    v_mfma_f32_16x16x32_bf16 v[68:71], v[108:111], v[100:103], v[68:71]
    ds_read_b128 v[136:139], v7 offset:20480
    v_mul_f32 v27, v27, v155
    v_mfma_f32_16x16x32_bf16 v[72:75], v[112:115], v[96:99], v[72:75]
    ds_read_b128 v[140:143], v7 offset:22528
    v_mul_f32 v152, v28, v28
    v_mfma_f32_16x16x32_bf16 v[76:79], v[112:115], v[100:103], v[76:79]
    ds_read_b128 v[144:147], v7 offset:24576
    v_mul_f32 v153, v29, v29
    v_mfma_f32_16x16x32_bf16 v[80:83], v[116:119], v[96:99], v[80:83]
    ds_read_b128 v[148:151], v7 offset:26624
    v_mul_f32 v154, v30, v30
    v_mfma_f32_16x16x32_bf16 v[84:87], v[116:119], v[100:103], v[84:87]
    v_mul_f32 v155, v31, v31
    v_mfma_f32_16x16x32_bf16 v[88:91], v[120:123], v[96:99], v[88:91]
    v_fma_f32 v152, v152, v159, v161
    v_mfma_f32_16x16x32_bf16 v[92:95], v[120:123], v[100:103], v[92:95]
    v_fma_f32 v153, v153, v159, v161
    s_waitcnt lgkmcnt(0)
    s_barrier
    v_mfma_f32_16x16x32_bf16 v[56:59], v[132:135], v[124:127], v[56:59]
    ds_read_b128 v[96:99], v8 offset:32768
    v_fma_f32 v154, v154, v159, v161
    v_mfma_f32_16x16x32_bf16 v[60:63], v[132:135], v[128:131], v[60:63]
    ds_read_b128 v[100:103], v8 offset:34816
    v_fma_f32 v155, v155, v159, v161
    v_mfma_f32_16x16x32_bf16 v[64:67], v[136:139], v[124:127], v[64:67]
    ds_read_b128 v[104:107], v6 offset:36864
    v_mul_f32 v152, v152, v28
    v_mfma_f32_16x16x32_bf16 v[68:71], v[136:139], v[128:131], v[68:71]
    ds_read_b128 v[108:111], v6 offset:38912
    v_mul_f32 v153, v153, v29
    v_mfma_f32_16x16x32_bf16 v[72:75], v[140:143], v[124:127], v[72:75]
    ds_read_b128 v[112:115], v6 offset:40960
    v_mul_f32 v154, v154, v30
    v_mfma_f32_16x16x32_bf16 v[76:79], v[140:143], v[128:131], v[76:79]
    ds_read_b128 v[116:119], v6 offset:43008
    v_mul_f32 v155, v155, v31
    v_mfma_f32_16x16x32_bf16 v[80:83], v[144:147], v[124:127], v[80:83]
    ds_read_b128 v[120:123], v6 offset:45056
    v_exp_f32 v152, v152
    v_mfma_f32_16x16x32_bf16 v[84:87], v[144:147], v[128:131], v[84:87]
    v_exp_f32 v153, v153
    v_mfma_f32_16x16x32_bf16 v[88:91], v[148:151], v[124:127], v[88:91]
    v_exp_f32 v154, v154
    v_mfma_f32_16x16x32_bf16 v[92:95], v[148:151], v[128:131], v[92:95]
    v_exp_f32 v155, v155
    s_waitcnt lgkmcnt(0)
    v_mfma_f32_16x16x32_bf16 v[56:59], v[104:107], v[96:99], v[56:59]
    ds_read_b128 v[124:127], v9 offset:32768
    v_fma_f32 v152, v152, v163, v163
    v_mfma_f32_16x16x32_bf16 v[60:63], v[104:107], v[100:103], v[60:63]
    ds_read_b128 v[128:131], v9 offset:34816
    v_fma_f32 v153, v153, v163, v163
    v_mfma_f32_16x16x32_bf16 v[64:67], v[108:111], v[96:99], v[64:67]
    ds_read_b128 v[132:135], v7 offset:36864
    v_fma_f32 v154, v154, v163, v163
    v_mfma_f32_16x16x32_bf16 v[68:71], v[108:111], v[100:103], v[68:71]
    ds_read_b128 v[136:139], v7 offset:38912
    v_fma_f32 v155, v155, v163, v163
    v_mfma_f32_16x16x32_bf16 v[72:75], v[112:115], v[96:99], v[72:75]
    ds_read_b128 v[140:143], v7 offset:40960
    v_rcp_f32 v152, v152
    v_mfma_f32_16x16x32_bf16 v[76:79], v[112:115], v[100:103], v[76:79]
    ds_read_b128 v[144:147], v7 offset:43008
    v_rcp_f32 v153, v153
    v_mfma_f32_16x16x32_bf16 v[80:83], v[116:119], v[96:99], v[80:83]
    ds_read_b128 v[148:151], v7 offset:45056
    v_rcp_f32 v154, v154
    v_mfma_f32_16x16x32_bf16 v[84:87], v[116:119], v[100:103], v[84:87]
    v_rcp_f32 v155, v155
    v_mfma_f32_16x16x32_bf16 v[88:91], v[120:123], v[96:99], v[88:91]
    v_mul_f32 v28, v28, v152
    v_mfma_f32_16x16x32_bf16 v[92:95], v[120:123], v[100:103], v[92:95]
    v_mul_f32 v29, v29, v153
    s_waitcnt lgkmcnt(0)
    s_barrier
    v_mfma_f32_16x16x32_bf16 v[56:59], v[132:135], v[124:127], v[56:59]
    ds_read_b128 v[96:99], v8 offset:49152
    v_mul_f32 v30, v30, v154
    v_mul_f32 v31, v31, v155
    v_mfma_f32_16x16x32_bf16 v[60:63], v[132:135], v[128:131], v[60:63]
    ds_read_b128 v[100:103], v8 offset:51200
    v_mul_f32 v152, v32, v32
    v_mul_f32 v153, v33, v33
    v_mfma_f32_16x16x32_bf16 v[64:67], v[136:139], v[124:127], v[64:67]
    ds_read_b128 v[104:107], v6 offset:55296
    v_mul_f32 v154, v34, v34
    v_mul_f32 v155, v35, v35
    v_mfma_f32_16x16x32_bf16 v[68:71], v[136:139], v[128:131], v[68:71]
    ds_read_b128 v[108:111], v6 offset:57344
    v_fma_f32 v152, v152, v156, v157
    v_fma_f32 v153, v153, v156, v157
    v_mfma_f32_16x16x32_bf16 v[72:75], v[140:143], v[124:127], v[72:75]
    ds_read_b128 v[112:115], v6 offset:59392
    v_fma_f32 v154, v154, v156, v157
    v_fma_f32 v155, v155, v156, v157
    v_mfma_f32_16x16x32_bf16 v[76:79], v[140:143], v[128:131], v[76:79]
    ds_read_b128 v[116:119], v6 offset:61440
    v_mul_f32 v152, v152, v32
    v_mul_f32 v153, v153, v33
    v_mfma_f32_16x16x32_bf16 v[80:83], v[144:147], v[124:127], v[80:83]
    ds_read_b128 v[120:123], v6 offset:63488
    v_mul_f32 v154, v154, v34
    v_mul_f32 v155, v155, v35
    v_mfma_f32_16x16x32_bf16 v[84:87], v[144:147], v[128:131], v[84:87]
    v_exp_f32 v152, v152
    v_exp_f32 v153, v153
    v_mfma_f32_16x16x32_bf16 v[88:91], v[148:151], v[124:127], v[88:91]
    v_exp_f32 v154, v154
    v_exp_f32 v155, v155
    v_mfma_f32_16x16x32_bf16 v[92:95], v[148:151], v[128:131], v[92:95]
    v_fma_f32 v152, v152, v158, v158
    v_fma_f32 v153, v153, v158, v158
    s_waitcnt lgkmcnt(0)
    v_mfma_f32_16x16x32_bf16 v[56:59], v[104:107], v[96:99], v[56:59]
    ds_read_b128 v[124:127], v9 offset:49152
    v_fma_f32 v154, v154, v158, v158
    v_mfma_f32_16x16x32_bf16 v[60:63], v[104:107], v[100:103], v[60:63]
    ds_read_b128 v[128:131], v9 offset:51200
    v_fma_f32 v155, v155, v158, v158
    v_mfma_f32_16x16x32_bf16 v[64:67], v[108:111], v[96:99], v[64:67]
    ds_read_b128 v[132:135], v7 offset:55296
    v_rcp_f32 v152, v152
    v_mfma_f32_16x16x32_bf16 v[68:71], v[108:111], v[100:103], v[68:71]
    ds_read_b128 v[136:139], v7 offset:57344
    v_rcp_f32 v153, v153
    v_mfma_f32_16x16x32_bf16 v[72:75], v[112:115], v[96:99], v[72:75]
    ds_read_b128 v[140:143], v7 offset:59392
    v_rcp_f32 v154, v154
    v_mfma_f32_16x16x32_bf16 v[76:79], v[112:115], v[100:103], v[76:79]
    ds_read_b128 v[144:147], v7 offset:61440
    v_rcp_f32 v155, v155
    v_mfma_f32_16x16x32_bf16 v[80:83], v[116:119], v[96:99], v[80:83]
    ds_read_b128 v[148:151], v7 offset:63488
    v_mul_f32 v32, v32, v152
    v_mfma_f32_16x16x32_bf16 v[84:87], v[116:119], v[100:103], v[84:87]
    v_mul_f32 v33, v33, v153
    v_mfma_f32_16x16x32_bf16 v[88:91], v[120:123], v[96:99], v[88:91]
    v_mul_f32 v34, v34, v154
    v_mfma_f32_16x16x32_bf16 v[92:95], v[120:123], v[100:103], v[92:95]
    v_mul_f32 v35, v35, v155
    s_waitcnt lgkmcnt(0)
    s_barrier
    v_mfma_f32_16x16x32_bf16 v[56:59], v[132:135], v[124:127], v[56:59]
    ds_read_b128 v[96:99], v8 offset:0
    v_mul_f32 v152, v36, v36
    v_mfma_f32_16x16x32_bf16 v[60:63], v[132:135], v[128:131], v[60:63]
    ds_read_b128 v[100:103], v8 offset:2048
    v_mul_f32 v153, v37, v37
    v_mfma_f32_16x16x32_bf16 v[64:67], v[136:139], v[124:127], v[64:67]
    ds_read_b128 v[104:107], v6 offset:0
    v_mul_f32 v154, v38, v38
    v_mfma_f32_16x16x32_bf16 v[68:71], v[136:139], v[128:131], v[68:71]
    ds_read_b128 v[108:111], v6 offset:2048
    v_mul_f32 v155, v39, v39
    v_mfma_f32_16x16x32_bf16 v[72:75], v[140:143], v[124:127], v[72:75]
    ds_read_b128 v[112:115], v6 offset:4096
    v_fma_f32 v152, v152, v159, v161
    v_mfma_f32_16x16x32_bf16 v[76:79], v[140:143], v[128:131], v[76:79]
    ds_read_b128 v[116:119], v6 offset:6144
    v_fma_f32 v153, v153, v159, v161
    v_mfma_f32_16x16x32_bf16 v[80:83], v[144:147], v[124:127], v[80:83]
    ds_read_b128 v[120:123], v6 offset:8192
    v_fma_f32 v154, v154, v159, v161
    v_mfma_f32_16x16x32_bf16 v[84:87], v[144:147], v[128:131], v[84:87]
    v_fma_f32 v155, v155, v159, v161
    v_mfma_f32_16x16x32_bf16 v[88:91], v[148:151], v[124:127], v[88:91]
    v_mul_f32 v152, v152, v36
    v_mfma_f32_16x16x32_bf16 v[92:95], v[148:151], v[128:131], v[92:95]
    v_mul_f32 v153, v153, v37
    s_waitcnt lgkmcnt(0)
    v_mfma_f32_16x16x32_bf16 v[56:59], v[104:107], v[96:99], v[56:59]
    ds_read_b128 v[124:127], v9 offset:0
    v_mul_f32 v154, v154, v38
    v_mfma_f32_16x16x32_bf16 v[60:63], v[104:107], v[100:103], v[60:63]
    ds_read_b128 v[128:131], v9 offset:2048
    v_mul_f32 v155, v155, v39
    v_mfma_f32_16x16x32_bf16 v[64:67], v[108:111], v[96:99], v[64:67]
    ds_read_b128 v[132:135], v7 offset:0
    v_exp_f32 v152, v152
    v_mfma_f32_16x16x32_bf16 v[68:71], v[108:111], v[100:103], v[68:71]
    ds_read_b128 v[136:139], v7 offset:2048
    v_exp_f32 v153, v153
    v_mfma_f32_16x16x32_bf16 v[72:75], v[112:115], v[96:99], v[72:75]
    ds_read_b128 v[140:143], v7 offset:4096
    v_exp_f32 v154, v154
    v_mfma_f32_16x16x32_bf16 v[76:79], v[112:115], v[100:103], v[76:79]
    ds_read_b128 v[144:147], v7 offset:6144
    v_exp_f32 v155, v155
    v_mfma_f32_16x16x32_bf16 v[80:83], v[116:119], v[96:99], v[80:83]
    ds_read_b128 v[148:151], v7 offset:8192
    v_fma_f32 v152, v152, v163, v163
    v_mfma_f32_16x16x32_bf16 v[84:87], v[116:119], v[100:103], v[84:87]
    v_fma_f32 v153, v153, v163, v163
    v_mfma_f32_16x16x32_bf16 v[88:91], v[120:123], v[96:99], v[88:91]
    v_fma_f32 v154, v154, v163, v163
    v_mfma_f32_16x16x32_bf16 v[92:95], v[120:123], v[100:103], v[92:95]
    v_fma_f32 v155, v155, v163, v163
    s_waitcnt lgkmcnt(0)
    s_barrier
    v_mfma_f32_16x16x32_bf16 v[56:59], v[132:135], v[124:127], v[56:59]
    ds_read_b128 v[96:99], v8 offset:16384
    v_rcp_f32 v152, v152
    v_rcp_f32 v153, v153
    v_mfma_f32_16x16x32_bf16 v[60:63], v[132:135], v[128:131], v[60:63]
    ds_read_b128 v[100:103], v8 offset:18432
    v_rcp_f32 v154, v154
    v_rcp_f32 v155, v155
    v_mfma_f32_16x16x32_bf16 v[64:67], v[136:139], v[124:127], v[64:67]
    ds_read_b128 v[104:107], v6 offset:18432
    v_mul_f32 v36, v36, v152
    v_mul_f32 v37, v37, v153
    v_mfma_f32_16x16x32_bf16 v[68:71], v[136:139], v[128:131], v[68:71]
    ds_read_b128 v[108:111], v6 offset:20480
    v_mul_f32 v38, v38, v154
    v_mul_f32 v39, v39, v155
    v_mfma_f32_16x16x32_bf16 v[72:75], v[140:143], v[124:127], v[72:75]
    ds_read_b128 v[112:115], v6 offset:22528
    v_mul_f32 v152, v40, v40
    v_mul_f32 v153, v41, v41
    v_mfma_f32_16x16x32_bf16 v[76:79], v[140:143], v[128:131], v[76:79]
    ds_read_b128 v[116:119], v6 offset:24576
    v_mul_f32 v154, v42, v42
    v_mul_f32 v155, v43, v43
    v_mfma_f32_16x16x32_bf16 v[80:83], v[144:147], v[124:127], v[80:83]
    ds_read_b128 v[120:123], v6 offset:26624
    v_fma_f32 v152, v152, v156, v157
    v_fma_f32 v153, v153, v156, v157
    v_mfma_f32_16x16x32_bf16 v[84:87], v[144:147], v[128:131], v[84:87]
    v_fma_f32 v154, v154, v156, v157
    v_fma_f32 v155, v155, v156, v157
    v_mfma_f32_16x16x32_bf16 v[88:91], v[148:151], v[124:127], v[88:91]
    v_mul_f32 v152, v152, v40
    v_mul_f32 v153, v153, v41
    v_mfma_f32_16x16x32_bf16 v[92:95], v[148:151], v[128:131], v[92:95]
    v_mul_f32 v154, v154, v42
    v_mul_f32 v155, v155, v43
    s_waitcnt lgkmcnt(0)
    v_mfma_f32_16x16x32_bf16 v[56:59], v[104:107], v[96:99], v[56:59]
    ds_read_b128 v[124:127], v9 offset:16384
    v_exp_f32 v152, v152
    v_mfma_f32_16x16x32_bf16 v[60:63], v[104:107], v[100:103], v[60:63]
    ds_read_b128 v[128:131], v9 offset:18432
    v_exp_f32 v153, v153
    v_mfma_f32_16x16x32_bf16 v[64:67], v[108:111], v[96:99], v[64:67]
    ds_read_b128 v[132:135], v7 offset:18432
    v_exp_f32 v154, v154
    v_mfma_f32_16x16x32_bf16 v[68:71], v[108:111], v[100:103], v[68:71]
    ds_read_b128 v[136:139], v7 offset:20480
    v_exp_f32 v155, v155
    v_mfma_f32_16x16x32_bf16 v[72:75], v[112:115], v[96:99], v[72:75]
    ds_read_b128 v[140:143], v7 offset:22528
    v_fma_f32 v152, v152, v158, v158
    v_mfma_f32_16x16x32_bf16 v[76:79], v[112:115], v[100:103], v[76:79]
    ds_read_b128 v[144:147], v7 offset:24576
    v_fma_f32 v153, v153, v158, v158
    v_mfma_f32_16x16x32_bf16 v[80:83], v[116:119], v[96:99], v[80:83]
    ds_read_b128 v[148:151], v7 offset:26624
    v_fma_f32 v154, v154, v158, v158
    v_mfma_f32_16x16x32_bf16 v[84:87], v[116:119], v[100:103], v[84:87]
    v_fma_f32 v155, v155, v158, v158
    v_mfma_f32_16x16x32_bf16 v[88:91], v[120:123], v[96:99], v[88:91]
    v_rcp_f32 v152, v152
    v_mfma_f32_16x16x32_bf16 v[92:95], v[120:123], v[100:103], v[92:95]
    v_rcp_f32 v153, v153
    s_waitcnt lgkmcnt(0)
    s_barrier
    v_mfma_f32_16x16x32_bf16 v[56:59], v[132:135], v[124:127], v[56:59]
    ds_read_b128 v[96:99], v8 offset:32768
    v_rcp_f32 v154, v154
    v_mfma_f32_16x16x32_bf16 v[60:63], v[132:135], v[128:131], v[60:63]
    ds_read_b128 v[100:103], v8 offset:34816
    v_rcp_f32 v155, v155
    v_mfma_f32_16x16x32_bf16 v[64:67], v[136:139], v[124:127], v[64:67]
    ds_read_b128 v[104:107], v6 offset:36864
    v_mul_f32 v40, v40, v152
    v_mfma_f32_16x16x32_bf16 v[68:71], v[136:139], v[128:131], v[68:71]
    ds_read_b128 v[108:111], v6 offset:38912
    v_mul_f32 v41, v41, v153
    v_mfma_f32_16x16x32_bf16 v[72:75], v[140:143], v[124:127], v[72:75]
    ds_read_b128 v[112:115], v6 offset:40960
    v_mul_f32 v42, v42, v154
    v_mfma_f32_16x16x32_bf16 v[76:79], v[140:143], v[128:131], v[76:79]
    ds_read_b128 v[116:119], v6 offset:43008
    v_mul_f32 v43, v43, v155
    v_mfma_f32_16x16x32_bf16 v[80:83], v[144:147], v[124:127], v[80:83]
    ds_read_b128 v[120:123], v6 offset:45056
    v_mul_f32 v152, v44, v44
    v_mfma_f32_16x16x32_bf16 v[84:87], v[144:147], v[128:131], v[84:87]
    v_mul_f32 v153, v45, v45
    v_mfma_f32_16x16x32_bf16 v[88:91], v[148:151], v[124:127], v[88:91]
    v_mul_f32 v154, v46, v46
    v_mfma_f32_16x16x32_bf16 v[92:95], v[148:151], v[128:131], v[92:95]
    v_mul_f32 v155, v47, v47
    s_waitcnt lgkmcnt(0)
    v_mfma_f32_16x16x32_bf16 v[56:59], v[104:107], v[96:99], v[56:59]
    ds_read_b128 v[124:127], v9 offset:32768
    v_fma_f32 v152, v152, v159, v161
    v_mfma_f32_16x16x32_bf16 v[60:63], v[104:107], v[100:103], v[60:63]
    ds_read_b128 v[128:131], v9 offset:34816
    v_fma_f32 v153, v153, v159, v161
    v_mfma_f32_16x16x32_bf16 v[64:67], v[108:111], v[96:99], v[64:67]
    ds_read_b128 v[132:135], v7 offset:36864
    v_fma_f32 v154, v154, v159, v161
    v_mfma_f32_16x16x32_bf16 v[68:71], v[108:111], v[100:103], v[68:71]
    ds_read_b128 v[136:139], v7 offset:38912
    v_fma_f32 v155, v155, v159, v161
    v_mfma_f32_16x16x32_bf16 v[72:75], v[112:115], v[96:99], v[72:75]
    ds_read_b128 v[140:143], v7 offset:40960
    v_mul_f32 v152, v152, v44
    v_mfma_f32_16x16x32_bf16 v[76:79], v[112:115], v[100:103], v[76:79]
    ds_read_b128 v[144:147], v7 offset:43008
    v_mul_f32 v153, v153, v45
    v_mfma_f32_16x16x32_bf16 v[80:83], v[116:119], v[96:99], v[80:83]
    ds_read_b128 v[148:151], v7 offset:45056
    v_mul_f32 v154, v154, v46
    v_mfma_f32_16x16x32_bf16 v[84:87], v[116:119], v[100:103], v[84:87]
    v_mul_f32 v155, v155, v47
    v_mfma_f32_16x16x32_bf16 v[88:91], v[120:123], v[96:99], v[88:91]
    v_exp_f32 v152, v152
    v_mfma_f32_16x16x32_bf16 v[92:95], v[120:123], v[100:103], v[92:95]
    v_exp_f32 v153, v153
    s_waitcnt lgkmcnt(0)
    s_barrier
    v_mfma_f32_16x16x32_bf16 v[56:59], v[132:135], v[124:127], v[56:59]
    ds_read_b128 v[96:99], v8 offset:49152
    v_exp_f32 v154, v154
    v_exp_f32 v155, v155
    v_mfma_f32_16x16x32_bf16 v[60:63], v[132:135], v[128:131], v[60:63]
    ds_read_b128 v[100:103], v8 offset:51200
    v_fma_f32 v152, v152, v163, v163
    v_fma_f32 v153, v153, v163, v163
    v_mfma_f32_16x16x32_bf16 v[64:67], v[136:139], v[124:127], v[64:67]
    ds_read_b128 v[104:107], v6 offset:55296
    v_fma_f32 v154, v154, v163, v163
    v_fma_f32 v155, v155, v163, v163
    v_mfma_f32_16x16x32_bf16 v[68:71], v[136:139], v[128:131], v[68:71]
    ds_read_b128 v[108:111], v6 offset:57344
    v_rcp_f32 v152, v152
    v_rcp_f32 v153, v153
    v_mfma_f32_16x16x32_bf16 v[72:75], v[140:143], v[124:127], v[72:75]
    ds_read_b128 v[112:115], v6 offset:59392
    v_rcp_f32 v154, v154
    v_rcp_f32 v155, v155
    v_mfma_f32_16x16x32_bf16 v[76:79], v[140:143], v[128:131], v[76:79]
    ds_read_b128 v[116:119], v6 offset:61440
    v_mul_f32 v44, v44, v152
    v_mul_f32 v45, v45, v153
    v_mfma_f32_16x16x32_bf16 v[80:83], v[144:147], v[124:127], v[80:83]
    ds_read_b128 v[120:123], v6 offset:63488
    v_mul_f32 v46, v46, v154
    v_mul_f32 v47, v47, v155
    v_mfma_f32_16x16x32_bf16 v[84:87], v[144:147], v[128:131], v[84:87]
    v_mul_f32 v152, v48, v48
    v_mul_f32 v153, v49, v49
    v_mfma_f32_16x16x32_bf16 v[88:91], v[148:151], v[124:127], v[88:91]
    v_mul_f32 v154, v50, v50
    v_mul_f32 v155, v51, v51
    v_mfma_f32_16x16x32_bf16 v[92:95], v[148:151], v[128:131], v[92:95]
    v_fma_f32 v152, v152, v156, v157
    v_fma_f32 v153, v153, v156, v157
    s_waitcnt lgkmcnt(0)
    v_mfma_f32_16x16x32_bf16 v[56:59], v[104:107], v[96:99], v[56:59]
    ds_read_b128 v[124:127], v9 offset:49152
    v_fma_f32 v154, v154, v156, v157
    v_mfma_f32_16x16x32_bf16 v[60:63], v[104:107], v[100:103], v[60:63]
    ds_read_b128 v[128:131], v9 offset:51200
    v_fma_f32 v155, v155, v156, v157
    v_mfma_f32_16x16x32_bf16 v[64:67], v[108:111], v[96:99], v[64:67]
    ds_read_b128 v[132:135], v7 offset:55296
    v_mul_f32 v152, v152, v48
    v_mfma_f32_16x16x32_bf16 v[68:71], v[108:111], v[100:103], v[68:71]
    ds_read_b128 v[136:139], v7 offset:57344
    v_mul_f32 v153, v153, v49
    v_mfma_f32_16x16x32_bf16 v[72:75], v[112:115], v[96:99], v[72:75]
    ds_read_b128 v[140:143], v7 offset:59392
    v_mul_f32 v154, v154, v50
    v_mfma_f32_16x16x32_bf16 v[76:79], v[112:115], v[100:103], v[76:79]
    ds_read_b128 v[144:147], v7 offset:61440
    v_mul_f32 v155, v155, v51
    v_mfma_f32_16x16x32_bf16 v[80:83], v[116:119], v[96:99], v[80:83]
    ds_read_b128 v[148:151], v7 offset:63488
    v_exp_f32 v152, v152
    v_mfma_f32_16x16x32_bf16 v[84:87], v[116:119], v[100:103], v[84:87]
    v_exp_f32 v153, v153
    v_mfma_f32_16x16x32_bf16 v[88:91], v[120:123], v[96:99], v[88:91]
    v_exp_f32 v154, v154
    v_mfma_f32_16x16x32_bf16 v[92:95], v[120:123], v[100:103], v[92:95]
    v_exp_f32 v155, v155
    s_waitcnt lgkmcnt(0)
    s_barrier
    v_mfma_f32_16x16x32_bf16 v[56:59], v[132:135], v[124:127], v[56:59]
    ds_read_b128 v[96:99], v8 offset:0
    v_fma_f32 v152, v152, v158, v158
    v_mfma_f32_16x16x32_bf16 v[60:63], v[132:135], v[128:131], v[60:63]
    ds_read_b128 v[100:103], v8 offset:2048
    v_fma_f32 v153, v153, v158, v158
    v_mfma_f32_16x16x32_bf16 v[64:67], v[136:139], v[124:127], v[64:67]
    ds_read_b128 v[104:107], v6 offset:0
    v_fma_f32 v154, v154, v158, v158
    v_mfma_f32_16x16x32_bf16 v[68:71], v[136:139], v[128:131], v[68:71]
    ds_read_b128 v[108:111], v6 offset:2048
    v_fma_f32 v155, v155, v158, v158
    v_mfma_f32_16x16x32_bf16 v[72:75], v[140:143], v[124:127], v[72:75]
    ds_read_b128 v[112:115], v6 offset:4096
    v_rcp_f32 v152, v152
    v_mfma_f32_16x16x32_bf16 v[76:79], v[140:143], v[128:131], v[76:79]
    ds_read_b128 v[116:119], v6 offset:6144
    v_rcp_f32 v153, v153
    v_mfma_f32_16x16x32_bf16 v[80:83], v[144:147], v[124:127], v[80:83]
    ds_read_b128 v[120:123], v6 offset:8192
    v_rcp_f32 v154, v154
    v_mfma_f32_16x16x32_bf16 v[84:87], v[144:147], v[128:131], v[84:87]
    v_rcp_f32 v155, v155
    v_mfma_f32_16x16x32_bf16 v[88:91], v[148:151], v[124:127], v[88:91]
    v_mul_f32 v48, v48, v152
    v_mfma_f32_16x16x32_bf16 v[92:95], v[148:151], v[128:131], v[92:95]
    v_mul_f32 v49, v49, v153
    s_waitcnt lgkmcnt(0)
    v_mfma_f32_16x16x32_bf16 v[56:59], v[104:107], v[96:99], v[56:59]
    ds_read_b128 v[124:127], v9 offset:0
    v_mul_f32 v50, v50, v154
    v_mfma_f32_16x16x32_bf16 v[60:63], v[104:107], v[100:103], v[60:63]
    ds_read_b128 v[128:131], v9 offset:2048
    v_mul_f32 v51, v51, v155
    v_mfma_f32_16x16x32_bf16 v[64:67], v[108:111], v[96:99], v[64:67]
    ds_read_b128 v[132:135], v7 offset:0
    v_mul_f32 v152, v52, v52
    v_mfma_f32_16x16x32_bf16 v[68:71], v[108:111], v[100:103], v[68:71]
    ds_read_b128 v[136:139], v7 offset:2048
    v_mul_f32 v153, v53, v53
    v_mfma_f32_16x16x32_bf16 v[72:75], v[112:115], v[96:99], v[72:75]
    ds_read_b128 v[140:143], v7 offset:4096
    v_mul_f32 v154, v54, v54
    v_mfma_f32_16x16x32_bf16 v[76:79], v[112:115], v[100:103], v[76:79]
    ds_read_b128 v[144:147], v7 offset:6144
    v_mul_f32 v155, v55, v55
    v_mfma_f32_16x16x32_bf16 v[80:83], v[116:119], v[96:99], v[80:83]
    ds_read_b128 v[148:151], v7 offset:8192
    v_fma_f32 v152, v152, v159, v161
    v_mfma_f32_16x16x32_bf16 v[84:87], v[116:119], v[100:103], v[84:87]
    v_fma_f32 v153, v153, v159, v161
    v_mfma_f32_16x16x32_bf16 v[88:91], v[120:123], v[96:99], v[88:91]
    v_fma_f32 v154, v154, v159, v161
    v_mfma_f32_16x16x32_bf16 v[92:95], v[120:123], v[100:103], v[92:95]
    v_fma_f32 v155, v155, v159, v161
    s_waitcnt lgkmcnt(0)
    s_barrier
    v_mfma_f32_16x16x32_bf16 v[56:59], v[132:135], v[124:127], v[56:59]
    ds_read_b128 v[96:99], v8 offset:16384
    v_mul_f32 v152, v152, v52
    v_mul_f32 v153, v153, v53
    v_mfma_f32_16x16x32_bf16 v[60:63], v[132:135], v[128:131], v[60:63]
    ds_read_b128 v[100:103], v8 offset:18432
    v_mul_f32 v154, v154, v54
    v_mul_f32 v155, v155, v55
    v_mfma_f32_16x16x32_bf16 v[64:67], v[136:139], v[124:127], v[64:67]
    ds_read_b128 v[104:107], v6 offset:18432
    v_exp_f32 v152, v152
    v_exp_f32 v153, v153
    v_mfma_f32_16x16x32_bf16 v[68:71], v[136:139], v[128:131], v[68:71]
    ds_read_b128 v[108:111], v6 offset:20480
    v_exp_f32 v154, v154
    v_exp_f32 v155, v155
    v_mfma_f32_16x16x32_bf16 v[72:75], v[140:143], v[124:127], v[72:75]
    ds_read_b128 v[112:115], v6 offset:22528
    v_fma_f32 v152, v152, v163, v163
    v_fma_f32 v153, v153, v163, v163
    v_mfma_f32_16x16x32_bf16 v[76:79], v[140:143], v[128:131], v[76:79]
    ds_read_b128 v[116:119], v6 offset:24576
    v_fma_f32 v154, v154, v163, v163
    v_fma_f32 v155, v155, v163, v163
    v_mfma_f32_16x16x32_bf16 v[80:83], v[144:147], v[124:127], v[80:83]
    ds_read_b128 v[120:123], v6 offset:26624
    v_rcp_f32 v152, v152
    v_rcp_f32 v153, v153
    v_mfma_f32_16x16x32_bf16 v[84:87], v[144:147], v[128:131], v[84:87]
    v_rcp_f32 v154, v154
    v_rcp_f32 v155, v155
    v_mfma_f32_16x16x32_bf16 v[88:91], v[148:151], v[124:127], v[88:91]
    v_mul_f32 v52, v52, v152
    v_mul_f32 v53, v53, v153
    v_mfma_f32_16x16x32_bf16 v[92:95], v[148:151], v[128:131], v[92:95]
    v_mul_f32 v54, v54, v154
    v_mul_f32 v55, v55, v155
    s_waitcnt lgkmcnt(0)
    v_mfma_f32_16x16x32_bf16 v[56:59], v[104:107], v[96:99], v[56:59]
    ds_read_b128 v[124:127], v9 offset:16384
    v_mfma_f32_16x16x32_bf16 v[60:63], v[104:107], v[100:103], v[60:63]
    ds_read_b128 v[128:131], v9 offset:18432
    v_mfma_f32_16x16x32_bf16 v[64:67], v[108:111], v[96:99], v[64:67]
    ds_read_b128 v[132:135], v7 offset:18432
    v_mfma_f32_16x16x32_bf16 v[68:71], v[108:111], v[100:103], v[68:71]
    ds_read_b128 v[136:139], v7 offset:20480
    v_mfma_f32_16x16x32_bf16 v[72:75], v[112:115], v[96:99], v[72:75]
    ds_read_b128 v[140:143], v7 offset:22528
    v_mfma_f32_16x16x32_bf16 v[76:79], v[112:115], v[100:103], v[76:79]
    ds_read_b128 v[144:147], v7 offset:24576
    v_mfma_f32_16x16x32_bf16 v[80:83], v[116:119], v[96:99], v[80:83]
    ds_read_b128 v[148:151], v7 offset:26624
    v_mfma_f32_16x16x32_bf16 v[84:87], v[116:119], v[100:103], v[84:87]
    v_mfma_f32_16x16x32_bf16 v[88:91], v[120:123], v[96:99], v[88:91]
    v_mfma_f32_16x16x32_bf16 v[92:95], v[120:123], v[100:103], v[92:95]
    s_waitcnt lgkmcnt(0)
    s_barrier
    v_mfma_f32_16x16x32_bf16 v[56:59], v[132:135], v[124:127], v[56:59]
    ds_read_b128 v[96:99], v8 offset:32768
    v_mfma_f32_16x16x32_bf16 v[60:63], v[132:135], v[128:131], v[60:63]
    ds_read_b128 v[100:103], v8 offset:34816
    v_mfma_f32_16x16x32_bf16 v[64:67], v[136:139], v[124:127], v[64:67]
    ds_read_b128 v[104:107], v6 offset:36864
    v_mfma_f32_16x16x32_bf16 v[68:71], v[136:139], v[128:131], v[68:71]
    ds_read_b128 v[108:111], v6 offset:38912
    v_mfma_f32_16x16x32_bf16 v[72:75], v[140:143], v[124:127], v[72:75]
    ds_read_b128 v[112:115], v6 offset:40960
    v_mfma_f32_16x16x32_bf16 v[76:79], v[140:143], v[128:131], v[76:79]
    ds_read_b128 v[116:119], v6 offset:43008
    v_mfma_f32_16x16x32_bf16 v[80:83], v[144:147], v[124:127], v[80:83]
    ds_read_b128 v[120:123], v6 offset:45056
    v_mfma_f32_16x16x32_bf16 v[84:87], v[144:147], v[128:131], v[84:87]
    v_mfma_f32_16x16x32_bf16 v[88:91], v[148:151], v[124:127], v[88:91]
    v_mfma_f32_16x16x32_bf16 v[92:95], v[148:151], v[128:131], v[92:95]
    s_waitcnt lgkmcnt(0)
    s_mov_b32 s43, 5
lp_mega_kernel_7:
    v_mfma_f32_16x16x32_bf16 v[56:59], v[104:107], v[96:99], v[56:59]
    ds_read_b128 v[124:127], v9 offset:32768
    v_mfma_f32_16x16x32_bf16 v[60:63], v[104:107], v[100:103], v[60:63]
    ds_read_b128 v[128:131], v9 offset:34816
    v_mfma_f32_16x16x32_bf16 v[64:67], v[108:111], v[96:99], v[64:67]
    ds_read_b128 v[132:135], v7 offset:36864
    v_mfma_f32_16x16x32_bf16 v[68:71], v[108:111], v[100:103], v[68:71]
    ds_read_b128 v[136:139], v7 offset:38912
    v_mfma_f32_16x16x32_bf16 v[72:75], v[112:115], v[96:99], v[72:75]
    ds_read_b128 v[140:143], v7 offset:40960
    v_mfma_f32_16x16x32_bf16 v[76:79], v[112:115], v[100:103], v[76:79]
    ds_read_b128 v[144:147], v7 offset:43008
    v_mfma_f32_16x16x32_bf16 v[80:83], v[116:119], v[96:99], v[80:83]
    ds_read_b128 v[148:151], v7 offset:45056
    v_mfma_f32_16x16x32_bf16 v[84:87], v[116:119], v[100:103], v[84:87]
    v_mfma_f32_16x16x32_bf16 v[88:91], v[120:123], v[96:99], v[88:91]
    v_mfma_f32_16x16x32_bf16 v[92:95], v[120:123], v[100:103], v[92:95]
    s_waitcnt lgkmcnt(0)
    s_barrier
    v_mfma_f32_16x16x32_bf16 v[56:59], v[132:135], v[124:127], v[56:59]
    ds_read_b128 v[96:99], v8 offset:49152
    v_mfma_f32_16x16x32_bf16 v[60:63], v[132:135], v[128:131], v[60:63]
    ds_read_b128 v[100:103], v8 offset:51200
    v_mfma_f32_16x16x32_bf16 v[64:67], v[136:139], v[124:127], v[64:67]
    ds_read_b128 v[104:107], v6 offset:55296
    v_mfma_f32_16x16x32_bf16 v[68:71], v[136:139], v[128:131], v[68:71]
    ds_read_b128 v[108:111], v6 offset:57344
    v_mfma_f32_16x16x32_bf16 v[72:75], v[140:143], v[124:127], v[72:75]
    ds_read_b128 v[112:115], v6 offset:59392
    v_mfma_f32_16x16x32_bf16 v[76:79], v[140:143], v[128:131], v[76:79]
    ds_read_b128 v[116:119], v6 offset:61440
    v_mfma_f32_16x16x32_bf16 v[80:83], v[144:147], v[124:127], v[80:83]
    ds_read_b128 v[120:123], v6 offset:63488
    v_mfma_f32_16x16x32_bf16 v[84:87], v[144:147], v[128:131], v[84:87]
    v_mfma_f32_16x16x32_bf16 v[88:91], v[148:151], v[124:127], v[88:91]
    v_mfma_f32_16x16x32_bf16 v[92:95], v[148:151], v[128:131], v[92:95]
    s_waitcnt lgkmcnt(0)
    v_mfma_f32_16x16x32_bf16 v[56:59], v[104:107], v[96:99], v[56:59]
    ds_read_b128 v[124:127], v9 offset:49152
    v_mfma_f32_16x16x32_bf16 v[60:63], v[104:107], v[100:103], v[60:63]
    ds_read_b128 v[128:131], v9 offset:51200
    v_mfma_f32_16x16x32_bf16 v[64:67], v[108:111], v[96:99], v[64:67]
    ds_read_b128 v[132:135], v7 offset:55296
    v_mfma_f32_16x16x32_bf16 v[68:71], v[108:111], v[100:103], v[68:71]
    ds_read_b128 v[136:139], v7 offset:57344
    v_mfma_f32_16x16x32_bf16 v[72:75], v[112:115], v[96:99], v[72:75]
    ds_read_b128 v[140:143], v7 offset:59392
    v_mfma_f32_16x16x32_bf16 v[76:79], v[112:115], v[100:103], v[76:79]
    ds_read_b128 v[144:147], v7 offset:61440
    v_mfma_f32_16x16x32_bf16 v[80:83], v[116:119], v[96:99], v[80:83]
    ds_read_b128 v[148:151], v7 offset:63488
    v_mfma_f32_16x16x32_bf16 v[84:87], v[116:119], v[100:103], v[84:87]
    v_mfma_f32_16x16x32_bf16 v[88:91], v[120:123], v[96:99], v[88:91]
    v_mfma_f32_16x16x32_bf16 v[92:95], v[120:123], v[100:103], v[92:95]
    s_waitcnt lgkmcnt(0)
    s_barrier
    v_mfma_f32_16x16x32_bf16 v[56:59], v[132:135], v[124:127], v[56:59]
    ds_read_b128 v[96:99], v8 offset:0
    v_mfma_f32_16x16x32_bf16 v[60:63], v[132:135], v[128:131], v[60:63]
    ds_read_b128 v[100:103], v8 offset:2048
    v_mfma_f32_16x16x32_bf16 v[64:67], v[136:139], v[124:127], v[64:67]
    ds_read_b128 v[104:107], v6 offset:0
    v_mfma_f32_16x16x32_bf16 v[68:71], v[136:139], v[128:131], v[68:71]
    ds_read_b128 v[108:111], v6 offset:2048
    v_mfma_f32_16x16x32_bf16 v[72:75], v[140:143], v[124:127], v[72:75]
    ds_read_b128 v[112:115], v6 offset:4096
    v_mfma_f32_16x16x32_bf16 v[76:79], v[140:143], v[128:131], v[76:79]
    ds_read_b128 v[116:119], v6 offset:6144
    v_mfma_f32_16x16x32_bf16 v[80:83], v[144:147], v[124:127], v[80:83]
    ds_read_b128 v[120:123], v6 offset:8192
    v_mfma_f32_16x16x32_bf16 v[84:87], v[144:147], v[128:131], v[84:87]
    v_mfma_f32_16x16x32_bf16 v[88:91], v[148:151], v[124:127], v[88:91]
    v_mfma_f32_16x16x32_bf16 v[92:95], v[148:151], v[128:131], v[92:95]
    s_waitcnt lgkmcnt(0)
    v_mfma_f32_16x16x32_bf16 v[56:59], v[104:107], v[96:99], v[56:59]
    ds_read_b128 v[124:127], v9 offset:0
    v_mfma_f32_16x16x32_bf16 v[60:63], v[104:107], v[100:103], v[60:63]
    ds_read_b128 v[128:131], v9 offset:2048
    v_mfma_f32_16x16x32_bf16 v[64:67], v[108:111], v[96:99], v[64:67]
    ds_read_b128 v[132:135], v7 offset:0
    v_mfma_f32_16x16x32_bf16 v[68:71], v[108:111], v[100:103], v[68:71]
    ds_read_b128 v[136:139], v7 offset:2048
    v_mfma_f32_16x16x32_bf16 v[72:75], v[112:115], v[96:99], v[72:75]
    ds_read_b128 v[140:143], v7 offset:4096
    v_mfma_f32_16x16x32_bf16 v[76:79], v[112:115], v[100:103], v[76:79]
    ds_read_b128 v[144:147], v7 offset:6144
    v_mfma_f32_16x16x32_bf16 v[80:83], v[116:119], v[96:99], v[80:83]
    ds_read_b128 v[148:151], v7 offset:8192
    v_mfma_f32_16x16x32_bf16 v[84:87], v[116:119], v[100:103], v[84:87]
    v_mfma_f32_16x16x32_bf16 v[88:91], v[120:123], v[96:99], v[88:91]
    v_mfma_f32_16x16x32_bf16 v[92:95], v[120:123], v[100:103], v[92:95]
    s_waitcnt lgkmcnt(0)
    s_barrier
    v_mfma_f32_16x16x32_bf16 v[56:59], v[132:135], v[124:127], v[56:59]
    ds_read_b128 v[96:99], v8 offset:16384
    v_mfma_f32_16x16x32_bf16 v[60:63], v[132:135], v[128:131], v[60:63]
    ds_read_b128 v[100:103], v8 offset:18432
    v_mfma_f32_16x16x32_bf16 v[64:67], v[136:139], v[124:127], v[64:67]
    ds_read_b128 v[104:107], v6 offset:18432
    v_mfma_f32_16x16x32_bf16 v[68:71], v[136:139], v[128:131], v[68:71]
    ds_read_b128 v[108:111], v6 offset:20480
    v_mfma_f32_16x16x32_bf16 v[72:75], v[140:143], v[124:127], v[72:75]
    ds_read_b128 v[112:115], v6 offset:22528
    v_mfma_f32_16x16x32_bf16 v[76:79], v[140:143], v[128:131], v[76:79]
    ds_read_b128 v[116:119], v6 offset:24576
    v_mfma_f32_16x16x32_bf16 v[80:83], v[144:147], v[124:127], v[80:83]
    ds_read_b128 v[120:123], v6 offset:26624
    v_mfma_f32_16x16x32_bf16 v[84:87], v[144:147], v[128:131], v[84:87]
    v_mfma_f32_16x16x32_bf16 v[88:91], v[148:151], v[124:127], v[88:91]
    v_mfma_f32_16x16x32_bf16 v[92:95], v[148:151], v[128:131], v[92:95]
    s_waitcnt lgkmcnt(0)
    v_mfma_f32_16x16x32_bf16 v[56:59], v[104:107], v[96:99], v[56:59]
    ds_read_b128 v[124:127], v9 offset:16384
    v_mfma_f32_16x16x32_bf16 v[60:63], v[104:107], v[100:103], v[60:63]
    ds_read_b128 v[128:131], v9 offset:18432
    v_mfma_f32_16x16x32_bf16 v[64:67], v[108:111], v[96:99], v[64:67]
    ds_read_b128 v[132:135], v7 offset:18432
    v_mfma_f32_16x16x32_bf16 v[68:71], v[108:111], v[100:103], v[68:71]
    ds_read_b128 v[136:139], v7 offset:20480
    v_mfma_f32_16x16x32_bf16 v[72:75], v[112:115], v[96:99], v[72:75]
    ds_read_b128 v[140:143], v7 offset:22528
    v_mfma_f32_16x16x32_bf16 v[76:79], v[112:115], v[100:103], v[76:79]
    ds_read_b128 v[144:147], v7 offset:24576
    v_mfma_f32_16x16x32_bf16 v[80:83], v[116:119], v[96:99], v[80:83]
    ds_read_b128 v[148:151], v7 offset:26624
    v_mfma_f32_16x16x32_bf16 v[84:87], v[116:119], v[100:103], v[84:87]
    v_mfma_f32_16x16x32_bf16 v[88:91], v[120:123], v[96:99], v[88:91]
    v_mfma_f32_16x16x32_bf16 v[92:95], v[120:123], v[100:103], v[92:95]
    s_waitcnt lgkmcnt(0)
    s_barrier
    v_mfma_f32_16x16x32_bf16 v[56:59], v[132:135], v[124:127], v[56:59]
    ds_read_b128 v[96:99], v8 offset:32768
    v_mfma_f32_16x16x32_bf16 v[60:63], v[132:135], v[128:131], v[60:63]
    ds_read_b128 v[100:103], v8 offset:34816
    v_mfma_f32_16x16x32_bf16 v[64:67], v[136:139], v[124:127], v[64:67]
    ds_read_b128 v[104:107], v6 offset:36864
    v_mfma_f32_16x16x32_bf16 v[68:71], v[136:139], v[128:131], v[68:71]
    ds_read_b128 v[108:111], v6 offset:38912
    v_mfma_f32_16x16x32_bf16 v[72:75], v[140:143], v[124:127], v[72:75]
    ds_read_b128 v[112:115], v6 offset:40960
    v_mfma_f32_16x16x32_bf16 v[76:79], v[140:143], v[128:131], v[76:79]
    ds_read_b128 v[116:119], v6 offset:43008
    v_mfma_f32_16x16x32_bf16 v[80:83], v[144:147], v[124:127], v[80:83]
    ds_read_b128 v[120:123], v6 offset:45056
    v_mfma_f32_16x16x32_bf16 v[84:87], v[144:147], v[128:131], v[84:87]
    v_mfma_f32_16x16x32_bf16 v[88:91], v[148:151], v[124:127], v[88:91]
    v_mfma_f32_16x16x32_bf16 v[92:95], v[148:151], v[128:131], v[92:95]
    s_waitcnt lgkmcnt(0)
    s_sub_u32 s43, s43, 1
    s_cmp_lg_u32 s43, 0
    s_cbranch_scc1 lp_mega_kernel_7
    s_lshl_b32 s42, s11, 3
    s_lshl_b32 s44, s40, 1
    s_add_u32 s42, s42, s44
    s_lshl_b32 s42, s42, 4
    s_add_u32 s42, s42, s10
    s_mul_i32 s42, s42, 4608
    v_lshlrev_b32 v14, 6, v3
    v_lshl_add_u32 v14, v4, 4, v14
    v_add_u32 v14, s42, v14
    v_lshlrev_b32 v15, 5, v3
    v_lshl_add_u32 v15, v4, 3, v15
    v_add_u32 v15, s42, v15
    v_add_u32 v15, 4096, v15
    s_waitcnt vmcnt(0)
    v_lshlrev_b32 v160, 16, v160
    v_lshlrev_b32 v162, 16, v162
    s_mov_b32 s44, 73728
    s_nop 1
    v_pk_add_f32 v[56:57], v[56:57], v[160:161] op_sel_hi:[1,0]
    v_pk_add_f32 v[58:59], v[58:59], v[160:161] op_sel_hi:[1,0]
    v_pk_mul_f32 v[56:57], v[56:57], v[16:17]
    v_pk_mul_f32 v[58:59], v[58:59], v[18:19]
    v_cvt_pk_bf16_f32 v96, v56, v57
    v_cvt_pk_bf16_f32 v97, v58, v59
    v_pk_add_f32 v[64:65], v[64:65], v[160:161] op_sel_hi:[1,0]
    v_pk_add_f32 v[66:67], v[66:67], v[160:161] op_sel_hi:[1,0]
    v_pk_mul_f32 v[64:65], v[64:65], v[24:25]
    v_pk_mul_f32 v[66:67], v[66:67], v[26:27]
    v_cvt_pk_bf16_f32 v98, v64, v65
    v_cvt_pk_bf16_f32 v99, v66, v67
    buffer_store_dwordx4 v[96:99], v14, s[28:31], 0 offen offset:0 sc1
    v_pk_add_f32 v[60:61], v[60:61], v[162:163] op_sel_hi:[1,0]
    v_pk_add_f32 v[62:63], v[62:63], v[162:163] op_sel_hi:[1,0]
    v_pk_mul_f32 v[60:61], v[60:61], v[20:21]
    v_pk_mul_f32 v[62:63], v[62:63], v[22:23]
    v_cvt_pk_bf16_f32 v100, v60, v61
    v_cvt_pk_bf16_f32 v101, v62, v63
    v_pk_add_f32 v[68:69], v[68:69], v[162:163] op_sel_hi:[1,0]
    v_pk_add_f32 v[70:71], v[70:71], v[162:163] op_sel_hi:[1,0]
    v_pk_mul_f32 v[68:69], v[68:69], v[28:29]
    v_pk_mul_f32 v[70:71], v[70:71], v[30:31]
    v_cvt_pk_bf16_f32 v102, v68, v69
    v_cvt_pk_bf16_f32 v103, v70, v71
    buffer_store_dwordx4 v[100:103], v14, s[28:31], s44 offen offset:0 sc1
    v_pk_add_f32 v[72:73], v[72:73], v[160:161] op_sel_hi:[1,0]
    v_pk_add_f32 v[74:75], v[74:75], v[160:161] op_sel_hi:[1,0]
    v_pk_mul_f32 v[72:73], v[72:73], v[32:33]
    v_pk_mul_f32 v[74:75], v[74:75], v[34:35]
    v_cvt_pk_bf16_f32 v104, v72, v73
    v_cvt_pk_bf16_f32 v105, v74, v75
    v_pk_add_f32 v[80:81], v[80:81], v[160:161] op_sel_hi:[1,0]
    v_pk_add_f32 v[82:83], v[82:83], v[160:161] op_sel_hi:[1,0]
    v_pk_mul_f32 v[80:81], v[80:81], v[40:41]
    v_pk_mul_f32 v[82:83], v[82:83], v[42:43]
    v_cvt_pk_bf16_f32 v106, v80, v81
    v_cvt_pk_bf16_f32 v107, v82, v83
    buffer_store_dwordx4 v[104:107], v14, s[28:31], 0 offen offset:1024 sc1
    v_pk_add_f32 v[76:77], v[76:77], v[162:163] op_sel_hi:[1,0]
    v_pk_add_f32 v[78:79], v[78:79], v[162:163] op_sel_hi:[1,0]
    v_pk_mul_f32 v[76:77], v[76:77], v[36:37]
    v_pk_mul_f32 v[78:79], v[78:79], v[38:39]
    v_cvt_pk_bf16_f32 v108, v76, v77
    v_cvt_pk_bf16_f32 v109, v78, v79
    v_pk_add_f32 v[84:85], v[84:85], v[162:163] op_sel_hi:[1,0]
    v_pk_add_f32 v[86:87], v[86:87], v[162:163] op_sel_hi:[1,0]
    v_pk_mul_f32 v[84:85], v[84:85], v[44:45]
    v_pk_mul_f32 v[86:87], v[86:87], v[46:47]
    v_cvt_pk_bf16_f32 v110, v84, v85
    v_cvt_pk_bf16_f32 v111, v86, v87
    buffer_store_dwordx4 v[108:111], v14, s[28:31], s44 offen offset:1024 sc1
    v_pk_add_f32 v[88:89], v[88:89], v[160:161] op_sel_hi:[1,0]
    v_pk_add_f32 v[90:91], v[90:91], v[160:161] op_sel_hi:[1,0]
    v_pk_mul_f32 v[88:89], v[88:89], v[48:49]
    v_pk_mul_f32 v[90:91], v[90:91], v[50:51]
    v_cvt_pk_bf16_f32 v112, v88, v89
    v_cvt_pk_bf16_f32 v113, v90, v91
    buffer_store_dwordx2 v[112:113], v15, s[28:31], 0 offen sc1
    v_pk_add_f32 v[92:93], v[92:93], v[162:163] op_sel_hi:[1,0]
    v_pk_add_f32 v[94:95], v[94:95], v[162:163] op_sel_hi:[1,0]
    v_pk_mul_f32 v[92:93], v[92:93], v[52:53]
    v_pk_mul_f32 v[94:95], v[94:95], v[54:55]
    v_cvt_pk_bf16_f32 v116, v92, v93
    v_cvt_pk_bf16_f32 v117, v94, v95
    buffer_store_dwordx2 v[116:117], v15, s[28:31], s44 offen sc1
    s_waitcnt vmcnt(0)
    s_barrier
    s_lshl_b32 s42, s40, 4
    s_add_u32 s42, s42, s77
    v_add_u32 v10, s42, v3
    v_lshlrev_b32 v12, 1, v10
    v_lshl_add_u32 v13, v4, 14, v12
    v_lshl_add_u32 v12, v4, 15, v12
    s_add_u32 s42, s76, 0
    s_lshl_b32 s42, s42, 12
    buffer_load_ushort v16, v12, s[20:23], s42 offen
    s_add_u32 s42, s76, 1
    s_lshl_b32 s42, s42, 12
    buffer_load_ushort v17, v12, s[20:23], s42 offen
    s_add_u32 s42, s76, 2
    s_lshl_b32 s42, s42, 12
    buffer_load_ushort v18, v12, s[20:23], s42 offen
    s_add_u32 s42, s76, 3
    s_lshl_b32 s42, s42, 12
    buffer_load_ushort v19, v12, s[20:23], s42 offen
    s_add_u32 s42, s76, 4
    s_lshl_b32 s42, s42, 12
    buffer_load_ushort v20, v12, s[20:23], s42 offen
    s_add_u32 s42, s76, 5
    s_lshl_b32 s42, s42, 12
    buffer_load_ushort v21, v12, s[20:23], s42 offen
    s_add_u32 s42, s76, 6
    s_lshl_b32 s42, s42, 12
    buffer_load_ushort v22, v12, s[20:23], s42 offen
    s_add_u32 s42, s76, 7
    s_lshl_b32 s42, s42, 12
    buffer_load_ushort v23, v12, s[20:23], s42 offen
    s_and_b32 s42, s40, 1
    s_lshl_b32 s42, s42, 6
    v_xor_b32 v14, s42, v5
    v_add_u32 v6, 0, v14
    v_add_u32 v7, 55296, v6
    s_lshl_b32 s42, s40, 11
    s_add_u32 s42, s42, 92160
    v_add_u32 v8, s42, v14
    s_xor_b32 s42, s40, 1
    s_lshl_b32 s42, s42, 11
    s_add_u32 s42, s42, 92160
    v_add_u32 v9, s42, v14
    v_mul_u32_u24 v10, 1152, v10
    s_lshl_b32 s42, s76, 1
    v_add_u32 v10, s42, v10
    v_lshl_add_u32 v11, v4, 3, v10
    v_lshl_add_u32 v10, v4, 4, v10
    v_mov_b32 v12, 0x7ffffff0
    v_cmp_gt_u32 vcc, 2, v4
    v_lshlrev_b32 v13, 4, v2
    s_mul_i32 s42, s15, 3072
    v_cndmask_b32 v11, v12, v11, vcc
    v_add_u32 v12, s42, v13
    s_xor_b32 s42, s15, 1
    s_mul_i32 s42, s42, 3072
    v_add_u32 v13, s42, v13
    v_mov_b32 v28, 0
    v_mov_b32 v29, 0
    v_mov_b32 v30, 0
    v_mov_b32 v31, 0
    v_mov_b32 v32, 0
    v_mov_b32 v33, 0
    v_mov_b32 v34, 0
    v_mov_b32 v35, 0
    s_waitcnt vmcnt(0)
    v_lshlrev_b32 v16, 16, v16
    v_lshlrev_b32 v17, 16, v17
    v_lshlrev_b32 v18, 16, v18
    v_lshlrev_b32 v19, 16, v19
    v_lshlrev_b32 v20, 16, v20
    v_lshlrev_b32 v21, 16, v21
    v_lshlrev_b32 v22, 16, v22
    v_lshlrev_b32 v23, 16, v23
    s_barrier
    ds_read_b128 v[48:51], v8 offset:0
    ds_read_b128 v[52:55], v9 offset:0
    ds_read_b128 v[56:59], v6 offset:36864
    ds_read_b128 v[60:63], v6 offset:38912
    ds_read_b128 v[68:71], v8 offset:8192
    ds_read_b128 v[72:75], v9 offset:8192
    ds_read_b128 v[76:79], v6 offset:46080
    ds_read_b128 v[80:83], v6 offset:48128
    s_waitcnt lgkmcnt(0)
    s_barrier
    v_mfma_f32_16x16x32_bf16 v[16:19], v[56:59], v[48:51], v[16:19]
    ds_read_b128 v[88:91], v8 offset:16384
    ds_read_b128 v[92:95], v9 offset:16384
    v_mfma_f32_16x16x32_bf16 v[28:31], v[56:59], v[52:55], v[28:31]
    ds_read_b128 v[96:99], v7 offset:0
    ds_read_b128 v[100:103], v7 offset:2048
    v_mfma_f32_16x16x32_bf16 v[20:23], v[60:63], v[48:51], v[20:23]
    ds_read_b128 v[108:111], v8 offset:24576
    ds_read_b128 v[112:115], v9 offset:24576
    v_mfma_f32_16x16x32_bf16 v[32:35], v[60:63], v[52:55], v[32:35]
    ds_read_b128 v[116:119], v7 offset:9216
    ds_read_b128 v[120:123], v7 offset:11264
    v_mfma_f32_16x16x32_bf16 v[16:19], v[76:79], v[68:71], v[16:19]
    v_mfma_f32_16x16x32_bf16 v[28:31], v[76:79], v[72:75], v[28:31]
    v_mfma_f32_16x16x32_bf16 v[20:23], v[80:83], v[68:71], v[20:23]
    v_mfma_f32_16x16x32_bf16 v[32:35], v[80:83], v[72:75], v[32:35]
    s_waitcnt lgkmcnt(0)
    s_barrier
    v_mfma_f32_16x16x32_bf16 v[16:19], v[96:99], v[88:91], v[16:19]
    ds_read_b128 v[48:51], v8 offset:32768
    ds_read_b128 v[52:55], v9 offset:32768
    v_mfma_f32_16x16x32_bf16 v[28:31], v[96:99], v[92:95], v[28:31]
    ds_read_b128 v[56:59], v6 offset:0
    ds_read_b128 v[60:63], v6 offset:2048
    v_mfma_f32_16x16x32_bf16 v[20:23], v[100:103], v[88:91], v[20:23]
    ds_read_b128 v[68:71], v8 offset:40960
    ds_read_b128 v[72:75], v9 offset:40960
    v_mfma_f32_16x16x32_bf16 v[32:35], v[100:103], v[92:95], v[32:35]
    ds_read_b128 v[76:79], v6 offset:9216
    ds_read_b128 v[80:83], v6 offset:11264
    v_mfma_f32_16x16x32_bf16 v[16:19], v[116:119], v[108:111], v[16:19]
    v_mfma_f32_16x16x32_bf16 v[28:31], v[116:119], v[112:115], v[28:31]
    v_mfma_f32_16x16x32_bf16 v[20:23], v[120:123], v[108:111], v[20:23]
    v_mfma_f32_16x16x32_bf16 v[32:35], v[120:123], v[112:115], v[32:35]
    s_waitcnt lgkmcnt(0)
    s_barrier
    v_mfma_f32_16x16x32_bf16 v[16:19], v[56:59], v[48:51], v[16:19]
    ds_read_b128 v[88:91], v8 offset:49152
    ds_read_b128 v[92:95], v9 offset:49152
    v_mfma_f32_16x16x32_bf16 v[28:31], v[56:59], v[52:55], v[28:31]
    ds_read_b128 v[96:99], v7 offset:18432
    ds_read_b128 v[100:103], v7 offset:20480
    v_mfma_f32_16x16x32_bf16 v[20:23], v[60:63], v[48:51], v[20:23]
    ds_read_b128 v[108:111], v8 offset:57344
    ds_read_b128 v[112:115], v9 offset:57344
    v_mfma_f32_16x16x32_bf16 v[32:35], v[60:63], v[52:55], v[32:35]
    ds_read_b128 v[116:119], v6 offset:18432
    ds_read_b128 v[120:123], v6 offset:20480
    v_mfma_f32_16x16x32_bf16 v[16:19], v[76:79], v[68:71], v[16:19]
    v_mfma_f32_16x16x32_bf16 v[28:31], v[76:79], v[72:75], v[28:31]
    v_mfma_f32_16x16x32_bf16 v[20:23], v[80:83], v[68:71], v[20:23]
    v_mfma_f32_16x16x32_bf16 v[32:35], v[80:83], v[72:75], v[32:35]
    s_waitcnt lgkmcnt(0)
    s_barrier
    v_mfma_f32_16x16x32_bf16 v[16:19], v[96:99], v[88:91], v[16:19]
    ds_read_b128 v[48:51], v8 offset:0
    ds_read_b128 v[52:55], v9 offset:0
    v_mfma_f32_16x16x32_bf16 v[28:31], v[96:99], v[92:95], v[28:31]
    ds_read_b128 v[56:59], v6 offset:27648
    ds_read_b128 v[60:63], v6 offset:29696
    v_mfma_f32_16x16x32_bf16 v[20:23], v[100:103], v[88:91], v[20:23]
    ds_read_b128 v[68:71], v8 offset:8192
    ds_read_b128 v[72:75], v9 offset:8192
    v_mfma_f32_16x16x32_bf16 v[32:35], v[100:103], v[92:95], v[32:35]
    ds_read_b128 v[76:79], v7 offset:27648
    ds_read_b128 v[80:83], v7 offset:29696
    v_mfma_f32_16x16x32_bf16 v[16:19], v[116:119], v[108:111], v[16:19]
    v_mfma_f32_16x16x32_bf16 v[28:31], v[116:119], v[112:115], v[28:31]
    v_mfma_f32_16x16x32_bf16 v[20:23], v[120:123], v[108:111], v[20:23]
    v_mfma_f32_16x16x32_bf16 v[32:35], v[120:123], v[112:115], v[32:35]
    s_waitcnt lgkmcnt(0)
    s_barrier
    v_mfma_f32_16x16x32_bf16 v[16:19], v[56:59], v[48:51], v[16:19]
    ds_read_b128 v[88:91], v8 offset:16384
    ds_read_b128 v[92:95], v9 offset:16384
    v_mfma_f32_16x16x32_bf16 v[28:31], v[56:59], v[52:55], v[28:31]
    ds_read_b128 v[96:99], v6 offset:36864
    ds_read_b128 v[100:103], v6 offset:38912
    v_mfma_f32_16x16x32_bf16 v[20:23], v[60:63], v[48:51], v[20:23]
    ds_read_b128 v[108:111], v8 offset:24576
    ds_read_b128 v[112:115], v9 offset:24576
    v_mfma_f32_16x16x32_bf16 v[32:35], v[60:63], v[52:55], v[32:35]
    ds_read_b128 v[116:119], v6 offset:46080
    ds_read_b128 v[120:123], v6 offset:48128
    v_mfma_f32_16x16x32_bf16 v[16:19], v[76:79], v[68:71], v[16:19]
    v_mfma_f32_16x16x32_bf16 v[28:31], v[76:79], v[72:75], v[28:31]
    v_mfma_f32_16x16x32_bf16 v[20:23], v[80:83], v[68:71], v[20:23]
    v_mfma_f32_16x16x32_bf16 v[32:35], v[80:83], v[72:75], v[32:35]
    s_waitcnt lgkmcnt(0)
    s_barrier
    v_mfma_f32_16x16x32_bf16 v[16:19], v[96:99], v[88:91], v[16:19]
    ds_read_b128 v[48:51], v8 offset:32768
    ds_read_b128 v[52:55], v9 offset:32768
    v_mfma_f32_16x16x32_bf16 v[28:31], v[96:99], v[92:95], v[28:31]
    ds_read_b128 v[56:59], v7 offset:0
    ds_read_b128 v[60:63], v7 offset:2048
    v_mfma_f32_16x16x32_bf16 v[20:23], v[100:103], v[88:91], v[20:23]
    ds_read_b128 v[68:71], v8 offset:40960
    ds_read_b128 v[72:75], v9 offset:40960
    v_mfma_f32_16x16x32_bf16 v[32:35], v[100:103], v[92:95], v[32:35]
    ds_read_b128 v[76:79], v7 offset:9216
    ds_read_b128 v[80:83], v7 offset:11264
    v_mfma_f32_16x16x32_bf16 v[16:19], v[116:119], v[108:111], v[16:19]
    v_mfma_f32_16x16x32_bf16 v[28:31], v[116:119], v[112:115], v[28:31]
    v_mfma_f32_16x16x32_bf16 v[20:23], v[120:123], v[108:111], v[20:23]
    v_mfma_f32_16x16x32_bf16 v[32:35], v[120:123], v[112:115], v[32:35]
    s_waitcnt lgkmcnt(0)
    s_barrier
    v_mfma_f32_16x16x32_bf16 v[16:19], v[56:59], v[48:51], v[16:19]
    ds_read_b128 v[88:91], v8 offset:49152
    ds_read_b128 v[92:95], v9 offset:49152
    v_mfma_f32_16x16x32_bf16 v[28:31], v[56:59], v[52:55], v[28:31]
    ds_read_b128 v[96:99], v6 offset:0
    ds_read_b128 v[100:103], v6 offset:2048
    v_mfma_f32_16x16x32_bf16 v[20:23], v[60:63], v[48:51], v[20:23]
    ds_read_b128 v[108:111], v8 offset:57344
    ds_read_b128 v[112:115], v9 offset:57344
    v_mfma_f32_16x16x32_bf16 v[32:35], v[60:63], v[52:55], v[32:35]
    ds_read_b128 v[116:119], v6 offset:9216
    ds_read_b128 v[120:123], v6 offset:11264
    v_mfma_f32_16x16x32_bf16 v[16:19], v[76:79], v[68:71], v[16:19]
    v_mfma_f32_16x16x32_bf16 v[28:31], v[76:79], v[72:75], v[28:31]
    v_mfma_f32_16x16x32_bf16 v[20:23], v[80:83], v[68:71], v[20:23]
    v_mfma_f32_16x16x32_bf16 v[32:35], v[80:83], v[72:75], v[32:35]
    s_waitcnt lgkmcnt(0)
    s_barrier
    v_mfma_f32_16x16x32_bf16 v[16:19], v[96:99], v[88:91], v[16:19]
    ds_read_b128 v[48:51], v8 offset:0
    ds_read_b128 v[52:55], v9 offset:0
    v_mfma_f32_16x16x32_bf16 v[28:31], v[96:99], v[92:95], v[28:31]
    ds_read_b128 v[56:59], v7 offset:18432
    ds_read_b128 v[60:63], v7 offset:20480
    v_mfma_f32_16x16x32_bf16 v[20:23], v[100:103], v[88:91], v[20:23]
    ds_read_b128 v[68:71], v8 offset:8192
    ds_read_b128 v[72:75], v9 offset:8192
    v_mfma_f32_16x16x32_bf16 v[32:35], v[100:103], v[92:95], v[32:35]
    ds_read_b128 v[76:79], v6 offset:18432
    ds_read_b128 v[80:83], v6 offset:20480
    v_mfma_f32_16x16x32_bf16 v[16:19], v[116:119], v[108:111], v[16:19]
    v_mfma_f32_16x16x32_bf16 v[28:31], v[116:119], v[112:115], v[28:31]
    v_mfma_f32_16x16x32_bf16 v[20:23], v[120:123], v[108:111], v[20:23]
    v_mfma_f32_16x16x32_bf16 v[32:35], v[120:123], v[112:115], v[32:35]
    s_waitcnt lgkmcnt(0)
    s_barrier
    v_mfma_f32_16x16x32_bf16 v[16:19], v[56:59], v[48:51], v[16:19]
    ds_read_b128 v[88:91], v8 offset:16384
    ds_read_b128 v[92:95], v9 offset:16384
    v_mfma_f32_16x16x32_bf16 v[28:31], v[56:59], v[52:55], v[28:31]
    ds_read_b128 v[96:99], v6 offset:27648
    ds_read_b128 v[100:103], v6 offset:29696
    v_mfma_f32_16x16x32_bf16 v[20:23], v[60:63], v[48:51], v[20:23]
    ds_read_b128 v[108:111], v8 offset:24576
    ds_read_b128 v[112:115], v9 offset:24576
    v_mfma_f32_16x16x32_bf16 v[32:35], v[60:63], v[52:55], v[32:35]
    ds_read_b128 v[116:119], v7 offset:27648
    ds_read_b128 v[120:123], v7 offset:29696
    v_mfma_f32_16x16x32_bf16 v[16:19], v[76:79], v[68:71], v[16:19]
    v_mfma_f32_16x16x32_bf16 v[28:31], v[76:79], v[72:75], v[28:31]
    v_mfma_f32_16x16x32_bf16 v[20:23], v[80:83], v[68:71], v[20:23]
    v_mfma_f32_16x16x32_bf16 v[32:35], v[80:83], v[72:75], v[32:35]
    s_waitcnt lgkmcnt(0)
    s_barrier
    v_mfma_f32_16x16x32_bf16 v[16:19], v[96:99], v[88:91], v[16:19]
    ds_read_b128 v[48:51], v8 offset:32768
    ds_read_b128 v[52:55], v9 offset:32768
    v_mfma_f32_16x16x32_bf16 v[28:31], v[96:99], v[92:95], v[28:31]
    ds_read_b128 v[56:59], v6 offset:36864
    ds_read_b128 v[60:63], v6 offset:38912
    v_mfma_f32_16x16x32_bf16 v[20:23], v[100:103], v[88:91], v[20:23]
    ds_read_b128 v[68:71], v8 offset:40960
    ds_read_b128 v[72:75], v9 offset:40960
    v_mfma_f32_16x16x32_bf16 v[32:35], v[100:103], v[92:95], v[32:35]
    ds_read_b128 v[76:79], v6 offset:46080
    ds_read_b128 v[80:83], v6 offset:48128
    v_mfma_f32_16x16x32_bf16 v[16:19], v[116:119], v[108:111], v[16:19]
    v_mfma_f32_16x16x32_bf16 v[28:31], v[116:119], v[112:115], v[28:31]
    v_mfma_f32_16x16x32_bf16 v[20:23], v[120:123], v[108:111], v[20:23]
    v_mfma_f32_16x16x32_bf16 v[32:35], v[120:123], v[112:115], v[32:35]
    s_waitcnt lgkmcnt(0)
    s_barrier
    v_mfma_f32_16x16x32_bf16 v[16:19], v[56:59], v[48:51], v[16:19]
    ds_read_b128 v[88:91], v8 offset:49152
    ds_read_b128 v[92:95], v9 offset:49152
    v_mfma_f32_16x16x32_bf16 v[28:31], v[56:59], v[52:55], v[28:31]
    ds_read_b128 v[96:99], v7 offset:0
    ds_read_b128 v[100:103], v7 offset:2048
    v_mfma_f32_16x16x32_bf16 v[20:23], v[60:63], v[48:51], v[20:23]
    ds_read_b128 v[108:111], v8 offset:57344
    ds_read_b128 v[112:115], v9 offset:57344
    v_mfma_f32_16x16x32_bf16 v[32:35], v[60:63], v[52:55], v[32:35]
    ds_read_b128 v[116:119], v7 offset:9216
    ds_read_b128 v[120:123], v7 offset:11264
    v_mfma_f32_16x16x32_bf16 v[16:19], v[76:79], v[68:71], v[16:19]
    v_mfma_f32_16x16x32_bf16 v[28:31], v[76:79], v[72:75], v[28:31]
    v_mfma_f32_16x16x32_bf16 v[20:23], v[80:83], v[68:71], v[20:23]
    v_mfma_f32_16x16x32_bf16 v[32:35], v[80:83], v[72:75], v[32:35]
    s_waitcnt lgkmcnt(0)
    s_barrier
    v_mfma_f32_16x16x32_bf16 v[16:19], v[96:99], v[88:91], v[16:19]
    ds_read_b128 v[48:51], v8 offset:0
    ds_read_b128 v[52:55], v9 offset:0
    v_mfma_f32_16x16x32_bf16 v[28:31], v[96:99], v[92:95], v[28:31]
    ds_read_b128 v[56:59], v6 offset:0
    ds_read_b128 v[60:63], v6 offset:2048
    v_mfma_f32_16x16x32_bf16 v[20:23], v[100:103], v[88:91], v[20:23]
    ds_read_b128 v[68:71], v8 offset:8192
    ds_read_b128 v[72:75], v9 offset:8192
    v_mfma_f32_16x16x32_bf16 v[32:35], v[100:103], v[92:95], v[32:35]
    ds_read_b128 v[76:79], v6 offset:9216
    ds_read_b128 v[80:83], v6 offset:11264
    v_mfma_f32_16x16x32_bf16 v[16:19], v[116:119], v[108:111], v[16:19]
    v_mfma_f32_16x16x32_bf16 v[28:31], v[116:119], v[112:115], v[28:31]
    v_mfma_f32_16x16x32_bf16 v[20:23], v[120:123], v[108:111], v[20:23]
    v_mfma_f32_16x16x32_bf16 v[32:35], v[120:123], v[112:115], v[32:35]
    s_waitcnt lgkmcnt(0)
    s_barrier
    v_mfma_f32_16x16x32_bf16 v[16:19], v[56:59], v[48:51], v[16:19]
    ds_read_b128 v[88:91], v8 offset:16384
    ds_read_b128 v[92:95], v9 offset:16384
    v_mfma_f32_16x16x32_bf16 v[28:31], v[56:59], v[52:55], v[28:31]
    ds_read_b128 v[96:99], v7 offset:18432
    ds_read_b128 v[100:103], v7 offset:20480
    v_mfma_f32_16x16x32_bf16 v[20:23], v[60:63], v[48:51], v[20:23]
    ds_read_b128 v[108:111], v8 offset:24576
    ds_read_b128 v[112:115], v9 offset:24576
    v_mfma_f32_16x16x32_bf16 v[32:35], v[60:63], v[52:55], v[32:35]
    ds_read_b128 v[116:119], v6 offset:18432
    ds_read_b128 v[120:123], v6 offset:20480
    v_mfma_f32_16x16x32_bf16 v[16:19], v[76:79], v[68:71], v[16:19]
    v_mfma_f32_16x16x32_bf16 v[28:31], v[76:79], v[72:75], v[28:31]
    v_mfma_f32_16x16x32_bf16 v[20:23], v[80:83], v[68:71], v[20:23]
    v_mfma_f32_16x16x32_bf16 v[32:35], v[80:83], v[72:75], v[32:35]
    s_waitcnt lgkmcnt(0)
    s_barrier
    v_mfma_f32_16x16x32_bf16 v[16:19], v[96:99], v[88:91], v[16:19]
    ds_read_b128 v[48:51], v8 offset:32768
    ds_read_b128 v[52:55], v9 offset:32768
    v_mfma_f32_16x16x32_bf16 v[28:31], v[96:99], v[92:95], v[28:31]
    ds_read_b128 v[56:59], v6 offset:27648
    ds_read_b128 v[60:63], v6 offset:29696
    v_mfma_f32_16x16x32_bf16 v[20:23], v[100:103], v[88:91], v[20:23]
    ds_read_b128 v[68:71], v8 offset:40960
    ds_read_b128 v[72:75], v9 offset:40960
    v_mfma_f32_16x16x32_bf16 v[32:35], v[100:103], v[92:95], v[32:35]
    ds_read_b128 v[76:79], v7 offset:27648
    ds_read_b128 v[80:83], v7 offset:29696
    v_mfma_f32_16x16x32_bf16 v[16:19], v[116:119], v[108:111], v[16:19]
    v_mfma_f32_16x16x32_bf16 v[28:31], v[116:119], v[112:115], v[28:31]
    v_mfma_f32_16x16x32_bf16 v[20:23], v[120:123], v[108:111], v[20:23]
    v_mfma_f32_16x16x32_bf16 v[32:35], v[120:123], v[112:115], v[32:35]
    s_waitcnt lgkmcnt(0)
    s_barrier
    v_mfma_f32_16x16x32_bf16 v[16:19], v[56:59], v[48:51], v[16:19]
    ds_read_b128 v[88:91], v8 offset:49152
    ds_read_b128 v[92:95], v9 offset:49152
    v_mfma_f32_16x16x32_bf16 v[28:31], v[56:59], v[52:55], v[28:31]
    ds_read_b128 v[96:99], v6 offset:36864
    ds_read_b128 v[100:103], v6 offset:38912
    v_mfma_f32_16x16x32_bf16 v[20:23], v[60:63], v[48:51], v[20:23]
    ds_read_b128 v[108:111], v8 offset:57344
    ds_read_b128 v[112:115], v9 offset:57344
    v_mfma_f32_16x16x32_bf16 v[32:35], v[60:63], v[52:55], v[32:35]
    ds_read_b128 v[116:119], v6 offset:46080
    ds_read_b128 v[120:123], v6 offset:48128
    v_mfma_f32_16x16x32_bf16 v[16:19], v[76:79], v[68:71], v[16:19]
    v_mfma_f32_16x16x32_bf16 v[28:31], v[76:79], v[72:75], v[28:31]
    v_mfma_f32_16x16x32_bf16 v[20:23], v[80:83], v[68:71], v[20:23]
    v_mfma_f32_16x16x32_bf16 v[32:35], v[80:83], v[72:75], v[32:35]
    s_waitcnt lgkmcnt(0)
    s_barrier
    v_mfma_f32_16x16x32_bf16 v[16:19], v[96:99], v[88:91], v[16:19]
    ds_read_b128 v[48:51], v8 offset:0
    ds_read_b128 v[52:55], v9 offset:0
    v_mfma_f32_16x16x32_bf16 v[28:31], v[96:99], v[92:95], v[28:31]
    ds_read_b128 v[56:59], v7 offset:0
    ds_read_b128 v[60:63], v7 offset:2048
    v_mfma_f32_16x16x32_bf16 v[20:23], v[100:103], v[88:91], v[20:23]
    ds_read_b128 v[68:71], v8 offset:8192
    ds_read_b128 v[72:75], v9 offset:8192
    v_mfma_f32_16x16x32_bf16 v[32:35], v[100:103], v[92:95], v[32:35]
    ds_read_b128 v[76:79], v7 offset:9216
    ds_read_b128 v[80:83], v7 offset:11264
    v_mfma_f32_16x16x32_bf16 v[16:19], v[116:119], v[108:111], v[16:19]
    v_mfma_f32_16x16x32_bf16 v[28:31], v[116:119], v[112:115], v[28:31]
    v_mfma_f32_16x16x32_bf16 v[20:23], v[120:123], v[108:111], v[20:23]
    v_mfma_f32_16x16x32_bf16 v[32:35], v[120:123], v[112:115], v[32:35]
    s_waitcnt lgkmcnt(0)
    s_barrier
    v_mfma_f32_16x16x32_bf16 v[16:19], v[56:59], v[48:51], v[16:19]
    ds_read_b128 v[88:91], v8 offset:16384
    ds_read_b128 v[92:95], v9 offset:16384
    v_mfma_f32_16x16x32_bf16 v[28:31], v[56:59], v[52:55], v[28:31]
    ds_read_b128 v[96:99], v6 offset:0
    ds_read_b128 v[100:103], v6 offset:2048
    v_mfma_f32_16x16x32_bf16 v[20:23], v[60:63], v[48:51], v[20:23]
    ds_read_b128 v[108:111], v8 offset:24576
    ds_read_b128 v[112:115], v9 offset:24576
    v_mfma_f32_16x16x32_bf16 v[32:35], v[60:63], v[52:55], v[32:35]
    ds_read_b128 v[116:119], v6 offset:9216
    ds_read_b128 v[120:123], v6 offset:11264
    v_mfma_f32_16x16x32_bf16 v[16:19], v[76:79], v[68:71], v[16:19]
    v_mfma_f32_16x16x32_bf16 v[28:31], v[76:79], v[72:75], v[28:31]
    v_mfma_f32_16x16x32_bf16 v[20:23], v[80:83], v[68:71], v[20:23]
    v_mfma_f32_16x16x32_bf16 v[32:35], v[80:83], v[72:75], v[32:35]
    s_waitcnt lgkmcnt(0)
    v_mfma_f32_16x16x32_bf16 v[16:19], v[96:99], v[88:91], v[16:19]
    v_mfma_f32_16x16x32_bf16 v[28:31], v[96:99], v[92:95], v[28:31]
    v_mfma_f32_16x16x32_bf16 v[20:23], v[100:103], v[88:91], v[20:23]
    v_mfma_f32_16x16x32_bf16 v[32:35], v[100:103], v[92:95], v[32:35]
    v_mfma_f32_16x16x32_bf16 v[16:19], v[116:119], v[108:111], v[16:19]
    v_mfma_f32_16x16x32_bf16 v[28:31], v[116:119], v[112:115], v[28:31]
    v_mfma_f32_16x16x32_bf16 v[20:23], v[120:123], v[108:111], v[20:23]
    v_mfma_f32_16x16x32_bf16 v[32:35], v[120:123], v[112:115], v[32:35]
    s_nop 7
    ds_write_b128 v12, v[28:31] offset:36864
    ds_write_b128 v12, v[32:35] offset:37888
    s_waitcnt lgkmcnt(0)
    s_barrier
    ds_read_b128 v[28:31], v13 offset:36864
    ds_read_b128 v[32:35], v13 offset:37888
    s_waitcnt lgkmcnt(0)
    v_pk_add_f32 v[16:17], v[16:17], v[28:29]
    v_cvt_pk_bf16_f32 v48, v16, v17
    v_pk_add_f32 v[18:19], v[18:19], v[30:31]
    v_cvt_pk_bf16_f32 v49, v18, v19
    v_pk_add_f32 v[20:21], v[20:21], v[32:33]
    v_cvt_pk_bf16_f32 v50, v20, v21
    v_pk_add_f32 v[22:23], v[22:23], v[34:35]
    v_cvt_pk_bf16_f32 v51, v22, v23
    buffer_store_dwordx4 v[48:51], v10, s[80:83], 0 offen offset:0
    s_endpgm
c1_mega_kernel_5:
    s_setprio 1
    s_barrier
    ds_read_b64_tr_b16 v[96:97], v10 offset:0
    ds_read_b64_tr_b16 v[98:99], v10 offset:1024
    ds_read_b64_tr_b16 v[100:101], v11 offset:0
    ds_read_b64_tr_b16 v[102:103], v11 offset:1024
    ds_read_b128 v[104:107], v6 offset:0
    ds_read_b128 v[108:111], v6 offset:2048
    ds_read_b128 v[112:115], v6 offset:4096
    ds_read_b128 v[116:119], v6 offset:6144
    s_waitcnt lgkmcnt(0)
    v_mfma_f32_16x16x32_bf16 v[56:59], v[96:99], v[104:107], 0
    ds_read_b64_tr_b16 v[124:125], v10 offset:8192
    v_mfma_f32_16x16x32_bf16 v[60:63], v[100:103], v[104:107], 0
    ds_read_b64_tr_b16 v[126:127], v10 offset:9216
    v_mfma_f32_16x16x32_bf16 v[64:67], v[96:99], v[108:111], 0
    ds_read_b64_tr_b16 v[128:129], v11 offset:8192
    v_mfma_f32_16x16x32_bf16 v[68:71], v[100:103], v[108:111], 0
    ds_read_b64_tr_b16 v[130:131], v11 offset:9216
    v_mfma_f32_16x16x32_bf16 v[72:75], v[96:99], v[112:115], 0
    ds_read_b128 v[132:135], v7 offset:0
    v_mfma_f32_16x16x32_bf16 v[76:79], v[100:103], v[112:115], 0
    ds_read_b128 v[136:139], v7 offset:2048
    v_mfma_f32_16x16x32_bf16 v[80:83], v[96:99], v[116:119], 0
    ds_read_b128 v[140:143], v7 offset:4096
    v_mfma_f32_16x16x32_bf16 v[84:87], v[100:103], v[116:119], 0
    ds_read_b128 v[144:147], v7 offset:6144
    s_waitcnt lgkmcnt(0)
    s_barrier
    v_mfma_f32_16x16x32_bf16 v[56:59], v[124:127], v[132:135], v[56:59]
    ds_read_b64_tr_b16 v[96:97], v10 offset:16384
    v_mfma_f32_16x16x32_bf16 v[60:63], v[128:131], v[132:135], v[60:63]
    ds_read_b64_tr_b16 v[98:99], v10 offset:17408
    v_mfma_f32_16x16x32_bf16 v[64:67], v[124:127], v[136:139], v[64:67]
    ds_read_b64_tr_b16 v[100:101], v11 offset:16384
    v_mfma_f32_16x16x32_bf16 v[68:71], v[128:131], v[136:139], v[68:71]
    ds_read_b64_tr_b16 v[102:103], v11 offset:17408
    v_mfma_f32_16x16x32_bf16 v[72:75], v[124:127], v[140:143], v[72:75]
    ds_read_b128 v[104:107], v6 offset:18432
    v_mfma_f32_16x16x32_bf16 v[76:79], v[128:131], v[140:143], v[76:79]
    ds_read_b128 v[108:111], v6 offset:20480
    v_mfma_f32_16x16x32_bf16 v[80:83], v[124:127], v[144:147], v[80:83]
    ds_read_b128 v[112:115], v6 offset:22528
    v_mfma_f32_16x16x32_bf16 v[84:87], v[128:131], v[144:147], v[84:87]
    ds_read_b128 v[116:119], v6 offset:24576
    s_waitcnt lgkmcnt(0)
    s_mov_b32 s43, 2
lp_mega_kernel_8:
    v_mfma_f32_16x16x32_bf16 v[56:59], v[96:99], v[104:107], v[56:59]
    ds_read_b64_tr_b16 v[124:125], v10 offset:24576
    v_mfma_f32_16x16x32_bf16 v[60:63], v[100:103], v[104:107], v[60:63]
    ds_read_b64_tr_b16 v[126:127], v10 offset:25600
    v_mfma_f32_16x16x32_bf16 v[64:67], v[96:99], v[108:111], v[64:67]
    ds_read_b64_tr_b16 v[128:129], v11 offset:24576
    v_mfma_f32_16x16x32_bf16 v[68:71], v[100:103], v[108:111], v[68:71]
    ds_read_b64_tr_b16 v[130:131], v11 offset:25600
    v_mfma_f32_16x16x32_bf16 v[72:75], v[96:99], v[112:115], v[72:75]
    ds_read_b128 v[132:135], v7 offset:18432
    v_mfma_f32_16x16x32_bf16 v[76:79], v[100:103], v[112:115], v[76:79]
    ds_read_b128 v[136:139], v7 offset:20480
    v_mfma_f32_16x16x32_bf16 v[80:83], v[96:99], v[116:119], v[80:83]
    ds_read_b128 v[140:143], v7 offset:22528
    v_mfma_f32_16x16x32_bf16 v[84:87], v[100:103], v[116:119], v[84:87]
    ds_read_b128 v[144:147], v7 offset:24576
    s_waitcnt lgkmcnt(0)
    s_barrier
    v_mfma_f32_16x16x32_bf16 v[56:59], v[124:127], v[132:135], v[56:59]
    ds_read_b64_tr_b16 v[96:97], v10 offset:32768
    v_mfma_f32_16x16x32_bf16 v[60:63], v[128:131], v[132:135], v[60:63]
    ds_read_b64_tr_b16 v[98:99], v10 offset:33792
    v_mfma_f32_16x16x32_bf16 v[64:67], v[124:127], v[136:139], v[64:67]
    ds_read_b64_tr_b16 v[100:101], v11 offset:32768
    v_mfma_f32_16x16x32_bf16 v[68:71], v[128:131], v[136:139], v[68:71]
    ds_read_b64_tr_b16 v[102:103], v11 offset:33792
    v_mfma_f32_16x16x32_bf16 v[72:75], v[124:127], v[140:143], v[72:75]
    ds_read_b128 v[104:107], v6 offset:36864
    v_mfma_f32_16x16x32_bf16 v[76:79], v[128:131], v[140:143], v[76:79]
    ds_read_b128 v[108:111], v6 offset:38912
    v_mfma_f32_16x16x32_bf16 v[80:83], v[124:127], v[144:147], v[80:83]
    ds_read_b128 v[112:115], v6 offset:40960
    v_mfma_f32_16x16x32_bf16 v[84:87], v[128:131], v[144:147], v[84:87]
    ds_read_b128 v[116:119], v6 offset:43008
    s_waitcnt lgkmcnt(0)
    v_mfma_f32_16x16x32_bf16 v[56:59], v[96:99], v[104:107], v[56:59]
    ds_read_b64_tr_b16 v[124:125], v10 offset:40960
    v_mfma_f32_16x16x32_bf16 v[60:63], v[100:103], v[104:107], v[60:63]
    ds_read_b64_tr_b16 v[126:127], v10 offset:41984
    v_mfma_f32_16x16x32_bf16 v[64:67], v[96:99], v[108:111], v[64:67]
    ds_read_b64_tr_b16 v[128:129], v11 offset:40960
    v_mfma_f32_16x16x32_bf16 v[68:71], v[100:103], v[108:111], v[68:71]
    ds_read_b64_tr_b16 v[130:131], v11 offset:41984
    v_mfma_f32_16x16x32_bf16 v[72:75], v[96:99], v[112:115], v[72:75]
    ds_read_b128 v[132:135], v7 offset:36864
    v_mfma_f32_16x16x32_bf16 v[76:79], v[100:103], v[112:115], v[76:79]
    ds_read_b128 v[136:139], v7 offset:38912
    v_mfma_f32_16x16x32_bf16 v[80:83], v[96:99], v[116:119], v[80:83]
    ds_read_b128 v[140:143], v7 offset:40960
    v_mfma_f32_16x16x32_bf16 v[84:87], v[100:103], v[116:119], v[84:87]
    ds_read_b128 v[144:147], v7 offset:43008
    s_waitcnt lgkmcnt(0)
    s_barrier
    v_mfma_f32_16x16x32_bf16 v[56:59], v[124:127], v[132:135], v[56:59]
    ds_read_b64_tr_b16 v[96:97], v10 offset:49152
    v_mfma_f32_16x16x32_bf16 v[60:63], v[128:131], v[132:135], v[60:63]
    ds_read_b64_tr_b16 v[98:99], v10 offset:50176
    v_mfma_f32_16x16x32_bf16 v[64:67], v[124:127], v[136:139], v[64:67]
    ds_read_b64_tr_b16 v[100:101], v11 offset:49152
    v_mfma_f32_16x16x32_bf16 v[68:71], v[128:131], v[136:139], v[68:71]
    ds_read_b64_tr_b16 v[102:103], v11 offset:50176
    v_mfma_f32_16x16x32_bf16 v[72:75], v[124:127], v[140:143], v[72:75]
    ds_read_b128 v[104:107], v6 offset:55296
    v_mfma_f32_16x16x32_bf16 v[76:79], v[128:131], v[140:143], v[76:79]
    ds_read_b128 v[108:111], v6 offset:57344
    v_mfma_f32_16x16x32_bf16 v[80:83], v[124:127], v[144:147], v[80:83]
    ds_read_b128 v[112:115], v6 offset:59392
    v_mfma_f32_16x16x32_bf16 v[84:87], v[128:131], v[144:147], v[84:87]
    ds_read_b128 v[116:119], v6 offset:61440
    s_waitcnt lgkmcnt(0)
    v_mfma_f32_16x16x32_bf16 v[56:59], v[96:99], v[104:107], v[56:59]
    ds_read_b64_tr_b16 v[124:125], v10 offset:57344
    v_mfma_f32_16x16x32_bf16 v[60:63], v[100:103], v[104:107], v[60:63]
    ds_read_b64_tr_b16 v[126:127], v10 offset:58368
    v_mfma_f32_16x16x32_bf16 v[64:67], v[96:99], v[108:111], v[64:67]
    ds_read_b64_tr_b16 v[128:129], v11 offset:57344
    v_mfma_f32_16x16x32_bf16 v[68:71], v[100:103], v[108:111], v[68:71]
    ds_read_b64_tr_b16 v[130:131], v11 offset:58368
    v_mfma_f32_16x16x32_bf16 v[72:75], v[96:99], v[112:115], v[72:75]
    ds_read_b128 v[132:135], v7 offset:55296
    v_mfma_f32_16x16x32_bf16 v[76:79], v[100:103], v[112:115], v[76:79]
    ds_read_b128 v[136:139], v7 offset:57344
    v_mfma_f32_16x16x32_bf16 v[80:83], v[96:99], v[116:119], v[80:83]
    ds_read_b128 v[140:143], v7 offset:59392
    v_mfma_f32_16x16x32_bf16 v[84:87], v[100:103], v[116:119], v[84:87]
    ds_read_b128 v[144:147], v7 offset:61440
    s_waitcnt lgkmcnt(0)
    s_barrier
    v_mfma_f32_16x16x32_bf16 v[56:59], v[124:127], v[132:135], v[56:59]
    ds_read_b64_tr_b16 v[96:97], v10 offset:0
    v_mfma_f32_16x16x32_bf16 v[60:63], v[128:131], v[132:135], v[60:63]
    ds_read_b64_tr_b16 v[98:99], v10 offset:1024
    v_mfma_f32_16x16x32_bf16 v[64:67], v[124:127], v[136:139], v[64:67]
    ds_read_b64_tr_b16 v[100:101], v11 offset:0
    v_mfma_f32_16x16x32_bf16 v[68:71], v[128:131], v[136:139], v[68:71]
    ds_read_b64_tr_b16 v[102:103], v11 offset:1024
    v_mfma_f32_16x16x32_bf16 v[72:75], v[124:127], v[140:143], v[72:75]
    ds_read_b128 v[104:107], v6 offset:0
    v_mfma_f32_16x16x32_bf16 v[76:79], v[128:131], v[140:143], v[76:79]
    ds_read_b128 v[108:111], v6 offset:2048
    v_mfma_f32_16x16x32_bf16 v[80:83], v[124:127], v[144:147], v[80:83]
    ds_read_b128 v[112:115], v6 offset:4096
    v_mfma_f32_16x16x32_bf16 v[84:87], v[128:131], v[144:147], v[84:87]
    ds_read_b128 v[116:119], v6 offset:6144
    s_waitcnt lgkmcnt(0)
    v_mfma_f32_16x16x32_bf16 v[56:59], v[96:99], v[104:107], v[56:59]
    ds_read_b64_tr_b16 v[124:125], v10 offset:8192
    v_mfma_f32_16x16x32_bf16 v[60:63], v[100:103], v[104:107], v[60:63]
    ds_read_b64_tr_b16 v[126:127], v10 offset:9216
    v_mfma_f32_16x16x32_bf16 v[64:67], v[96:99], v[108:111], v[64:67]
    ds_read_b64_tr_b16 v[128:129], v11 offset:8192
    v_mfma_f32_16x16x32_bf16 v[68:71], v[100:103], v[108:111], v[68:71]
    ds_read_b64_tr_b16 v[130:131], v11 offset:9216
    v_mfma_f32_16x16x32_bf16 v[72:75], v[96:99], v[112:115], v[72:75]
    ds_read_b128 v[132:135], v7 offset:0
    v_mfma_f32_16x16x32_bf16 v[76:79], v[100:103], v[112:115], v[76:79]
    ds_read_b128 v[136:139], v7 offset:2048
    v_mfma_f32_16x16x32_bf16 v[80:83], v[96:99], v[116:119], v[80:83]
    ds_read_b128 v[140:143], v7 offset:4096
    v_mfma_f32_16x16x32_bf16 v[84:87], v[100:103], v[116:119], v[84:87]
    ds_read_b128 v[144:147], v7 offset:6144
    s_waitcnt lgkmcnt(0)
    s_barrier
    v_mfma_f32_16x16x32_bf16 v[56:59], v[124:127], v[132:135], v[56:59]
    ds_read_b64_tr_b16 v[96:97], v10 offset:16384
    v_mfma_f32_16x16x32_bf16 v[60:63], v[128:131], v[132:135], v[60:63]
    ds_read_b64_tr_b16 v[98:99], v10 offset:17408
    v_mfma_f32_16x16x32_bf16 v[64:67], v[124:127], v[136:139], v[64:67]
    ds_read_b64_tr_b16 v[100:101], v11 offset:16384
    v_mfma_f32_16x16x32_bf16 v[68:71], v[128:131], v[136:139], v[68:71]
    ds_read_b64_tr_b16 v[102:103], v11 offset:17408
    v_mfma_f32_16x16x32_bf16 v[72:75], v[124:127], v[140:143], v[72:75]
    ds_read_b128 v[104:107], v6 offset:18432
    v_mfma_f32_16x16x32_bf16 v[76:79], v[128:131], v[140:143], v[76:79]
    ds_read_b128 v[108:111], v6 offset:20480
    v_mfma_f32_16x16x32_bf16 v[80:83], v[124:127], v[144:147], v[80:83]
    ds_read_b128 v[112:115], v6 offset:22528
    v_mfma_f32_16x16x32_bf16 v[84:87], v[128:131], v[144:147], v[84:87]
    ds_read_b128 v[116:119], v6 offset:24576
    s_waitcnt lgkmcnt(0)
    s_sub_u32 s43, s43, 1
    s_cmp_lg_u32 s43, 0
    s_cbranch_scc1 lp_mega_kernel_8
    v_lshlrev_b32 v14, 4, v4
    s_lshl_b32 s42, s40, 7
    v_add_u32 v14, s42, v14
    v_add_u32 v15, 139264, v14
    ds_read_b128 v[140:143], v15
    ds_read_b128 v[144:147], v15 offset:64
    v_lshlrev_b32 v12, 2, v3
    s_lshl_b32 s42, s40, 7
    s_add_u32 s42, s42, 139776
    v_add_u32 v13, s42, v12
    ds_read_b32 v124, v13
    ds_read_b32 v126, v13 offset:64
    v_add_u32 v12, 144128, v12
    ds_read_b32 v128, v12 offset:320
    v_mov_b32 v129, 0
    ds_read_b32 v130, v12 offset:384
    v_mov_b32 v131, 0
    ds_read_b32 v132, v12 offset:448
    v_mov_b32 v133, 0
    ds_read_b32 v134, v12 offset:512
    v_mov_b32 v135, 0
    v_mov_b32 v125, 0
    v_mov_b32 v127, 0
    v_cmp_eq_u32 vcc, 0, v4
    s_nop 0
    s_waitcnt lgkmcnt(0)
    v_cndmask_b32 v124, 0, v124, vcc
    v_cndmask_b32 v126, 0, v126, vcc
    s_nop 1
    v_mfma_f32_16x16x16_bf16 v[56:59], v[124:125], v[128:129], v[56:59]
    v_mfma_f32_16x16x16_bf16 v[60:63], v[126:127], v[128:129], v[60:63]
    v_mfma_f32_16x16x16_bf16 v[64:67], v[124:125], v[130:131], v[64:67]
    v_mfma_f32_16x16x16_bf16 v[68:71], v[126:127], v[130:131], v[68:71]
    v_mfma_f32_16x16x16_bf16 v[72:75], v[124:125], v[132:133], v[72:75]
    v_mfma_f32_16x16x16_bf16 v[76:79], v[126:127], v[132:133], v[76:79]
    v_mfma_f32_16x16x16_bf16 v[80:83], v[124:125], v[134:135], v[80:83]
    v_mfma_f32_16x16x16_bf16 v[84:87], v[126:127], v[134:135], v[84:87]
    v_bfe_u32 v12, v3, 2, 1
    v_lshlrev_b32 v12, 4, v12
    v_lshl_add_u32 v12, v4, 2, v12
    v_and_b32 v13, 3, v3
    v_add_u32 v12, v12, v13
    v_lshrrev_b32 v13, 3, v3
    v_lshl_add_u32 v12, v12, 1, v13
    v_lshlrev_b32 v12, 2, v12
    s_lshl_b32 s42, s40, 8
    s_add_u32 s42, s42, 141312
    v_add_u32 v12, s42, v12
    v_pk_mul_f32 v[56:57], v[56:57], v[140:141]
    v_pk_mul_f32 v[58:59], v[58:59], v[142:143]
    v_pk_mul_f32 v[60:61], v[60:61], v[144:145]
    v_pk_mul_f32 v[62:63], v[62:63], v[146:147]
    v_pk_mul_f32 v[152:153], v[56:57], v[56:57]
    v_pk_mul_f32 v[154:155], v[58:59], v[58:59]
    v_pk_mul_f32 v[156:157], v[60:61], v[60:61]
    v_pk_mul_f32 v[158:159], v[62:63], v[62:63]
    v_pk_fma_f32 v[152:153], v[152:153], s[78:79], s[78:79] op_sel:[0,0,1] op_sel_hi:[1,0,1]
    v_pk_fma_f32 v[154:155], v[154:155], s[78:79], s[78:79] op_sel:[0,0,1] op_sel_hi:[1,0,1]
    v_pk_fma_f32 v[156:157], v[156:157], s[78:79], s[78:79] op_sel:[0,0,1] op_sel_hi:[1,0,1]
    v_pk_fma_f32 v[158:159], v[158:159], s[78:79], s[78:79] op_sel:[0,0,1] op_sel_hi:[1,0,1]
    v_pk_mul_f32 v[152:153], v[152:153], v[56:57]
    v_pk_mul_f32 v[154:155], v[154:155], v[58:59]
    v_pk_mul_f32 v[156:157], v[156:157], v[60:61]
    v_pk_mul_f32 v[158:159], v[158:159], v[62:63]
    v_exp_f32 v152, v152
    v_exp_f32 v153, v153
    v_exp_f32 v154, v154
    v_exp_f32 v155, v155
    v_exp_f32 v156, v156
    v_exp_f32 v157, v157
    v_exp_f32 v158, v158
    v_exp_f32 v159, v159
    v_pk_add_f32 v[152:153], v[152:153], 1.0 op_sel_hi:[1,0]
    v_pk_add_f32 v[154:155], v[154:155], 1.0 op_sel_hi:[1,0]
    v_pk_add_f32 v[156:157], v[156:157], 1.0 op_sel_hi:[1,0]
    v_pk_add_f32 v[158:159], v[158:159], 1.0 op_sel_hi:[1,0]
    v_rcp_f32 v152, v152
    v_rcp_f32 v153, v153
    v_rcp_f32 v154, v154
    v_rcp_f32 v155, v155
    v_rcp_f32 v156, v156
    v_rcp_f32 v157, v157
    v_rcp_f32 v158, v158
    v_rcp_f32 v159, v159
    v_pk_mul_f32 v[56:57], v[56:57], v[152:153]
    v_pk_mul_f32 v[58:59], v[58:59], v[154:155]
    v_pk_mul_f32 v[60:61], v[60:61], v[156:157]
    v_pk_mul_f32 v[62:63], v[62:63], v[158:159]
    v_pk_mov_b32 v[124:125], v[56:57], v[56:57] op_sel:[0,1]
    v_pk_mul_f32 v[132:133], v[56:57], v[56:57]
    v_pk_mov_b32 v[126:127], v[58:59], v[58:59] op_sel:[0,1]
    v_pk_mul_f32 v[134:135], v[58:59], v[58:59]
    v_pk_mov_b32 v[128:129], v[60:61], v[60:61] op_sel:[0,1]
    v_pk_mul_f32 v[136:137], v[60:61], v[60:61]
    v_pk_mov_b32 v[130:131], v[62:63], v[62:63] op_sel:[0,1]
    v_pk_mul_f32 v[138:139], v[62:63], v[62:63]
    v_pk_mul_f32 v[64:65], v[64:65], v[140:141]
    v_pk_mul_f32 v[66:67], v[66:67], v[142:143]
    v_pk_mul_f32 v[68:69], v[68:69], v[144:145]
    v_pk_mul_f32 v[70:71], v[70:71], v[146:147]
    v_pk_mul_f32 v[152:153], v[64:65], v[64:65]
    v_pk_mul_f32 v[154:155], v[66:67], v[66:67]
    v_pk_mul_f32 v[156:157], v[68:69], v[68:69]
    v_pk_mul_f32 v[158:159], v[70:71], v[70:71]
    v_pk_fma_f32 v[152:153], v[152:153], s[78:79], s[78:79] op_sel:[0,0,1] op_sel_hi:[1,0,1]
    v_pk_fma_f32 v[154:155], v[154:155], s[78:79], s[78:79] op_sel:[0,0,1] op_sel_hi:[1,0,1]
    v_pk_fma_f32 v[156:157], v[156:157], s[78:79], s[78:79] op_sel:[0,0,1] op_sel_hi:[1,0,1]
    v_pk_fma_f32 v[158:159], v[158:159], s[78:79], s[78:79] op_sel:[0,0,1] op_sel_hi:[1,0,1]
    v_pk_mul_f32 v[152:153], v[152:153], v[64:65]
    v_pk_mul_f32 v[154:155], v[154:155], v[66:67]
    v_pk_mul_f32 v[156:157], v[156:157], v[68:69]
    v_pk_mul_f32 v[158:159], v[158:159], v[70:71]
    v_exp_f32 v152, v152
    v_exp_f32 v153, v153
    v_exp_f32 v154, v154
    v_exp_f32 v155, v155
    v_exp_f32 v156, v156
    v_exp_f32 v157, v157
    v_exp_f32 v158, v158
    v_exp_f32 v159, v159
    v_pk_add_f32 v[152:153], v[152:153], 1.0 op_sel_hi:[1,0]
    v_pk_add_f32 v[154:155], v[154:155], 1.0 op_sel_hi:[1,0]
    v_pk_add_f32 v[156:157], v[156:157], 1.0 op_sel_hi:[1,0]
    v_pk_add_f32 v[158:159], v[158:159], 1.0 op_sel_hi:[1,0]
    v_rcp_f32 v152, v152
    v_rcp_f32 v153, v153
    v_rcp_f32 v154, v154
    v_rcp_f32 v155, v155
    v_rcp_f32 v156, v156
    v_rcp_f32 v157, v157
    v_rcp_f32 v158, v158
    v_rcp_f32 v159, v159
    v_pk_mul_f32 v[64:65], v[64:65], v[152:153]
    v_pk_mul_f32 v[66:67], v[66:67], v[154:155]
    v_pk_mul_f32 v[68:69], v[68:69], v[156:157]
    v_pk_mul_f32 v[70:71], v[70:71], v[158:159]
    v_pk_add_f32 v[124:125], v[124:125], v[64:65]
    v_pk_fma_f32 v[132:133], v[64:65], v[64:65], v[132:133]
    v_pk_add_f32 v[126:127], v[126:127], v[66:67]
    v_pk_fma_f32 v[134:135], v[66:67], v[66:67], v[134:135]
    v_pk_add_f32 v[128:129], v[128:129], v[68:69]
    v_pk_fma_f32 v[136:137], v[68:69], v[68:69], v[136:137]
    v_pk_add_f32 v[130:131], v[130:131], v[70:71]
    v_pk_fma_f32 v[138:139], v[70:71], v[70:71], v[138:139]
    v_pk_mul_f32 v[72:73], v[72:73], v[140:141]
    v_pk_mul_f32 v[74:75], v[74:75], v[142:143]
    v_pk_mul_f32 v[76:77], v[76:77], v[144:145]
    v_pk_mul_f32 v[78:79], v[78:79], v[146:147]
    v_pk_mul_f32 v[152:153], v[72:73], v[72:73]
    v_pk_mul_f32 v[154:155], v[74:75], v[74:75]
    v_pk_mul_f32 v[156:157], v[76:77], v[76:77]
    v_pk_mul_f32 v[158:159], v[78:79], v[78:79]
    v_pk_fma_f32 v[152:153], v[152:153], s[78:79], s[78:79] op_sel:[0,0,1] op_sel_hi:[1,0,1]
    v_pk_fma_f32 v[154:155], v[154:155], s[78:79], s[78:79] op_sel:[0,0,1] op_sel_hi:[1,0,1]
    v_pk_fma_f32 v[156:157], v[156:157], s[78:79], s[78:79] op_sel:[0,0,1] op_sel_hi:[1,0,1]
    v_pk_fma_f32 v[158:159], v[158:159], s[78:79], s[78:79] op_sel:[0,0,1] op_sel_hi:[1,0,1]
    v_pk_mul_f32 v[152:153], v[152:153], v[72:73]
    v_pk_mul_f32 v[154:155], v[154:155], v[74:75]
    v_pk_mul_f32 v[156:157], v[156:157], v[76:77]
    v_pk_mul_f32 v[158:159], v[158:159], v[78:79]
    v_exp_f32 v152, v152
    v_exp_f32 v153, v153
    v_exp_f32 v154, v154
    v_exp_f32 v155, v155
    v_exp_f32 v156, v156
    v_exp_f32 v157, v157
    v_exp_f32 v158, v158
    v_exp_f32 v159, v159
    v_pk_add_f32 v[152:153], v[152:153], 1.0 op_sel_hi:[1,0]
    v_pk_add_f32 v[154:155], v[154:155], 1.0 op_sel_hi:[1,0]
    v_pk_add_f32 v[156:157], v[156:157], 1.0 op_sel_hi:[1,0]
    v_pk_add_f32 v[158:159], v[158:159], 1.0 op_sel_hi:[1,0]
    v_rcp_f32 v152, v152
    v_rcp_f32 v153, v153
    v_rcp_f32 v154, v154
    v_rcp_f32 v155, v155
    v_rcp_f32 v156, v156
    v_rcp_f32 v157, v157
    v_rcp_f32 v158, v158
    v_rcp_f32 v159, v159
    v_pk_mul_f32 v[72:73], v[72:73], v[152:153]
    v_pk_mul_f32 v[74:75], v[74:75], v[154:155]
    v_pk_mul_f32 v[76:77], v[76:77], v[156:157]
    v_pk_mul_f32 v[78:79], v[78:79], v[158:159]
    v_pk_add_f32 v[124:125], v[124:125], v[72:73]
    v_pk_fma_f32 v[132:133], v[72:73], v[72:73], v[132:133]
    v_pk_add_f32 v[126:127], v[126:127], v[74:75]
    v_pk_fma_f32 v[134:135], v[74:75], v[74:75], v[134:135]
    v_pk_add_f32 v[128:129], v[128:129], v[76:77]
    v_pk_fma_f32 v[136:137], v[76:77], v[76:77], v[136:137]
    v_pk_add_f32 v[130:131], v[130:131], v[78:79]
    v_pk_fma_f32 v[138:139], v[78:79], v[78:79], v[138:139]
    v_pk_mul_f32 v[80:81], v[80:81], v[140:141]
    v_pk_mul_f32 v[82:83], v[82:83], v[142:143]
    v_pk_mul_f32 v[84:85], v[84:85], v[144:145]
    v_pk_mul_f32 v[86:87], v[86:87], v[146:147]
    v_pk_mul_f32 v[152:153], v[80:81], v[80:81]
    v_pk_mul_f32 v[154:155], v[82:83], v[82:83]
    v_pk_mul_f32 v[156:157], v[84:85], v[84:85]
    v_pk_mul_f32 v[158:159], v[86:87], v[86:87]
    v_pk_fma_f32 v[152:153], v[152:153], s[78:79], s[78:79] op_sel:[0,0,1] op_sel_hi:[1,0,1]
    v_pk_fma_f32 v[154:155], v[154:155], s[78:79], s[78:79] op_sel:[0,0,1] op_sel_hi:[1,0,1]
    v_pk_fma_f32 v[156:157], v[156:157], s[78:79], s[78:79] op_sel:[0,0,1] op_sel_hi:[1,0,1]
    v_pk_fma_f32 v[158:159], v[158:159], s[78:79], s[78:79] op_sel:[0,0,1] op_sel_hi:[1,0,1]
    v_pk_mul_f32 v[152:153], v[152:153], v[80:81]
    v_pk_mul_f32 v[154:155], v[154:155], v[82:83]
    v_pk_mul_f32 v[156:157], v[156:157], v[84:85]
    v_pk_mul_f32 v[158:159], v[158:159], v[86:87]
    v_exp_f32 v152, v152
    v_exp_f32 v153, v153
    v_exp_f32 v154, v154
    v_exp_f32 v155, v155
    v_exp_f32 v156, v156
    v_exp_f32 v157, v157
    v_exp_f32 v158, v158
    v_exp_f32 v159, v159
    v_pk_add_f32 v[152:153], v[152:153], 1.0 op_sel_hi:[1,0]
    v_pk_add_f32 v[154:155], v[154:155], 1.0 op_sel_hi:[1,0]
    v_pk_add_f32 v[156:157], v[156:157], 1.0 op_sel_hi:[1,0]
    v_pk_add_f32 v[158:159], v[158:159], 1.0 op_sel_hi:[1,0]
    v_rcp_f32 v152, v152
    v_rcp_f32 v153, v153
    v_rcp_f32 v154, v154
    v_rcp_f32 v155, v155
    v_rcp_f32 v156, v156
    v_rcp_f32 v157, v157
    v_rcp_f32 v158, v158
    v_rcp_f32 v159, v159
    v_pk_mul_f32 v[80:81], v[80:81], v[152:153]
    v_pk_mul_f32 v[82:83], v[82:83], v[154:155]
    v_pk_mul_f32 v[84:85], v[84:85], v[156:157]
    v_pk_mul_f32 v[86:87], v[86:87], v[158:159]
    v_pk_add_f32 v[124:125], v[124:125], v[80:81]
    v_pk_fma_f32 v[132:133], v[80:81], v[80:81], v[132:133]
    v_pk_add_f32 v[126:127], v[126:127], v[82:83]
    v_pk_fma_f32 v[134:135], v[82:83], v[82:83], v[134:135]
    v_pk_add_f32 v[128:129], v[128:129], v[84:85]
    v_pk_fma_f32 v[136:137], v[84:85], v[84:85], v[136:137]
    v_pk_add_f32 v[130:131], v[130:131], v[86:87]
    v_pk_fma_f32 v[138:139], v[86:87], v[86:87], v[138:139]
    v_cndmask_b32 v140, v132, v124, s[64:65]
    v_cndmask_b32 v124, v124, v132, s[64:65]
    v_cndmask_b32 v141, v133, v125, s[64:65]
    v_cndmask_b32 v125, v125, v133, s[64:65]
    v_cndmask_b32 v142, v134, v126, s[64:65]
    v_cndmask_b32 v126, v126, v134, s[64:65]
    v_cndmask_b32 v143, v135, v127, s[64:65]
    v_cndmask_b32 v127, v127, v135, s[64:65]
    v_cndmask_b32 v144, v136, v128, s[64:65]
    v_cndmask_b32 v128, v128, v136, s[64:65]
    v_cndmask_b32 v145, v137, v129, s[64:65]
    v_cndmask_b32 v129, v129, v137, s[64:65]
    v_cndmask_b32 v146, v138, v130, s[64:65]
    v_cndmask_b32 v130, v130, v138, s[64:65]
    v_cndmask_b32 v147, v139, v131, s[64:65]
    v_cndmask_b32 v131, v131, v139, s[64:65]
    s_nop 1
    v_add_f32_dpp v124, v140, v124 row_ror:8 row_mask:0xf bank_mask:0xf
    v_add_f32_dpp v125, v141, v125 row_ror:8 row_mask:0xf bank_mask:0xf
    v_add_f32_dpp v126, v142, v126 row_ror:8 row_mask:0xf bank_mask:0xf
    v_add_f32_dpp v127, v143, v127 row_ror:8 row_mask:0xf bank_mask:0xf
    v_add_f32_dpp v128, v144, v128 row_ror:8 row_mask:0xf bank_mask:0xf
    v_add_f32_dpp v129, v145, v129 row_ror:8 row_mask:0xf bank_mask:0xf
    v_add_f32_dpp v130, v146, v130 row_ror:8 row_mask:0xf bank_mask:0xf
    v_add_f32_dpp v131, v147, v131 row_ror:8 row_mask:0xf bank_mask:0xf
    v_cndmask_b32 v140, v128, v124, s[66:67]
    v_cndmask_b32 v124, v124, v128, s[66:67]
    v_cndmask_b32 v141, v129, v125, s[66:67]
    v_cndmask_b32 v125, v125, v129, s[66:67]
    v_cndmask_b32 v142, v130, v126, s[66:67]
    v_cndmask_b32 v126, v126, v130, s[66:67]
    v_cndmask_b32 v143, v131, v127, s[66:67]
    v_cndmask_b32 v127, v127, v131, s[66:67]
    s_nop 1
    v_add_f32_dpp v124, v140, v124 row_half_mirror row_mask:0xf bank_mask:0xf
    v_add_f32_dpp v125, v141, v125 row_half_mirror row_mask:0xf bank_mask:0xf
    v_add_f32_dpp v126, v142, v126 row_half_mirror row_mask:0xf bank_mask:0xf
    v_add_f32_dpp v127, v143, v127 row_half_mirror row_mask:0xf bank_mask:0xf
    v_cndmask_b32 v140, v126, v124, s[68:69]
    v_cndmask_b32 v124, v124, v126, s[68:69]
    v_cndmask_b32 v141, v127, v125, s[68:69]
    v_cndmask_b32 v125, v125, v127, s[68:69]
    s_nop 1
    v_add_f32_dpp v124, v140, v124 quad_perm:[2,3,0,1] row_mask:0xf bank_mask:0xf
    v_add_f32_dpp v125, v141, v125 quad_perm:[2,3,0,1] row_mask:0xf bank_mask:0xf
    v_cndmask_b32 v140, v125, v124, s[70:71]
    v_cndmask_b32 v124, v124, v125, s[70:71]
    s_nop 1
    v_add_f32_dpp v124, v140, v124 quad_perm:[1,0,3,2] row_mask:0xf bank_mask:0xf
    ds_write_b32 v12, v124
    s_waitcnt lgkmcnt(0)
    s_barrier
    v_mfma_f32_16x16x32_bf16 v[16:19], v[104:107], v[96:99], 0
    ds_read_b64_tr_b16 v[124:125], v10 offset:24576
    v_mfma_f32_16x16x32_bf16 v[20:23], v[104:107], v[100:103], 0
    ds_read_b64_tr_b16 v[126:127], v10 offset:25600
    v_mfma_f32_16x16x32_bf16 v[24:27], v[108:111], v[96:99], 0
    ds_read_b64_tr_b16 v[128:129], v11 offset:24576
    v_mfma_f32_16x16x32_bf16 v[28:31], v[108:111], v[100:103], 0
    ds_read_b64_tr_b16 v[130:131], v11 offset:25600
    v_mfma_f32_16x16x32_bf16 v[32:35], v[112:115], v[96:99], 0
    ds_read_b128 v[132:135], v7 offset:18432
    v_mfma_f32_16x16x32_bf16 v[36:39], v[112:115], v[100:103], 0
    ds_read_b128 v[136:139], v7 offset:20480
    v_mfma_f32_16x16x32_bf16 v[40:43], v[116:119], v[96:99], 0
    ds_read_b128 v[140:143], v7 offset:22528
    v_mfma_f32_16x16x32_bf16 v[44:47], v[116:119], v[100:103], 0
    ds_read_b128 v[144:147], v7 offset:24576
    s_waitcnt lgkmcnt(0)
    s_barrier
    v_mfma_f32_16x16x32_bf16 v[16:19], v[132:135], v[124:127], v[16:19]
    ds_read_b64_tr_b16 v[96:97], v10 offset:32768
    v_mfma_f32_16x16x32_bf16 v[20:23], v[132:135], v[128:131], v[20:23]
    ds_read_b64_tr_b16 v[98:99], v10 offset:33792
    v_mfma_f32_16x16x32_bf16 v[24:27], v[136:139], v[124:127], v[24:27]
    ds_read_b64_tr_b16 v[100:101], v11 offset:32768
    v_mfma_f32_16x16x32_bf16 v[28:31], v[136:139], v[128:131], v[28:31]
    ds_read_b64_tr_b16 v[102:103], v11 offset:33792
    v_mfma_f32_16x16x32_bf16 v[32:35], v[140:143], v[124:127], v[32:35]
    ds_read_b128 v[104:107], v6 offset:36864
    v_mfma_f32_16x16x32_bf16 v[36:39], v[140:143], v[128:131], v[36:39]
    ds_read_b128 v[108:111], v6 offset:38912
    v_mfma_f32_16x16x32_bf16 v[40:43], v[144:147], v[124:127], v[40:43]
    ds_read_b128 v[112:115], v6 offset:40960
    v_mfma_f32_16x16x32_bf16 v[44:47], v[144:147], v[128:131], v[44:47]
    ds_read_b128 v[116:119], v6 offset:43008
    s_waitcnt lgkmcnt(0)
    v_mfma_f32_16x16x32_bf16 v[16:19], v[104:107], v[96:99], v[16:19]
    ds_read_b64_tr_b16 v[124:125], v10 offset:40960
    v_mfma_f32_16x16x32_bf16 v[20:23], v[104:107], v[100:103], v[20:23]
    ds_read_b64_tr_b16 v[126:127], v10 offset:41984
    v_mfma_f32_16x16x32_bf16 v[24:27], v[108:111], v[96:99], v[24:27]
    ds_read_b64_tr_b16 v[128:129], v11 offset:40960
    v_mfma_f32_16x16x32_bf16 v[28:31], v[108:111], v[100:103], v[28:31]
    ds_read_b64_tr_b16 v[130:131], v11 offset:41984
    v_mfma_f32_16x16x32_bf16 v[32:35], v[112:115], v[96:99], v[32:35]
    ds_read_b128 v[132:135], v7 offset:36864
    v_mfma_f32_16x16x32_bf16 v[36:39], v[112:115], v[100:103], v[36:39]
    ds_read_b128 v[136:139], v7 offset:38912
    v_mfma_f32_16x16x32_bf16 v[40:43], v[116:119], v[96:99], v[40:43]
    ds_read_b128 v[140:143], v7 offset:40960
    v_mfma_f32_16x16x32_bf16 v[44:47], v[116:119], v[100:103], v[44:47]
    ds_read_b128 v[144:147], v7 offset:43008
    s_waitcnt lgkmcnt(0)
    s_barrier
    v_mfma_f32_16x16x32_bf16 v[16:19], v[132:135], v[124:127], v[16:19]
    ds_read_b64_tr_b16 v[96:97], v10 offset:49152
    v_mfma_f32_16x16x32_bf16 v[20:23], v[132:135], v[128:131], v[20:23]
    ds_read_b64_tr_b16 v[98:99], v10 offset:50176
    v_mfma_f32_16x16x32_bf16 v[24:27], v[136:139], v[124:127], v[24:27]
    ds_read_b64_tr_b16 v[100:101], v11 offset:49152
    v_mfma_f32_16x16x32_bf16 v[28:31], v[136:139], v[128:131], v[28:31]
    ds_read_b64_tr_b16 v[102:103], v11 offset:50176
    v_mfma_f32_16x16x32_bf16 v[32:35], v[140:143], v[124:127], v[32:35]
    ds_read_b128 v[104:107], v6 offset:55296
    v_mfma_f32_16x16x32_bf16 v[36:39], v[140:143], v[128:131], v[36:39]
    ds_read_b128 v[108:111], v6 offset:57344
    v_mfma_f32_16x16x32_bf16 v[40:43], v[144:147], v[124:127], v[40:43]
    ds_read_b128 v[112:115], v6 offset:59392
    v_mfma_f32_16x16x32_bf16 v[44:47], v[144:147], v[128:131], v[44:47]
    ds_read_b128 v[116:119], v6 offset:61440
    s_waitcnt lgkmcnt(0)
    v_mfma_f32_16x16x32_bf16 v[16:19], v[104:107], v[96:99], v[16:19]
    ds_read_b64_tr_b16 v[124:125], v10 offset:57344
    v_mfma_f32_16x16x32_bf16 v[20:23], v[104:107], v[100:103], v[20:23]
    ds_read_b64_tr_b16 v[126:127], v10 offset:58368
    v_mfma_f32_16x16x32_bf16 v[24:27], v[108:111], v[96:99], v[24:27]
    ds_read_b64_tr_b16 v[128:129], v11 offset:57344
    v_mfma_f32_16x16x32_bf16 v[28:31], v[108:111], v[100:103], v[28:31]
    ds_read_b64_tr_b16 v[130:131], v11 offset:58368
    v_mfma_f32_16x16x32_bf16 v[32:35], v[112:115], v[96:99], v[32:35]
    ds_read_b128 v[132:135], v7 offset:55296
    v_mfma_f32_16x16x32_bf16 v[36:39], v[112:115], v[100:103], v[36:39]
    ds_read_b128 v[136:139], v7 offset:57344
    v_mfma_f32_16x16x32_bf16 v[40:43], v[116:119], v[96:99], v[40:43]
    ds_read_b128 v[140:143], v7 offset:59392
    v_mfma_f32_16x16x32_bf16 v[44:47], v[116:119], v[100:103], v[44:47]
    ds_read_b128 v[144:147], v7 offset:61440
    s_waitcnt lgkmcnt(0)
    s_barrier
    v_mfma_f32_16x16x32_bf16 v[16:19], v[132:135], v[124:127], v[16:19]
    ds_read_b64_tr_b16 v[96:97], v10 offset:0
    v_mfma_f32_16x16x32_bf16 v[20:23], v[132:135], v[128:131], v[20:23]
    ds_read_b64_tr_b16 v[98:99], v10 offset:1024
    v_mfma_f32_16x16x32_bf16 v[24:27], v[136:139], v[124:127], v[24:27]
    ds_read_b64_tr_b16 v[100:101], v11 offset:0
    v_mfma_f32_16x16x32_bf16 v[28:31], v[136:139], v[128:131], v[28:31]
    ds_read_b64_tr_b16 v[102:103], v11 offset:1024
    v_mfma_f32_16x16x32_bf16 v[32:35], v[140:143], v[124:127], v[32:35]
    ds_read_b128 v[104:107], v6 offset:0
    v_mfma_f32_16x16x32_bf16 v[36:39], v[140:143], v[128:131], v[36:39]
    ds_read_b128 v[108:111], v6 offset:2048
    v_mfma_f32_16x16x32_bf16 v[40:43], v[144:147], v[124:127], v[40:43]
    ds_read_b128 v[112:115], v6 offset:4096
    v_mfma_f32_16x16x32_bf16 v[44:47], v[144:147], v[128:131], v[44:47]
    ds_read_b128 v[116:119], v6 offset:6144
    s_waitcnt lgkmcnt(0)
    v_mfma_f32_16x16x32_bf16 v[16:19], v[104:107], v[96:99], v[16:19]
    ds_read_b64_tr_b16 v[124:125], v10 offset:8192
    v_mfma_f32_16x16x32_bf16 v[20:23], v[104:107], v[100:103], v[20:23]
    ds_read_b64_tr_b16 v[126:127], v10 offset:9216
    v_mfma_f32_16x16x32_bf16 v[24:27], v[108:111], v[96:99], v[24:27]
    ds_read_b64_tr_b16 v[128:129], v11 offset:8192
    v_mfma_f32_16x16x32_bf16 v[28:31], v[108:111], v[100:103], v[28:31]
    ds_read_b64_tr_b16 v[130:131], v11 offset:9216
    v_mfma_f32_16x16x32_bf16 v[32:35], v[112:115], v[96:99], v[32:35]
    ds_read_b128 v[132:135], v7 offset:0
    v_mfma_f32_16x16x32_bf16 v[36:39], v[112:115], v[100:103], v[36:39]
    ds_read_b128 v[136:139], v7 offset:2048
    v_mfma_f32_16x16x32_bf16 v[40:43], v[116:119], v[96:99], v[40:43]
    ds_read_b128 v[140:143], v7 offset:4096
    v_mfma_f32_16x16x32_bf16 v[44:47], v[116:119], v[100:103], v[44:47]
    ds_read_b128 v[144:147], v7 offset:6144
    s_waitcnt lgkmcnt(0)
    s_barrier
    v_mfma_f32_16x16x32_bf16 v[16:19], v[132:135], v[124:127], v[16:19]
    ds_read_b64_tr_b16 v[96:97], v10 offset:16384
    v_mfma_f32_16x16x32_bf16 v[20:23], v[132:135], v[128:131], v[20:23]
    ds_read_b64_tr_b16 v[98:99], v10 offset:17408
    v_mfma_f32_16x16x32_bf16 v[24:27], v[136:139], v[124:127], v[24:27]
    ds_read_b64_tr_b16 v[100:101], v11 offset:16384
    v_mfma_f32_16x16x32_bf16 v[28:31], v[136:139], v[128:131], v[28:31]
    ds_read_b64_tr_b16 v[102:103], v11 offset:17408
    v_mfma_f32_16x16x32_bf16 v[32:35], v[140:143], v[124:127], v[32:35]
    ds_read_b128 v[104:107], v6 offset:18432
    v_mfma_f32_16x16x32_bf16 v[36:39], v[140:143], v[128:131], v[36:39]
    ds_read_b128 v[108:111], v6 offset:20480
    v_mfma_f32_16x16x32_bf16 v[40:43], v[144:147], v[124:127], v[40:43]
    ds_read_b128 v[112:115], v6 offset:22528
    v_mfma_f32_16x16x32_bf16 v[44:47], v[144:147], v[128:131], v[44:47]
    ds_read_b128 v[116:119], v6 offset:24576
    s_waitcnt lgkmcnt(0)
    v_mfma_f32_16x16x32_bf16 v[16:19], v[104:107], v[96:99], v[16:19]
    ds_read_b64_tr_b16 v[124:125], v10 offset:24576
    v_mfma_f32_16x16x32_bf16 v[20:23], v[104:107], v[100:103], v[20:23]
    ds_read_b64_tr_b16 v[126:127], v10 offset:25600
    v_mfma_f32_16x16x32_bf16 v[24:27], v[108:111], v[96:99], v[24:27]
    ds_read_b64_tr_b16 v[128:129], v11 offset:24576
    v_mfma_f32_16x16x32_bf16 v[28:31], v[108:111], v[100:103], v[28:31]
    ds_read_b64_tr_b16 v[130:131], v11 offset:25600
    v_mfma_f32_16x16x32_bf16 v[32:35], v[112:115], v[96:99], v[32:35]
    ds_read_b128 v[132:135], v7 offset:18432
    v_mfma_f32_16x16x32_bf16 v[36:39], v[112:115], v[100:103], v[36:39]
    ds_read_b128 v[136:139], v7 offset:20480
    v_mfma_f32_16x16x32_bf16 v[40:43], v[116:119], v[96:99], v[40:43]
    ds_read_b128 v[140:143], v7 offset:22528
    v_mfma_f32_16x16x32_bf16 v[44:47], v[116:119], v[100:103], v[44:47]
    ds_read_b128 v[144:147], v7 offset:24576
    s_waitcnt lgkmcnt(0)
    s_barrier
    v_mfma_f32_16x16x32_bf16 v[16:19], v[132:135], v[124:127], v[16:19]
    ds_read_b64_tr_b16 v[96:97], v10 offset:32768
    v_mfma_f32_16x16x32_bf16 v[20:23], v[132:135], v[128:131], v[20:23]
    ds_read_b64_tr_b16 v[98:99], v10 offset:33792
    v_mfma_f32_16x16x32_bf16 v[24:27], v[136:139], v[124:127], v[24:27]
    ds_read_b64_tr_b16 v[100:101], v11 offset:32768
    v_mfma_f32_16x16x32_bf16 v[28:31], v[136:139], v[128:131], v[28:31]
    ds_read_b64_tr_b16 v[102:103], v11 offset:33792
    v_mfma_f32_16x16x32_bf16 v[32:35], v[140:143], v[124:127], v[32:35]
    ds_read_b128 v[104:107], v6 offset:36864
    v_mfma_f32_16x16x32_bf16 v[36:39], v[140:143], v[128:131], v[36:39]
    ds_read_b128 v[108:111], v6 offset:38912
    v_mfma_f32_16x16x32_bf16 v[40:43], v[144:147], v[124:127], v[40:43]
    ds_read_b128 v[112:115], v6 offset:40960
    v_mfma_f32_16x16x32_bf16 v[44:47], v[144:147], v[128:131], v[44:47]
    ds_read_b128 v[116:119], v6 offset:43008
    s_waitcnt lgkmcnt(0)
    v_add_u32 v15, 142336, v14
    ds_read_b128 v[124:127], v15 offset:0
    ds_read_b128 v[132:135], v15 offset:512
    ds_read_b128 v[128:131], v15 offset:64
    ds_read_b128 v[136:139], v15 offset:576
    v_lshlrev_b32 v13, 6, v3
    v_lshl_add_u32 v13, v4, 4, v13
    s_lshl_b32 s42, s10, 6
    s_lshl_b32 s44, s11, 2
    s_add_u32 s42, s42, s44
    s_add_u32 s42, s42, s40
    s_mul_i32 s42, s42, 9216
    v_add_u32 v13, s42, v13
    s_waitcnt lgkmcnt(0)
    v_pk_fma_f32 v[56:57], v[56:57], v[124:125], v[132:133] neg_lo:[0,0,1] neg_hi:[0,0,1]
    v_pk_fma_f32 v[58:59], v[58:59], v[126:127], v[134:135] neg_lo:[0,0,1] neg_hi:[0,0,1]
    v_pk_fma_f32 v[60:61], v[60:61], v[128:129], v[136:137] neg_lo:[0,0,1] neg_hi:[0,0,1]
    v_pk_fma_f32 v[62:63], v[62:63], v[130:131], v[138:139] neg_lo:[0,0,1] neg_hi:[0,0,1]
    v_cvt_pk_bf16_f32 v56, v56, v57
    v_cvt_pk_bf16_f32 v57, v58, v59
    v_cvt_pk_bf16_f32 v58, v60, v61
    v_cvt_pk_bf16_f32 v59, v62, v63
    s_mov_b32 s44, 5120
    s_nop 0
    v_permlane32_swap_b32 v56, v58
    v_permlane32_swap_b32 v57, v59
    s_nop 0
    v_permlane16_swap_b32 v56, v58
    v_permlane16_swap_b32 v57, v59
    buffer_store_dwordx4 v[56:59], v13, s[24:27], s44 offen sc1
    v_pk_fma_f32 v[64:65], v[64:65], v[124:125], v[132:133] neg_lo:[0,0,1] neg_hi:[0,0,1]
    v_pk_fma_f32 v[66:67], v[66:67], v[126:127], v[134:135] neg_lo:[0,0,1] neg_hi:[0,0,1]
    v_pk_fma_f32 v[68:69], v[68:69], v[128:129], v[136:137] neg_lo:[0,0,1] neg_hi:[0,0,1]
    v_pk_fma_f32 v[70:71], v[70:71], v[130:131], v[138:139] neg_lo:[0,0,1] neg_hi:[0,0,1]
    v_cvt_pk_bf16_f32 v64, v64, v65
    v_cvt_pk_bf16_f32 v65, v66, v67
    v_cvt_pk_bf16_f32 v66, v68, v69
    v_cvt_pk_bf16_f32 v67, v70, v71
    s_mov_b32 s44, 6144
    s_nop 0
    v_permlane32_swap_b32 v64, v66
    v_permlane32_swap_b32 v65, v67
    s_nop 0
    v_permlane16_swap_b32 v64, v66
    v_permlane16_swap_b32 v65, v67
    buffer_store_dwordx4 v[64:67], v13, s[24:27], s44 offen sc1
    v_pk_fma_f32 v[72:73], v[72:73], v[124:125], v[132:133] neg_lo:[0,0,1] neg_hi:[0,0,1]
    v_pk_fma_f32 v[74:75], v[74:75], v[126:127], v[134:135] neg_lo:[0,0,1] neg_hi:[0,0,1]
    v_pk_fma_f32 v[76:77], v[76:77], v[128:129], v[136:137] neg_lo:[0,0,1] neg_hi:[0,0,1]
    v_pk_fma_f32 v[78:79], v[78:79], v[130:131], v[138:139] neg_lo:[0,0,1] neg_hi:[0,0,1]
    v_cvt_pk_bf16_f32 v72, v72, v73
    v_cvt_pk_bf16_f32 v73, v74, v75
    v_cvt_pk_bf16_f32 v74, v76, v77
    v_cvt_pk_bf16_f32 v75, v78, v79
    s_mov_b32 s44, 7168
    s_nop 0
    v_permlane32_swap_b32 v72, v74
    v_permlane32_swap_b32 v73, v75
    s_nop 0
    v_permlane16_swap_b32 v72, v74
    v_permlane16_swap_b32 v73, v75
    buffer_store_dwordx4 v[72:75], v13, s[24:27], s44 offen sc1
    v_pk_fma_f32 v[80:81], v[80:81], v[124:125], v[132:133] neg_lo:[0,0,1] neg_hi:[0,0,1]
    v_pk_fma_f32 v[82:83], v[82:83], v[126:127], v[134:135] neg_lo:[0,0,1] neg_hi:[0,0,1]
    v_pk_fma_f32 v[84:85], v[84:85], v[128:129], v[136:137] neg_lo:[0,0,1] neg_hi:[0,0,1]
    v_pk_fma_f32 v[86:87], v[86:87], v[130:131], v[138:139] neg_lo:[0,0,1] neg_hi:[0,0,1]
    v_cvt_pk_bf16_f32 v80, v80, v81
    v_cvt_pk_bf16_f32 v81, v82, v83
    v_cvt_pk_bf16_f32 v82, v84, v85
    v_cvt_pk_bf16_f32 v83, v86, v87
    s_mov_b32 s44, 8192
    s_nop 0
    v_permlane32_swap_b32 v80, v82
    v_permlane32_swap_b32 v81, v83
    s_nop 0
    v_permlane16_swap_b32 v80, v82
    v_permlane16_swap_b32 v81, v83
    buffer_store_dwordx4 v[80:83], v13, s[24:27], s44 offen sc1
    v_mfma_f32_16x16x32_bf16 v[16:19], v[104:107], v[96:99], v[16:19]
    ds_read_b64_tr_b16 v[124:125], v10 offset:40960
    v_mfma_f32_16x16x32_bf16 v[20:23], v[104:107], v[100:103], v[20:23]
    ds_read_b64_tr_b16 v[126:127], v10 offset:41984
    v_mfma_f32_16x16x32_bf16 v[24:27], v[108:111], v[96:99], v[24:27]
    ds_read_b64_tr_b16 v[128:129], v11 offset:40960
    v_mfma_f32_16x16x32_bf16 v[28:31], v[108:111], v[100:103], v[28:31]
    ds_read_b64_tr_b16 v[130:131], v11 offset:41984
    v_mfma_f32_16x16x32_bf16 v[32:35], v[112:115], v[96:99], v[32:35]
    ds_read_b128 v[132:135], v7 offset:36864
    v_mfma_f32_16x16x32_bf16 v[36:39], v[112:115], v[100:103], v[36:39]
    ds_read_b128 v[136:139], v7 offset:38912
    v_mfma_f32_16x16x32_bf16 v[40:43], v[116:119], v[96:99], v[40:43]
    ds_read_b128 v[140:143], v7 offset:40960
    v_mfma_f32_16x16x32_bf16 v[44:47], v[116:119], v[100:103], v[44:47]
    ds_read_b128 v[144:147], v7 offset:43008
    s_waitcnt lgkmcnt(0)
    s_barrier
    v_mfma_f32_16x16x32_bf16 v[16:19], v[132:135], v[124:127], v[16:19]
    ds_read_b64_tr_b16 v[96:97], v10 offset:49152
    v_mfma_f32_16x16x32_bf16 v[20:23], v[132:135], v[128:131], v[20:23]
    ds_read_b64_tr_b16 v[98:99], v10 offset:50176
    v_mfma_f32_16x16x32_bf16 v[24:27], v[136:139], v[124:127], v[24:27]
    ds_read_b64_tr_b16 v[100:101], v11 offset:49152
    v_mfma_f32_16x16x32_bf16 v[28:31], v[136:139], v[128:131], v[28:31]
    ds_read_b64_tr_b16 v[102:103], v11 offset:50176
    v_mfma_f32_16x16x32_bf16 v[32:35], v[140:143], v[124:127], v[32:35]
    ds_read_b128 v[104:107], v6 offset:55296
    v_mfma_f32_16x16x32_bf16 v[36:39], v[140:143], v[128:131], v[36:39]
    ds_read_b128 v[108:111], v6 offset:57344
    v_mfma_f32_16x16x32_bf16 v[40:43], v[144:147], v[124:127], v[40:43]
    ds_read_b128 v[112:115], v6 offset:59392
    v_mfma_f32_16x16x32_bf16 v[44:47], v[144:147], v[128:131], v[44:47]
    ds_read_b128 v[116:119], v6 offset:61440
    s_waitcnt lgkmcnt(0)
    v_mfma_f32_16x16x32_bf16 v[16:19], v[104:107], v[96:99], v[16:19]
    ds_read_b64_tr_b16 v[124:125], v10 offset:57344
    v_mfma_f32_16x16x32_bf16 v[20:23], v[104:107], v[100:103], v[20:23]
    ds_read_b64_tr_b16 v[126:127], v10 offset:58368
    v_mfma_f32_16x16x32_bf16 v[24:27], v[108:111], v[96:99], v[24:27]
    ds_read_b64_tr_b16 v[128:129], v11 offset:57344
    v_mfma_f32_16x16x32_bf16 v[28:31], v[108:111], v[100:103], v[28:31]
    ds_read_b64_tr_b16 v[130:131], v11 offset:58368
    v_mfma_f32_16x16x32_bf16 v[32:35], v[112:115], v[96:99], v[32:35]
    ds_read_b128 v[132:135], v7 offset:55296
    v_mfma_f32_16x16x32_bf16 v[36:39], v[112:115], v[100:103], v[36:39]
    ds_read_b128 v[136:139], v7 offset:57344
    v_mfma_f32_16x16x32_bf16 v[40:43], v[116:119], v[96:99], v[40:43]
    ds_read_b128 v[140:143], v7 offset:59392
    v_mfma_f32_16x16x32_bf16 v[44:47], v[116:119], v[100:103], v[44:47]
    ds_read_b128 v[144:147], v7 offset:61440
    s_waitcnt lgkmcnt(0)
    s_waitcnt vmcnt(0)
    s_barrier
    v_mfma_f32_16x16x32_bf16 v[16:19], v[132:135], v[124:127], v[16:19]
    ds_read_b64_tr_b16 v[96:97], v10 offset:0
    v_mfma_f32_16x16x32_bf16 v[20:23], v[132:135], v[128:131], v[20:23]
    ds_read_b64_tr_b16 v[98:99], v10 offset:1024
    v_mfma_f32_16x16x32_bf16 v[24:27], v[136:139], v[124:127], v[24:27]
    ds_read_b64_tr_b16 v[100:101], v11 offset:0
    v_mfma_f32_16x16x32_bf16 v[28:31], v[136:139], v[128:131], v[28:31]
    ds_read_b64_tr_b16 v[102:103], v11 offset:1024
    v_mfma_f32_16x16x32_bf16 v[32:35], v[140:143], v[124:127], v[32:35]
    ds_read_b128 v[104:107], v6 offset:0
    v_mfma_f32_16x16x32_bf16 v[36:39], v[140:143], v[128:131], v[36:39]
    ds_read_b128 v[108:111], v6 offset:2048
    v_mfma_f32_16x16x32_bf16 v[40:43], v[144:147], v[124:127], v[40:43]
    ds_read_b128 v[112:115], v6 offset:4096
    v_mfma_f32_16x16x32_bf16 v[44:47], v[144:147], v[128:131], v[44:47]
    ds_read_b128 v[116:119], v6 offset:6144
    s_waitcnt lgkmcnt(0)
    v_mfma_f32_16x16x32_bf16 v[16:19], v[104:107], v[96:99], v[16:19]
    ds_read_b64_tr_b16 v[124:125], v10 offset:8192
    v_mfma_f32_16x16x32_bf16 v[20:23], v[104:107], v[100:103], v[20:23]
    ds_read_b64_tr_b16 v[126:127], v10 offset:9216
    v_mfma_f32_16x16x32_bf16 v[24:27], v[108:111], v[96:99], v[24:27]
    ds_read_b64_tr_b16 v[128:129], v11 offset:8192
    v_mfma_f32_16x16x32_bf16 v[28:31], v[108:111], v[100:103], v[28:31]
    ds_read_b64_tr_b16 v[130:131], v11 offset:9216
    v_mfma_f32_16x16x32_bf16 v[32:35], v[112:115], v[96:99], v[32:35]
    ds_read_b128 v[132:135], v7 offset:0
    v_mfma_f32_16x16x32_bf16 v[36:39], v[112:115], v[100:103], v[36:39]
    ds_read_b128 v[136:139], v7 offset:2048
    v_mfma_f32_16x16x32_bf16 v[40:43], v[116:119], v[96:99], v[40:43]
    ds_read_b128 v[140:143], v7 offset:4096
    v_mfma_f32_16x16x32_bf16 v[44:47], v[116:119], v[100:103], v[44:47]
    ds_read_b128 v[144:147], v7 offset:6144
    s_waitcnt lgkmcnt(0)
    s_barrier
    v_mfma_f32_16x16x32_bf16 v[16:19], v[132:135], v[124:127], v[16:19]
    ds_read_b64_tr_b16 v[96:97], v10 offset:16384
    v_mfma_f32_16x16x32_bf16 v[20:23], v[132:135], v[128:131], v[20:23]
    ds_read_b64_tr_b16 v[98:99], v10 offset:17408
    v_mfma_f32_16x16x32_bf16 v[24:27], v[136:139], v[124:127], v[24:27]
    ds_read_b64_tr_b16 v[100:101], v11 offset:16384
    v_mfma_f32_16x16x32_bf16 v[28:31], v[136:139], v[128:131], v[28:31]
    ds_read_b64_tr_b16 v[102:103], v11 offset:17408
    v_mfma_f32_16x16x32_bf16 v[32:35], v[140:143], v[124:127], v[32:35]
    ds_read_b128 v[104:107], v6 offset:18432
    v_mfma_f32_16x16x32_bf16 v[36:39], v[140:143], v[128:131], v[36:39]
    ds_read_b128 v[108:111], v6 offset:20480
    v_mfma_f32_16x16x32_bf16 v[40:43], v[144:147], v[124:127], v[40:43]
    ds_read_b128 v[112:115], v6 offset:22528
    v_mfma_f32_16x16x32_bf16 v[44:47], v[144:147], v[128:131], v[44:47]
    ds_read_b128 v[116:119], v6 offset:24576
    s_waitcnt lgkmcnt(0)
    v_mfma_f32_16x16x32_bf16 v[16:19], v[104:107], v[96:99], v[16:19]
    ds_read_b64_tr_b16 v[124:125], v10 offset:24576
    v_mfma_f32_16x16x32_bf16 v[20:23], v[104:107], v[100:103], v[20:23]
    ds_read_b64_tr_b16 v[126:127], v10 offset:25600
    v_mfma_f32_16x16x32_bf16 v[24:27], v[108:111], v[96:99], v[24:27]
    ds_read_b64_tr_b16 v[128:129], v11 offset:24576
    v_mfma_f32_16x16x32_bf16 v[28:31], v[108:111], v[100:103], v[28:31]
    ds_read_b64_tr_b16 v[130:131], v11 offset:25600
    v_mfma_f32_16x16x32_bf16 v[32:35], v[112:115], v[96:99], v[32:35]
    ds_read_b128 v[132:135], v7 offset:18432
    v_mfma_f32_16x16x32_bf16 v[36:39], v[112:115], v[100:103], v[36:39]
    ds_read_b128 v[136:139], v7 offset:20480
    v_mfma_f32_16x16x32_bf16 v[40:43], v[116:119], v[96:99], v[40:43]
    ds_read_b128 v[140:143], v7 offset:22528
    v_mfma_f32_16x16x32_bf16 v[44:47], v[116:119], v[100:103], v[44:47]
    ds_read_b128 v[144:147], v7 offset:24576
    s_waitcnt lgkmcnt(0)
    s_barrier
    v_mfma_f32_16x16x32_bf16 v[16:19], v[132:135], v[124:127], v[16:19]
    v_mfma_f32_16x16x32_bf16 v[20:23], v[132:135], v[128:131], v[20:23]
    v_mfma_f32_16x16x32_bf16 v[24:27], v[136:139], v[124:127], v[24:27]
    v_mfma_f32_16x16x32_bf16 v[28:31], v[136:139], v[128:131], v[28:31]
    v_mfma_f32_16x16x32_bf16 v[32:35], v[140:143], v[124:127], v[32:35]
    v_mfma_f32_16x16x32_bf16 v[36:39], v[140:143], v[128:131], v[36:39]
    v_mfma_f32_16x16x32_bf16 v[40:43], v[144:147], v[124:127], v[40:43]
    v_mfma_f32_16x16x32_bf16 v[44:47], v[144:147], v[128:131], v[44:47]
    v_lshlrev_b32 v12, 2, v3
    s_lshl_b32 s42, s40, 7
    s_add_u32 s42, s42, 139264
    v_add_u32 v12, s42, v12
    ds_read_b32 v142, v12
    ds_read_b32 v146, v12 offset:64
    s_lshl_b32 s42, s40, 5
    s_add_u32 s42, s42, s13
    v_add_u32 v14, s42, v3
    v_lshlrev_b32 v15, 1, v14
    buffer_load_ushort v160, v15, s[32:35], 0 offen
    buffer_load_ushort v162, v15, s[32:35], 0 offen offset:32
    v_lshlrev_b32 v12, 2, v3
    s_lshl_b32 s42, s40, 7
    s_add_u32 s42, s42, 139776
    v_add_u32 v13, s42, v12
    ds_read_b32 v124, v13
    ds_read_b32 v126, v13 offset:64
    v_add_u32 v12, 143360, v12
    v_lshrrev_b32 v13, 2, v3
    v_lshlrev_b32 v13, 4, v13
    v_add_u32 v13, v13, v12
    ds_read_b32 v128, v13 offset:320
    v_mov_b32 v129, 0
    ds_read_b32 v130, v13 offset:336
    v_mov_b32 v131, 0
    ds_read_b32 v132, v13 offset:448
    v_mov_b32 v133, 0
    ds_read_b32 v134, v13 offset:464
    v_mov_b32 v135, 0
    v_mov_b32 v125, 0
    v_mov_b32 v127, 0
    v_cmp_eq_u32 vcc, 0, v4
    s_nop 0
    s_waitcnt lgkmcnt(0)
    v_cndmask_b32 v124, 0, v124, vcc
    v_cndmask_b32 v126, 0, v126, vcc
    s_nop 1
    v_mfma_f32_16x16x16_bf16 v[16:19], v[128:129], v[124:125], v[16:19]
    v_mfma_f32_16x16x16_bf16 v[20:23], v[128:129], v[126:127], v[20:23]
    v_mfma_f32_16x16x16_bf16 v[24:27], v[130:131], v[124:125], v[24:27]
    v_mfma_f32_16x16x16_bf16 v[28:31], v[130:131], v[126:127], v[28:31]
    v_mfma_f32_16x16x16_bf16 v[32:35], v[132:133], v[124:125], v[32:35]
    v_mfma_f32_16x16x16_bf16 v[36:39], v[132:133], v[126:127], v[36:39]
    v_mfma_f32_16x16x16_bf16 v[40:43], v[134:135], v[124:125], v[40:43]
    v_mfma_f32_16x16x16_bf16 v[44:47], v[134:135], v[126:127], v[44:47]
    v_mul_f32 v141, 0xc0135761, v142
    v_mul_f32 v140, v142, v142
    v_mul_f32 v140, v140, v142
    v_mul_f32 v140, 0xbdd2d3e8, v140
    v_rcp_f32 v142, v142
    v_mul_f32 v145, 0xc0135761, v146
    v_mul_f32 v144, v146, v146
    v_mul_f32 v144, v144, v146
    v_mul_f32 v144, 0xbdd2d3e8, v144
    v_rcp_f32 v146, v146
    s_nop 1
    v_mov_b32 v156, v140
    v_mov_b32 v157, v141
    v_mov_b32 v158, v142
    v_mov_b32 v159, v144
    v_mov_b32 v161, v145
    v_mov_b32 v163, v146
    s_barrier
    ds_read_b128 v[96:99], v8 offset:32768
    ds_read_b128 v[100:103], v8 offset:34816
    ds_read_b128 v[104:107], v6 offset:36864
    ds_read_b128 v[108:111], v6 offset:38912
    ds_read_b128 v[112:115], v6 offset:40960
    ds_read_b128 v[116:119], v6 offset:43008
    s_waitcnt lgkmcnt(0)
    v_mfma_f32_16x16x32_bf16 v[56:59], v[104:107], v[96:99], 0
    ds_read_b128 v[124:127], v9 offset:32768
    v_mul_f32 v152, v16, v16
    v_mfma_f32_16x16x32_bf16 v[60:63], v[104:107], v[100:103], 0
    ds_read_b128 v[128:131], v9 offset:34816
    v_mul_f32 v153, v17, v17
    v_mfma_f32_16x16x32_bf16 v[64:67], v[108:111], v[96:99], 0
    ds_read_b128 v[132:135], v7 offset:36864
    v_mul_f32 v154, v18, v18
    v_mfma_f32_16x16x32_bf16 v[68:71], v[108:111], v[100:103], 0
    ds_read_b128 v[136:139], v7 offset:38912
    v_mul_f32 v155, v19, v19
    v_mfma_f32_16x16x32_bf16 v[72:75], v[112:115], v[96:99], 0
    ds_read_b128 v[140:143], v7 offset:40960
    v_fma_f32 v152, v152, v156, v157
    v_mfma_f32_16x16x32_bf16 v[76:79], v[112:115], v[100:103], 0
    ds_read_b128 v[144:147], v7 offset:43008
    v_fma_f32 v153, v153, v156, v157
    v_mfma_f32_16x16x32_bf16 v[80:83], v[116:119], v[96:99], 0
    v_fma_f32 v154, v154, v156, v157
    v_mfma_f32_16x16x32_bf16 v[84:87], v[116:119], v[100:103], 0
    v_fma_f32 v155, v155, v156, v157
    s_waitcnt lgkmcnt(0)
    s_barrier
    v_mfma_f32_16x16x32_bf16 v[56:59], v[132:135], v[124:127], v[56:59]
    ds_read_b128 v[96:99], v8 offset:49152
    v_mul_f32 v152, v152, v16
    v_mul_f32 v153, v153, v17
    v_mfma_f32_16x16x32_bf16 v[60:63], v[132:135], v[128:131], v[60:63]
    ds_read_b128 v[100:103], v8 offset:51200
    v_mul_f32 v154, v154, v18
    v_mul_f32 v155, v155, v19
    v_mfma_f32_16x16x32_bf16 v[64:67], v[136:139], v[124:127], v[64:67]
    ds_read_b128 v[104:107], v6 offset:55296
    v_exp_f32 v152, v152
    v_exp_f32 v153, v153
    v_mfma_f32_16x16x32_bf16 v[68:71], v[136:139], v[128:131], v[68:71]
    ds_read_b128 v[108:111], v6 offset:57344
    v_exp_f32 v154, v154
    v_exp_f32 v155, v155
    v_mfma_f32_16x16x32_bf16 v[72:75], v[140:143], v[124:127], v[72:75]
    ds_read_b128 v[112:115], v6 offset:59392
    v_fma_f32 v152, v152, v158, v158
    v_fma_f32 v153, v153, v158, v158
    v_mfma_f32_16x16x32_bf16 v[76:79], v[140:143], v[128:131], v[76:79]
    ds_read_b128 v[116:119], v6 offset:61440
    v_fma_f32 v154, v154, v158, v158
    v_fma_f32 v155, v155, v158, v158
    v_mfma_f32_16x16x32_bf16 v[80:83], v[144:147], v[124:127], v[80:83]
    v_rcp_f32 v152, v152
    v_rcp_f32 v153, v153
    v_mfma_f32_16x16x32_bf16 v[84:87], v[144:147], v[128:131], v[84:87]
    v_rcp_f32 v154, v154
    v_rcp_f32 v155, v155
    s_waitcnt lgkmcnt(0)
    v_mfma_f32_16x16x32_bf16 v[56:59], v[104:107], v[96:99], v[56:59]
    ds_read_b128 v[124:127], v9 offset:49152
    v_mul_f32 v16, v16, v152
    v_mfma_f32_16x16x32_bf16 v[60:63], v[104:107], v[100:103], v[60:63]
    ds_read_b128 v[128:131], v9 offset:51200
    v_mul_f32 v17, v17, v153
    v_mfma_f32_16x16x32_bf16 v[64:67], v[108:111], v[96:99], v[64:67]
    ds_read_b128 v[132:135], v7 offset:55296
    v_mul_f32 v18, v18, v154
    v_mfma_f32_16x16x32_bf16 v[68:71], v[108:111], v[100:103], v[68:71]
    ds_read_b128 v[136:139], v7 offset:57344
    v_mul_f32 v19, v19, v155
    v_mfma_f32_16x16x32_bf16 v[72:75], v[112:115], v[96:99], v[72:75]
    ds_read_b128 v[140:143], v7 offset:59392
    v_mul_f32 v152, v20, v20
    v_mfma_f32_16x16x32_bf16 v[76:79], v[112:115], v[100:103], v[76:79]
    ds_read_b128 v[144:147], v7 offset:61440
    v_mul_f32 v153, v21, v21
    v_mfma_f32_16x16x32_bf16 v[80:83], v[116:119], v[96:99], v[80:83]
    v_mul_f32 v154, v22, v22
    v_mfma_f32_16x16x32_bf16 v[84:87], v[116:119], v[100:103], v[84:87]
    v_mul_f32 v155, v23, v23
    s_waitcnt lgkmcnt(0)
    s_barrier
    v_mfma_f32_16x16x32_bf16 v[56:59], v[132:135], v[124:127], v[56:59]
    ds_read_b128 v[96:99], v8 offset:0
    v_fma_f32 v152, v152, v159, v161
    v_mfma_f32_16x16x32_bf16 v[60:63], v[132:135], v[128:131], v[60:63]
    ds_read_b128 v[100:103], v8 offset:2048
    v_fma_f32 v153, v153, v159, v161
    v_mfma_f32_16x16x32_bf16 v[64:67], v[136:139], v[124:127], v[64:67]
    ds_read_b128 v[104:107], v6 offset:0
    v_fma_f32 v154, v154, v159, v161
    v_mfma_f32_16x16x32_bf16 v[68:71], v[136:139], v[128:131], v[68:71]
    ds_read_b128 v[108:111], v6 offset:2048
    v_fma_f32 v155, v155, v159, v161
    v_mfma_f32_16x16x32_bf16 v[72:75], v[140:143], v[124:127], v[72:75]
    ds_read_b128 v[112:115], v6 offset:4096
    v_mul_f32 v152, v152, v20
    v_mfma_f32_16x16x32_bf16 v[76:79], v[140:143], v[128:131], v[76:79]
    ds_read_b128 v[116:119], v6 offset:6144
    v_mul_f32 v153, v153, v21
    v_mfma_f32_16x16x32_bf16 v[80:83], v[144:147], v[124:127], v[80:83]
    v_mul_f32 v154, v154, v22
    v_mfma_f32_16x16x32_bf16 v[84:87], v[144:147], v[128:131], v[84:87]
    v_mul_f32 v155, v155, v23
    s_waitcnt lgkmcnt(0)
    v_mfma_f32_16x16x32_bf16 v[56:59], v[104:107], v[96:99], v[56:59]
    ds_read_b128 v[124:127], v9 offset:0
    v_exp_f32 v152, v152
    v_mfma_f32_16x16x32_bf16 v[60:63], v[104:107], v[100:103], v[60:63]
    ds_read_b128 v[128:131], v9 offset:2048
    v_exp_f32 v153, v153
    v_mfma_f32_16x16x32_bf16 v[64:67], v[108:111], v[96:99], v[64:67]
    ds_read_b128 v[132:135], v7 offset:0
    v_exp_f32 v154, v154
    v_mfma_f32_16x16x32_bf16 v[68:71], v[108:111], v[100:103], v[68:71]
    ds_read_b128 v[136:139], v7 offset:2048
    v_exp_f32 v155, v155
    v_mfma_f32_16x16x32_bf16 v[72:75], v[112:115], v[96:99], v[72:75]
    ds_read_b128 v[140:143], v7 offset:4096
    v_fma_f32 v152, v152, v163, v163
    v_mfma_f32_16x16x32_bf16 v[76:79], v[112:115], v[100:103], v[76:79]
    ds_read_b128 v[144:147], v7 offset:6144
    v_fma_f32 v153, v153, v163, v163
    v_mfma_f32_16x16x32_bf16 v[80:83], v[116:119], v[96:99], v[80:83]
    v_fma_f32 v154, v154, v163, v163
    v_mfma_f32_16x16x32_bf16 v[84:87], v[116:119], v[100:103], v[84:87]
    v_fma_f32 v155, v155, v163, v163
    s_waitcnt lgkmcnt(0)
    s_barrier
    v_mfma_f32_16x16x32_bf16 v[56:59], v[132:135], v[124:127], v[56:59]
    ds_read_b128 v[96:99], v8 offset:16384
    v_rcp_f32 v152, v152
    v_rcp_f32 v153, v153
    v_mfma_f32_16x16x32_bf16 v[60:63], v[132:135], v[128:131], v[60:63]
    ds_read_b128 v[100:103], v8 offset:18432
    v_rcp_f32 v154, v154
    v_rcp_f32 v155, v155
    v_mfma_f32_16x16x32_bf16 v[64:67], v[136:139], v[124:127], v[64:67]
    ds_read_b128 v[104:107], v6 offset:18432
    v_mul_f32 v20, v20, v152
    v_mul_f32 v21, v21, v153
    v_mfma_f32_16x16x32_bf16 v[68:71], v[136:139], v[128:131], v[68:71]
    ds_read_b128 v[108:111], v6 offset:20480
    v_mul_f32 v22, v22, v154
    v_mul_f32 v23, v23, v155
    v_mfma_f32_16x16x32_bf16 v[72:75], v[140:143], v[124:127], v[72:75]
    ds_read_b128 v[112:115], v6 offset:22528
    v_mul_f32 v152, v24, v24
    v_mul_f32 v153, v25, v25
    v_mfma_f32_16x16x32_bf16 v[76:79], v[140:143], v[128:131], v[76:79]
    ds_read_b128 v[116:119], v6 offset:24576
    v_mul_f32 v154, v26, v26
    v_mul_f32 v155, v27, v27
    v_mfma_f32_16x16x32_bf16 v[80:83], v[144:147], v[124:127], v[80:83]
    v_fma_f32 v152, v152, v156, v157
    v_fma_f32 v153, v153, v156, v157
    v_mfma_f32_16x16x32_bf16 v[84:87], v[144:147], v[128:131], v[84:87]
    v_fma_f32 v154, v154, v156, v157
    v_fma_f32 v155, v155, v156, v157
    s_waitcnt lgkmcnt(0)
    v_mfma_f32_16x16x32_bf16 v[56:59], v[104:107], v[96:99], v[56:59]
    ds_read_b128 v[124:127], v9 offset:16384
    v_mul_f32 v152, v152, v24
    v_mfma_f32_16x16x32_bf16 v[60:63], v[104:107], v[100:103], v[60:63]
    ds_read_b128 v[128:131], v9 offset:18432
    v_mul_f32 v153, v153, v25
    v_mfma_f32_16x16x32_bf16 v[64:67], v[108:111], v[96:99], v[64:67]
    ds_read_b128 v[132:135], v7 offset:18432
    v_mul_f32 v154, v154, v26
    v_mfma_f32_16x16x32_bf16 v[68:71], v[108:111], v[100:103], v[68:71]
    ds_read_b128 v[136:139], v7 offset:20480
    v_mul_f32 v155, v155, v27
    v_mfma_f32_16x16x32_bf16 v[72:75], v[112:115], v[96:99], v[72:75]
    ds_read_b128 v[140:143], v7 offset:22528
    v_exp_f32 v152, v152
    v_mfma_f32_16x16x32_bf16 v[76:79], v[112:115], v[100:103], v[76:79]
    ds_read_b128 v[144:147], v7 offset:24576
    v_exp_f32 v153, v153
    v_mfma_f32_16x16x32_bf16 v[80:83], v[116:119], v[96:99], v[80:83]
    v_exp_f32 v154, v154
    v_mfma_f32_16x16x32_bf16 v[84:87], v[116:119], v[100:103], v[84:87]
    v_exp_f32 v155, v155
    s_waitcnt lgkmcnt(0)
    s_barrier
    v_mfma_f32_16x16x32_bf16 v[56:59], v[132:135], v[124:127], v[56:59]
    ds_read_b128 v[96:99], v8 offset:32768
    v_fma_f32 v152, v152, v158, v158
    v_mfma_f32_16x16x32_bf16 v[60:63], v[132:135], v[128:131], v[60:63]
    ds_read_b128 v[100:103], v8 offset:34816
    v_fma_f32 v153, v153, v158, v158
    v_mfma_f32_16x16x32_bf16 v[64:67], v[136:139], v[124:127], v[64:67]
    ds_read_b128 v[104:107], v6 offset:36864
    v_fma_f32 v154, v154, v158, v158
    v_mfma_f32_16x16x32_bf16 v[68:71], v[136:139], v[128:131], v[68:71]
    ds_read_b128 v[108:111], v6 offset:38912
    v_fma_f32 v155, v155, v158, v158
    v_mfma_f32_16x16x32_bf16 v[72:75], v[140:143], v[124:127], v[72:75]
    ds_read_b128 v[112:115], v6 offset:40960
    v_rcp_f32 v152, v152
    v_mfma_f32_16x16x32_bf16 v[76:79], v[140:143], v[128:131], v[76:79]
    ds_read_b128 v[116:119], v6 offset:43008
    v_rcp_f32 v153, v153
    v_mfma_f32_16x16x32_bf16 v[80:83], v[144:147], v[124:127], v[80:83]
    v_rcp_f32 v154, v154
    v_mfma_f32_16x16x32_bf16 v[84:87], v[144:147], v[128:131], v[84:87]
    v_rcp_f32 v155, v155
    s_waitcnt lgkmcnt(0)
    v_mfma_f32_16x16x32_bf16 v[56:59], v[104:107], v[96:99], v[56:59]
    ds_read_b128 v[124:127], v9 offset:32768
    v_mul_f32 v24, v24, v152
    v_mfma_f32_16x16x32_bf16 v[60:63], v[104:107], v[100:103], v[60:63]
    ds_read_b128 v[128:131], v9 offset:34816
    v_mul_f32 v25, v25, v153
    v_mfma_f32_16x16x32_bf16 v[64:67], v[108:111], v[96:99], v[64:67]
    ds_read_b128 v[132:135], v7 offset:36864
    v_mul_f32 v26, v26, v154
    v_mfma_f32_16x16x32_bf16 v[68:71], v[108:111], v[100:103], v[68:71]
    ds_read_b128 v[136:139], v7 offset:38912
    v_mul_f32 v27, v27, v155
    v_mfma_f32_16x16x32_bf16 v[72:75], v[112:115], v[96:99], v[72:75]
    ds_read_b128 v[140:143], v7 offset:40960
    v_mul_f32 v152, v28, v28
    v_mfma_f32_16x16x32_bf16 v[76:79], v[112:115], v[100:103], v[76:79]
    ds_read_b128 v[144:147], v7 offset:43008
    v_mul_f32 v153, v29, v29
    v_mfma_f32_16x16x32_bf16 v[80:83], v[116:119], v[96:99], v[80:83]
    v_mul_f32 v154, v30, v30
    v_mfma_f32_16x16x32_bf16 v[84:87], v[116:119], v[100:103], v[84:87]
    v_mul_f32 v155, v31, v31
    s_waitcnt lgkmcnt(0)
    s_barrier
    v_mfma_f32_16x16x32_bf16 v[56:59], v[132:135], v[124:127], v[56:59]
    ds_read_b128 v[96:99], v8 offset:49152
    v_fma_f32 v152, v152, v159, v161
    v_fma_f32 v153, v153, v159, v161
    v_mfma_f32_16x16x32_bf16 v[60:63], v[132:135], v[128:131], v[60:63]
    ds_read_b128 v[100:103], v8 offset:51200
    v_fma_f32 v154, v154, v159, v161
    v_fma_f32 v155, v155, v159, v161
    v_mfma_f32_16x16x32_bf16 v[64:67], v[136:139], v[124:127], v[64:67]
    ds_read_b128 v[104:107], v6 offset:55296
    v_mul_f32 v152, v152, v28
    v_mul_f32 v153, v153, v29
    v_mfma_f32_16x16x32_bf16 v[68:71], v[136:139], v[128:131], v[68:71]
    ds_read_b128 v[108:111], v6 offset:57344
    v_mul_f32 v154, v154, v30
    v_mul_f32 v155, v155, v31
    v_mfma_f32_16x16x32_bf16 v[72:75], v[140:143], v[124:127], v[72:75]
    ds_read_b128 v[112:115], v6 offset:59392
    v_exp_f32 v152, v152
    v_exp_f32 v153, v153
    v_mfma_f32_16x16x32_bf16 v[76:79], v[140:143], v[128:131], v[76:79]
    ds_read_b128 v[116:119], v6 offset:61440
    v_exp_f32 v154, v154
    v_exp_f32 v155, v155
    v_mfma_f32_16x16x32_bf16 v[80:83], v[144:147], v[124:127], v[80:83]
    v_fma_f32 v152, v152, v163, v163
    v_fma_f32 v153, v153, v163, v163
    v_mfma_f32_16x16x32_bf16 v[84:87], v[144:147], v[128:131], v[84:87]
    v_fma_f32 v154, v154, v163, v163
    v_fma_f32 v155, v155, v163, v163
    s_waitcnt lgkmcnt(0)
    v_mfma_f32_16x16x32_bf16 v[56:59], v[104:107], v[96:99], v[56:59]
    ds_read_b128 v[124:127], v9 offset:49152
    v_rcp_f32 v152, v152
    v_mfma_f32_16x16x32_bf16 v[60:63], v[104:107], v[100:103], v[60:63]
    ds_read_b128 v[128:131], v9 offset:51200
    v_rcp_f32 v153, v153
    v_mfma_f32_16x16x32_bf16 v[64:67], v[108:111], v[96:99], v[64:67]
    ds_read_b128 v[132:135], v7 offset:55296
    v_rcp_f32 v154, v154
    v_mfma_f32_16x16x32_bf16 v[68:71], v[108:111], v[100:103], v[68:71]
    ds_read_b128 v[136:139], v7 offset:57344
    v_rcp_f32 v155, v155
    v_mfma_f32_16x16x32_bf16 v[72:75], v[112:115], v[96:99], v[72:75]
    ds_read_b128 v[140:143], v7 offset:59392
    v_mul_f32 v28, v28, v152
    v_mfma_f32_16x16x32_bf16 v[76:79], v[112:115], v[100:103], v[76:79]
    ds_read_b128 v[144:147], v7 offset:61440
    v_mul_f32 v29, v29, v153
    v_mfma_f32_16x16x32_bf16 v[80:83], v[116:119], v[96:99], v[80:83]
    v_mul_f32 v30, v30, v154
    v_mfma_f32_16x16x32_bf16 v[84:87], v[116:119], v[100:103], v[84:87]
    v_mul_f32 v31, v31, v155
    s_waitcnt lgkmcnt(0)
    s_barrier
    v_mfma_f32_16x16x32_bf16 v[56:59], v[132:135], v[124:127], v[56:59]
    ds_read_b128 v[96:99], v8 offset:0
    v_mul_f32 v152, v32, v32
    v_mfma_f32_16x16x32_bf16 v[60:63], v[132:135], v[128:131], v[60:63]
    ds_read_b128 v[100:103], v8 offset:2048
    v_mul_f32 v153, v33, v33
    v_mfma_f32_16x16x32_bf16 v[64:67], v[136:139], v[124:127], v[64:67]
    ds_read_b128 v[104:107], v6 offset:0
    v_mul_f32 v154, v34, v34
    v_mfma_f32_16x16x32_bf16 v[68:71], v[136:139], v[128:131], v[68:71]
    ds_read_b128 v[108:111], v6 offset:2048
    v_mul_f32 v155, v35, v35
    v_mfma_f32_16x16x32_bf16 v[72:75], v[140:143], v[124:127], v[72:75]
    ds_read_b128 v[112:115], v6 offset:4096
    v_fma_f32 v152, v152, v156, v157
    v_mfma_f32_16x16x32_bf16 v[76:79], v[140:143], v[128:131], v[76:79]
    ds_read_b128 v[116:119], v6 offset:6144
    v_fma_f32 v153, v153, v156, v157
    v_mfma_f32_16x16x32_bf16 v[80:83], v[144:147], v[124:127], v[80:83]
    v_fma_f32 v154, v154, v156, v157
    v_mfma_f32_16x16x32_bf16 v[84:87], v[144:147], v[128:131], v[84:87]
    v_fma_f32 v155, v155, v156, v157
    s_waitcnt lgkmcnt(0)
    v_mfma_f32_16x16x32_bf16 v[56:59], v[104:107], v[96:99], v[56:59]
    ds_read_b128 v[124:127], v9 offset:0
    v_mul_f32 v152, v152, v32
    v_mfma_f32_16x16x32_bf16 v[60:63], v[104:107], v[100:103], v[60:63]
    ds_read_b128 v[128:131], v9 offset:2048
    v_mul_f32 v153, v153, v33
    v_mfma_f32_16x16x32_bf16 v[64:67], v[108:111], v[96:99], v[64:67]
    ds_read_b128 v[132:135], v7 offset:0
    v_mul_f32 v154, v154, v34
    v_mfma_f32_16x16x32_bf16 v[68:71], v[108:111], v[100:103], v[68:71]
    ds_read_b128 v[136:139], v7 offset:2048
    v_mul_f32 v155, v155, v35
    v_mfma_f32_16x16x32_bf16 v[72:75], v[112:115], v[96:99], v[72:75]
    ds_read_b128 v[140:143], v7 offset:4096
    v_exp_f32 v152, v152
    v_mfma_f32_16x16x32_bf16 v[76:79], v[112:115], v[100:103], v[76:79]
    ds_read_b128 v[144:147], v7 offset:6144
    v_exp_f32 v153, v153
    v_mfma_f32_16x16x32_bf16 v[80:83], v[116:119], v[96:99], v[80:83]
    v_exp_f32 v154, v154
    v_mfma_f32_16x16x32_bf16 v[84:87], v[116:119], v[100:103], v[84:87]
    v_exp_f32 v155, v155
    s_waitcnt lgkmcnt(0)
    s_barrier
    v_mfma_f32_16x16x32_bf16 v[56:59], v[132:135], v[124:127], v[56:59]
    ds_read_b128 v[96:99], v8 offset:16384
    v_fma_f32 v152, v152, v158, v158
    v_fma_f32 v153, v153, v158, v158
    v_mfma_f32_16x16x32_bf16 v[60:63], v[132:135], v[128:131], v[60:63]
    ds_read_b128 v[100:103], v8 offset:18432
    v_fma_f32 v154, v154, v158, v158
    v_fma_f32 v155, v155, v158, v158
    v_mfma_f32_16x16x32_bf16 v[64:67], v[136:139], v[124:127], v[64:67]
    ds_read_b128 v[104:107], v6 offset:18432
    v_rcp_f32 v152, v152
    v_rcp_f32 v153, v153
    v_mfma_f32_16x16x32_bf16 v[68:71], v[136:139], v[128:131], v[68:71]
    ds_read_b128 v[108:111], v6 offset:20480
    v_rcp_f32 v154, v154
    v_rcp_f32 v155, v155
    v_mfma_f32_16x16x32_bf16 v[72:75], v[140:143], v[124:127], v[72:75]
    ds_read_b128 v[112:115], v6 offset:22528
    v_mul_f32 v32, v32, v152
    v_mul_f32 v33, v33, v153
    v_mfma_f32_16x16x32_bf16 v[76:79], v[140:143], v[128:131], v[76:79]
    ds_read_b128 v[116:119], v6 offset:24576
    v_mul_f32 v34, v34, v154
    v_mul_f32 v35, v35, v155
    v_mfma_f32_16x16x32_bf16 v[80:83], v[144:147], v[124:127], v[80:83]
    v_mul_f32 v152, v36, v36
    v_mul_f32 v153, v37, v37
    v_mfma_f32_16x16x32_bf16 v[84:87], v[144:147], v[128:131], v[84:87]
    v_mul_f32 v154, v38, v38
    v_mul_f32 v155, v39, v39
    s_waitcnt lgkmcnt(0)
    v_mfma_f32_16x16x32_bf16 v[56:59], v[104:107], v[96:99], v[56:59]
    ds_read_b128 v[124:127], v9 offset:16384
    v_fma_f32 v152, v152, v159, v161
    v_mfma_f32_16x16x32_bf16 v[60:63], v[104:107], v[100:103], v[60:63]
    ds_read_b128 v[128:131], v9 offset:18432
    v_fma_f32 v153, v153, v159, v161
    v_mfma_f32_16x16x32_bf16 v[64:67], v[108:111], v[96:99], v[64:67]
    ds_read_b128 v[132:135], v7 offset:18432
    v_fma_f32 v154, v154, v159, v161
    v_mfma_f32_16x16x32_bf16 v[68:71], v[108:111], v[100:103], v[68:71]
    ds_read_b128 v[136:139], v7 offset:20480
    v_fma_f32 v155, v155, v159, v161
    v_mfma_f32_16x16x32_bf16 v[72:75], v[112:115], v[96:99], v[72:75]
    ds_read_b128 v[140:143], v7 offset:22528
    v_mul_f32 v152, v152, v36
    v_mfma_f32_16x16x32_bf16 v[76:79], v[112:115], v[100:103], v[76:79]
    ds_read_b128 v[144:147], v7 offset:24576
    v_mul_f32 v153, v153, v37
    v_mfma_f32_16x16x32_bf16 v[80:83], v[116:119], v[96:99], v[80:83]
    v_mul_f32 v154, v154, v38
    v_mfma_f32_16x16x32_bf16 v[84:87], v[116:119], v[100:103], v[84:87]
    v_mul_f32 v155, v155, v39
    s_waitcnt lgkmcnt(0)
    s_barrier
    v_mfma_f32_16x16x32_bf16 v[56:59], v[132:135], v[124:127], v[56:59]
    ds_read_b128 v[96:99], v8 offset:32768
    v_exp_f32 v152, v152
    v_mfma_f32_16x16x32_bf16 v[60:63], v[132:135], v[128:131], v[60:63]
    ds_read_b128 v[100:103], v8 offset:34816
    v_exp_f32 v153, v153
    v_mfma_f32_16x16x32_bf16 v[64:67], v[136:139], v[124:127], v[64:67]
    ds_read_b128 v[104:107], v6 offset:36864
    v_exp_f32 v154, v154
    v_mfma_f32_16x16x32_bf16 v[68:71], v[136:139], v[128:131], v[68:71]
    ds_read_b128 v[108:111], v6 offset:38912
    v_exp_f32 v155, v155
    v_mfma_f32_16x16x32_bf16 v[72:75], v[140:143], v[124:127], v[72:75]
    ds_read_b128 v[112:115], v6 offset:40960
    v_fma_f32 v152, v152, v163, v163
    v_mfma_f32_16x16x32_bf16 v[76:79], v[140:143], v[128:131], v[76:79]
    ds_read_b128 v[116:119], v6 offset:43008
    v_fma_f32 v153, v153, v163, v163
    v_mfma_f32_16x16x32_bf16 v[80:83], v[144:147], v[124:127], v[80:83]
    v_fma_f32 v154, v154, v163, v163
    v_mfma_f32_16x16x32_bf16 v[84:87], v[144:147], v[128:131], v[84:87]
    v_fma_f32 v155, v155, v163, v163
    s_waitcnt lgkmcnt(0)
    v_mfma_f32_16x16x32_bf16 v[56:59], v[104:107], v[96:99], v[56:59]
    ds_read_b128 v[124:127], v9 offset:32768
    v_rcp_f32 v152, v152
    v_mfma_f32_16x16x32_bf16 v[60:63], v[104:107], v[100:103], v[60:63]
    ds_read_b128 v[128:131], v9 offset:34816
    v_rcp_f32 v153, v153
    v_mfma_f32_16x16x32_bf16 v[64:67], v[108:111], v[96:99], v[64:67]
    ds_read_b128 v[132:135], v7 offset:36864
    v_rcp_f32 v154, v154
    v_mfma_f32_16x16x32_bf16 v[68:71], v[108:111], v[100:103], v[68:71]
    ds_read_b128 v[136:139], v7 offset:38912
    v_rcp_f32 v155, v155
    v_mfma_f32_16x16x32_bf16 v[72:75], v[112:115], v[96:99], v[72:75]
    ds_read_b128 v[140:143], v7 offset:40960
    v_mul_f32 v36, v36, v152
    v_mfma_f32_16x16x32_bf16 v[76:79], v[112:115], v[100:103], v[76:79]
    ds_read_b128 v[144:147], v7 offset:43008
    v_mul_f32 v37, v37, v153
    v_mfma_f32_16x16x32_bf16 v[80:83], v[116:119], v[96:99], v[80:83]
    v_mul_f32 v38, v38, v154
    v_mfma_f32_16x16x32_bf16 v[84:87], v[116:119], v[100:103], v[84:87]
    v_mul_f32 v39, v39, v155
    s_waitcnt lgkmcnt(0)
    s_barrier
    v_mfma_f32_16x16x32_bf16 v[56:59], v[132:135], v[124:127], v[56:59]
    ds_read_b128 v[96:99], v8 offset:49152
    v_mul_f32 v152, v40, v40
    v_mul_f32 v153, v41, v41
    v_mfma_f32_16x16x32_bf16 v[60:63], v[132:135], v[128:131], v[60:63]
    ds_read_b128 v[100:103], v8 offset:51200
    v_mul_f32 v154, v42, v42
    v_mul_f32 v155, v43, v43
    v_mfma_f32_16x16x32_bf16 v[64:67], v[136:139], v[124:127], v[64:67]
    ds_read_b128 v[104:107], v6 offset:55296
    v_fma_f32 v152, v152, v156, v157
    v_fma_f32 v153, v153, v156, v157
    v_mfma_f32_16x16x32_bf16 v[68:71], v[136:139], v[128:131], v[68:71]
    ds_read_b128 v[108:111], v6 offset:57344
    v_fma_f32 v154, v154, v156, v157
    v_fma_f32 v155, v155, v156, v157
    v_mfma_f32_16x16x32_bf16 v[72:75], v[140:143], v[124:127], v[72:75]
    ds_read_b128 v[112:115], v6 offset:59392
    v_mul_f32 v152, v152, v40
    v_mul_f32 v153, v153, v41
    v_mfma_f32_16x16x32_bf16 v[76:79], v[140:143], v[128:131], v[76:79]
    ds_read_b128 v[116:119], v6 offset:61440
    v_mul_f32 v154, v154, v42
    v_mul_f32 v155, v155, v43
    v_mfma_f32_16x16x32_bf16 v[80:83], v[144:147], v[124:127], v[80:83]
    v_exp_f32 v152, v152
    v_exp_f32 v153, v153
    v_mfma_f32_16x16x32_bf16 v[84:87], v[144:147], v[128:131], v[84:87]
    v_exp_f32 v154, v154
    v_exp_f32 v155, v155
    s_waitcnt lgkmcnt(0)
    v_mfma_f32_16x16x32_bf16 v[56:59], v[104:107], v[96:99], v[56:59]
    ds_read_b128 v[124:127], v9 offset:49152
    v_fma_f32 v152, v152, v158, v158
    v_mfma_f32_16x16x32_bf16 v[60:63], v[104:107], v[100:103], v[60:63]
    ds_read_b128 v[128:131], v9 offset:51200
    v_fma_f32 v153, v153, v158, v158
    v_mfma_f32_16x16x32_bf16 v[64:67], v[108:111], v[96:99], v[64:67]
    ds_read_b128 v[132:135], v7 offset:55296
    v_fma_f32 v154, v154, v158, v158
    v_mfma_f32_16x16x32_bf16 v[68:71], v[108:111], v[100:103], v[68:71]
    ds_read_b128 v[136:139], v7 offset:57344
    v_fma_f32 v155, v155, v158, v158
    v_mfma_f32_16x16x32_bf16 v[72:75], v[112:115], v[96:99], v[72:75]
    ds_read_b128 v[140:143], v7 offset:59392
    v_rcp_f32 v152, v152
    v_mfma_f32_16x16x32_bf16 v[76:79], v[112:115], v[100:103], v[76:79]
    ds_read_b128 v[144:147], v7 offset:61440
    v_rcp_f32 v153, v153
    v_mfma_f32_16x16x32_bf16 v[80:83], v[116:119], v[96:99], v[80:83]
    v_rcp_f32 v154, v154
    v_mfma_f32_16x16x32_bf16 v[84:87], v[116:119], v[100:103], v[84:87]
    v_rcp_f32 v155, v155
    s_waitcnt lgkmcnt(0)
    s_barrier
    v_mfma_f32_16x16x32_bf16 v[56:59], v[132:135], v[124:127], v[56:59]
    ds_read_b128 v[96:99], v8 offset:0
    v_mul_f32 v40, v40, v152
    v_mfma_f32_16x16x32_bf16 v[60:63], v[132:135], v[128:131], v[60:63]
    ds_read_b128 v[100:103], v8 offset:2048
    v_mul_f32 v41, v41, v153
    v_mfma_f32_16x16x32_bf16 v[64:67], v[136:139], v[124:127], v[64:67]
    ds_read_b128 v[104:107], v6 offset:0
    v_mul_f32 v42, v42, v154
    v_mfma_f32_16x16x32_bf16 v[68:71], v[136:139], v[128:131], v[68:71]
    ds_read_b128 v[108:111], v6 offset:2048
    v_mul_f32 v43, v43, v155
    v_mfma_f32_16x16x32_bf16 v[72:75], v[140:143], v[124:127], v[72:75]
    ds_read_b128 v[112:115], v6 offset:4096
    v_mul_f32 v152, v44, v44
    v_mfma_f32_16x16x32_bf16 v[76:79], v[140:143], v[128:131], v[76:79]
    ds_read_b128 v[116:119], v6 offset:6144
    v_mul_f32 v153, v45, v45
    v_mfma_f32_16x16x32_bf16 v[80:83], v[144:147], v[124:127], v[80:83]
    v_mul_f32 v154, v46, v46
    v_mfma_f32_16x16x32_bf16 v[84:87], v[144:147], v[128:131], v[84:87]
    v_mul_f32 v155, v47, v47
    s_waitcnt lgkmcnt(0)
    v_mfma_f32_16x16x32_bf16 v[56:59], v[104:107], v[96:99], v[56:59]
    ds_read_b128 v[124:127], v9 offset:0
    v_fma_f32 v152, v152, v159, v161
    v_mfma_f32_16x16x32_bf16 v[60:63], v[104:107], v[100:103], v[60:63]
    ds_read_b128 v[128:131], v9 offset:2048
    v_fma_f32 v153, v153, v159, v161
    v_mfma_f32_16x16x32_bf16 v[64:67], v[108:111], v[96:99], v[64:67]
    ds_read_b128 v[132:135], v7 offset:0
    v_fma_f32 v154, v154, v159, v161
    v_mfma_f32_16x16x32_bf16 v[68:71], v[108:111], v[100:103], v[68:71]
    ds_read_b128 v[136:139], v7 offset:2048
    v_fma_f32 v155, v155, v159, v161
    v_mfma_f32_16x16x32_bf16 v[72:75], v[112:115], v[96:99], v[72:75]
    ds_read_b128 v[140:143], v7 offset:4096
    v_mul_f32 v152, v152, v44
    v_mfma_f32_16x16x32_bf16 v[76:79], v[112:115], v[100:103], v[76:79]
    ds_read_b128 v[144:147], v7 offset:6144
    v_mul_f32 v153, v153, v45
    v_mfma_f32_16x16x32_bf16 v[80:83], v[116:119], v[96:99], v[80:83]
    v_mul_f32 v154, v154, v46
    v_mfma_f32_16x16x32_bf16 v[84:87], v[116:119], v[100:103], v[84:87]
    v_mul_f32 v155, v155, v47
    s_waitcnt lgkmcnt(0)
    s_barrier
    v_mfma_f32_16x16x32_bf16 v[56:59], v[132:135], v[124:127], v[56:59]
    ds_read_b128 v[96:99], v8 offset:16384
    v_exp_f32 v152, v152
    v_exp_f32 v153, v153
    v_mfma_f32_16x16x32_bf16 v[60:63], v[132:135], v[128:131], v[60:63]
    ds_read_b128 v[100:103], v8 offset:18432
    v_exp_f32 v154, v154
    v_exp_f32 v155, v155
    v_mfma_f32_16x16x32_bf16 v[64:67], v[136:139], v[124:127], v[64:67]
    ds_read_b128 v[104:107], v6 offset:18432
    v_fma_f32 v152, v152, v163, v163
    v_fma_f32 v153, v153, v163, v163
    v_mfma_f32_16x16x32_bf16 v[68:71], v[136:139], v[128:131], v[68:71]
    ds_read_b128 v[108:111], v6 offset:20480
    v_fma_f32 v154, v154, v163, v163
    v_fma_f32 v155, v155, v163, v163
    v_mfma_f32_16x16x32_bf16 v[72:75], v[140:143], v[124:127], v[72:75]
    ds_read_b128 v[112:115], v6 offset:22528
    v_rcp_f32 v152, v152
    v_rcp_f32 v153, v153
    v_mfma_f32_16x16x32_bf16 v[76:79], v[140:143], v[128:131], v[76:79]
    ds_read_b128 v[116:119], v6 offset:24576
    v_rcp_f32 v154, v154
    v_rcp_f32 v155, v155
    v_mfma_f32_16x16x32_bf16 v[80:83], v[144:147], v[124:127], v[80:83]
    v_mul_f32 v44, v44, v152
    v_mul_f32 v45, v45, v153
    v_mfma_f32_16x16x32_bf16 v[84:87], v[144:147], v[128:131], v[84:87]
    v_mul_f32 v46, v46, v154
    v_mul_f32 v47, v47, v155
    s_waitcnt lgkmcnt(0)
    v_mfma_f32_16x16x32_bf16 v[56:59], v[104:107], v[96:99], v[56:59]
    ds_read_b128 v[124:127], v9 offset:16384
    v_mfma_f32_16x16x32_bf16 v[60:63], v[104:107], v[100:103], v[60:63]
    ds_read_b128 v[128:131], v9 offset:18432
    v_mfma_f32_16x16x32_bf16 v[64:67], v[108:111], v[96:99], v[64:67]
    ds_read_b128 v[132:135], v7 offset:18432
    v_mfma_f32_16x16x32_bf16 v[68:71], v[108:111], v[100:103], v[68:71]
    ds_read_b128 v[136:139], v7 offset:20480
    v_mfma_f32_16x16x32_bf16 v[72:75], v[112:115], v[96:99], v[72:75]
    ds_read_b128 v[140:143], v7 offset:22528
    v_mfma_f32_16x16x32_bf16 v[76:79], v[112:115], v[100:103], v[76:79]
    ds_read_b128 v[144:147], v7 offset:24576
    v_mfma_f32_16x16x32_bf16 v[80:83], v[116:119], v[96:99], v[80:83]
    v_mfma_f32_16x16x32_bf16 v[84:87], v[116:119], v[100:103], v[84:87]
    s_waitcnt lgkmcnt(0)
    s_barrier
    v_mfma_f32_16x16x32_bf16 v[56:59], v[132:135], v[124:127], v[56:59]
    ds_read_b128 v[96:99], v8 offset:32768
    v_mfma_f32_16x16x32_bf16 v[60:63], v[132:135], v[128:131], v[60:63]
    ds_read_b128 v[100:103], v8 offset:34816
    v_mfma_f32_16x16x32_bf16 v[64:67], v[136:139], v[124:127], v[64:67]
    ds_read_b128 v[104:107], v6 offset:36864
    v_mfma_f32_16x16x32_bf16 v[68:71], v[136:139], v[128:131], v[68:71]
    ds_read_b128 v[108:111], v6 offset:38912
    v_mfma_f32_16x16x32_bf16 v[72:75], v[140:143], v[124:127], v[72:75]
    ds_read_b128 v[112:115], v6 offset:40960
    v_mfma_f32_16x16x32_bf16 v[76:79], v[140:143], v[128:131], v[76:79]
    ds_read_b128 v[116:119], v6 offset:43008
    v_mfma_f32_16x16x32_bf16 v[80:83], v[144:147], v[124:127], v[80:83]
    v_mfma_f32_16x16x32_bf16 v[84:87], v[144:147], v[128:131], v[84:87]
    s_waitcnt lgkmcnt(0)
    s_mov_b32 s43, 5
lp_mega_kernel_9:
    v_mfma_f32_16x16x32_bf16 v[56:59], v[104:107], v[96:99], v[56:59]
    ds_read_b128 v[124:127], v9 offset:32768
    v_mfma_f32_16x16x32_bf16 v[60:63], v[104:107], v[100:103], v[60:63]
    ds_read_b128 v[128:131], v9 offset:34816
    v_mfma_f32_16x16x32_bf16 v[64:67], v[108:111], v[96:99], v[64:67]
    ds_read_b128 v[132:135], v7 offset:36864
    v_mfma_f32_16x16x32_bf16 v[68:71], v[108:111], v[100:103], v[68:71]
    ds_read_b128 v[136:139], v7 offset:38912
    v_mfma_f32_16x16x32_bf16 v[72:75], v[112:115], v[96:99], v[72:75]
    ds_read_b128 v[140:143], v7 offset:40960
    v_mfma_f32_16x16x32_bf16 v[76:79], v[112:115], v[100:103], v[76:79]
    ds_read_b128 v[144:147], v7 offset:43008
    v_mfma_f32_16x16x32_bf16 v[80:83], v[116:119], v[96:99], v[80:83]
    v_mfma_f32_16x16x32_bf16 v[84:87], v[116:119], v[100:103], v[84:87]
    s_waitcnt lgkmcnt(0)
    s_barrier
    v_mfma_f32_16x16x32_bf16 v[56:59], v[132:135], v[124:127], v[56:59]
    ds_read_b128 v[96:99], v8 offset:49152
    v_mfma_f32_16x16x32_bf16 v[60:63], v[132:135], v[128:131], v[60:63]
    ds_read_b128 v[100:103], v8 offset:51200
    v_mfma_f32_16x16x32_bf16 v[64:67], v[136:139], v[124:127], v[64:67]
    ds_read_b128 v[104:107], v6 offset:55296
    v_mfma_f32_16x16x32_bf16 v[68:71], v[136:139], v[128:131], v[68:71]
    ds_read_b128 v[108:111], v6 offset:57344
    v_mfma_f32_16x16x32_bf16 v[72:75], v[140:143], v[124:127], v[72:75]
    ds_read_b128 v[112:115], v6 offset:59392
    v_mfma_f32_16x16x32_bf16 v[76:79], v[140:143], v[128:131], v[76:79]
    ds_read_b128 v[116:119], v6 offset:61440
    v_mfma_f32_16x16x32_bf16 v[80:83], v[144:147], v[124:127], v[80:83]
    v_mfma_f32_16x16x32_bf16 v[84:87], v[144:147], v[128:131], v[84:87]
    s_waitcnt lgkmcnt(0)
    v_mfma_f32_16x16x32_bf16 v[56:59], v[104:107], v[96:99], v[56:59]
    ds_read_b128 v[124:127], v9 offset:49152
    v_mfma_f32_16x16x32_bf16 v[60:63], v[104:107], v[100:103], v[60:63]
    ds_read_b128 v[128:131], v9 offset:51200
    v_mfma_f32_16x16x32_bf16 v[64:67], v[108:111], v[96:99], v[64:67]
    ds_read_b128 v[132:135], v7 offset:55296
    v_mfma_f32_16x16x32_bf16 v[68:71], v[108:111], v[100:103], v[68:71]
    ds_read_b128 v[136:139], v7 offset:57344
    v_mfma_f32_16x16x32_bf16 v[72:75], v[112:115], v[96:99], v[72:75]
    ds_read_b128 v[140:143], v7 offset:59392
    v_mfma_f32_16x16x32_bf16 v[76:79], v[112:115], v[100:103], v[76:79]
    ds_read_b128 v[144:147], v7 offset:61440
    v_mfma_f32_16x16x32_bf16 v[80:83], v[116:119], v[96:99], v[80:83]
    v_mfma_f32_16x16x32_bf16 v[84:87], v[116:119], v[100:103], v[84:87]
    s_waitcnt lgkmcnt(0)
    s_barrier
    v_mfma_f32_16x16x32_bf16 v[56:59], v[132:135], v[124:127], v[56:59]
    ds_read_b128 v[96:99], v8 offset:0
    v_mfma_f32_16x16x32_bf16 v[60:63], v[132:135], v[128:131], v[60:63]
    ds_read_b128 v[100:103], v8 offset:2048
    v_mfma_f32_16x16x32_bf16 v[64:67], v[136:139], v[124:127], v[64:67]
    ds_read_b128 v[104:107], v6 offset:0
    v_mfma_f32_16x16x32_bf16 v[68:71], v[136:139], v[128:131], v[68:71]
    ds_read_b128 v[108:111], v6 offset:2048
    v_mfma_f32_16x16x32_bf16 v[72:75], v[140:143], v[124:127], v[72:75]
    ds_read_b128 v[112:115], v6 offset:4096
    v_mfma_f32_16x16x32_bf16 v[76:79], v[140:143], v[128:131], v[76:79]
    ds_read_b128 v[116:119], v6 offset:6144
    v_mfma_f32_16x16x32_bf16 v[80:83], v[144:147], v[124:127], v[80:83]
    v_mfma_f32_16x16x32_bf16 v[84:87], v[144:147], v[128:131], v[84:87]
    s_waitcnt lgkmcnt(0)
    v_mfma_f32_16x16x32_bf16 v[56:59], v[104:107], v[96:99], v[56:59]
    ds_read_b128 v[124:127], v9 offset:0
    v_mfma_f32_16x16x32_bf16 v[60:63], v[104:107], v[100:103], v[60:63]
    ds_read_b128 v[128:131], v9 offset:2048
    v_mfma_f32_16x16x32_bf16 v[64:67], v[108:111], v[96:99], v[64:67]
    ds_read_b128 v[132:135], v7 offset:0
    v_mfma_f32_16x16x32_bf16 v[68:71], v[108:111], v[100:103], v[68:71]
    ds_read_b128 v[136:139], v7 offset:2048
    v_mfma_f32_16x16x32_bf16 v[72:75], v[112:115], v[96:99], v[72:75]
    ds_read_b128 v[140:143], v7 offset:4096
    v_mfma_f32_16x16x32_bf16 v[76:79], v[112:115], v[100:103], v[76:79]
    ds_read_b128 v[144:147], v7 offset:6144
    v_mfma_f32_16x16x32_bf16 v[80:83], v[116:119], v[96:99], v[80:83]
    v_mfma_f32_16x16x32_bf16 v[84:87], v[116:119], v[100:103], v[84:87]
    s_waitcnt lgkmcnt(0)
    s_barrier
    v_mfma_f32_16x16x32_bf16 v[56:59], v[132:135], v[124:127], v[56:59]
    ds_read_b128 v[96:99], v8 offset:16384
    v_mfma_f32_16x16x32_bf16 v[60:63], v[132:135], v[128:131], v[60:63]
    ds_read_b128 v[100:103], v8 offset:18432
    v_mfma_f32_16x16x32_bf16 v[64:67], v[136:139], v[124:127], v[64:67]
    ds_read_b128 v[104:107], v6 offset:18432
    v_mfma_f32_16x16x32_bf16 v[68:71], v[136:139], v[128:131], v[68:71]
    ds_read_b128 v[108:111], v6 offset:20480
    v_mfma_f32_16x16x32_bf16 v[72:75], v[140:143], v[124:127], v[72:75]
    ds_read_b128 v[112:115], v6 offset:22528
    v_mfma_f32_16x16x32_bf16 v[76:79], v[140:143], v[128:131], v[76:79]
    ds_read_b128 v[116:119], v6 offset:24576
    v_mfma_f32_16x16x32_bf16 v[80:83], v[144:147], v[124:127], v[80:83]
    v_mfma_f32_16x16x32_bf16 v[84:87], v[144:147], v[128:131], v[84:87]
    s_waitcnt lgkmcnt(0)
    v_mfma_f32_16x16x32_bf16 v[56:59], v[104:107], v[96:99], v[56:59]
    ds_read_b128 v[124:127], v9 offset:16384
    v_mfma_f32_16x16x32_bf16 v[60:63], v[104:107], v[100:103], v[60:63]
    ds_read_b128 v[128:131], v9 offset:18432
    v_mfma_f32_16x16x32_bf16 v[64:67], v[108:111], v[96:99], v[64:67]
    ds_read_b128 v[132:135], v7 offset:18432
    v_mfma_f32_16x16x32_bf16 v[68:71], v[108:111], v[100:103], v[68:71]
    ds_read_b128 v[136:139], v7 offset:20480
    v_mfma_f32_16x16x32_bf16 v[72:75], v[112:115], v[96:99], v[72:75]
    ds_read_b128 v[140:143], v7 offset:22528
    v_mfma_f32_16x16x32_bf16 v[76:79], v[112:115], v[100:103], v[76:79]
    ds_read_b128 v[144:147], v7 offset:24576
    v_mfma_f32_16x16x32_bf16 v[80:83], v[116:119], v[96:99], v[80:83]
    v_mfma_f32_16x16x32_bf16 v[84:87], v[116:119], v[100:103], v[84:87]
    s_waitcnt lgkmcnt(0)
    s_barrier
    v_mfma_f32_16x16x32_bf16 v[56:59], v[132:135], v[124:127], v[56:59]
    ds_read_b128 v[96:99], v8 offset:32768
    v_mfma_f32_16x16x32_bf16 v[60:63], v[132:135], v[128:131], v[60:63]
    ds_read_b128 v[100:103], v8 offset:34816
    v_mfma_f32_16x16x32_bf16 v[64:67], v[136:139], v[124:127], v[64:67]
    ds_read_b128 v[104:107], v6 offset:36864
    v_mfma_f32_16x16x32_bf16 v[68:71], v[136:139], v[128:131], v[68:71]
    ds_read_b128 v[108:111], v6 offset:38912
    v_mfma_f32_16x16x32_bf16 v[72:75], v[140:143], v[124:127], v[72:75]
    ds_read_b128 v[112:115], v6 offset:40960
    v_mfma_f32_16x16x32_bf16 v[76:79], v[140:143], v[128:131], v[76:79]
    ds_read_b128 v[116:119], v6 offset:43008
    v_mfma_f32_16x16x32_bf16 v[80:83], v[144:147], v[124:127], v[80:83]
    v_mfma_f32_16x16x32_bf16 v[84:87], v[144:147], v[128:131], v[84:87]
    s_waitcnt lgkmcnt(0)
    s_sub_u32 s43, s43, 1
    s_cmp_lg_u32 s43, 0
    s_cbranch_scc1 lp_mega_kernel_9
    s_lshl_b32 s42, s11, 3
    s_lshl_b32 s44, s40, 1
    s_add_u32 s42, s42, s44
    s_lshl_b32 s42, s42, 4
    s_add_u32 s42, s42, s10
    s_mul_i32 s42, s42, 4608
    v_lshlrev_b32 v14, 6, v3
    v_lshl_add_u32 v14, v4, 4, v14
    v_add_u32 v14, s42, v14
    v_lshlrev_b32 v15, 5, v3
    v_lshl_add_u32 v15, v4, 3, v15
    v_add_u32 v15, s42, v15
    v_add_u32 v15, 4096, v15
    s_waitcnt vmcnt(0)
    v_lshlrev_b32 v160, 16, v160
    v_lshlrev_b32 v162, 16, v162
    s_mov_b32 s44, 73728
    s_nop 1
    v_pk_add_f32 v[56:57], v[56:57], v[160:161] op_sel_hi:[1,0]
    v_pk_add_f32 v[58:59], v[58:59], v[160:161] op_sel_hi:[1,0]
    v_pk_mul_f32 v[56:57], v[56:57], v[16:17]
    v_pk_mul_f32 v[58:59], v[58:59], v[18:19]
    v_cvt_pk_bf16_f32 v96, v56, v57
    v_cvt_pk_bf16_f32 v97, v58, v59
    v_pk_add_f32 v[64:65], v[64:65], v[160:161] op_sel_hi:[1,0]
    v_pk_add_f32 v[66:67], v[66:67], v[160:161] op_sel_hi:[1,0]
    v_pk_mul_f32 v[64:65], v[64:65], v[24:25]
    v_pk_mul_f32 v[66:67], v[66:67], v[26:27]
    v_cvt_pk_bf16_f32 v98, v64, v65
    v_cvt_pk_bf16_f32 v99, v66, v67
    buffer_store_dwordx4 v[96:99], v14, s[28:31], 0 offen offset:2048 sc1
    v_pk_add_f32 v[60:61], v[60:61], v[162:163] op_sel_hi:[1,0]
    v_pk_add_f32 v[62:63], v[62:63], v[162:163] op_sel_hi:[1,0]
    v_pk_mul_f32 v[60:61], v[60:61], v[20:21]
    v_pk_mul_f32 v[62:63], v[62:63], v[22:23]
    v_cvt_pk_bf16_f32 v100, v60, v61
    v_cvt_pk_bf16_f32 v101, v62, v63
    v_pk_add_f32 v[68:69], v[68:69], v[162:163] op_sel_hi:[1,0]
    v_pk_add_f32 v[70:71], v[70:71], v[162:163] op_sel_hi:[1,0]
    v_pk_mul_f32 v[68:69], v[68:69], v[28:29]
    v_pk_mul_f32 v[70:71], v[70:71], v[30:31]
    v_cvt_pk_bf16_f32 v102, v68, v69
    v_cvt_pk_bf16_f32 v103, v70, v71
    buffer_store_dwordx4 v[100:103], v14, s[28:31], s44 offen offset:2048 sc1
    v_pk_add_f32 v[72:73], v[72:73], v[160:161] op_sel_hi:[1,0]
    v_pk_add_f32 v[74:75], v[74:75], v[160:161] op_sel_hi:[1,0]
    v_pk_mul_f32 v[72:73], v[72:73], v[32:33]
    v_pk_mul_f32 v[74:75], v[74:75], v[34:35]
    v_cvt_pk_bf16_f32 v104, v72, v73
    v_cvt_pk_bf16_f32 v105, v74, v75
    v_pk_add_f32 v[80:81], v[80:81], v[160:161] op_sel_hi:[1,0]
    v_pk_add_f32 v[82:83], v[82:83], v[160:161] op_sel_hi:[1,0]
    v_pk_mul_f32 v[80:81], v[80:81], v[40:41]
    v_pk_mul_f32 v[82:83], v[82:83], v[42:43]
    v_cvt_pk_bf16_f32 v106, v80, v81
    v_cvt_pk_bf16_f32 v107, v82, v83
    buffer_store_dwordx4 v[104:107], v14, s[28:31], 0 offen offset:3072 sc1
    v_pk_add_f32 v[76:77], v[76:77], v[162:163] op_sel_hi:[1,0]
    v_pk_add_f32 v[78:79], v[78:79], v[162:163] op_sel_hi:[1,0]
    v_pk_mul_f32 v[76:77], v[76:77], v[36:37]
    v_pk_mul_f32 v[78:79], v[78:79], v[38:39]
    v_cvt_pk_bf16_f32 v108, v76, v77
    v_cvt_pk_bf16_f32 v109, v78, v79
    v_pk_add_f32 v[84:85], v[84:85], v[162:163] op_sel_hi:[1,0]
    v_pk_add_f32 v[86:87], v[86:87], v[162:163] op_sel_hi:[1,0]
    v_pk_mul_f32 v[84:85], v[84:85], v[44:45]
    v_pk_mul_f32 v[86:87], v[86:87], v[46:47]
    v_cvt_pk_bf16_f32 v110, v84, v85
    v_cvt_pk_bf16_f32 v111, v86, v87
    buffer_store_dwordx4 v[108:111], v14, s[28:31], s44 offen offset:3072 sc1
    s_waitcnt vmcnt(0)
    s_barrier
    s_lshl_b32 s42, s40, 4
    s_add_u32 s42, s42, s77
    v_add_u32 v10, s42, v3
    v_lshlrev_b32 v12, 1, v10
    v_lshl_add_u32 v13, v4, 14, v12
    v_lshl_add_u32 v12, v4, 15, v12
    s_add_u32 s42, s76, 32
    s_lshl_b32 s42, s42, 12
    buffer_load_ushort v16, v12, s[20:23], s42 offen
    s_add_u32 s42, s76, 33
    s_lshl_b32 s42, s42, 12
    buffer_load_ushort v17, v12, s[20:23], s42 offen
    s_add_u32 s42, s76, 34
    s_lshl_b32 s42, s42, 12
    buffer_load_ushort v18, v12, s[20:23], s42 offen
    s_add_u32 s42, s76, 35
    s_lshl_b32 s42, s42, 12
    buffer_load_ushort v19, v12, s[20:23], s42 offen
    s_add_u32 s42, s76, 36
    s_lshl_b32 s42, s42, 12
    buffer_load_ushort v20, v12, s[20:23], s42 offen
    s_add_u32 s42, s76, 37
    s_lshl_b32 s42, s42, 12
    buffer_load_ushort v21, v12, s[20:23], s42 offen
    s_add_u32 s42, s76, 38
    s_lshl_b32 s42, s42, 12
    buffer_load_ushort v22, v12, s[20:23], s42 offen
    s_add_u32 s42, s76, 39
    s_lshl_b32 s42, s42, 12
    buffer_load_ushort v23, v12, s[20:23], s42 offen
    s_add_u32 s42, s76, 64
    s_lshl_b32 s42, s42, 12
    buffer_load_ushort v24, v13, s[20:23], s42 offen
    s_add_u32 s42, s76, 65
    s_lshl_b32 s42, s42, 12
    buffer_load_ushort v25, v13, s[20:23], s42 offen
    s_add_u32 s42, s76, 66
    s_lshl_b32 s42, s42, 12
    buffer_load_ushort v26, v13, s[20:23], s42 offen
    s_add_u32 s42, s76, 67
    s_lshl_b32 s42, s42, 12
    buffer_load_ushort v27, v13, s[20:23], s42 offen
    s_and_b32 s42, s40, 1
    s_lshl_b32 s42, s42, 6
    v_xor_b32 v14, s42, v5
    v_add_u32 v6, 4096, v14
    v_add_u32 v7, 55296, v6
    s_lshl_b32 s42, s40, 11
    s_add_u32 s42, s42, 92160
    v_add_u32 v8, s42, v14
    s_xor_b32 s42, s40, 1
    s_lshl_b32 s42, s42, 11
    s_add_u32 s42, s42, 92160
    v_add_u32 v9, s42, v14
    v_mul_u32_u24 v10, 1152, v10
    s_lshl_b32 s42, s76, 1
    v_add_u32 v10, s42, v10
    v_lshl_add_u32 v11, v4, 3, v10
    v_lshl_add_u32 v10, v4, 4, v10
    v_mov_b32 v12, 0x7ffffff0
    v_cmp_gt_u32 vcc, 2, v4
    v_lshlrev_b32 v13, 4, v2
    s_mul_i32 s42, s15, 3072
    v_cndmask_b32 v11, v12, v11, vcc
    v_add_u32 v12, s42, v13
    s_xor_b32 s42, s15, 1
    s_mul_i32 s42, s42, 3072
    v_add_u32 v13, s42, v13
    v_mov_b32 v28, 0
    v_mov_b32 v29, 0
    v_mov_b32 v30, 0
    v_mov_b32 v31, 0
    v_mov_b32 v32, 0
    v_mov_b32 v33, 0
    v_mov_b32 v34, 0
    v_mov_b32 v35, 0
    v_mov_b32 v36, 0
    v_mov_b32 v37, 0
    v_mov_b32 v38, 0
    v_mov_b32 v39, 0
    s_waitcnt vmcnt(0)
    v_lshlrev_b32 v16, 16, v16
    v_lshlrev_b32 v17, 16, v17
    v_lshlrev_b32 v18, 16, v18
    v_lshlrev_b32 v19, 16, v19
    v_lshlrev_b32 v20, 16, v20
    v_lshlrev_b32 v21, 16, v21
    v_lshlrev_b32 v22, 16, v22
    v_lshlrev_b32 v23, 16, v23
    v_lshlrev_b32 v24, 16, v24
    v_lshlrev_b32 v25, 16, v25
    v_lshlrev_b32 v26, 16, v26
    v_lshlrev_b32 v27, 16, v27
    s_barrier
    ds_read_b128 v[48:51], v8 offset:0
    ds_read_b128 v[52:55], v9 offset:0
    ds_read_b128 v[56:59], v6 offset:36864
    ds_read_b128 v[60:63], v6 offset:38912
    ds_read_b128 v[64:67], v6 offset:40960
    ds_read_b128 v[68:71], v8 offset:8192
    ds_read_b128 v[72:75], v9 offset:8192
    ds_read_b128 v[76:79], v6 offset:46080
    ds_read_b128 v[80:83], v6 offset:48128
    ds_read_b128 v[84:87], v6 offset:50176
    s_waitcnt lgkmcnt(0)
    s_barrier
    v_mfma_f32_16x16x32_bf16 v[16:19], v[56:59], v[48:51], v[16:19]
    ds_read_b128 v[88:91], v8 offset:16384
    ds_read_b128 v[92:95], v9 offset:16384
    v_mfma_f32_16x16x32_bf16 v[28:31], v[56:59], v[52:55], v[28:31]
    ds_read_b128 v[96:99], v7 offset:0
    ds_read_b128 v[100:103], v7 offset:2048
    v_mfma_f32_16x16x32_bf16 v[20:23], v[60:63], v[48:51], v[20:23]
    ds_read_b128 v[104:107], v7 offset:4096
    ds_read_b128 v[108:111], v8 offset:24576
    v_mfma_f32_16x16x32_bf16 v[32:35], v[60:63], v[52:55], v[32:35]
    ds_read_b128 v[112:115], v9 offset:24576
    ds_read_b128 v[116:119], v7 offset:9216
    v_mfma_f32_16x16x32_bf16 v[24:27], v[64:67], v[48:51], v[24:27]
    ds_read_b128 v[120:123], v7 offset:11264
    ds_read_b128 v[124:127], v7 offset:13312
    v_mfma_f32_16x16x32_bf16 v[36:39], v[64:67], v[52:55], v[36:39]
    v_mfma_f32_16x16x32_bf16 v[16:19], v[76:79], v[68:71], v[16:19]
    v_mfma_f32_16x16x32_bf16 v[28:31], v[76:79], v[72:75], v[28:31]
    v_mfma_f32_16x16x32_bf16 v[20:23], v[80:83], v[68:71], v[20:23]
    v_mfma_f32_16x16x32_bf16 v[32:35], v[80:83], v[72:75], v[32:35]
    v_mfma_f32_16x16x32_bf16 v[24:27], v[84:87], v[68:71], v[24:27]
    v_mfma_f32_16x16x32_bf16 v[36:39], v[84:87], v[72:75], v[36:39]
    s_waitcnt lgkmcnt(0)
    s_barrier
    v_mfma_f32_16x16x32_bf16 v[16:19], v[96:99], v[88:91], v[16:19]
    ds_read_b128 v[48:51], v8 offset:32768
    ds_read_b128 v[52:55], v9 offset:32768
    v_mfma_f32_16x16x32_bf16 v[28:31], v[96:99], v[92:95], v[28:31]
    ds_read_b128 v[56:59], v6 offset:0
    ds_read_b128 v[60:63], v6 offset:2048
    v_mfma_f32_16x16x32_bf16 v[20:23], v[100:103], v[88:91], v[20:23]
    ds_read_b128 v[64:67], v6 offset:4096
    ds_read_b128 v[68:71], v8 offset:40960
    v_mfma_f32_16x16x32_bf16 v[32:35], v[100:103], v[92:95], v[32:35]
    ds_read_b128 v[72:75], v9 offset:40960
    ds_read_b128 v[76:79], v6 offset:9216
    v_mfma_f32_16x16x32_bf16 v[24:27], v[104:107], v[88:91], v[24:27]
    ds_read_b128 v[80:83], v6 offset:11264
    ds_read_b128 v[84:87], v6 offset:13312
    v_mfma_f32_16x16x32_bf16 v[36:39], v[104:107], v[92:95], v[36:39]
    v_mfma_f32_16x16x32_bf16 v[16:19], v[116:119], v[108:111], v[16:19]
    v_mfma_f32_16x16x32_bf16 v[28:31], v[116:119], v[112:115], v[28:31]
    v_mfma_f32_16x16x32_bf16 v[20:23], v[120:123], v[108:111], v[20:23]
    v_mfma_f32_16x16x32_bf16 v[32:35], v[120:123], v[112:115], v[32:35]
    v_mfma_f32_16x16x32_bf16 v[24:27], v[124:127], v[108:111], v[24:27]
    v_mfma_f32_16x16x32_bf16 v[36:39], v[124:127], v[112:115], v[36:39]
    s_waitcnt lgkmcnt(0)
    s_barrier
    v_mfma_f32_16x16x32_bf16 v[16:19], v[56:59], v[48:51], v[16:19]
    ds_read_b128 v[88:91], v8 offset:49152
    ds_read_b128 v[92:95], v9 offset:49152
    v_mfma_f32_16x16x32_bf16 v[28:31], v[56:59], v[52:55], v[28:31]
    ds_read_b128 v[96:99], v7 offset:18432
    ds_read_b128 v[100:103], v7 offset:20480
    v_mfma_f32_16x16x32_bf16 v[20:23], v[60:63], v[48:51], v[20:23]
    ds_read_b128 v[104:107], v7 offset:22528
    ds_read_b128 v[108:111], v8 offset:57344
    v_mfma_f32_16x16x32_bf16 v[32:35], v[60:63], v[52:55], v[32:35]
    ds_read_b128 v[112:115], v9 offset:57344
    ds_read_b128 v[116:119], v6 offset:18432
    v_mfma_f32_16x16x32_bf16 v[24:27], v[64:67], v[48:51], v[24:27]
    ds_read_b128 v[120:123], v6 offset:20480
    ds_read_b128 v[124:127], v6 offset:22528
    v_mfma_f32_16x16x32_bf16 v[36:39], v[64:67], v[52:55], v[36:39]
    v_mfma_f32_16x16x32_bf16 v[16:19], v[76:79], v[68:71], v[16:19]
    v_mfma_f32_16x16x32_bf16 v[28:31], v[76:79], v[72:75], v[28:31]
    v_mfma_f32_16x16x32_bf16 v[20:23], v[80:83], v[68:71], v[20:23]
    v_mfma_f32_16x16x32_bf16 v[32:35], v[80:83], v[72:75], v[32:35]
    v_mfma_f32_16x16x32_bf16 v[24:27], v[84:87], v[68:71], v[24:27]
    v_mfma_f32_16x16x32_bf16 v[36:39], v[84:87], v[72:75], v[36:39]
    s_waitcnt lgkmcnt(0)
    s_barrier
    v_mfma_f32_16x16x32_bf16 v[16:19], v[96:99], v[88:91], v[16:19]
    ds_read_b128 v[48:51], v8 offset:0
    ds_read_b128 v[52:55], v9 offset:0
    v_mfma_f32_16x16x32_bf16 v[28:31], v[96:99], v[92:95], v[28:31]
    ds_read_b128 v[56:59], v6 offset:27648
    ds_read_b128 v[60:63], v6 offset:29696
    v_mfma_f32_16x16x32_bf16 v[20:23], v[100:103], v[88:91], v[20:23]
    ds_read_b128 v[64:67], v6 offset:31744
    ds_read_b128 v[68:71], v8 offset:8192
    v_mfma_f32_16x16x32_bf16 v[32:35], v[100:103], v[92:95], v[32:35]
    ds_read_b128 v[72:75], v9 offset:8192
    ds_read_b128 v[76:79], v7 offset:27648
    v_mfma_f32_16x16x32_bf16 v[24:27], v[104:107], v[88:91], v[24:27]
    ds_read_b128 v[80:83], v7 offset:29696
    ds_read_b128 v[84:87], v7 offset:31744
    v_mfma_f32_16x16x32_bf16 v[36:39], v[104:107], v[92:95], v[36:39]
    v_mfma_f32_16x16x32_bf16 v[16:19], v[116:119], v[108:111], v[16:19]
    v_mfma_f32_16x16x32_bf16 v[28:31], v[116:119], v[112:115], v[28:31]
    v_mfma_f32_16x16x32_bf16 v[20:23], v[120:123], v[108:111], v[20:23]
    v_mfma_f32_16x16x32_bf16 v[32:35], v[120:123], v[112:115], v[32:35]
    v_mfma_f32_16x16x32_bf16 v[24:27], v[124:127], v[108:111], v[24:27]
    v_mfma_f32_16x16x32_bf16 v[36:39], v[124:127], v[112:115], v[36:39]
    s_waitcnt lgkmcnt(0)
    s_barrier
    v_mfma_f32_16x16x32_bf16 v[16:19], v[56:59], v[48:51], v[16:19]
    ds_read_b128 v[88:91], v8 offset:16384
    ds_read_b128 v[92:95], v9 offset:16384
    v_mfma_f32_16x16x32_bf16 v[28:31], v[56:59], v[52:55], v[28:31]
    ds_read_b128 v[96:99], v6 offset:36864
    ds_read_b128 v[100:103], v6 offset:38912
    v_mfma_f32_16x16x32_bf16 v[20:23], v[60:63], v[48:51], v[20:23]
    ds_read_b128 v[104:107], v6 offset:40960
    ds_read_b128 v[108:111], v8 offset:24576
    v_mfma_f32_16x16x32_bf16 v[32:35], v[60:63], v[52:55], v[32:35]
    ds_read_b128 v[112:115], v9 offset:24576
    ds_read_b128 v[116:119], v6 offset:46080
    v_mfma_f32_16x16x32_bf16 v[24:27], v[64:67], v[48:51], v[24:27]
    ds_read_b128 v[120:123], v6 offset:48128
    ds_read_b128 v[124:127], v6 offset:50176
    v_mfma_f32_16x16x32_bf16 v[36:39], v[64:67], v[52:55], v[36:39]
    v_mfma_f32_16x16x32_bf16 v[16:19], v[76:79], v[68:71], v[16:19]
    v_mfma_f32_16x16x32_bf16 v[28:31], v[76:79], v[72:75], v[28:31]
    v_mfma_f32_16x16x32_bf16 v[20:23], v[80:83], v[68:71], v[20:23]
    v_mfma_f32_16x16x32_bf16 v[32:35], v[80:83], v[72:75], v[32:35]
    v_mfma_f32_16x16x32_bf16 v[24:27], v[84:87], v[68:71], v[24:27]
    v_mfma_f32_16x16x32_bf16 v[36:39], v[84:87], v[72:75], v[36:39]
    s_waitcnt lgkmcnt(0)
    s_barrier
    v_mfma_f32_16x16x32_bf16 v[16:19], v[96:99], v[88:91], v[16:19]
    ds_read_b128 v[48:51], v8 offset:32768
    ds_read_b128 v[52:55], v9 offset:32768
    v_mfma_f32_16x16x32_bf16 v[28:31], v[96:99], v[92:95], v[28:31]
    ds_read_b128 v[56:59], v7 offset:0
    ds_read_b128 v[60:63], v7 offset:2048
    v_mfma_f32_16x16x32_bf16 v[20:23], v[100:103], v[88:91], v[20:23]
    ds_read_b128 v[64:67], v7 offset:4096
    ds_read_b128 v[68:71], v8 offset:40960
    v_mfma_f32_16x16x32_bf16 v[32:35], v[100:103], v[92:95], v[32:35]
    ds_read_b128 v[72:75], v9 offset:40960
    ds_read_b128 v[76:79], v7 offset:9216
    v_mfma_f32_16x16x32_bf16 v[24:27], v[104:107], v[88:91], v[24:27]
    ds_read_b128 v[80:83], v7 offset:11264
    ds_read_b128 v[84:87], v7 offset:13312
    v_mfma_f32_16x16x32_bf16 v[36:39], v[104:107], v[92:95], v[36:39]
    v_mfma_f32_16x16x32_bf16 v[16:19], v[116:119], v[108:111], v[16:19]
    v_mfma_f32_16x16x32_bf16 v[28:31], v[116:119], v[112:115], v[28:31]
    v_mfma_f32_16x16x32_bf16 v[20:23], v[120:123], v[108:111], v[20:23]
    v_mfma_f32_16x16x32_bf16 v[32:35], v[120:123], v[112:115], v[32:35]
    v_mfma_f32_16x16x32_bf16 v[24:27], v[124:127], v[108:111], v[24:27]
    v_mfma_f32_16x16x32_bf16 v[36:39], v[124:127], v[112:115], v[36:39]
    s_waitcnt lgkmcnt(0)
    s_barrier
    v_mfma_f32_16x16x32_bf16 v[16:19], v[56:59], v[48:51], v[16:19]
    ds_read_b128 v[88:91], v8 offset:49152
    ds_read_b128 v[92:95], v9 offset:49152
    v_mfma_f32_16x16x32_bf16 v[28:31], v[56:59], v[52:55], v[28:31]
    ds_read_b128 v[96:99], v6 offset:0
    ds_read_b128 v[100:103], v6 offset:2048
    v_mfma_f32_16x16x32_bf16 v[20:23], v[60:63], v[48:51], v[20:23]
    ds_read_b128 v[104:107], v6 offset:4096
    ds_read_b128 v[108:111], v8 offset:57344
    v_mfma_f32_16x16x32_bf16 v[32:35], v[60:63], v[52:55], v[32:35]
    ds_read_b128 v[112:115], v9 offset:57344
    ds_read_b128 v[116:119], v6 offset:9216
    v_mfma_f32_16x16x32_bf16 v[24:27], v[64:67], v[48:51], v[24:27]
    ds_read_b128 v[120:123], v6 offset:11264
    ds_read_b128 v[124:127], v6 offset:13312
    v_mfma_f32_16x16x32_bf16 v[36:39], v[64:67], v[52:55], v[36:39]
    v_mfma_f32_16x16x32_bf16 v[16:19], v[76:79], v[68:71], v[16:19]
    v_mfma_f32_16x16x32_bf16 v[28:31], v[76:79], v[72:75], v[28:31]
    v_mfma_f32_16x16x32_bf16 v[20:23], v[80:83], v[68:71], v[20:23]
    v_mfma_f32_16x16x32_bf16 v[32:35], v[80:83], v[72:75], v[32:35]
    v_mfma_f32_16x16x32_bf16 v[24:27], v[84:87], v[68:71], v[24:27]
    v_mfma_f32_16x16x32_bf16 v[36:39], v[84:87], v[72:75], v[36:39]
    s_waitcnt lgkmcnt(0)
    s_barrier
    v_mfma_f32_16x16x32_bf16 v[16:19], v[96:99], v[88:91], v[16:19]
    ds_read_b128 v[48:51], v8 offset:0
    ds_read_b128 v[52:55], v9 offset:0
    v_mfma_f32_16x16x32_bf16 v[28:31], v[96:99], v[92:95], v[28:31]
    ds_read_b128 v[56:59], v7 offset:18432
    ds_read_b128 v[60:63], v7 offset:20480
    v_mfma_f32_16x16x32_bf16 v[20:23], v[100:103], v[88:91], v[20:23]
    ds_read_b128 v[64:67], v7 offset:22528
    ds_read_b128 v[68:71], v8 offset:8192
    v_mfma_f32_16x16x32_bf16 v[32:35], v[100:103], v[92:95], v[32:35]
    ds_read_b128 v[72:75], v9 offset:8192
    ds_read_b128 v[76:79], v6 offset:18432
    v_mfma_f32_16x16x32_bf16 v[24:27], v[104:107], v[88:91], v[24:27]
    ds_read_b128 v[80:83], v6 offset:20480
    ds_read_b128 v[84:87], v6 offset:22528
    v_mfma_f32_16x16x32_bf16 v[36:39], v[104:107], v[92:95], v[36:39]
    v_mfma_f32_16x16x32_bf16 v[16:19], v[116:119], v[108:111], v[16:19]
    v_mfma_f32_16x16x32_bf16 v[28:31], v[116:119], v[112:115], v[28:31]
    v_mfma_f32_16x16x32_bf16 v[20:23], v[120:123], v[108:111], v[20:23]
    v_mfma_f32_16x16x32_bf16 v[32:35], v[120:123], v[112:115], v[32:35]
    v_mfma_f32_16x16x32_bf16 v[24:27], v[124:127], v[108:111], v[24:27]
    v_mfma_f32_16x16x32_bf16 v[36:39], v[124:127], v[112:115], v[36:39]
    s_waitcnt lgkmcnt(0)
    s_barrier
    v_mfma_f32_16x16x32_bf16 v[16:19], v[56:59], v[48:51], v[16:19]
    ds_read_b128 v[88:91], v8 offset:16384
    ds_read_b128 v[92:95], v9 offset:16384
    v_mfma_f32_16x16x32_bf16 v[28:31], v[56:59], v[52:55], v[28:31]
    ds_read_b128 v[96:99], v6 offset:27648
    ds_read_b128 v[100:103], v6 offset:29696
    v_mfma_f32_16x16x32_bf16 v[20:23], v[60:63], v[48:51], v[20:23]
    ds_read_b128 v[104:107], v6 offset:31744
    ds_read_b128 v[108:111], v8 offset:24576
    v_mfma_f32_16x16x32_bf16 v[32:35], v[60:63], v[52:55], v[32:35]
    ds_read_b128 v[112:115], v9 offset:24576
    ds_read_b128 v[116:119], v7 offset:27648
    v_mfma_f32_16x16x32_bf16 v[24:27], v[64:67], v[48:51], v[24:27]
    ds_read_b128 v[120:123], v7 offset:29696
    ds_read_b128 v[124:127], v7 offset:31744
    v_mfma_f32_16x16x32_bf16 v[36:39], v[64:67], v[52:55], v[36:39]
    v_mfma_f32_16x16x32_bf16 v[16:19], v[76:79], v[68:71], v[16:19]
    v_mfma_f32_16x16x32_bf16 v[28:31], v[76:79], v[72:75], v[28:31]
    v_mfma_f32_16x16x32_bf16 v[20:23], v[80:83], v[68:71], v[20:23]
    v_mfma_f32_16x16x32_bf16 v[32:35], v[80:83], v[72:75], v[32:35]
    v_mfma_f32_16x16x32_bf16 v[24:27], v[84:87], v[68:71], v[24:27]
    v_mfma_f32_16x16x32_bf16 v[36:39], v[84:87], v[72:75], v[36:39]
    s_waitcnt lgkmcnt(0)
    s_barrier
    v_mfma_f32_16x16x32_bf16 v[16:19], v[96:99], v[88:91], v[16:19]
    ds_read_b128 v[48:51], v8 offset:32768
    ds_read_b128 v[52:55], v9 offset:32768
    v_mfma_f32_16x16x32_bf16 v[28:31], v[96:99], v[92:95], v[28:31]
    ds_read_b128 v[56:59], v6 offset:36864
    ds_read_b128 v[60:63], v6 offset:38912
    v_mfma_f32_16x16x32_bf16 v[20:23], v[100:103], v[88:91], v[20:23]
    ds_read_b128 v[64:67], v6 offset:40960
    ds_read_b128 v[68:71], v8 offset:40960
    v_mfma_f32_16x16x32_bf16 v[32:35], v[100:103], v[92:95], v[32:35]
    ds_read_b128 v[72:75], v9 offset:40960
    ds_read_b128 v[76:79], v6 offset:46080
    v_mfma_f32_16x16x32_bf16 v[24:27], v[104:107], v[88:91], v[24:27]
    ds_read_b128 v[80:83], v6 offset:48128
    ds_read_b128 v[84:87], v6 offset:50176
    v_mfma_f32_16x16x32_bf16 v[36:39], v[104:107], v[92:95], v[36:39]
    v_mfma_f32_16x16x32_bf16 v[16:19], v[116:119], v[108:111], v[16:19]
    v_mfma_f32_16x16x32_bf16 v[28:31], v[116:119], v[112:115], v[28:31]
    v_mfma_f32_16x16x32_bf16 v[20:23], v[120:123], v[108:111], v[20:23]
    v_mfma_f32_16x16x32_bf16 v[32:35], v[120:123], v[112:115], v[32:35]
    v_mfma_f32_16x16x32_bf16 v[24:27], v[124:127], v[108:111], v[24:27]
    v_mfma_f32_16x16x32_bf16 v[36:39], v[124:127], v[112:115], v[36:39]
    s_waitcnt lgkmcnt(0)
    s_barrier
    v_mfma_f32_16x16x32_bf16 v[16:19], v[56:59], v[48:51], v[16:19]
    ds_read_b128 v[88:91], v8 offset:49152
    ds_read_b128 v[92:95], v9 offset:49152
    v_mfma_f32_16x16x32_bf16 v[28:31], v[56:59], v[52:55], v[28:31]
    ds_read_b128 v[96:99], v7 offset:0
    ds_read_b128 v[100:103], v7 offset:2048
    v_mfma_f32_16x16x32_bf16 v[20:23], v[60:63], v[48:51], v[20:23]
    ds_read_b128 v[104:107], v7 offset:4096
    ds_read_b128 v[108:111], v8 offset:57344
    v_mfma_f32_16x16x32_bf16 v[32:35], v[60:63], v[52:55], v[32:35]
    ds_read_b128 v[112:115], v9 offset:57344
    ds_read_b128 v[116:119], v7 offset:9216
    v_mfma_f32_16x16x32_bf16 v[24:27], v[64:67], v[48:51], v[24:27]
    ds_read_b128 v[120:123], v7 offset:11264
    ds_read_b128 v[124:127], v7 offset:13312
    v_mfma_f32_16x16x32_bf16 v[36:39], v[64:67], v[52:55], v[36:39]
    v_mfma_f32_16x16x32_bf16 v[16:19], v[76:79], v[68:71], v[16:19]
    v_mfma_f32_16x16x32_bf16 v[28:31], v[76:79], v[72:75], v[28:31]
    v_mfma_f32_16x16x32_bf16 v[20:23], v[80:83], v[68:71], v[20:23]
    v_mfma_f32_16x16x32_bf16 v[32:35], v[80:83], v[72:75], v[32:35]
    v_mfma_f32_16x16x32_bf16 v[24:27], v[84:87], v[68:71], v[24:27]
    v_mfma_f32_16x16x32_bf16 v[36:39], v[84:87], v[72:75], v[36:39]
    s_waitcnt lgkmcnt(0)
    s_barrier
    v_mfma_f32_16x16x32_bf16 v[16:19], v[96:99], v[88:91], v[16:19]
    ds_read_b128 v[48:51], v8 offset:0
    ds_read_b128 v[52:55], v9 offset:0
    v_mfma_f32_16x16x32_bf16 v[28:31], v[96:99], v[92:95], v[28:31]
    ds_read_b128 v[56:59], v6 offset:0
    ds_read_b128 v[60:63], v6 offset:2048
    v_mfma_f32_16x16x32_bf16 v[20:23], v[100:103], v[88:91], v[20:23]
    ds_read_b128 v[64:67], v6 offset:4096
    ds_read_b128 v[68:71], v8 offset:8192
    v_mfma_f32_16x16x32_bf16 v[32:35], v[100:103], v[92:95], v[32:35]
    ds_read_b128 v[72:75], v9 offset:8192
    ds_read_b128 v[76:79], v6 offset:9216
    v_mfma_f32_16x16x32_bf16 v[24:27], v[104:107], v[88:91], v[24:27]
    ds_read_b128 v[80:83], v6 offset:11264
    ds_read_b128 v[84:87], v6 offset:13312
    v_mfma_f32_16x16x32_bf16 v[36:39], v[104:107], v[92:95], v[36:39]
    v_mfma_f32_16x16x32_bf16 v[16:19], v[116:119], v[108:111], v[16:19]
    v_mfma_f32_16x16x32_bf16 v[28:31], v[116:119], v[112:115], v[28:31]
    v_mfma_f32_16x16x32_bf16 v[20:23], v[120:123], v[108:111], v[20:23]
    v_mfma_f32_16x16x32_bf16 v[32:35], v[120:123], v[112:115], v[32:35]
    v_mfma_f32_16x16x32_bf16 v[24:27], v[124:127], v[108:111], v[24:27]
    v_mfma_f32_16x16x32_bf16 v[36:39], v[124:127], v[112:115], v[36:39]
    s_waitcnt lgkmcnt(0)
    s_barrier
    v_mfma_f32_16x16x32_bf16 v[16:19], v[56:59], v[48:51], v[16:19]
    ds_read_b128 v[88:91], v8 offset:16384
    ds_read_b128 v[92:95], v9 offset:16384
    v_mfma_f32_16x16x32_bf16 v[28:31], v[56:59], v[52:55], v[28:31]
    ds_read_b128 v[96:99], v7 offset:18432
    ds_read_b128 v[100:103], v7 offset:20480
    v_mfma_f32_16x16x32_bf16 v[20:23], v[60:63], v[48:51], v[20:23]
    ds_read_b128 v[104:107], v7 offset:22528
    ds_read_b128 v[108:111], v8 offset:24576
    v_mfma_f32_16x16x32_bf16 v[32:35], v[60:63], v[52:55], v[32:35]
    ds_read_b128 v[112:115], v9 offset:24576
    ds_read_b128 v[116:119], v6 offset:18432
    v_mfma_f32_16x16x32_bf16 v[24:27], v[64:67], v[48:51], v[24:27]
    ds_read_b128 v[120:123], v6 offset:20480
    ds_read_b128 v[124:127], v6 offset:22528
    v_mfma_f32_16x16x32_bf16 v[36:39], v[64:67], v[52:55], v[36:39]
    v_mfma_f32_16x16x32_bf16 v[16:19], v[76:79], v[68:71], v[16:19]
    v_mfma_f32_16x16x32_bf16 v[28:31], v[76:79], v[72:75], v[28:31]
    v_mfma_f32_16x16x32_bf16 v[20:23], v[80:83], v[68:71], v[20:23]
    v_mfma_f32_16x16x32_bf16 v[32:35], v[80:83], v[72:75], v[32:35]
    v_mfma_f32_16x16x32_bf16 v[24:27], v[84:87], v[68:71], v[24:27]
    v_mfma_f32_16x16x32_bf16 v[36:39], v[84:87], v[72:75], v[36:39]
    s_waitcnt lgkmcnt(0)
    s_barrier
    v_mfma_f32_16x16x32_bf16 v[16:19], v[96:99], v[88:91], v[16:19]
    ds_read_b128 v[48:51], v8 offset:32768
    ds_read_b128 v[52:55], v9 offset:32768
    v_mfma_f32_16x16x32_bf16 v[28:31], v[96:99], v[92:95], v[28:31]
    ds_read_b128 v[56:59], v6 offset:27648
    ds_read_b128 v[60:63], v6 offset:29696
    v_mfma_f32_16x16x32_bf16 v[20:23], v[100:103], v[88:91], v[20:23]
    ds_read_b128 v[64:67], v6 offset:31744
    ds_read_b128 v[68:71], v8 offset:40960
    v_mfma_f32_16x16x32_bf16 v[32:35], v[100:103], v[92:95], v[32:35]
    ds_read_b128 v[72:75], v9 offset:40960
    ds_read_b128 v[76:79], v7 offset:27648
    v_mfma_f32_16x16x32_bf16 v[24:27], v[104:107], v[88:91], v[24:27]
    ds_read_b128 v[80:83], v7 offset:29696
    ds_read_b128 v[84:87], v7 offset:31744
    v_mfma_f32_16x16x32_bf16 v[36:39], v[104:107], v[92:95], v[36:39]
    v_mfma_f32_16x16x32_bf16 v[16:19], v[116:119], v[108:111], v[16:19]
    v_mfma_f32_16x16x32_bf16 v[28:31], v[116:119], v[112:115], v[28:31]
    v_mfma_f32_16x16x32_bf16 v[20:23], v[120:123], v[108:111], v[20:23]
    v_mfma_f32_16x16x32_bf16 v[32:35], v[120:123], v[112:115], v[32:35]
    v_mfma_f32_16x16x32_bf16 v[24:27], v[124:127], v[108:111], v[24:27]
    v_mfma_f32_16x16x32_bf16 v[36:39], v[124:127], v[112:115], v[36:39]
    s_waitcnt lgkmcnt(0)
    s_barrier
    v_mfma_f32_16x16x32_bf16 v[16:19], v[56:59], v[48:51], v[16:19]
    ds_read_b128 v[88:91], v8 offset:49152
    ds_read_b128 v[92:95], v9 offset:49152
    v_mfma_f32_16x16x32_bf16 v[28:31], v[56:59], v[52:55], v[28:31]
    ds_read_b128 v[96:99], v6 offset:36864
    ds_read_b128 v[100:103], v6 offset:38912
    v_mfma_f32_16x16x32_bf16 v[20:23], v[60:63], v[48:51], v[20:23]
    ds_read_b128 v[104:107], v6 offset:40960
    ds_read_b128 v[108:111], v8 offset:57344
    v_mfma_f32_16x16x32_bf16 v[32:35], v[60:63], v[52:55], v[32:35]
    ds_read_b128 v[112:115], v9 offset:57344
    ds_read_b128 v[116:119], v6 offset:46080
    v_mfma_f32_16x16x32_bf16 v[24:27], v[64:67], v[48:51], v[24:27]
    ds_read_b128 v[120:123], v6 offset:48128
    ds_read_b128 v[124:127], v6 offset:50176
    v_mfma_f32_16x16x32_bf16 v[36:39], v[64:67], v[52:55], v[36:39]
    v_mfma_f32_16x16x32_bf16 v[16:19], v[76:79], v[68:71], v[16:19]
    v_mfma_f32_16x16x32_bf16 v[28:31], v[76:79], v[72:75], v[28:31]
    v_mfma_f32_16x16x32_bf16 v[20:23], v[80:83], v[68:71], v[20:23]
    v_mfma_f32_16x16x32_bf16 v[32:35], v[80:83], v[72:75], v[32:35]
    v_mfma_f32_16x16x32_bf16 v[24:27], v[84:87], v[68:71], v[24:27]
    v_mfma_f32_16x16x32_bf16 v[36:39], v[84:87], v[72:75], v[36:39]
    s_waitcnt lgkmcnt(0)
    s_barrier
    v_mfma_f32_16x16x32_bf16 v[16:19], v[96:99], v[88:91], v[16:19]
    ds_read_b128 v[48:51], v8 offset:0
    ds_read_b128 v[52:55], v9 offset:0
    v_mfma_f32_16x16x32_bf16 v[28:31], v[96:99], v[92:95], v[28:31]
    ds_read_b128 v[56:59], v7 offset:0
    ds_read_b128 v[60:63], v7 offset:2048
    v_mfma_f32_16x16x32_bf16 v[20:23], v[100:103], v[88:91], v[20:23]
    ds_read_b128 v[64:67], v7 offset:4096
    ds_read_b128 v[68:71], v8 offset:8192
    v_mfma_f32_16x16x32_bf16 v[32:35], v[100:103], v[92:95], v[32:35]
    ds_read_b128 v[72:75], v9 offset:8192
    ds_read_b128 v[76:79], v7 offset:9216
    v_mfma_f32_16x16x32_bf16 v[24:27], v[104:107], v[88:91], v[24:27]
    ds_read_b128 v[80:83], v7 offset:11264
    ds_read_b128 v[84:87], v7 offset:13312
    v_mfma_f32_16x16x32_bf16 v[36:39], v[104:107], v[92:95], v[36:39]
    v_mfma_f32_16x16x32_bf16 v[16:19], v[116:119], v[108:111], v[16:19]
    v_mfma_f32_16x16x32_bf16 v[28:31], v[116:119], v[112:115], v[28:31]
    v_mfma_f32_16x16x32_bf16 v[20:23], v[120:123], v[108:111], v[20:23]
    v_mfma_f32_16x16x32_bf16 v[32:35], v[120:123], v[112:115], v[32:35]
    v_mfma_f32_16x16x32_bf16 v[24:27], v[124:127], v[108:111], v[24:27]
    v_mfma_f32_16x16x32_bf16 v[36:39], v[124:127], v[112:115], v[36:39]
    s_waitcnt lgkmcnt(0)
    s_barrier
    v_mfma_f32_16x16x32_bf16 v[16:19], v[56:59], v[48:51], v[16:19]
    ds_read_b128 v[88:91], v8 offset:16384
    ds_read_b128 v[92:95], v9 offset:16384
    v_mfma_f32_16x16x32_bf16 v[28:31], v[56:59], v[52:55], v[28:31]
    ds_read_b128 v[96:99], v6 offset:0
    ds_read_b128 v[100:103], v6 offset:2048
    v_mfma_f32_16x16x32_bf16 v[20:23], v[60:63], v[48:51], v[20:23]
    ds_read_b128 v[104:107], v6 offset:4096
    ds_read_b128 v[108:111], v8 offset:24576
    v_mfma_f32_16x16x32_bf16 v[32:35], v[60:63], v[52:55], v[32:35]
    ds_read_b128 v[112:115], v9 offset:24576
    ds_read_b128 v[116:119], v6 offset:9216
    v_mfma_f32_16x16x32_bf16 v[24:27], v[64:67], v[48:51], v[24:27]
    ds_read_b128 v[120:123], v6 offset:11264
    ds_read_b128 v[124:127], v6 offset:13312
    v_mfma_f32_16x16x32_bf16 v[36:39], v[64:67], v[52:55], v[36:39]
    v_mfma_f32_16x16x32_bf16 v[16:19], v[76:79], v[68:71], v[16:19]
    v_mfma_f32_16x16x32_bf16 v[28:31], v[76:79], v[72:75], v[28:31]
    v_mfma_f32_16x16x32_bf16 v[20:23], v[80:83], v[68:71], v[20:23]
    v_mfma_f32_16x16x32_bf16 v[32:35], v[80:83], v[72:75], v[32:35]
    v_mfma_f32_16x16x32_bf16 v[24:27], v[84:87], v[68:71], v[24:27]
    v_mfma_f32_16x16x32_bf16 v[36:39], v[84:87], v[72:75], v[36:39]
    s_waitcnt lgkmcnt(0)
    v_mfma_f32_16x16x32_bf16 v[16:19], v[96:99], v[88:91], v[16:19]
    v_mfma_f32_16x16x32_bf16 v[28:31], v[96:99], v[92:95], v[28:31]
    v_mfma_f32_16x16x32_bf16 v[20:23], v[100:103], v[88:91], v[20:23]
    v_mfma_f32_16x16x32_bf16 v[32:35], v[100:103], v[92:95], v[32:35]
    v_mfma_f32_16x16x32_bf16 v[24:27], v[104:107], v[88:91], v[24:27]
    v_mfma_f32_16x16x32_bf16 v[36:39], v[104:107], v[92:95], v[36:39]
    v_mfma_f32_16x16x32_bf16 v[16:19], v[116:119], v[108:111], v[16:19]
    v_mfma_f32_16x16x32_bf16 v[28:31], v[116:119], v[112:115], v[28:31]
    v_mfma_f32_16x16x32_bf16 v[20:23], v[120:123], v[108:111], v[20:23]
    v_mfma_f32_16x16x32_bf16 v[32:35], v[120:123], v[112:115], v[32:35]
    v_mfma_f32_16x16x32_bf16 v[24:27], v[124:127], v[108:111], v[24:27]
    v_mfma_f32_16x16x32_bf16 v[36:39], v[124:127], v[112:115], v[36:39]
    s_nop 7
    ds_write_b128 v12, v[28:31] offset:36864
    ds_write_b128 v12, v[32:35] offset:37888
    ds_write_b128 v12, v[36:39] offset:38912
    s_waitcnt lgkmcnt(0)
    s_barrier
    ds_read_b128 v[28:31], v13 offset:36864
    ds_read_b128 v[32:35], v13 offset:37888
    ds_read_b128 v[36:39], v13 offset:38912
    s_waitcnt lgkmcnt(0)
    v_pk_add_f32 v[16:17], v[16:17], v[28:29]
    v_cvt_pk_bf16_f32 v48, v16, v17
    v_pk_add_f32 v[18:19], v[18:19], v[30:31]
    v_cvt_pk_bf16_f32 v49, v18, v19
    v_pk_add_f32 v[20:21], v[20:21], v[32:33]
    v_cvt_pk_bf16_f32 v50, v20, v21
    v_pk_add_f32 v[22:23], v[22:23], v[34:35]
    v_cvt_pk_bf16_f32 v51, v22, v23
    buffer_store_dwordx4 v[48:51], v10, s[80:83], 0 offen offset:64
    v_pk_add_f32 v[24:25], v[24:25], v[36:37]
    v_cvt_pk_bf16_f32 v52, v24, v25
    v_pk_add_f32 v[26:27], v[26:27], v[38:39]
    v_cvt_pk_bf16_f32 v53, v26, v27
    buffer_store_dwordx2 v[52:53], v11, s[80:83], 0 offen offset:128
    s_endpgm
ldP_mega_kernel_2:
    s_setprio 3
    s_add_u32 s45, s12, 2304
    s_mul_i32 s45, s45, 1152
    s_lshr_b32 s46, s10, 1
    s_lshl_b32 s44, s46, 11
    s_add_u32 s44, s44, s45
    v_lshrrev_b32 v3, 3, v2
    v_and_b32 v4, 7, v2
    v_lshrrev_b32 v5, 4, v2
    v_xor_b32 v4, v4, v5
    v_lshrrev_b32 v5, 2, v4
    v_and_b32 v4, 3, v4
    v_lshlrev_b32 v4, 4, v4
    v_mul_u32_u24 v6, 1024, v5
    v_xor_b32 v5, 1, v5
    v_mul_u32_u24 v5, 1024, v5
    v_add_u32 v5, v5, v4
    v_add_u32 v4, v6, v4
    v_lshrrev_b32 v6, 2, v3
    v_lshlrev_b32 v6, 3, v6
    v_and_b32 v7, 3, v3
    v_add_u32 v6, v6, v7
    v_mul_u32_u24 v6, 64, v6
    v_mul_u32_u24 v3, 64, v3
    v_add_u32 v8, v6, v4
    v_add_u32 v9, v6, v5
    v_add_u32 v10, v3, v4
    v_add_u32 v11, v3, v5
    v_mov_b32 v16, v10
    v_add_u32 v17, 0x200, v11
    v_add_u32 v18, 0x4800, v10
    v_add_u32 v19, 0x4a00, v11
    v_add_u32 v20, 0x9000, v10
    v_add_u32 v21, 0x9200, v11
    v_add_u32 v22, 0xd800, v10
    v_add_u32 v23, 0xda00, v11
    v_add_u32 v24, 0x12000, v10
    v_add_u32 v25, 0x12200, v11
    v_add_u32 v26, 0x16800, v10
    v_add_u32 v27, 0x16a00, v11
    v_add_u32 v28, 0x1b000, v10
    v_add_u32 v29, 0x1b200, v11
    v_add_u32 v30, 0x1f800, v10
    v_add_u32 v31, 0x1fa00, v11
    v_add_u32 v32, 0x24000, v10
    v_add_u32 v33, 0x24200, v11
    s_waitcnt lgkmcnt(0)
    s_add_u32 s16, s6, 0x1400000
    s_addc_u32 s17, s7, 0
    s_mov_b32 s18, 0x510000
    s_mov_b32 s19, 0x00020000
    s_mov_b32 m0, 0
    s_nop 0
    buffer_load_dwordx4 v16, s[16:19], s44 offen  lds
    s_mov_b32 m0, 1024
    s_nop 0
    buffer_load_dwordx4 v17, s[16:19], s44 offen  lds
    s_mov_b32 m0, 2048
    s_nop 0
    buffer_load_dwordx4 v18, s[16:19], s44 offen  lds
    s_mov_b32 m0, 3072
    s_nop 0
    buffer_load_dwordx4 v19, s[16:19], s44 offen  lds
    s_mov_b32 m0, 4096
    s_nop 0
    buffer_load_dwordx4 v20, s[16:19], s44 offen  lds
    s_mov_b32 m0, 5120
    s_nop 0
    buffer_load_dwordx4 v21, s[16:19], s44 offen  lds
    s_mov_b32 m0, 6144
    s_nop 0
    buffer_load_dwordx4 v22, s[16:19], s44 offen  lds
    s_mov_b32 m0, 7168
    s_nop 0
    buffer_load_dwordx4 v23, s[16:19], s44 offen  lds
    s_mov_b32 m0, 8192
    s_nop 0
    buffer_load_dwordx4 v24, s[16:19], s44 offen  lds
    s_mov_b32 m0, 9216
    s_nop 0
    buffer_load_dwordx4 v25, s[16:19], s44 offen  lds
    s_mov_b32 m0, 10240
    s_nop 0
    buffer_load_dwordx4 v26, s[16:19], s44 offen  lds
    s_mov_b32 m0, 11264
    s_nop 0
    buffer_load_dwordx4 v27, s[16:19], s44 offen  lds
    s_mov_b32 m0, 12288
    s_nop 0
    buffer_load_dwordx4 v28, s[16:19], s44 offen  lds
    s_mov_b32 m0, 13312
    s_nop 0
    buffer_load_dwordx4 v29, s[16:19], s44 offen  lds
    s_mov_b32 m0, 14336
    s_nop 0
    buffer_load_dwordx4 v30, s[16:19], s44 offen  lds
    s_mov_b32 m0, 15360
    s_nop 0
    buffer_load_dwordx4 v31, s[16:19], s44 offen  lds
    s_mov_b32 m0, 16384
    s_nop 0
    buffer_load_dwordx4 v32, s[16:19], s44 offen  lds
    s_mov_b32 m0, 17408
    s_nop 0
    buffer_load_dwordx4 v33, s[16:19], s44 offen  lds
    s_add_u32 s46, s46, 1
    s_cmp_eq_u32 s46, 9
    s_cselect_b32 s46, 0, s46
    s_mul_i32 s44, s46, 2048
    s_add_u32 s44, s44, s45
    s_mov_b32 m0, 18432
    s_nop 0
    buffer_load_dwordx4 v16, s[16:19], s44 offen  lds
    s_mov_b32 m0, 19456
    s_nop 0
    buffer_load_dwordx4 v17, s[16:19], s44 offen  lds
    s_mov_b32 m0, 20480
    s_nop 0
    buffer_load_dwordx4 v18, s[16:19], s44 offen  lds
    s_mov_b32 m0, 21504
    s_nop 0
    buffer_load_dwordx4 v19, s[16:19], s44 offen  lds
    s_mov_b32 m0, 22528
    s_nop 0
    buffer_load_dwordx4 v20, s[16:19], s44 offen  lds
    s_mov_b32 m0, 23552
    s_nop 0
    buffer_load_dwordx4 v21, s[16:19], s44 offen  lds
    s_mov_b32 m0, 24576
    s_nop 0
    buffer_load_dwordx4 v22, s[16:19], s44 offen  lds
    s_mov_b32 m0, 25600
    s_nop 0
    buffer_load_dwordx4 v23, s[16:19], s44 offen  lds
    s_mov_b32 m0, 26624
    s_nop 0
    buffer_load_dwordx4 v24, s[16:19], s44 offen  lds
    s_mov_b32 m0, 27648
    s_nop 0
    buffer_load_dwordx4 v25, s[16:19], s44 offen  lds
    s_mov_b32 m0, 28672
    s_nop 0
    buffer_load_dwordx4 v26, s[16:19], s44 offen  lds
    s_mov_b32 m0, 29696
    s_nop 0
    buffer_load_dwordx4 v27, s[16:19], s44 offen  lds
    s_mov_b32 m0, 30720
    s_nop 0
    buffer_load_dwordx4 v28, s[16:19], s44 offen  lds
    s_mov_b32 m0, 31744
    s_nop 0
    buffer_load_dwordx4 v29, s[16:19], s44 offen  lds
    s_mov_b32 m0, 32768
    s_nop 0
    buffer_load_dwordx4 v30, s[16:19], s44 offen  lds
    s_mov_b32 m0, 33792
    s_nop 0
    buffer_load_dwordx4 v31, s[16:19], s44 offen  lds
    s_mov_b32 m0, 34816
    s_nop 0
    buffer_load_dwordx4 v32, s[16:19], s44 offen  lds
    s_mov_b32 m0, 35840
    s_nop 0
    buffer_load_dwordx4 v33, s[16:19], s44 offen  lds
    s_add_u32 s46, s46, 1
    s_cmp_eq_u32 s46, 9
    s_cselect_b32 s46, 0, s46
    s_mul_i32 s44, s46, 2048
    s_add_u32 s44, s44, s45
    v_lshrrev_b32 v3, 3, v2
    v_and_b32 v4, 7, v2
    v_lshrrev_b32 v5, 4, v2
    v_xor_b32 v4, v4, v5
    v_lshrrev_b32 v5, 2, v4
    v_and_b32 v4, 3, v4
    v_lshlrev_b32 v4, 4, v4
    v_mul_u32_u24 v6, 1024, v5
    v_xor_b32 v5, 1, v5
    v_mul_u32_u24 v5, 1024, v5
    v_add_u32 v5, v5, v4
    v_add_u32 v4, v6, v4
    v_lshrrev_b32 v6, 2, v3
    v_lshlrev_b32 v6, 3, v6
    v_and_b32 v7, 3, v3
    v_add_u32 v6, v6, v7
    v_mul_u32_u24 v6, 64, v6
    v_mul_u32_u24 v3, 64, v3
    v_add_u32 v8, v6, v4
    v_add_u32 v9, v6, v5
    v_add_u32 v10, v3, v4
    v_add_u32 v11, v3, v5
    v_mov_b32 v48, v8
    v_add_u32 v49, 0x4800, v9
    v_add_u32 v50, 0x100, v8
    v_add_u32 v51, 0x4900, v9
    v_add_u32 v52, 0x9000, v8
    v_add_u32 v53, 0xd800, v9
    v_add_u32 v54, 0x9100, v8
    v_add_u32 v55, 0xd900, v9
    v_add_u32 v56, 0x12000, v10
    v_add_u32 v57, 0x12200, v11
    v_add_u32 v58, 0x16800, v8
    v_add_u32 v59, 0x1b000, v9
    v_add_u32 v60, 0x16900, v8
    v_add_u32 v61, 0x1b100, v9
    v_add_u32 v62, 0x1f800, v8
    v_add_u32 v63, 0x24000, v9
    v_add_u32 v64, 0x1f900, v8
    v_add_u32 v65, 0x24100, v9
    s_waitcnt vmcnt(18)
    s_barrier
    s_mov_b32 m0, 36864
    s_nop 0
    buffer_load_dwordx4 v16, s[16:19], s44 offen  lds
    s_mov_b32 m0, 37888
    s_nop 0
    buffer_load_dwordx4 v17, s[16:19], s44 offen  lds
    s_mov_b32 m0, 38912
    s_nop 0
    buffer_load_dwordx4 v18, s[16:19], s44 offen  lds
    s_mov_b32 m0, 39936
    s_nop 0
    buffer_load_dwordx4 v19, s[16:19], s44 offen  lds
    s_mov_b32 m0, 40960
    s_nop 0
    buffer_load_dwordx4 v20, s[16:19], s44 offen  lds
    s_mov_b32 m0, 41984
    s_nop 0
    buffer_load_dwordx4 v21, s[16:19], s44 offen  lds
    s_mov_b32 m0, 43008
    s_nop 0
    buffer_load_dwordx4 v22, s[16:19], s44 offen  lds
    s_mov_b32 m0, 44032
    s_nop 0
    buffer_load_dwordx4 v23, s[16:19], s44 offen  lds
    s_mov_b32 m0, 45056
    s_nop 0
    buffer_load_dwordx4 v24, s[16:19], s44 offen  lds
    s_mov_b32 m0, 46080
    s_nop 0
    buffer_load_dwordx4 v25, s[16:19], s44 offen  lds
    s_mov_b32 m0, 47104
    s_nop 0
    buffer_load_dwordx4 v26, s[16:19], s44 offen  lds
    s_mov_b32 m0, 48128
    s_nop 0
    buffer_load_dwordx4 v27, s[16:19], s44 offen  lds
    s_mov_b32 m0, 49152
    s_nop 0
    buffer_load_dwordx4 v28, s[16:19], s44 offen  lds
    s_mov_b32 m0, 50176
    s_nop 0
    buffer_load_dwordx4 v29, s[16:19], s44 offen  lds
    s_mov_b32 m0, 51200
    s_nop 0
    buffer_load_dwordx4 v30, s[16:19], s44 offen  lds
    s_mov_b32 m0, 52224
    s_nop 0
    buffer_load_dwordx4 v31, s[16:19], s44 offen  lds
    s_mov_b32 m0, 53248
    s_nop 0
    buffer_load_dwordx4 v32, s[16:19], s44 offen  lds
    s_mov_b32 m0, 54272
    s_nop 0
    buffer_load_dwordx4 v33, s[16:19], s44 offen  lds
    s_add_u32 s46, s46, 1
    s_cmp_eq_u32 s46, 9
    s_cselect_b32 s46, 0, s46
    s_mul_i32 s44, s46, 2048
    s_add_u32 s44, s44, s45
    s_waitcnt vmcnt(18)
    s_barrier
    s_mov_b32 m0, 55296
    s_nop 0
    buffer_load_dwordx4 v16, s[16:19], s44 offen  lds
    s_mov_b32 m0, 56320
    s_nop 0
    buffer_load_dwordx4 v17, s[16:19], s44 offen  lds
    s_mov_b32 m0, 57344
    s_nop 0
    buffer_load_dwordx4 v18, s[16:19], s44 offen  lds
    s_mov_b32 m0, 58368
    s_nop 0
    buffer_load_dwordx4 v19, s[16:19], s44 offen  lds
    s_mov_b32 m0, 59392
    s_nop 0
    buffer_load_dwordx4 v20, s[16:19], s44 offen  lds
    s_mov_b32 m0, 60416
    s_nop 0
    buffer_load_dwordx4 v21, s[16:19], s44 offen  lds
    s_mov_b32 m0, 61440
    s_nop 0
    buffer_load_dwordx4 v22, s[16:19], s44 offen  lds
    s_mov_b32 m0, 62464
    s_nop 0
    buffer_load_dwordx4 v23, s[16:19], s44 offen  lds
    s_mov_b32 m0, 63488
    s_nop 0
    buffer_load_dwordx4 v24, s[16:19], s44 offen  lds
    s_mov_b32 m0, 64512
    s_nop 0
    buffer_load_dwordx4 v25, s[16:19], s44 offen  lds
    s_mov_b32 m0, 65536
    s_nop 0
    buffer_load_dwordx4 v26, s[16:19], s44 offen  lds
    s_mov_b32 m0, 66560
    s_nop 0
    buffer_load_dwordx4 v27, s[16:19], s44 offen  lds
    s_mov_b32 m0, 67584
    s_nop 0
    buffer_load_dwordx4 v28, s[16:19], s44 offen  lds
    s_mov_b32 m0, 68608
    s_nop 0
    buffer_load_dwordx4 v29, s[16:19], s44 offen  lds
    s_mov_b32 m0, 69632
    s_nop 0
    buffer_load_dwordx4 v30, s[16:19], s44 offen  lds
    s_mov_b32 m0, 70656
    s_nop 0
    buffer_load_dwordx4 v31, s[16:19], s44 offen  lds
    s_mov_b32 m0, 71680
    s_nop 0
    buffer_load_dwordx4 v32, s[16:19], s44 offen  lds
    s_mov_b32 m0, 72704
    s_nop 0
    buffer_load_dwordx4 v33, s[16:19], s44 offen  lds
    s_add_u32 s46, s46, 1
    s_cmp_eq_u32 s46, 9
    s_cselect_b32 s46, 0, s46
    s_mul_i32 s44, s46, 2048
    s_add_u32 s44, s44, s45
    s_waitcnt vmcnt(18)
    s_barrier
    s_mov_b32 m0, 0
    s_nop 0
    buffer_load_dwordx4 v16, s[16:19], s44 offen  lds
    s_mov_b32 m0, 1024
    s_nop 0
    buffer_load_dwordx4 v17, s[16:19], s44 offen  lds
    s_mov_b32 m0, 2048
    s_nop 0
    buffer_load_dwordx4 v18, s[16:19], s44 offen  lds
    s_mov_b32 m0, 3072
    s_nop 0
    buffer_load_dwordx4 v19, s[16:19], s44 offen  lds
    s_mov_b32 m0, 4096
    s_nop 0
    buffer_load_dwordx4 v20, s[16:19], s44 offen  lds
    s_mov_b32 m0, 5120
    s_nop 0
    buffer_load_dwordx4 v21, s[16:19], s44 offen  lds
    s_mov_b32 m0, 6144
    s_nop 0
    buffer_load_dwordx4 v22, s[16:19], s44 offen  lds
    s_mov_b32 m0, 7168
    s_nop 0
    buffer_load_dwordx4 v23, s[16:19], s44 offen  lds
    s_mov_b32 m0, 8192
    s_nop 0
    buffer_load_dwordx4 v24, s[16:19], s44 offen  lds
    s_mov_b32 m0, 9216
    s_nop 0
    buffer_load_dwordx4 v25, s[16:19], s44 offen  lds
    s_mov_b32 m0, 10240
    s_nop 0
    buffer_load_dwordx4 v26, s[16:19], s44 offen  lds
    s_mov_b32 m0, 11264
    s_nop 0
    buffer_load_dwordx4 v27, s[16:19], s44 offen  lds
    s_mov_b32 m0, 12288
    s_nop 0
    buffer_load_dwordx4 v28, s[16:19], s44 offen  lds
    s_mov_b32 m0, 13312
    s_nop 0
    buffer_load_dwordx4 v29, s[16:19], s44 offen  lds
    s_mov_b32 m0, 14336
    s_nop 0
    buffer_load_dwordx4 v30, s[16:19], s44 offen  lds
    s_mov_b32 m0, 15360
    s_nop 0
    buffer_load_dwordx4 v31, s[16:19], s44 offen  lds
    s_mov_b32 m0, 16384
    s_nop 0
    buffer_load_dwordx4 v32, s[16:19], s44 offen  lds
    s_mov_b32 m0, 17408
    s_nop 0
    buffer_load_dwordx4 v33, s[16:19], s44 offen  lds
    s_add_u32 s46, s46, 1
    s_cmp_eq_u32 s46, 9
    s_cselect_b32 s46, 0, s46
    s_mul_i32 s44, s46, 2048
    s_add_u32 s44, s44, s45
    s_waitcnt vmcnt(18)
    s_barrier
    s_mov_b32 m0, 18432
    s_nop 0
    buffer_load_dwordx4 v16, s[16:19], s44 offen  lds
    s_mov_b32 m0, 19456
    s_nop 0
    buffer_load_dwordx4 v17, s[16:19], s44 offen  lds
    s_mov_b32 m0, 20480
    s_nop 0
    buffer_load_dwordx4 v18, s[16:19], s44 offen  lds
    s_mov_b32 m0, 21504
    s_nop 0
    buffer_load_dwordx4 v19, s[16:19], s44 offen  lds
    s_mov_b32 m0, 22528
    s_nop 0
    buffer_load_dwordx4 v20, s[16:19], s44 offen  lds
    s_mov_b32 m0, 23552
    s_nop 0
    buffer_load_dwordx4 v21, s[16:19], s44 offen  lds
    s_mov_b32 m0, 24576
    s_nop 0
    buffer_load_dwordx4 v22, s[16:19], s44 offen  lds
    s_mov_b32 m0, 25600
    s_nop 0
    buffer_load_dwordx4 v23, s[16:19], s44 offen  lds
    s_mov_b32 m0, 26624
    s_nop 0
    buffer_load_dwordx4 v24, s[16:19], s44 offen  lds
    s_mov_b32 m0, 27648
    s_nop 0
    buffer_load_dwordx4 v25, s[16:19], s44 offen  lds
    s_mov_b32 m0, 28672
    s_nop 0
    buffer_load_dwordx4 v26, s[16:19], s44 offen  lds
    s_mov_b32 m0, 29696
    s_nop 0
    buffer_load_dwordx4 v27, s[16:19], s44 offen  lds
    s_mov_b32 m0, 30720
    s_nop 0
    buffer_load_dwordx4 v28, s[16:19], s44 offen  lds
    s_mov_b32 m0, 31744
    s_nop 0
    buffer_load_dwordx4 v29, s[16:19], s44 offen  lds
    s_mov_b32 m0, 32768
    s_nop 0
    buffer_load_dwordx4 v30, s[16:19], s44 offen  lds
    s_mov_b32 m0, 33792
    s_nop 0
    buffer_load_dwordx4 v31, s[16:19], s44 offen  lds
    s_mov_b32 m0, 34816
    s_nop 0
    buffer_load_dwordx4 v32, s[16:19], s44 offen  lds
    s_mov_b32 m0, 35840
    s_nop 0
    buffer_load_dwordx4 v33, s[16:19], s44 offen  lds
    s_add_u32 s46, s46, 1
    s_cmp_eq_u32 s46, 9
    s_cselect_b32 s46, 0, s46
    s_mul_i32 s44, s46, 2048
    s_add_u32 s44, s44, s45
    s_waitcnt vmcnt(18)
    s_barrier
    s_mov_b32 m0, 36864
    s_nop 0
    buffer_load_dwordx4 v16, s[16:19], s44 offen  lds
    s_mov_b32 m0, 37888
    s_nop 0
    buffer_load_dwordx4 v17, s[16:19], s44 offen  lds
    s_mov_b32 m0, 38912
    s_nop 0
    buffer_load_dwordx4 v18, s[16:19], s44 offen  lds
    s_mov_b32 m0, 39936
    s_nop 0
    buffer_load_dwordx4 v19, s[16:19], s44 offen  lds
    s_mov_b32 m0, 40960
    s_nop 0
    buffer_load_dwordx4 v20, s[16:19], s44 offen  lds
    s_mov_b32 m0, 41984
    s_nop 0
    buffer_load_dwordx4 v21, s[16:19], s44 offen  lds
    s_mov_b32 m0, 43008
    s_nop 0
    buffer_load_dwordx4 v22, s[16:19], s44 offen  lds
    s_mov_b32 m0, 44032
    s_nop 0
    buffer_load_dwordx4 v23, s[16:19], s44 offen  lds
    s_mov_b32 m0, 45056
    s_nop 0
    buffer_load_dwordx4 v24, s[16:19], s44 offen  lds
    s_mov_b32 m0, 46080
    s_nop 0
    buffer_load_dwordx4 v25, s[16:19], s44 offen  lds
    s_mov_b32 m0, 47104
    s_nop 0
    buffer_load_dwordx4 v26, s[16:19], s44 offen  lds
    s_mov_b32 m0, 48128
    s_nop 0
    buffer_load_dwordx4 v27, s[16:19], s44 offen  lds
    s_mov_b32 m0, 49152
    s_nop 0
    buffer_load_dwordx4 v28, s[16:19], s44 offen  lds
    s_mov_b32 m0, 50176
    s_nop 0
    buffer_load_dwordx4 v29, s[16:19], s44 offen  lds
    s_mov_b32 m0, 51200
    s_nop 0
    buffer_load_dwordx4 v30, s[16:19], s44 offen  lds
    s_mov_b32 m0, 52224
    s_nop 0
    buffer_load_dwordx4 v31, s[16:19], s44 offen  lds
    s_mov_b32 m0, 53248
    s_nop 0
    buffer_load_dwordx4 v32, s[16:19], s44 offen  lds
    s_mov_b32 m0, 54272
    s_nop 0
    buffer_load_dwordx4 v33, s[16:19], s44 offen  lds
    s_add_u32 s46, s46, 1
    s_cmp_eq_u32 s46, 9
    s_cselect_b32 s46, 0, s46
    s_mul_i32 s44, s46, 2048
    s_add_u32 s44, s44, s45
    s_waitcnt vmcnt(18)
    s_barrier
    s_mov_b32 m0, 55296
    s_nop 0
    buffer_load_dwordx4 v16, s[16:19], s44 offen  lds
    s_mov_b32 m0, 56320
    s_nop 0
    buffer_load_dwordx4 v17, s[16:19], s44 offen  lds
    s_mov_b32 m0, 57344
    s_nop 0
    buffer_load_dwordx4 v18, s[16:19], s44 offen  lds
    s_mov_b32 m0, 58368
    s_nop 0
    buffer_load_dwordx4 v19, s[16:19], s44 offen  lds
    s_mov_b32 m0, 59392
    s_nop 0
    buffer_load_dwordx4 v20, s[16:19], s44 offen  lds
    s_mov_b32 m0, 60416
    s_nop 0
    buffer_load_dwordx4 v21, s[16:19], s44 offen  lds
    s_mov_b32 m0, 61440
    s_nop 0
    buffer_load_dwordx4 v22, s[16:19], s44 offen  lds
    s_mov_b32 m0, 62464
    s_nop 0
    buffer_load_dwordx4 v23, s[16:19], s44 offen  lds
    s_mov_b32 m0, 63488
    s_nop 0
    buffer_load_dwordx4 v24, s[16:19], s44 offen  lds
    s_mov_b32 m0, 64512
    s_nop 0
    buffer_load_dwordx4 v25, s[16:19], s44 offen  lds
    s_mov_b32 m0, 65536
    s_nop 0
    buffer_load_dwordx4 v26, s[16:19], s44 offen  lds
    s_mov_b32 m0, 66560
    s_nop 0
    buffer_load_dwordx4 v27, s[16:19], s44 offen  lds
    s_mov_b32 m0, 67584
    s_nop 0
    buffer_load_dwordx4 v28, s[16:19], s44 offen  lds
    s_mov_b32 m0, 68608
    s_nop 0
    buffer_load_dwordx4 v29, s[16:19], s44 offen  lds
    s_mov_b32 m0, 69632
    s_nop 0
    buffer_load_dwordx4 v30, s[16:19], s44 offen  lds
    s_mov_b32 m0, 70656
    s_nop 0
    buffer_load_dwordx4 v31, s[16:19], s44 offen  lds
    s_mov_b32 m0, 71680
    s_nop 0
    buffer_load_dwordx4 v32, s[16:19], s44 offen  lds
    s_mov_b32 m0, 72704
    s_nop 0
    buffer_load_dwordx4 v33, s[16:19], s44 offen  lds
    s_add_u32 s46, s46, 1
    s_cmp_eq_u32 s46, 9
    s_cselect_b32 s46, 0, s46
    s_mul_i32 s44, s46, 2048
    s_add_u32 s44, s44, s45
    s_waitcnt vmcnt(18)
    s_barrier
    s_mov_b32 m0, 0
    s_nop 0
    buffer_load_dwordx4 v16, s[16:19], s44 offen  lds
    s_mov_b32 m0, 1024
    s_nop 0
    buffer_load_dwordx4 v17, s[16:19], s44 offen  lds
    s_mov_b32 m0, 2048
    s_nop 0
    buffer_load_dwordx4 v18, s[16:19], s44 offen  lds
    s_mov_b32 m0, 3072
    s_nop 0
    buffer_load_dwordx4 v19, s[16:19], s44 offen  lds
    s_mov_b32 m0, 4096
    s_nop 0
    buffer_load_dwordx4 v20, s[16:19], s44 offen  lds
    s_mov_b32 m0, 5120
    s_nop 0
    buffer_load_dwordx4 v21, s[16:19], s44 offen  lds
    s_mov_b32 m0, 6144
    s_nop 0
    buffer_load_dwordx4 v22, s[16:19], s44 offen  lds
    s_mov_b32 m0, 7168
    s_nop 0
    buffer_load_dwordx4 v23, s[16:19], s44 offen  lds
    s_mov_b32 m0, 8192
    s_nop 0
    buffer_load_dwordx4 v24, s[16:19], s44 offen  lds
    s_mov_b32 m0, 9216
    s_nop 0
    buffer_load_dwordx4 v25, s[16:19], s44 offen  lds
    s_mov_b32 m0, 10240
    s_nop 0
    buffer_load_dwordx4 v26, s[16:19], s44 offen  lds
    s_mov_b32 m0, 11264
    s_nop 0
    buffer_load_dwordx4 v27, s[16:19], s44 offen  lds
    s_mov_b32 m0, 12288
    s_nop 0
    buffer_load_dwordx4 v28, s[16:19], s44 offen  lds
    s_mov_b32 m0, 13312
    s_nop 0
    buffer_load_dwordx4 v29, s[16:19], s44 offen  lds
    s_mov_b32 m0, 14336
    s_nop 0
    buffer_load_dwordx4 v30, s[16:19], s44 offen  lds
    s_mov_b32 m0, 15360
    s_nop 0
    buffer_load_dwordx4 v31, s[16:19], s44 offen  lds
    s_mov_b32 m0, 16384
    s_nop 0
    buffer_load_dwordx4 v32, s[16:19], s44 offen  lds
    s_mov_b32 m0, 17408
    s_nop 0
    buffer_load_dwordx4 v33, s[16:19], s44 offen  lds
    s_add_u32 s46, s46, 1
    s_cmp_eq_u32 s46, 9
    s_cselect_b32 s46, 0, s46
    s_mul_i32 s44, s46, 2048
    s_add_u32 s44, s44, s45
    s_waitcnt vmcnt(18)
    s_barrier
    s_mul_i32 s45, s12, 1152
    s_lshl_b32 s44, s46, 11
    s_add_u32 s44, s44, s45
    s_mov_b32 m0, 18432
    s_nop 0
    buffer_load_dwordx4 v48, s[16:19], s44 offen  lds
    s_mov_b32 m0, 19456
    s_nop 0
    buffer_load_dwordx4 v49, s[16:19], s44 offen  lds
    s_mov_b32 m0, 20480
    s_nop 0
    buffer_load_dwordx4 v50, s[16:19], s44 offen  lds
    s_mov_b32 m0, 21504
    s_nop 0
    buffer_load_dwordx4 v51, s[16:19], s44 offen  lds
    s_mov_b32 m0, 22528
    s_nop 0
    buffer_load_dwordx4 v52, s[16:19], s44 offen  lds
    s_mov_b32 m0, 23552
    s_nop 0
    buffer_load_dwordx4 v53, s[16:19], s44 offen  lds
    s_mov_b32 m0, 24576
    s_nop 0
    buffer_load_dwordx4 v54, s[16:19], s44 offen  lds
    s_mov_b32 m0, 25600
    s_nop 0
    buffer_load_dwordx4 v55, s[16:19], s44 offen  lds
    s_mov_b32 m0, 26624
    s_nop 0
    buffer_load_dwordx4 v56, s[16:19], s44 offen  lds
    s_mov_b32 m0, 27648
    s_nop 0
    buffer_load_dwordx4 v57, s[16:19], s44 offen  lds
    s_mov_b32 m0, 28672
    s_nop 0
    buffer_load_dwordx4 v58, s[16:19], s44 offen  lds
    s_mov_b32 m0, 29696
    s_nop 0
    buffer_load_dwordx4 v59, s[16:19], s44 offen  lds
    s_mov_b32 m0, 30720
    s_nop 0
    buffer_load_dwordx4 v60, s[16:19], s44 offen  lds
    s_mov_b32 m0, 31744
    s_nop 0
    buffer_load_dwordx4 v61, s[16:19], s44 offen  lds
    s_mov_b32 m0, 32768
    s_nop 0
    buffer_load_dwordx4 v62, s[16:19], s44 offen  lds
    s_mov_b32 m0, 33792
    s_nop 0
    buffer_load_dwordx4 v63, s[16:19], s44 offen  lds
    s_mov_b32 m0, 34816
    s_nop 0
    buffer_load_dwordx4 v64, s[16:19], s44 offen  lds
    s_mov_b32 m0, 35840
    s_nop 0
    buffer_load_dwordx4 v65, s[16:19], s44 offen  lds
    s_add_u32 s46, s46, 1
    s_cmp_eq_u32 s46, 9
    s_cselect_b32 s46, 0, s46
    s_mul_i32 s44, s46, 2048
    s_add_u32 s44, s44, s45
    s_waitcnt vmcnt(18)
    s_barrier
    s_mov_b32 m0, 36864
    s_nop 0
    buffer_load_dwordx4 v48, s[16:19], s44 offen  lds
    s_mov_b32 m0, 37888
    s_nop 0
    buffer_load_dwordx4 v49, s[16:19], s44 offen  lds
    s_mov_b32 m0, 38912
    s_nop 0
    buffer_load_dwordx4 v50, s[16:19], s44 offen  lds
    s_mov_b32 m0, 39936
    s_nop 0
    buffer_load_dwordx4 v51, s[16:19], s44 offen  lds
    s_mov_b32 m0, 40960
    s_nop 0
    buffer_load_dwordx4 v52, s[16:19], s44 offen  lds
    s_mov_b32 m0, 41984
    s_nop 0
    buffer_load_dwordx4 v53, s[16:19], s44 offen  lds
    s_mov_b32 m0, 43008
    s_nop 0
    buffer_load_dwordx4 v54, s[16:19], s44 offen  lds
    s_mov_b32 m0, 44032
    s_nop 0
    buffer_load_dwordx4 v55, s[16:19], s44 offen  lds
    s_mov_b32 m0, 45056
    s_nop 0
    buffer_load_dwordx4 v56, s[16:19], s44 offen  lds
    s_mov_b32 m0, 46080
    s_nop 0
    buffer_load_dwordx4 v57, s[16:19], s44 offen  lds
    s_mov_b32 m0, 47104
    s_nop 0
    buffer_load_dwordx4 v58, s[16:19], s44 offen  lds
    s_mov_b32 m0, 48128
    s_nop 0
    buffer_load_dwordx4 v59, s[16:19], s44 offen  lds
    s_mov_b32 m0, 49152
    s_nop 0
    buffer_load_dwordx4 v60, s[16:19], s44 offen  lds
    s_mov_b32 m0, 50176
    s_nop 0
    buffer_load_dwordx4 v61, s[16:19], s44 offen  lds
    s_mov_b32 m0, 51200
    s_nop 0
    buffer_load_dwordx4 v62, s[16:19], s44 offen  lds
    s_mov_b32 m0, 52224
    s_nop 0
    buffer_load_dwordx4 v63, s[16:19], s44 offen  lds
    s_mov_b32 m0, 53248
    s_nop 0
    buffer_load_dwordx4 v64, s[16:19], s44 offen  lds
    s_mov_b32 m0, 54272
    s_nop 0
    buffer_load_dwordx4 v65, s[16:19], s44 offen  lds
    s_add_u32 s46, s46, 1
    s_cmp_eq_u32 s46, 9
    s_cselect_b32 s46, 0, s46
    s_mul_i32 s44, s46, 2048
    s_add_u32 s44, s44, s45
    s_waitcnt vmcnt(18)
    s_barrier
    s_mov_b32 m0, 55296
    s_nop 0
    buffer_load_dwordx4 v48, s[16:19], s44 offen  lds
    s_mov_b32 m0, 56320
    s_nop 0
    buffer_load_dwordx4 v49, s[16:19], s44 offen  lds
    s_mov_b32 m0, 57344
    s_nop 0
    buffer_load_dwordx4 v50, s[16:19], s44 offen  lds
    s_mov_b32 m0, 58368
    s_nop 0
    buffer_load_dwordx4 v51, s[16:19], s44 offen  lds
    s_mov_b32 m0, 59392
    s_nop 0
    buffer_load_dwordx4 v52, s[16:19], s44 offen  lds
    s_mov_b32 m0, 60416
    s_nop 0
    buffer_load_dwordx4 v53, s[16:19], s44 offen  lds
    s_mov_b32 m0, 61440
    s_nop 0
    buffer_load_dwordx4 v54, s[16:19], s44 offen  lds
    s_mov_b32 m0, 62464
    s_nop 0
    buffer_load_dwordx4 v55, s[16:19], s44 offen  lds
    s_mov_b32 m0, 63488
    s_nop 0
    buffer_load_dwordx4 v56, s[16:19], s44 offen  lds
    s_mov_b32 m0, 64512
    s_nop 0
    buffer_load_dwordx4 v57, s[16:19], s44 offen  lds
    s_mov_b32 m0, 65536
    s_nop 0
    buffer_load_dwordx4 v58, s[16:19], s44 offen  lds
    s_mov_b32 m0, 66560
    s_nop 0
    buffer_load_dwordx4 v59, s[16:19], s44 offen  lds
    s_mov_b32 m0, 67584
    s_nop 0
    buffer_load_dwordx4 v60, s[16:19], s44 offen  lds
    s_mov_b32 m0, 68608
    s_nop 0
    buffer_load_dwordx4 v61, s[16:19], s44 offen  lds
    s_mov_b32 m0, 69632
    s_nop 0
    buffer_load_dwordx4 v62, s[16:19], s44 offen  lds
    s_mov_b32 m0, 70656
    s_nop 0
    buffer_load_dwordx4 v63, s[16:19], s44 offen  lds
    s_mov_b32 m0, 71680
    s_nop 0
    buffer_load_dwordx4 v64, s[16:19], s44 offen  lds
    s_mov_b32 m0, 72704
    s_nop 0
    buffer_load_dwordx4 v65, s[16:19], s44 offen  lds
    s_add_u32 s46, s46, 1
    s_cmp_eq_u32 s46, 9
    s_cselect_b32 s46, 0, s46
    s_mul_i32 s44, s46, 2048
    s_add_u32 s44, s44, s45
    s_waitcnt vmcnt(36)
    s_mov_b32 m0, 0
    s_nop 0
    buffer_load_dwordx4 v48, s[16:19], s44 offen  lds
    s_mov_b32 m0, 1024
    s_nop 0
    buffer_load_dwordx4 v49, s[16:19], s44 offen  lds
    s_mov_b32 m0, 2048
    s_nop 0
    buffer_load_dwordx4 v50, s[16:19], s44 offen  lds
    s_mov_b32 m0, 3072
    s_nop 0
    buffer_load_dwordx4 v51, s[16:19], s44 offen  lds
    s_mov_b32 m0, 4096
    s_nop 0
    buffer_load_dwordx4 v52, s[16:19], s44 offen  lds
    s_mov_b32 m0, 5120
    s_nop 0
    buffer_load_dwordx4 v53, s[16:19], s44 offen  lds
    s_mov_b32 m0, 6144
    s_nop 0
    buffer_load_dwordx4 v54, s[16:19], s44 offen  lds
    s_mov_b32 m0, 7168
    s_nop 0
    buffer_load_dwordx4 v55, s[16:19], s44 offen  lds
    s_mov_b32 m0, 8192
    s_nop 0
    buffer_load_dwordx4 v56, s[16:19], s44 offen  lds
    s_mov_b32 m0, 9216
    s_nop 0
    buffer_load_dwordx4 v57, s[16:19], s44 offen  lds
    s_mov_b32 m0, 10240
    s_nop 0
    buffer_load_dwordx4 v58, s[16:19], s44 offen  lds
    s_mov_b32 m0, 11264
    s_nop 0
    buffer_load_dwordx4 v59, s[16:19], s44 offen  lds
    s_mov_b32 m0, 12288
    s_nop 0
    buffer_load_dwordx4 v60, s[16:19], s44 offen  lds
    s_mov_b32 m0, 13312
    s_nop 0
    buffer_load_dwordx4 v61, s[16:19], s44 offen  lds
    s_mov_b32 m0, 14336
    s_nop 0
    buffer_load_dwordx4 v62, s[16:19], s44 offen  lds
    s_mov_b32 m0, 15360
    s_nop 0
    buffer_load_dwordx4 v63, s[16:19], s44 offen  lds
    s_mov_b32 m0, 16384
    s_nop 0
    buffer_load_dwordx4 v64, s[16:19], s44 offen  lds
    s_mov_b32 m0, 17408
    s_nop 0
    buffer_load_dwordx4 v65, s[16:19], s44 offen  lds
    s_add_u32 s46, s46, 1
    s_cmp_eq_u32 s46, 9
    s_cselect_b32 s46, 0, s46
    s_mul_i32 s44, s46, 2048
    s_add_u32 s44, s44, s45
    s_barrier
    s_waitcnt vmcnt(36)
    s_barrier
    s_mov_b32 m0, 18432
    s_nop 0
    buffer_load_dwordx4 v48, s[16:19], s44 offen  lds
    s_mov_b32 m0, 19456
    s_nop 0
    buffer_load_dwordx4 v49, s[16:19], s44 offen  lds
    s_mov_b32 m0, 20480
    s_nop 0
    buffer_load_dwordx4 v50, s[16:19], s44 offen  lds
    s_mov_b32 m0, 21504
    s_nop 0
    buffer_load_dwordx4 v51, s[16:19], s44 offen  lds
    s_mov_b32 m0, 22528
    s_nop 0
    buffer_load_dwordx4 v52, s[16:19], s44 offen  lds
    s_mov_b32 m0, 23552
    s_nop 0
    buffer_load_dwordx4 v53, s[16:19], s44 offen  lds
    s_mov_b32 m0, 24576
    s_nop 0
    buffer_load_dwordx4 v54, s[16:19], s44 offen  lds
    s_mov_b32 m0, 25600
    s_nop 0
    buffer_load_dwordx4 v55, s[16:19], s44 offen  lds
    s_mov_b32 m0, 26624
    s_nop 0
    buffer_load_dwordx4 v56, s[16:19], s44 offen  lds
    s_mov_b32 m0, 27648
    s_nop 0
    buffer_load_dwordx4 v57, s[16:19], s44 offen  lds
    s_mov_b32 m0, 28672
    s_nop 0
    buffer_load_dwordx4 v58, s[16:19], s44 offen  lds
    s_mov_b32 m0, 29696
    s_nop 0
    buffer_load_dwordx4 v59, s[16:19], s44 offen  lds
    s_mov_b32 m0, 30720
    s_nop 0
    buffer_load_dwordx4 v60, s[16:19], s44 offen  lds
    s_mov_b32 m0, 31744
    s_nop 0
    buffer_load_dwordx4 v61, s[16:19], s44 offen  lds
    s_mov_b32 m0, 32768
    s_nop 0
    buffer_load_dwordx4 v62, s[16:19], s44 offen  lds
    s_mov_b32 m0, 33792
    s_nop 0
    buffer_load_dwordx4 v63, s[16:19], s44 offen  lds
    s_mov_b32 m0, 34816
    s_nop 0
    buffer_load_dwordx4 v64, s[16:19], s44 offen  lds
    s_mov_b32 m0, 35840
    s_nop 0
    buffer_load_dwordx4 v65, s[16:19], s44 offen  lds
    s_add_u32 s46, s46, 1
    s_cmp_eq_u32 s46, 9
    s_cselect_b32 s46, 0, s46
    s_mul_i32 s44, s46, 2048
    s_add_u32 s44, s44, s45
    s_waitcnt vmcnt(36)
    s_barrier
    s_mov_b32 m0, 36864
    s_nop 0
    buffer_load_dwordx4 v48, s[16:19], s44 offen  lds
    s_mov_b32 m0, 37888
    s_nop 0
    buffer_load_dwordx4 v49, s[16:19], s44 offen  lds
    s_mov_b32 m0, 38912
    s_nop 0
    buffer_load_dwordx4 v50, s[16:19], s44 offen  lds
    s_mov_b32 m0, 39936
    s_nop 0
    buffer_load_dwordx4 v51, s[16:19], s44 offen  lds
    s_mov_b32 m0, 40960
    s_nop 0
    buffer_load_dwordx4 v52, s[16:19], s44 offen  lds
    s_mov_b32 m0, 41984
    s_nop 0
    buffer_load_dwordx4 v53, s[16:19], s44 offen  lds
    s_mov_b32 m0, 43008
    s_nop 0
    buffer_load_dwordx4 v54, s[16:19], s44 offen  lds
    s_mov_b32 m0, 44032
    s_nop 0
    buffer_load_dwordx4 v55, s[16:19], s44 offen  lds
    s_mov_b32 m0, 45056
    s_nop 0
    buffer_load_dwordx4 v56, s[16:19], s44 offen  lds
    s_mov_b32 m0, 46080
    s_nop 0
    buffer_load_dwordx4 v57, s[16:19], s44 offen  lds
    s_mov_b32 m0, 47104
    s_nop 0
    buffer_load_dwordx4 v58, s[16:19], s44 offen  lds
    s_mov_b32 m0, 48128
    s_nop 0
    buffer_load_dwordx4 v59, s[16:19], s44 offen  lds
    s_mov_b32 m0, 49152
    s_nop 0
    buffer_load_dwordx4 v60, s[16:19], s44 offen  lds
    s_mov_b32 m0, 50176
    s_nop 0
    buffer_load_dwordx4 v61, s[16:19], s44 offen  lds
    s_mov_b32 m0, 51200
    s_nop 0
    buffer_load_dwordx4 v62, s[16:19], s44 offen  lds
    s_mov_b32 m0, 52224
    s_nop 0
    buffer_load_dwordx4 v63, s[16:19], s44 offen  lds
    s_mov_b32 m0, 53248
    s_nop 0
    buffer_load_dwordx4 v64, s[16:19], s44 offen  lds
    s_mov_b32 m0, 54272
    s_nop 0
    buffer_load_dwordx4 v65, s[16:19], s44 offen  lds
    s_add_u32 s46, s46, 1
    s_cmp_eq_u32 s46, 9
    s_cselect_b32 s46, 0, s46
    s_mul_i32 s44, s46, 2048
    s_add_u32 s44, s44, s45
    s_waitcnt vmcnt(36)
    s_barrier
    s_mov_b32 m0, 55296
    s_nop 0
    buffer_load_dwordx4 v48, s[16:19], s44 offen  lds
    s_mov_b32 m0, 56320
    s_nop 0
    buffer_load_dwordx4 v49, s[16:19], s44 offen  lds
    s_mov_b32 m0, 57344
    s_nop 0
    buffer_load_dwordx4 v50, s[16:19], s44 offen  lds
    s_mov_b32 m0, 58368
    s_nop 0
    buffer_load_dwordx4 v51, s[16:19], s44 offen  lds
    s_mov_b32 m0, 59392
    s_nop 0
    buffer_load_dwordx4 v52, s[16:19], s44 offen  lds
    s_mov_b32 m0, 60416
    s_nop 0
    buffer_load_dwordx4 v53, s[16:19], s44 offen  lds
    s_mov_b32 m0, 61440
    s_nop 0
    buffer_load_dwordx4 v54, s[16:19], s44 offen  lds
    s_mov_b32 m0, 62464
    s_nop 0
    buffer_load_dwordx4 v55, s[16:19], s44 offen  lds
    s_mov_b32 m0, 63488
    s_nop 0
    buffer_load_dwordx4 v56, s[16:19], s44 offen  lds
    s_mov_b32 m0, 64512
    s_nop 0
    buffer_load_dwordx4 v57, s[16:19], s44 offen  lds
    s_mov_b32 m0, 65536
    s_nop 0
    buffer_load_dwordx4 v58, s[16:19], s44 offen  lds
    s_mov_b32 m0, 66560
    s_nop 0
    buffer_load_dwordx4 v59, s[16:19], s44 offen  lds
    s_mov_b32 m0, 67584
    s_nop 0
    buffer_load_dwordx4 v60, s[16:19], s44 offen  lds
    s_mov_b32 m0, 68608
    s_nop 0
    buffer_load_dwordx4 v61, s[16:19], s44 offen  lds
    s_mov_b32 m0, 69632
    s_nop 0
    buffer_load_dwordx4 v62, s[16:19], s44 offen  lds
    s_mov_b32 m0, 70656
    s_nop 0
    buffer_load_dwordx4 v63, s[16:19], s44 offen  lds
    s_mov_b32 m0, 71680
    s_nop 0
    buffer_load_dwordx4 v64, s[16:19], s44 offen  lds
    s_mov_b32 m0, 72704
    s_nop 0
    buffer_load_dwordx4 v65, s[16:19], s44 offen  lds
    s_add_u32 s46, s46, 1
    s_cmp_eq_u32 s46, 9
    s_cselect_b32 s46, 0, s46
    s_mul_i32 s44, s46, 2048
    s_add_u32 s44, s44, s45
    s_waitcnt vmcnt(36)
    s_barrier
    s_mov_b32 m0, 0
    s_nop 0
    buffer_load_dwordx4 v48, s[16:19], s44 offen  lds
    s_mov_b32 m0, 1024
    s_nop 0
    buffer_load_dwordx4 v49, s[16:19], s44 offen  lds
    s_mov_b32 m0, 2048
    s_nop 0
    buffer_load_dwordx4 v50, s[16:19], s44 offen  lds
    s_mov_b32 m0, 3072
    s_nop 0
    buffer_load_dwordx4 v51, s[16:19], s44 offen  lds
    s_mov_b32 m0, 4096
    s_nop 0
    buffer_load_dwordx4 v52, s[16:19], s44 offen  lds
    s_mov_b32 m0, 5120
    s_nop 0
    buffer_load_dwordx4 v53, s[16:19], s44 offen  lds
    s_mov_b32 m0, 6144
    s_nop 0
    buffer_load_dwordx4 v54, s[16:19], s44 offen  lds
    s_mov_b32 m0, 7168
    s_nop 0
    buffer_load_dwordx4 v55, s[16:19], s44 offen  lds
    s_mov_b32 m0, 8192
    s_nop 0
    buffer_load_dwordx4 v56, s[16:19], s44 offen  lds
    s_mov_b32 m0, 9216
    s_nop 0
    buffer_load_dwordx4 v57, s[16:19], s44 offen  lds
    s_mov_b32 m0, 10240
    s_nop 0
    buffer_load_dwordx4 v58, s[16:19], s44 offen  lds
    s_mov_b32 m0, 11264
    s_nop 0
    buffer_load_dwordx4 v59, s[16:19], s44 offen  lds
    s_mov_b32 m0, 12288
    s_nop 0
    buffer_load_dwordx4 v60, s[16:19], s44 offen  lds
    s_mov_b32 m0, 13312
    s_nop 0
    buffer_load_dwordx4 v61, s[16:19], s44 offen  lds
    s_mov_b32 m0, 14336
    s_nop 0
    buffer_load_dwordx4 v62, s[16:19], s44 offen  lds
    s_mov_b32 m0, 15360
    s_nop 0
    buffer_load_dwordx4 v63, s[16:19], s44 offen  lds
    s_mov_b32 m0, 16384
    s_nop 0
    buffer_load_dwordx4 v64, s[16:19], s44 offen  lds
    s_mov_b32 m0, 17408
    s_nop 0
    buffer_load_dwordx4 v65, s[16:19], s44 offen  lds
    s_add_u32 s46, s46, 1
    s_cmp_eq_u32 s46, 9
    s_cselect_b32 s46, 0, s46
    s_mul_i32 s44, s46, 2048
    s_add_u32 s44, s44, s45
    s_waitcnt vmcnt(36)
    s_barrier
    s_mov_b32 m0, 18432
    s_nop 0
    buffer_load_dwordx4 v48, s[16:19], s44 offen  lds
    s_mov_b32 m0, 19456
    s_nop 0
    buffer_load_dwordx4 v49, s[16:19], s44 offen  lds
    s_mov_b32 m0, 20480
    s_nop 0
    buffer_load_dwordx4 v50, s[16:19], s44 offen  lds
    s_mov_b32 m0, 21504
    s_nop 0
    buffer_load_dwordx4 v51, s[16:19], s44 offen  lds
    s_mov_b32 m0, 22528
    s_nop 0
    buffer_load_dwordx4 v52, s[16:19], s44 offen  lds
    s_mov_b32 m0, 23552
    s_nop 0
    buffer_load_dwordx4 v53, s[16:19], s44 offen  lds
    s_mov_b32 m0, 24576
    s_nop 0
    buffer_load_dwordx4 v54, s[16:19], s44 offen  lds
    s_mov_b32 m0, 25600
    s_nop 0
    buffer_load_dwordx4 v55, s[16:19], s44 offen  lds
    s_mov_b32 m0, 26624
    s_nop 0
    buffer_load_dwordx4 v56, s[16:19], s44 offen  lds
    s_mov_b32 m0, 27648
    s_nop 0
    buffer_load_dwordx4 v57, s[16:19], s44 offen  lds
    s_mov_b32 m0, 28672
    s_nop 0
    buffer_load_dwordx4 v58, s[16:19], s44 offen  lds
    s_mov_b32 m0, 29696
    s_nop 0
    buffer_load_dwordx4 v59, s[16:19], s44 offen  lds
    s_mov_b32 m0, 30720
    s_nop 0
    buffer_load_dwordx4 v60, s[16:19], s44 offen  lds
    s_mov_b32 m0, 31744
    s_nop 0
    buffer_load_dwordx4 v61, s[16:19], s44 offen  lds
    s_mov_b32 m0, 32768
    s_nop 0
    buffer_load_dwordx4 v62, s[16:19], s44 offen  lds
    s_mov_b32 m0, 33792
    s_nop 0
    buffer_load_dwordx4 v63, s[16:19], s44 offen  lds
    s_mov_b32 m0, 34816
    s_nop 0
    buffer_load_dwordx4 v64, s[16:19], s44 offen  lds
    s_mov_b32 m0, 35840
    s_nop 0
    buffer_load_dwordx4 v65, s[16:19], s44 offen  lds
    s_add_u32 s46, s46, 1
    s_cmp_eq_u32 s46, 9
    s_cselect_b32 s46, 0, s46
    s_mul_i32 s44, s46, 2048
    s_add_u32 s44, s44, s45
    v_lshrrev_b32 v3, 3, v2
    v_and_b32 v4, 7, v2
    v_lshrrev_b32 v5, 4, v2
    v_xor_b32 v4, v4, v5
    v_lshrrev_b32 v5, 2, v4
    v_and_b32 v4, 3, v4
    v_lshlrev_b32 v4, 4, v4
    v_mul_u32_u24 v6, 9216, v5
    v_xor_b32 v5, 1, v5
    v_mul_u32_u24 v5, 9216, v5
    v_add_u32 v5, v5, v4
    v_add_u32 v4, v6, v4
    v_lshrrev_b32 v6, 2, v3
    v_lshlrev_b32 v6, 3, v6
    v_and_b32 v7, 3, v3
    v_add_u32 v6, v6, v7
    v_mul_u32_u24 v6, 64, v6
    v_mul_u32_u24 v3, 64, v3
    v_add_u32 v8, v6, v4
    v_add_u32 v9, v6, v5
    v_add_u32 v10, v3, v4
    v_add_u32 v11, v3, v5
    v_mov_b32 v16, v8
    v_add_u32 v17, 0x400, v9
    v_add_u32 v18, 0x100, v8
    v_add_u32 v19, 0x500, v9
    v_add_u32 v20, 0x800, v8
    v_add_u32 v21, 0xc00, v9
    v_add_u32 v22, 0x900, v8
    v_add_u32 v23, 0xd00, v9
    v_add_u32 v24, 0x1000, v10
    v_add_u32 v25, 0x1200, v11
    v_add_u32 v26, 0x1400, v8
    v_add_u32 v27, 0x1800, v9
    v_add_u32 v28, 0x1500, v8
    v_add_u32 v29, 0x1900, v9
    v_add_u32 v30, 0x1c00, v8
    v_add_u32 v31, 0x2000, v9
    v_add_u32 v32, 0x1d00, v8
    v_add_u32 v33, 0x2100, v9
    s_waitcnt vmcnt(36)
    s_barrier
    s_waitcnt vmcnt(18)
    s_barrier
    s_waitcnt vmcnt(0)
    s_barrier
    s_waitcnt vmcnt(0)
    s_barrier
    s_add_u32 s16, s6, 0x2800000
    s_addc_u32 s17, s7, 0
    s_mov_b32 s18, 0x900000
    s_mov_b32 s19, 0x00020000
    s_mul_i32 s45, s10, 589824
    s_lshl_b32 s46, s11, 1
    s_mul_i32 s44, s46, 18432
    s_add_u32 s44, s44, s45
    s_mov_b32 m0, 36864
    s_nop 0
    buffer_load_dwordx4 v16, s[16:19], s44 offen sc1 lds
    s_mov_b32 m0, 37888
    s_nop 0
    buffer_load_dwordx4 v17, s[16:19], s44 offen sc1 lds
    s_mov_b32 m0, 38912
    s_nop 0
    buffer_load_dwordx4 v18, s[16:19], s44 offen sc1 lds
    s_mov_b32 m0, 39936
    s_nop 0
    buffer_load_dwordx4 v19, s[16:19], s44 offen sc1 lds
    s_mov_b32 m0, 40960
    s_nop 0
    buffer_load_dwordx4 v20, s[16:19], s44 offen sc1 lds
    s_mov_b32 m0, 41984
    s_nop 0
    buffer_load_dwordx4 v21, s[16:19], s44 offen sc1 lds
    s_mov_b32 m0, 43008
    s_nop 0
    buffer_load_dwordx4 v22, s[16:19], s44 offen sc1 lds
    s_mov_b32 m0, 44032
    s_nop 0
    buffer_load_dwordx4 v23, s[16:19], s44 offen sc1 lds
    s_mov_b32 m0, 45056
    s_nop 0
    buffer_load_dwordx4 v24, s[16:19], s44 offen sc1 lds
    s_mov_b32 m0, 46080
    s_nop 0
    buffer_load_dwordx4 v25, s[16:19], s44 offen sc1 lds
    s_mov_b32 m0, 47104
    s_nop 0
    buffer_load_dwordx4 v26, s[16:19], s44 offen sc1 lds
    s_mov_b32 m0, 48128
    s_nop 0
    buffer_load_dwordx4 v27, s[16:19], s44 offen sc1 lds
    s_mov_b32 m0, 49152
    s_nop 0
    buffer_load_dwordx4 v28, s[16:19], s44 offen sc1 lds
    s_mov_b32 m0, 50176
    s_nop 0
    buffer_load_dwordx4 v29, s[16:19], s44 offen sc1 lds
    s_mov_b32 m0, 51200
    s_nop 0
    buffer_load_dwordx4 v30, s[16:19], s44 offen sc1 lds
    s_mov_b32 m0, 52224
    s_nop 0
    buffer_load_dwordx4 v31, s[16:19], s44 offen sc1 lds
    s_mov_b32 m0, 53248
    s_nop 0
    buffer_load_dwordx4 v32, s[16:19], s44 offen sc1 lds
    s_mov_b32 m0, 54272
    s_nop 0
    buffer_load_dwordx4 v33, s[16:19], s44 offen sc1 lds
    s_add_u32 s46, s46, 1
    s_and_b32 s46, s46, 31
    s_mul_i32 s44, s46, 18432
    s_add_u32 s44, s44, s45
    s_mov_b32 m0, 55296
    s_nop 0
    buffer_load_dwordx4 v16, s[16:19], s44 offen sc1 lds
    s_mov_b32 m0, 56320
    s_nop 0
    buffer_load_dwordx4 v17, s[16:19], s44 offen sc1 lds
    s_mov_b32 m0, 57344
    s_nop 0
    buffer_load_dwordx4 v18, s[16:19], s44 offen sc1 lds
    s_mov_b32 m0, 58368
    s_nop 0
    buffer_load_dwordx4 v19, s[16:19], s44 offen sc1 lds
    s_mov_b32 m0, 59392
    s_nop 0
    buffer_load_dwordx4 v20, s[16:19], s44 offen sc1 lds
    s_mov_b32 m0, 60416
    s_nop 0
    buffer_load_dwordx4 v21, s[16:19], s44 offen sc1 lds
    s_mov_b32 m0, 61440
    s_nop 0
    buffer_load_dwordx4 v22, s[16:19], s44 offen sc1 lds
    s_mov_b32 m0, 62464
    s_nop 0
    buffer_load_dwordx4 v23, s[16:19], s44 offen sc1 lds
    s_mov_b32 m0, 63488
    s_nop 0
    buffer_load_dwordx4 v24, s[16:19], s44 offen sc1 lds
    s_mov_b32 m0, 64512
    s_nop 0
    buffer_load_dwordx4 v25, s[16:19], s44 offen sc1 lds
    s_mov_b32 m0, 65536
    s_nop 0
    buffer_load_dwordx4 v26, s[16:19], s44 offen sc1 lds
    s_mov_b32 m0, 66560
    s_nop 0
    buffer_load_dwordx4 v27, s[16:19], s44 offen sc1 lds
    s_mov_b32 m0, 67584
    s_nop 0
    buffer_load_dwordx4 v28, s[16:19], s44 offen sc1 lds
    s_mov_b32 m0, 68608
    s_nop 0
    buffer_load_dwordx4 v29, s[16:19], s44 offen sc1 lds
    s_mov_b32 m0, 69632
    s_nop 0
    buffer_load_dwordx4 v30, s[16:19], s44 offen sc1 lds
    s_mov_b32 m0, 70656
    s_nop 0
    buffer_load_dwordx4 v31, s[16:19], s44 offen sc1 lds
    s_mov_b32 m0, 71680
    s_nop 0
    buffer_load_dwordx4 v32, s[16:19], s44 offen sc1 lds
    s_mov_b32 m0, 72704
    s_nop 0
    buffer_load_dwordx4 v33, s[16:19], s44 offen sc1 lds
    s_add_u32 s46, s46, 1
    s_and_b32 s46, s46, 31
    s_mul_i32 s44, s46, 18432
    s_add_u32 s44, s44, s45
    s_waitcnt vmcnt(18)
    s_barrier
    s_mov_b32 m0, 0
    s_nop 0
    buffer_load_dwordx4 v16, s[16:19], s44 offen sc1 lds
    s_mov_b32 m0, 1024
    s_nop 0
    buffer_load_dwordx4 v17, s[16:19], s44 offen sc1 lds
    s_mov_b32 m0, 2048
    s_nop 0
    buffer_load_dwordx4 v18, s[16:19], s44 offen sc1 lds
    s_mov_b32 m0, 3072
    s_nop 0
    buffer_load_dwordx4 v19, s[16:19], s44 offen sc1 lds
    s_mov_b32 m0, 4096
    s_nop 0
    buffer_load_dwordx4 v20, s[16:19], s44 offen sc1 lds
    s_mov_b32 m0, 5120
    s_nop 0
    buffer_load_dwordx4 v21, s[16:19], s44 offen sc1 lds
    s_mov_b32 m0, 6144
    s_nop 0
    buffer_load_dwordx4 v22, s[16:19], s44 offen sc1 lds
    s_mov_b32 m0, 7168
    s_nop 0
    buffer_load_dwordx4 v23, s[16:19], s44 offen sc1 lds
    s_mov_b32 m0, 8192
    s_nop 0
    buffer_load_dwordx4 v24, s[16:19], s44 offen sc1 lds
    s_mov_b32 m0, 9216
    s_nop 0
    buffer_load_dwordx4 v25, s[16:19], s44 offen sc1 lds
    s_mov_b32 m0, 10240
    s_nop 0
    buffer_load_dwordx4 v26, s[16:19], s44 offen sc1 lds
    s_mov_b32 m0, 11264
    s_nop 0
    buffer_load_dwordx4 v27, s[16:19], s44 offen sc1 lds
    s_mov_b32 m0, 12288
    s_nop 0
    buffer_load_dwordx4 v28, s[16:19], s44 offen sc1 lds
    s_mov_b32 m0, 13312
    s_nop 0
    buffer_load_dwordx4 v29, s[16:19], s44 offen sc1 lds
    s_mov_b32 m0, 14336
    s_nop 0
    buffer_load_dwordx4 v30, s[16:19], s44 offen sc1 lds
    s_mov_b32 m0, 15360
    s_nop 0
    buffer_load_dwordx4 v31, s[16:19], s44 offen sc1 lds
    s_mov_b32 m0, 16384
    s_nop 0
    buffer_load_dwordx4 v32, s[16:19], s44 offen sc1 lds
    s_mov_b32 m0, 17408
    s_nop 0
    buffer_load_dwordx4 v33, s[16:19], s44 offen sc1 lds
    s_add_u32 s46, s46, 1
    s_and_b32 s46, s46, 31
    s_mul_i32 s44, s46, 18432
    s_add_u32 s44, s44, s45
    s_waitcnt vmcnt(18)
    s_barrier
    s_mov_b32 m0, 18432
    s_nop 0
    buffer_load_dwordx4 v16, s[16:19], s44 offen sc1 lds
    s_mov_b32 m0, 19456
    s_nop 0
    buffer_load_dwordx4 v17, s[16:19], s44 offen sc1 lds
    s_mov_b32 m0, 20480
    s_nop 0
    buffer_load_dwordx4 v18, s[16:19], s44 offen sc1 lds
    s_mov_b32 m0, 21504
    s_nop 0
    buffer_load_dwordx4 v19, s[16:19], s44 offen sc1 lds
    s_mov_b32 m0, 22528
    s_nop 0
    buffer_load_dwordx4 v20, s[16:19], s44 offen sc1 lds
    s_mov_b32 m0, 23552
    s_nop 0
    buffer_load_dwordx4 v21, s[16:19], s44 offen sc1 lds
    s_mov_b32 m0, 24576
    s_nop 0
    buffer_load_dwordx4 v22, s[16:19], s44 offen sc1 lds
    s_mov_b32 m0, 25600
    s_nop 0
    buffer_load_dwordx4 v23, s[16:19], s44 offen sc1 lds
    s_mov_b32 m0, 26624
    s_nop 0
    buffer_load_dwordx4 v24, s[16:19], s44 offen sc1 lds
    s_mov_b32 m0, 27648
    s_nop 0
    buffer_load_dwordx4 v25, s[16:19], s44 offen sc1 lds
    s_mov_b32 m0, 28672
    s_nop 0
    buffer_load_dwordx4 v26, s[16:19], s44 offen sc1 lds
    s_mov_b32 m0, 29696
    s_nop 0
    buffer_load_dwordx4 v27, s[16:19], s44 offen sc1 lds
    s_mov_b32 m0, 30720
    s_nop 0
    buffer_load_dwordx4 v28, s[16:19], s44 offen sc1 lds
    s_mov_b32 m0, 31744
    s_nop 0
    buffer_load_dwordx4 v29, s[16:19], s44 offen sc1 lds
    s_mov_b32 m0, 32768
    s_nop 0
    buffer_load_dwordx4 v30, s[16:19], s44 offen sc1 lds
    s_mov_b32 m0, 33792
    s_nop 0
    buffer_load_dwordx4 v31, s[16:19], s44 offen sc1 lds
    s_mov_b32 m0, 34816
    s_nop 0
    buffer_load_dwordx4 v32, s[16:19], s44 offen sc1 lds
    s_mov_b32 m0, 35840
    s_nop 0
    buffer_load_dwordx4 v33, s[16:19], s44 offen sc1 lds
    s_add_u32 s46, s46, 1
    s_and_b32 s46, s46, 31
    s_mul_i32 s44, s46, 18432
    s_add_u32 s44, s44, s45
    s_waitcnt vmcnt(18)
    s_barrier
    s_mov_b32 m0, 36864
    s_nop 0
    buffer_load_dwordx4 v16, s[16:19], s44 offen sc1 lds
    s_mov_b32 m0, 37888
    s_nop 0
    buffer_load_dwordx4 v17, s[16:19], s44 offen sc1 lds
    s_mov_b32 m0, 38912
    s_nop 0
    buffer_load_dwordx4 v18, s[16:19], s44 offen sc1 lds
    s_mov_b32 m0, 39936
    s_nop 0
    buffer_load_dwordx4 v19, s[16:19], s44 offen sc1 lds
    s_mov_b32 m0, 40960
    s_nop 0
    buffer_load_dwordx4 v20, s[16:19], s44 offen sc1 lds
    s_mov_b32 m0, 41984
    s_nop 0
    buffer_load_dwordx4 v21, s[16:19], s44 offen sc1 lds
    s_mov_b32 m0, 43008
    s_nop 0
    buffer_load_dwordx4 v22, s[16:19], s44 offen sc1 lds
    s_mov_b32 m0, 44032
    s_nop 0
    buffer_load_dwordx4 v23, s[16:19], s44 offen sc1 lds
    s_mov_b32 m0, 45056
    s_nop 0
    buffer_load_dwordx4 v24, s[16:19], s44 offen sc1 lds
    s_mov_b32 m0, 46080
    s_nop 0
    buffer_load_dwordx4 v25, s[16:19], s44 offen sc1 lds
    s_mov_b32 m0, 47104
    s_nop 0
    buffer_load_dwordx4 v26, s[16:19], s44 offen sc1 lds
    s_mov_b32 m0, 48128
    s_nop 0
    buffer_load_dwordx4 v27, s[16:19], s44 offen sc1 lds
    s_mov_b32 m0, 49152
    s_nop 0
    buffer_load_dwordx4 v28, s[16:19], s44 offen sc1 lds
    s_mov_b32 m0, 50176
    s_nop 0
    buffer_load_dwordx4 v29, s[16:19], s44 offen sc1 lds
    s_mov_b32 m0, 51200
    s_nop 0
    buffer_load_dwordx4 v30, s[16:19], s44 offen sc1 lds
    s_mov_b32 m0, 52224
    s_nop 0
    buffer_load_dwordx4 v31, s[16:19], s44 offen sc1 lds
    s_mov_b32 m0, 53248
    s_nop 0
    buffer_load_dwordx4 v32, s[16:19], s44 offen sc1 lds
    s_mov_b32 m0, 54272
    s_nop 0
    buffer_load_dwordx4 v33, s[16:19], s44 offen sc1 lds
    s_add_u32 s46, s46, 1
    s_and_b32 s46, s46, 31
    s_mul_i32 s44, s46, 18432
    s_add_u32 s44, s44, s45
    s_waitcnt vmcnt(18)
    s_barrier
    s_mov_b32 m0, 55296
    s_nop 0
    buffer_load_dwordx4 v16, s[16:19], s44 offen sc1 lds
    s_mov_b32 m0, 56320
    s_nop 0
    buffer_load_dwordx4 v17, s[16:19], s44 offen sc1 lds
    s_mov_b32 m0, 57344
    s_nop 0
    buffer_load_dwordx4 v18, s[16:19], s44 offen sc1 lds
    s_mov_b32 m0, 58368
    s_nop 0
    buffer_load_dwordx4 v19, s[16:19], s44 offen sc1 lds
    s_mov_b32 m0, 59392
    s_nop 0
    buffer_load_dwordx4 v20, s[16:19], s44 offen sc1 lds
    s_mov_b32 m0, 60416
    s_nop 0
    buffer_load_dwordx4 v21, s[16:19], s44 offen sc1 lds
    s_mov_b32 m0, 61440
    s_nop 0
    buffer_load_dwordx4 v22, s[16:19], s44 offen sc1 lds
    s_mov_b32 m0, 62464
    s_nop 0
    buffer_load_dwordx4 v23, s[16:19], s44 offen sc1 lds
    s_mov_b32 m0, 63488
    s_nop 0
    buffer_load_dwordx4 v24, s[16:19], s44 offen sc1 lds
    s_mov_b32 m0, 64512
    s_nop 0
    buffer_load_dwordx4 v25, s[16:19], s44 offen sc1 lds
    s_mov_b32 m0, 65536
    s_nop 0
    buffer_load_dwordx4 v26, s[16:19], s44 offen sc1 lds
    s_mov_b32 m0, 66560
    s_nop 0
    buffer_load_dwordx4 v27, s[16:19], s44 offen sc1 lds
    s_mov_b32 m0, 67584
    s_nop 0
    buffer_load_dwordx4 v28, s[16:19], s44 offen sc1 lds
    s_mov_b32 m0, 68608
    s_nop 0
    buffer_load_dwordx4 v29, s[16:19], s44 offen sc1 lds
    s_mov_b32 m0, 69632
    s_nop 0
    buffer_load_dwordx4 v30, s[16:19], s44 offen sc1 lds
    s_mov_b32 m0, 70656
    s_nop 0
    buffer_load_dwordx4 v31, s[16:19], s44 offen sc1 lds
    s_mov_b32 m0, 71680
    s_nop 0
    buffer_load_dwordx4 v32, s[16:19], s44 offen sc1 lds
    s_mov_b32 m0, 72704
    s_nop 0
    buffer_load_dwordx4 v33, s[16:19], s44 offen sc1 lds
    s_add_u32 s46, s46, 1
    s_and_b32 s46, s46, 31
    s_mul_i32 s44, s46, 18432
    s_add_u32 s44, s44, s45
    s_waitcnt vmcnt(18)
    s_barrier
    s_mov_b32 m0, 0
    s_nop 0
    buffer_load_dwordx4 v16, s[16:19], s44 offen sc1 lds
    s_mov_b32 m0, 1024
    s_nop 0
    buffer_load_dwordx4 v17, s[16:19], s44 offen sc1 lds
    s_mov_b32 m0, 2048
    s_nop 0
    buffer_load_dwordx4 v18, s[16:19], s44 offen sc1 lds
    s_mov_b32 m0, 3072
    s_nop 0
    buffer_load_dwordx4 v19, s[16:19], s44 offen sc1 lds
    s_mov_b32 m0, 4096
    s_nop 0
    buffer_load_dwordx4 v20, s[16:19], s44 offen sc1 lds
    s_mov_b32 m0, 5120
    s_nop 0
    buffer_load_dwordx4 v21, s[16:19], s44 offen sc1 lds
    s_mov_b32 m0, 6144
    s_nop 0
    buffer_load_dwordx4 v22, s[16:19], s44 offen sc1 lds
    s_mov_b32 m0, 7168
    s_nop 0
    buffer_load_dwordx4 v23, s[16:19], s44 offen sc1 lds
    s_mov_b32 m0, 8192
    s_nop 0
    buffer_load_dwordx4 v24, s[16:19], s44 offen sc1 lds
    s_mov_b32 m0, 9216
    s_nop 0
    buffer_load_dwordx4 v25, s[16:19], s44 offen sc1 lds
    s_mov_b32 m0, 10240
    s_nop 0
    buffer_load_dwordx4 v26, s[16:19], s44 offen sc1 lds
    s_mov_b32 m0, 11264
    s_nop 0
    buffer_load_dwordx4 v27, s[16:19], s44 offen sc1 lds
    s_mov_b32 m0, 12288
    s_nop 0
    buffer_load_dwordx4 v28, s[16:19], s44 offen sc1 lds
    s_mov_b32 m0, 13312
    s_nop 0
    buffer_load_dwordx4 v29, s[16:19], s44 offen sc1 lds
    s_mov_b32 m0, 14336
    s_nop 0
    buffer_load_dwordx4 v30, s[16:19], s44 offen sc1 lds
    s_mov_b32 m0, 15360
    s_nop 0
    buffer_load_dwordx4 v31, s[16:19], s44 offen sc1 lds
    s_mov_b32 m0, 16384
    s_nop 0
    buffer_load_dwordx4 v32, s[16:19], s44 offen sc1 lds
    s_mov_b32 m0, 17408
    s_nop 0
    buffer_load_dwordx4 v33, s[16:19], s44 offen sc1 lds
    s_add_u32 s46, s46, 1
    s_and_b32 s46, s46, 31
    s_mul_i32 s44, s46, 18432
    s_add_u32 s44, s44, s45
    s_mov_b32 m0, 18432
    s_nop 0
    buffer_load_dwordx4 v16, s[16:19], s44 offen sc1 lds
    s_mov_b32 m0, 19456
    s_nop 0
    buffer_load_dwordx4 v17, s[16:19], s44 offen sc1 lds
    s_mov_b32 m0, 20480
    s_nop 0
    buffer_load_dwordx4 v18, s[16:19], s44 offen sc1 lds
    s_mov_b32 m0, 21504
    s_nop 0
    buffer_load_dwordx4 v19, s[16:19], s44 offen sc1 lds
    s_mov_b32 m0, 22528
    s_nop 0
    buffer_load_dwordx4 v20, s[16:19], s44 offen sc1 lds
    s_mov_b32 m0, 23552
    s_nop 0
    buffer_load_dwordx4 v21, s[16:19], s44 offen sc1 lds
    s_mov_b32 m0, 24576
    s_nop 0
    buffer_load_dwordx4 v22, s[16:19], s44 offen sc1 lds
    s_mov_b32 m0, 25600
    s_nop 0
    buffer_load_dwordx4 v23, s[16:19], s44 offen sc1 lds
    s_mov_b32 m0, 26624
    s_nop 0
    buffer_load_dwordx4 v24, s[16:19], s44 offen sc1 lds
    s_mov_b32 m0, 27648
    s_nop 0
    buffer_load_dwordx4 v25, s[16:19], s44 offen sc1 lds
    s_mov_b32 m0, 28672
    s_nop 0
    buffer_load_dwordx4 v26, s[16:19], s44 offen sc1 lds
    s_mov_b32 m0, 29696
    s_nop 0
    buffer_load_dwordx4 v27, s[16:19], s44 offen sc1 lds
    s_mov_b32 m0, 30720
    s_nop 0
    buffer_load_dwordx4 v28, s[16:19], s44 offen sc1 lds
    s_mov_b32 m0, 31744
    s_nop 0
    buffer_load_dwordx4 v29, s[16:19], s44 offen sc1 lds
    s_mov_b32 m0, 32768
    s_nop 0
    buffer_load_dwordx4 v30, s[16:19], s44 offen sc1 lds
    s_mov_b32 m0, 33792
    s_nop 0
    buffer_load_dwordx4 v31, s[16:19], s44 offen sc1 lds
    s_mov_b32 m0, 34816
    s_nop 0
    buffer_load_dwordx4 v32, s[16:19], s44 offen sc1 lds
    s_mov_b32 m0, 35840
    s_nop 0
    buffer_load_dwordx4 v33, s[16:19], s44 offen sc1 lds
    s_add_u32 s46, s46, 1
    s_and_b32 s46, s46, 31
    s_mul_i32 s44, s46, 18432
    s_add_u32 s44, s44, s45
    s_mov_b32 s43, 6
lpl_mega_kernel_10:
    s_waitcnt vmcnt(36)
    s_barrier
    s_mov_b32 m0, 36864
    s_nop 0
    buffer_load_dwordx4 v16, s[16:19], s44 offen sc1 lds
    s_mov_b32 m0, 37888
    s_nop 0
    buffer_load_dwordx4 v17, s[16:19], s44 offen sc1 lds
    s_mov_b32 m0, 38912
    s_nop 0
    buffer_load_dwordx4 v18, s[16:19], s44 offen sc1 lds
    s_mov_b32 m0, 39936
    s_nop 0
    buffer_load_dwordx4 v19, s[16:19], s44 offen sc1 lds
    s_mov_b32 m0, 40960
    s_nop 0
    buffer_load_dwordx4 v20, s[16:19], s44 offen sc1 lds
    s_mov_b32 m0, 41984
    s_nop 0
    buffer_load_dwordx4 v21, s[16:19], s44 offen sc1 lds
    s_mov_b32 m0, 43008
    s_nop 0
    buffer_load_dwordx4 v22, s[16:19], s44 offen sc1 lds
    s_mov_b32 m0, 44032
    s_nop 0
    buffer_load_dwordx4 v23, s[16:19], s44 offen sc1 lds
    s_mov_b32 m0, 45056
    s_nop 0
    buffer_load_dwordx4 v24, s[16:19], s44 offen sc1 lds
    s_mov_b32 m0, 46080
    s_nop 0
    buffer_load_dwordx4 v25, s[16:19], s44 offen sc1 lds
    s_mov_b32 m0, 47104
    s_nop 0
    buffer_load_dwordx4 v26, s[16:19], s44 offen sc1 lds
    s_mov_b32 m0, 48128
    s_nop 0
    buffer_load_dwordx4 v27, s[16:19], s44 offen sc1 lds
    s_mov_b32 m0, 49152
    s_nop 0
    buffer_load_dwordx4 v28, s[16:19], s44 offen sc1 lds
    s_mov_b32 m0, 50176
    s_nop 0
    buffer_load_dwordx4 v29, s[16:19], s44 offen sc1 lds
    s_mov_b32 m0, 51200
    s_nop 0
    buffer_load_dwordx4 v30, s[16:19], s44 offen sc1 lds
    s_mov_b32 m0, 52224
    s_nop 0
    buffer_load_dwordx4 v31, s[16:19], s44 offen sc1 lds
    s_mov_b32 m0, 53248
    s_nop 0
    buffer_load_dwordx4 v32, s[16:19], s44 offen sc1 lds
    s_mov_b32 m0, 54272
    s_nop 0
    buffer_load_dwordx4 v33, s[16:19], s44 offen sc1 lds
    s_add_u32 s46, s46, 1
    s_and_b32 s46, s46, 31
    s_mul_i32 s44, s46, 18432
    s_add_u32 s44, s44, s45
    s_waitcnt vmcnt(36)
    s_barrier
    s_mov_b32 m0, 55296
    s_nop 0
    buffer_load_dwordx4 v16, s[16:19], s44 offen sc1 lds
    s_mov_b32 m0, 56320
    s_nop 0
    buffer_load_dwordx4 v17, s[16:19], s44 offen sc1 lds
    s_mov_b32 m0, 57344
    s_nop 0
    buffer_load_dwordx4 v18, s[16:19], s44 offen sc1 lds
    s_mov_b32 m0, 58368
    s_nop 0
    buffer_load_dwordx4 v19, s[16:19], s44 offen sc1 lds
    s_mov_b32 m0, 59392
    s_nop 0
    buffer_load_dwordx4 v20, s[16:19], s44 offen sc1 lds
    s_mov_b32 m0, 60416
    s_nop 0
    buffer_load_dwordx4 v21, s[16:19], s44 offen sc1 lds
    s_mov_b32 m0, 61440
    s_nop 0
    buffer_load_dwordx4 v22, s[16:19], s44 offen sc1 lds
    s_mov_b32 m0, 62464
    s_nop 0
    buffer_load_dwordx4 v23, s[16:19], s44 offen sc1 lds
    s_mov_b32 m0, 63488
    s_nop 0
    buffer_load_dwordx4 v24, s[16:19], s44 offen sc1 lds
    s_mov_b32 m0, 64512
    s_nop 0
    buffer_load_dwordx4 v25, s[16:19], s44 offen sc1 lds
    s_mov_b32 m0, 65536
    s_nop 0
    buffer_load_dwordx4 v26, s[16:19], s44 offen sc1 lds
    s_mov_b32 m0, 66560
    s_nop 0
    buffer_load_dwordx4 v27, s[16:19], s44 offen sc1 lds
    s_mov_b32 m0, 67584
    s_nop 0
    buffer_load_dwordx4 v28, s[16:19], s44 offen sc1 lds
    s_mov_b32 m0, 68608
    s_nop 0
    buffer_load_dwordx4 v29, s[16:19], s44 offen sc1 lds
    s_mov_b32 m0, 69632
    s_nop 0
    buffer_load_dwordx4 v30, s[16:19], s44 offen sc1 lds
    s_mov_b32 m0, 70656
    s_nop 0
    buffer_load_dwordx4 v31, s[16:19], s44 offen sc1 lds
    s_mov_b32 m0, 71680
    s_nop 0
    buffer_load_dwordx4 v32, s[16:19], s44 offen sc1 lds
    s_mov_b32 m0, 72704
    s_nop 0
    buffer_load_dwordx4 v33, s[16:19], s44 offen sc1 lds
    s_add_u32 s46, s46, 1
    s_and_b32 s46, s46, 31
    s_mul_i32 s44, s46, 18432
    s_add_u32 s44, s44, s45
    s_waitcnt vmcnt(36)
    s_barrier
    s_mov_b32 m0, 0
    s_nop 0
    buffer_load_dwordx4 v16, s[16:19], s44 offen sc1 lds
    s_mov_b32 m0, 1024
    s_nop 0
    buffer_load_dwordx4 v17, s[16:19], s44 offen sc1 lds
    s_mov_b32 m0, 2048
    s_nop 0
    buffer_load_dwordx4 v18, s[16:19], s44 offen sc1 lds
    s_mov_b32 m0, 3072
    s_nop 0
    buffer_load_dwordx4 v19, s[16:19], s44 offen sc1 lds
    s_mov_b32 m0, 4096
    s_nop 0
    buffer_load_dwordx4 v20, s[16:19], s44 offen sc1 lds
    s_mov_b32 m0, 5120
    s_nop 0
    buffer_load_dwordx4 v21, s[16:19], s44 offen sc1 lds
    s_mov_b32 m0, 6144
    s_nop 0
    buffer_load_dwordx4 v22, s[16:19], s44 offen sc1 lds
    s_mov_b32 m0, 7168
    s_nop 0
    buffer_load_dwordx4 v23, s[16:19], s44 offen sc1 lds
    s_mov_b32 m0, 8192
    s_nop 0
    buffer_load_dwordx4 v24, s[16:19], s44 offen sc1 lds
    s_mov_b32 m0, 9216
    s_nop 0
    buffer_load_dwordx4 v25, s[16:19], s44 offen sc1 lds
    s_mov_b32 m0, 10240
    s_nop 0
    buffer_load_dwordx4 v26, s[16:19], s44 offen sc1 lds
    s_mov_b32 m0, 11264
    s_nop 0
    buffer_load_dwordx4 v27, s[16:19], s44 offen sc1 lds
    s_mov_b32 m0, 12288
    s_nop 0
    buffer_load_dwordx4 v28, s[16:19], s44 offen sc1 lds
    s_mov_b32 m0, 13312
    s_nop 0
    buffer_load_dwordx4 v29, s[16:19], s44 offen sc1 lds
    s_mov_b32 m0, 14336
    s_nop 0
    buffer_load_dwordx4 v30, s[16:19], s44 offen sc1 lds
    s_mov_b32 m0, 15360
    s_nop 0
    buffer_load_dwordx4 v31, s[16:19], s44 offen sc1 lds
    s_mov_b32 m0, 16384
    s_nop 0
    buffer_load_dwordx4 v32, s[16:19], s44 offen sc1 lds
    s_mov_b32 m0, 17408
    s_nop 0
    buffer_load_dwordx4 v33, s[16:19], s44 offen sc1 lds
    s_add_u32 s46, s46, 1
    s_and_b32 s46, s46, 31
    s_mul_i32 s44, s46, 18432
    s_add_u32 s44, s44, s45
    s_waitcnt vmcnt(36)
    s_barrier
    s_mov_b32 m0, 18432
    s_nop 0
    buffer_load_dwordx4 v16, s[16:19], s44 offen sc1 lds
    s_mov_b32 m0, 19456
    s_nop 0
    buffer_load_dwordx4 v17, s[16:19], s44 offen sc1 lds
    s_mov_b32 m0, 20480
    s_nop 0
    buffer_load_dwordx4 v18, s[16:19], s44 offen sc1 lds
    s_mov_b32 m0, 21504
    s_nop 0
    buffer_load_dwordx4 v19, s[16:19], s44 offen sc1 lds
    s_mov_b32 m0, 22528
    s_nop 0
    buffer_load_dwordx4 v20, s[16:19], s44 offen sc1 lds
    s_mov_b32 m0, 23552
    s_nop 0
    buffer_load_dwordx4 v21, s[16:19], s44 offen sc1 lds
    s_mov_b32 m0, 24576
    s_nop 0
    buffer_load_dwordx4 v22, s[16:19], s44 offen sc1 lds
    s_mov_b32 m0, 25600
    s_nop 0
    buffer_load_dwordx4 v23, s[16:19], s44 offen sc1 lds
    s_mov_b32 m0, 26624
    s_nop 0
    buffer_load_dwordx4 v24, s[16:19], s44 offen sc1 lds
    s_mov_b32 m0, 27648
    s_nop 0
    buffer_load_dwordx4 v25, s[16:19], s44 offen sc1 lds
    s_mov_b32 m0, 28672
    s_nop 0
    buffer_load_dwordx4 v26, s[16:19], s44 offen sc1 lds
    s_mov_b32 m0, 29696
    s_nop 0
    buffer_load_dwordx4 v27, s[16:19], s44 offen sc1 lds
    s_mov_b32 m0, 30720
    s_nop 0
    buffer_load_dwordx4 v28, s[16:19], s44 offen sc1 lds
    s_mov_b32 m0, 31744
    s_nop 0
    buffer_load_dwordx4 v29, s[16:19], s44 offen sc1 lds
    s_mov_b32 m0, 32768
    s_nop 0
    buffer_load_dwordx4 v30, s[16:19], s44 offen sc1 lds
    s_mov_b32 m0, 33792
    s_nop 0
    buffer_load_dwordx4 v31, s[16:19], s44 offen sc1 lds
    s_mov_b32 m0, 34816
    s_nop 0
    buffer_load_dwordx4 v32, s[16:19], s44 offen sc1 lds
    s_mov_b32 m0, 35840
    s_nop 0
    buffer_load_dwordx4 v33, s[16:19], s44 offen sc1 lds
    s_add_u32 s46, s46, 1
    s_and_b32 s46, s46, 31
    s_mul_i32 s44, s46, 18432
    s_add_u32 s44, s44, s45
    s_sub_u32 s43, s43, 1
    s_cmp_lg_u32 s43, 0
    s_cbranch_scc1 lpl_mega_kernel_10
    v_lshrrev_b32 v3, 3, v2
    v_and_b32 v4, 7, v2
    v_lshrrev_b32 v5, 4, v2
    v_xor_b32 v4, v4, v5
    v_lshlrev_b32 v4, 4, v4
    v_xor_b32 v5, 64, v4
    v_lshrrev_b32 v6, 2, v3
    v_lshlrev_b32 v6, 3, v6
    v_and_b32 v7, 3, v3
    v_add_u32 v6, v6, v7
    v_mul_u32_u24 v6, 4608, v6
    v_mul_u32_u24 v3, 4608, v3
    v_add_u32 v8, v6, v4
    v_add_u32 v9, v6, v5
    v_add_u32 v10, v3, v4
    v_add_u32 v11, v3, v5
    v_mov_b32 v48, v8
    v_add_u32 v49, 0x12000, v9
    v_add_u32 v50, 0x4800, v8
    v_add_u32 v51, 0x16800, v9
    v_add_u32 v52, 0x24000, v8
    v_add_u32 v53, 0x36000, v9
    v_add_u32 v54, 0x28800, v8
    v_add_u32 v55, 0x3a800, v9
    v_add_u32 v56, 0x48000, v10
    s_add_u32 s16, s6, 0x1a00000
    s_addc_u32 s17, s7, 0
    s_mov_b32 s18, 0x288000
    s_mov_b32 s19, 0x00020000
    s_mul_i32 s44, s76, 4608
    s_waitcnt vmcnt(36)
    s_barrier
    s_mov_b32 m0, 36864
    s_nop 0
    buffer_load_dwordx4 v48, s[16:19], s44 offen lds
    s_mov_b32 m0, 37888
    s_nop 0
    buffer_load_dwordx4 v49, s[16:19], s44 offen lds
    s_mov_b32 m0, 38912
    s_nop 0
    buffer_load_dwordx4 v50, s[16:19], s44 offen lds
    s_mov_b32 m0, 39936
    s_nop 0
    buffer_load_dwordx4 v51, s[16:19], s44 offen lds
    s_mov_b32 m0, 40960
    s_nop 0
    buffer_load_dwordx4 v52, s[16:19], s44 offen lds
    s_mov_b32 m0, 41984
    s_nop 0
    buffer_load_dwordx4 v53, s[16:19], s44 offen lds
    s_mov_b32 m0, 43008
    s_nop 0
    buffer_load_dwordx4 v54, s[16:19], s44 offen lds
    s_mov_b32 m0, 44032
    s_nop 0
    buffer_load_dwordx4 v55, s[16:19], s44 offen lds
    s_mov_b32 m0, 45056
    s_nop 0
    buffer_load_dwordx4 v56, s[16:19], s44 offen lds
    s_add_u32 s44, s44, 128
    s_mov_b32 m0, 46080
    s_nop 0
    buffer_load_dwordx4 v48, s[16:19], s44 offen lds
    s_mov_b32 m0, 47104
    s_nop 0
    buffer_load_dwordx4 v49, s[16:19], s44 offen lds
    s_mov_b32 m0, 48128
    s_nop 0
    buffer_load_dwordx4 v50, s[16:19], s44 offen lds
    s_mov_b32 m0, 49152
    s_nop 0
    buffer_load_dwordx4 v51, s[16:19], s44 offen lds
    s_mov_b32 m0, 50176
    s_nop 0
    buffer_load_dwordx4 v52, s[16:19], s44 offen lds
    s_mov_b32 m0, 51200
    s_nop 0
    buffer_load_dwordx4 v53, s[16:19], s44 offen lds
    s_mov_b32 m0, 52224
    s_nop 0
    buffer_load_dwordx4 v54, s[16:19], s44 offen lds
    s_mov_b32 m0, 53248
    s_nop 0
    buffer_load_dwordx4 v55, s[16:19], s44 offen lds
    s_mov_b32 m0, 54272
    s_nop 0
    buffer_load_dwordx4 v56, s[16:19], s44 offen lds
    s_add_u32 s44, s44, 128
    s_waitcnt vmcnt(36)
    s_barrier
    s_mov_b32 m0, 55296
    s_nop 0
    buffer_load_dwordx4 v48, s[16:19], s44 offen lds
    s_mov_b32 m0, 56320
    s_nop 0
    buffer_load_dwordx4 v49, s[16:19], s44 offen lds
    s_mov_b32 m0, 57344
    s_nop 0
    buffer_load_dwordx4 v50, s[16:19], s44 offen lds
    s_mov_b32 m0, 58368
    s_nop 0
    buffer_load_dwordx4 v51, s[16:19], s44 offen lds
    s_mov_b32 m0, 59392
    s_nop 0
    buffer_load_dwordx4 v52, s[16:19], s44 offen lds
    s_mov_b32 m0, 60416
    s_nop 0
    buffer_load_dwordx4 v53, s[16:19], s44 offen lds
    s_mov_b32 m0, 61440
    s_nop 0
    buffer_load_dwordx4 v54, s[16:19], s44 offen lds
    s_mov_b32 m0, 62464
    s_nop 0
    buffer_load_dwordx4 v55, s[16:19], s44 offen lds
    s_mov_b32 m0, 63488
    s_nop 0
    buffer_load_dwordx4 v56, s[16:19], s44 offen lds
    s_add_u32 s44, s44, 128
    s_mov_b32 m0, 64512
    s_nop 0
    buffer_load_dwordx4 v48, s[16:19], s44 offen lds
    s_mov_b32 m0, 65536
    s_nop 0
    buffer_load_dwordx4 v49, s[16:19], s44 offen lds
    s_mov_b32 m0, 66560
    s_nop 0
    buffer_load_dwordx4 v50, s[16:19], s44 offen lds
    s_mov_b32 m0, 67584
    s_nop 0
    buffer_load_dwordx4 v51, s[16:19], s44 offen lds
    s_mov_b32 m0, 68608
    s_nop 0
    buffer_load_dwordx4 v52, s[16:19], s44 offen lds
    s_mov_b32 m0, 69632
    s_nop 0
    buffer_load_dwordx4 v53, s[16:19], s44 offen lds
    s_mov_b32 m0, 70656
    s_nop 0
    buffer_load_dwordx4 v54, s[16:19], s44 offen lds
    s_mov_b32 m0, 71680
    s_nop 0
    buffer_load_dwordx4 v55, s[16:19], s44 offen lds
    s_mov_b32 m0, 72704
    s_nop 0
    buffer_load_dwordx4 v56, s[16:19], s44 offen lds
    s_add_u32 s44, s44, 128
    s_waitcnt vmcnt(36)
    s_barrier
    s_mov_b32 m0, 0
    s_nop 0
    buffer_load_dwordx4 v48, s[16:19], s44 offen lds
    s_mov_b32 m0, 1024
    s_nop 0
    buffer_load_dwordx4 v49, s[16:19], s44 offen lds
    s_mov_b32 m0, 2048
    s_nop 0
    buffer_load_dwordx4 v50, s[16:19], s44 offen lds
    s_mov_b32 m0, 3072
    s_nop 0
    buffer_load_dwordx4 v51, s[16:19], s44 offen lds
    s_mov_b32 m0, 4096
    s_nop 0
    buffer_load_dwordx4 v52, s[16:19], s44 offen lds
    s_mov_b32 m0, 5120
    s_nop 0
    buffer_load_dwordx4 v53, s[16:19], s44 offen lds
    s_mov_b32 m0, 6144
    s_nop 0
    buffer_load_dwordx4 v54, s[16:19], s44 offen lds
    s_mov_b32 m0, 7168
    s_nop 0
    buffer_load_dwordx4 v55, s[16:19], s44 offen lds
    s_mov_b32 m0, 8192
    s_nop 0
    buffer_load_dwordx4 v56, s[16:19], s44 offen lds
    s_add_u32 s44, s44, 128
    s_mov_b32 m0, 9216
    s_nop 0
    buffer_load_dwordx4 v48, s[16:19], s44 offen lds
    s_mov_b32 m0, 10240
    s_nop 0
    buffer_load_dwordx4 v49, s[16:19], s44 offen lds
    s_mov_b32 m0, 11264
    s_nop 0
    buffer_load_dwordx4 v50, s[16:19], s44 offen lds
    s_mov_b32 m0, 12288
    s_nop 0
    buffer_load_dwordx4 v51, s[16:19], s44 offen lds
    s_mov_b32 m0, 13312
    s_nop 0
    buffer_load_dwordx4 v52, s[16:19], s44 offen lds
    s_mov_b32 m0, 14336
    s_nop 0
    buffer_load_dwordx4 v53, s[16:19], s44 offen lds
    s_mov_b32 m0, 15360
    s_nop 0
    buffer_load_dwordx4 v54, s[16:19], s44 offen lds
    s_mov_b32 m0, 16384
    s_nop 0
    buffer_load_dwordx4 v55, s[16:19], s44 offen lds
    s_mov_b32 m0, 17408
    s_nop 0
    buffer_load_dwordx4 v56, s[16:19], s44 offen lds
    s_add_u32 s44, s44, 128
    s_waitcnt vmcnt(54)
    s_mov_b32 m0, 73728
    s_nop 0
    buffer_load_dwordx4 v48, s[16:19], s44 offen lds
    s_mov_b32 m0, 74752
    s_nop 0
    buffer_load_dwordx4 v49, s[16:19], s44 offen lds
    s_mov_b32 m0, 75776
    s_nop 0
    buffer_load_dwordx4 v50, s[16:19], s44 offen lds
    s_mov_b32 m0, 76800
    s_nop 0
    buffer_load_dwordx4 v51, s[16:19], s44 offen lds
    s_mov_b32 m0, 77824
    s_nop 0
    buffer_load_dwordx4 v52, s[16:19], s44 offen lds
    s_mov_b32 m0, 78848
    s_nop 0
    buffer_load_dwordx4 v53, s[16:19], s44 offen lds
    s_mov_b32 m0, 79872
    s_nop 0
    buffer_load_dwordx4 v54, s[16:19], s44 offen lds
    s_mov_b32 m0, 80896
    s_nop 0
    buffer_load_dwordx4 v55, s[16:19], s44 offen lds
    s_mov_b32 m0, 81920
    s_nop 0
    buffer_load_dwordx4 v56, s[16:19], s44 offen lds
    s_add_u32 s44, s44, 128
    s_barrier
    s_waitcnt vmcnt(54)
    s_mov_b32 m0, 18432
    s_nop 0
    buffer_load_dwordx4 v48, s[16:19], s44 offen lds
    s_mov_b32 m0, 19456
    s_nop 0
    buffer_load_dwordx4 v49, s[16:19], s44 offen lds
    s_mov_b32 m0, 20480
    s_nop 0
    buffer_load_dwordx4 v50, s[16:19], s44 offen lds
    s_mov_b32 m0, 21504
    s_nop 0
    buffer_load_dwordx4 v51, s[16:19], s44 offen lds
    s_mov_b32 m0, 22528
    s_nop 0
    buffer_load_dwordx4 v52, s[16:19], s44 offen lds
    s_mov_b32 m0, 23552
    s_nop 0
    buffer_load_dwordx4 v53, s[16:19], s44 offen lds
    s_mov_b32 m0, 24576
    s_nop 0
    buffer_load_dwordx4 v54, s[16:19], s44 offen lds
    s_mov_b32 m0, 25600
    s_nop 0
    buffer_load_dwordx4 v55, s[16:19], s44 offen lds
    s_mov_b32 m0, 26624
    s_nop 0
    buffer_load_dwordx4 v56, s[16:19], s44 offen lds
    s_add_u32 s44, s44, 128
    s_waitcnt vmcnt(54)
    s_mov_b32 m0, 27648
    s_nop 0
    buffer_load_dwordx4 v48, s[16:19], s44 offen lds
    s_mov_b32 m0, 28672
    s_nop 0
    buffer_load_dwordx4 v49, s[16:19], s44 offen lds
    s_mov_b32 m0, 29696
    s_nop 0
    buffer_load_dwordx4 v50, s[16:19], s44 offen lds
    s_mov_b32 m0, 30720
    s_nop 0
    buffer_load_dwordx4 v51, s[16:19], s44 offen lds
    s_mov_b32 m0, 31744
    s_nop 0
    buffer_load_dwordx4 v52, s[16:19], s44 offen lds
    s_mov_b32 m0, 32768
    s_nop 0
    buffer_load_dwordx4 v53, s[16:19], s44 offen lds
    s_mov_b32 m0, 33792
    s_nop 0
    buffer_load_dwordx4 v54, s[16:19], s44 offen lds
    s_mov_b32 m0, 34816
    s_nop 0
    buffer_load_dwordx4 v55, s[16:19], s44 offen lds
    s_mov_b32 m0, 35840
    s_nop 0
    buffer_load_dwordx4 v56, s[16:19], s44 offen lds
    s_add_u32 s44, s44, 128
    s_waitcnt vmcnt(54)
    s_mov_b32 m0, 82944
    s_nop 0
    buffer_load_dwordx4 v48, s[16:19], s44 offen lds
    s_mov_b32 m0, 83968
    s_nop 0
    buffer_load_dwordx4 v49, s[16:19], s44 offen lds
    s_mov_b32 m0, 84992
    s_nop 0
    buffer_load_dwordx4 v50, s[16:19], s44 offen lds
    s_mov_b32 m0, 86016
    s_nop 0
    buffer_load_dwordx4 v51, s[16:19], s44 offen lds
    s_mov_b32 m0, 87040
    s_nop 0
    buffer_load_dwordx4 v52, s[16:19], s44 offen lds
    s_mov_b32 m0, 88064
    s_nop 0
    buffer_load_dwordx4 v53, s[16:19], s44 offen lds
    s_mov_b32 m0, 89088
    s_nop 0
    buffer_load_dwordx4 v54, s[16:19], s44 offen lds
    s_mov_b32 m0, 90112
    s_nop 0
    buffer_load_dwordx4 v55, s[16:19], s44 offen lds
    s_mov_b32 m0, 91136
    s_nop 0
    buffer_load_dwordx4 v56, s[16:19], s44 offen lds
    s_add_u32 s44, s44, 128
    s_barrier
    s_waitcnt vmcnt(63)
    s_barrier
    s_waitcnt vmcnt(54)
    s_barrier
    s_waitcnt vmcnt(54)
    s_mov_b32 m0, 36864
    s_nop 0
    buffer_load_dwordx4 v48, s[16:19], s44 offen lds
    s_mov_b32 m0, 37888
    s_nop 0
    buffer_load_dwordx4 v49, s[16:19], s44 offen lds
    s_mov_b32 m0, 38912
    s_nop 0
    buffer_load_dwordx4 v50, s[16:19], s44 offen lds
    s_mov_b32 m0, 39936
    s_nop 0
    buffer_load_dwordx4 v51, s[16:19], s44 offen lds
    s_mov_b32 m0, 40960
    s_nop 0
    buffer_load_dwordx4 v52, s[16:19], s44 offen lds
    s_mov_b32 m0, 41984
    s_nop 0
    buffer_load_dwordx4 v53, s[16:19], s44 offen lds
    s_mov_b32 m0, 43008
    s_nop 0
    buffer_load_dwordx4 v54, s[16:19], s44 offen lds
    s_mov_b32 m0, 44032
    s_nop 0
    buffer_load_dwordx4 v55, s[16:19], s44 offen lds
    s_mov_b32 m0, 45056
    s_nop 0
    buffer_load_dwordx4 v56, s[16:19], s44 offen lds
    s_add_u32 s44, s44, 128
    s_waitcnt vmcnt(54)
    s_mov_b32 m0, 46080
    s_nop 0
    buffer_load_dwordx4 v48, s[16:19], s44 offen lds
    s_mov_b32 m0, 47104
    s_nop 0
    buffer_load_dwordx4 v49, s[16:19], s44 offen lds
    s_mov_b32 m0, 48128
    s_nop 0
    buffer_load_dwordx4 v50, s[16:19], s44 offen lds
    s_mov_b32 m0, 49152
    s_nop 0
    buffer_load_dwordx4 v51, s[16:19], s44 offen lds
    s_mov_b32 m0, 50176
    s_nop 0
    buffer_load_dwordx4 v52, s[16:19], s44 offen lds
    s_mov_b32 m0, 51200
    s_nop 0
    buffer_load_dwordx4 v53, s[16:19], s44 offen lds
    s_mov_b32 m0, 52224
    s_nop 0
    buffer_load_dwordx4 v54, s[16:19], s44 offen lds
    s_mov_b32 m0, 53248
    s_nop 0
    buffer_load_dwordx4 v55, s[16:19], s44 offen lds
    s_mov_b32 m0, 54272
    s_nop 0
    buffer_load_dwordx4 v56, s[16:19], s44 offen lds
    s_add_u32 s44, s44, 128
    s_waitcnt vmcnt(54)
    s_barrier
    s_waitcnt vmcnt(54)
    s_mov_b32 m0, 55296
    s_nop 0
    buffer_load_dwordx4 v48, s[16:19], s44 offen lds
    s_mov_b32 m0, 56320
    s_nop 0
    buffer_load_dwordx4 v49, s[16:19], s44 offen lds
    s_mov_b32 m0, 57344
    s_nop 0
    buffer_load_dwordx4 v50, s[16:19], s44 offen lds
    s_mov_b32 m0, 58368
    s_nop 0
    buffer_load_dwordx4 v51, s[16:19], s44 offen lds
    s_mov_b32 m0, 59392
    s_nop 0
    buffer_load_dwordx4 v52, s[16:19], s44 offen lds
    s_mov_b32 m0, 60416
    s_nop 0
    buffer_load_dwordx4 v53, s[16:19], s44 offen lds
    s_mov_b32 m0, 61440
    s_nop 0
    buffer_load_dwordx4 v54, s[16:19], s44 offen lds
    s_mov_b32 m0, 62464
    s_nop 0
    buffer_load_dwordx4 v55, s[16:19], s44 offen lds
    s_mov_b32 m0, 63488
    s_nop 0
    buffer_load_dwordx4 v56, s[16:19], s44 offen lds
    s_add_u32 s44, s44, 128
    s_waitcnt vmcnt(54)
    s_mov_b32 m0, 64512
    s_nop 0
    buffer_load_dwordx4 v48, s[16:19], s44 offen lds
    s_mov_b32 m0, 65536
    s_nop 0
    buffer_load_dwordx4 v49, s[16:19], s44 offen lds
    s_mov_b32 m0, 66560
    s_nop 0
    buffer_load_dwordx4 v50, s[16:19], s44 offen lds
    s_mov_b32 m0, 67584
    s_nop 0
    buffer_load_dwordx4 v51, s[16:19], s44 offen lds
    s_mov_b32 m0, 68608
    s_nop 0
    buffer_load_dwordx4 v52, s[16:19], s44 offen lds
    s_mov_b32 m0, 69632
    s_nop 0
    buffer_load_dwordx4 v53, s[16:19], s44 offen lds
    s_mov_b32 m0, 70656
    s_nop 0
    buffer_load_dwordx4 v54, s[16:19], s44 offen lds
    s_mov_b32 m0, 71680
    s_nop 0
    buffer_load_dwordx4 v55, s[16:19], s44 offen lds
    s_mov_b32 m0, 72704
    s_nop 0
    buffer_load_dwordx4 v56, s[16:19], s44 offen lds
    s_add_u32 s44, s44, 128
    s_waitcnt vmcnt(54)
    s_barrier
    s_waitcnt vmcnt(54)
    s_mov_b32 m0, 0
    s_nop 0
    buffer_load_dwordx4 v48, s[16:19], s44 offen lds
    s_mov_b32 m0, 1024
    s_nop 0
    buffer_load_dwordx4 v49, s[16:19], s44 offen lds
    s_mov_b32 m0, 2048
    s_nop 0
    buffer_load_dwordx4 v50, s[16:19], s44 offen lds
    s_mov_b32 m0, 3072
    s_nop 0
    buffer_load_dwordx4 v51, s[16:19], s44 offen lds
    s_mov_b32 m0, 4096
    s_nop 0
    buffer_load_dwordx4 v52, s[16:19], s44 offen lds
    s_mov_b32 m0, 5120
    s_nop 0
    buffer_load_dwordx4 v53, s[16:19], s44 offen lds
    s_mov_b32 m0, 6144
    s_nop 0
    buffer_load_dwordx4 v54, s[16:19], s44 offen lds
    s_mov_b32 m0, 7168
    s_nop 0
    buffer_load_dwordx4 v55, s[16:19], s44 offen lds
    s_mov_b32 m0, 8192
    s_nop 0
    buffer_load_dwordx4 v56, s[16:19], s44 offen lds
    s_add_u32 s44, s44, 128
    s_waitcnt vmcnt(54)
    s_mov_b32 m0, 9216
    s_nop 0
    buffer_load_dwordx4 v48, s[16:19], s44 offen lds
    s_mov_b32 m0, 10240
    s_nop 0
    buffer_load_dwordx4 v49, s[16:19], s44 offen lds
    s_mov_b32 m0, 11264
    s_nop 0
    buffer_load_dwordx4 v50, s[16:19], s44 offen lds
    s_mov_b32 m0, 12288
    s_nop 0
    buffer_load_dwordx4 v51, s[16:19], s44 offen lds
    s_mov_b32 m0, 13312
    s_nop 0
    buffer_load_dwordx4 v52, s[16:19], s44 offen lds
    s_mov_b32 m0, 14336
    s_nop 0
    buffer_load_dwordx4 v53, s[16:19], s44 offen lds
    s_mov_b32 m0, 15360
    s_nop 0
    buffer_load_dwordx4 v54, s[16:19], s44 offen lds
    s_mov_b32 m0, 16384
    s_nop 0
    buffer_load_dwordx4 v55, s[16:19], s44 offen lds
    s_mov_b32 m0, 17408
    s_nop 0
    buffer_load_dwordx4 v56, s[16:19], s44 offen lds
    s_add_u32 s44, s44, 128
    s_waitcnt vmcnt(54)
    s_barrier
    s_waitcnt vmcnt(54)
    s_mov_b32 m0, 73728
    s_nop 0
    buffer_load_dwordx4 v48, s[16:19], s44 offen lds
    s_mov_b32 m0, 74752
    s_nop 0
    buffer_load_dwordx4 v49, s[16:19], s44 offen lds
    s_mov_b32 m0, 75776
    s_nop 0
    buffer_load_dwordx4 v50, s[16:19], s44 offen lds
    s_mov_b32 m0, 76800
    s_nop 0
    buffer_load_dwordx4 v51, s[16:19], s44 offen lds
    s_mov_b32 m0, 77824
    s_nop 0
    buffer_load_dwordx4 v52, s[16:19], s44 offen lds
    s_mov_b32 m0, 78848
    s_nop 0
    buffer_load_dwordx4 v53, s[16:19], s44 offen lds
    s_mov_b32 m0, 79872
    s_nop 0
    buffer_load_dwordx4 v54, s[16:19], s44 offen lds
    s_mov_b32 m0, 80896
    s_nop 0
    buffer_load_dwordx4 v55, s[16:19], s44 offen lds
    s_mov_b32 m0, 81920
    s_nop 0
    buffer_load_dwordx4 v56, s[16:19], s44 offen lds
    s_add_u32 s44, s44, 128
    s_waitcnt vmcnt(45)
    s_barrier
    s_waitcnt vmcnt(54)
    s_mov_b32 m0, 18432
    s_nop 0
    buffer_load_dwordx4 v48, s[16:19], s44 offen lds
    s_mov_b32 m0, 19456
    s_nop 0
    buffer_load_dwordx4 v49, s[16:19], s44 offen lds
    s_mov_b32 m0, 20480
    s_nop 0
    buffer_load_dwordx4 v50, s[16:19], s44 offen lds
    s_mov_b32 m0, 21504
    s_nop 0
    buffer_load_dwordx4 v51, s[16:19], s44 offen lds
    s_mov_b32 m0, 22528
    s_nop 0
    buffer_load_dwordx4 v52, s[16:19], s44 offen lds
    s_mov_b32 m0, 23552
    s_nop 0
    buffer_load_dwordx4 v53, s[16:19], s44 offen lds
    s_mov_b32 m0, 24576
    s_nop 0
    buffer_load_dwordx4 v54, s[16:19], s44 offen lds
    s_mov_b32 m0, 25600
    s_nop 0
    buffer_load_dwordx4 v55, s[16:19], s44 offen lds
    s_mov_b32 m0, 26624
    s_nop 0
    buffer_load_dwordx4 v56, s[16:19], s44 offen lds
    s_add_u32 s44, s44, 128
    s_waitcnt vmcnt(54)
    s_mov_b32 m0, 27648
    s_nop 0
    buffer_load_dwordx4 v48, s[16:19], s44 offen lds
    s_mov_b32 m0, 28672
    s_nop 0
    buffer_load_dwordx4 v49, s[16:19], s44 offen lds
    s_mov_b32 m0, 29696
    s_nop 0
    buffer_load_dwordx4 v50, s[16:19], s44 offen lds
    s_mov_b32 m0, 30720
    s_nop 0
    buffer_load_dwordx4 v51, s[16:19], s44 offen lds
    s_mov_b32 m0, 31744
    s_nop 0
    buffer_load_dwordx4 v52, s[16:19], s44 offen lds
    s_mov_b32 m0, 32768
    s_nop 0
    buffer_load_dwordx4 v53, s[16:19], s44 offen lds
    s_mov_b32 m0, 33792
    s_nop 0
    buffer_load_dwordx4 v54, s[16:19], s44 offen lds
    s_mov_b32 m0, 34816
    s_nop 0
    buffer_load_dwordx4 v55, s[16:19], s44 offen lds
    s_mov_b32 m0, 35840
    s_nop 0
    buffer_load_dwordx4 v56, s[16:19], s44 offen lds
    s_add_u32 s44, s44, 128
    s_waitcnt vmcnt(45)
    s_barrier
    s_waitcnt vmcnt(54)
    s_mov_b32 m0, 82944
    s_nop 0
    buffer_load_dwordx4 v48, s[16:19], s44 offen lds
    s_mov_b32 m0, 83968
    s_nop 0
    buffer_load_dwordx4 v49, s[16:19], s44 offen lds
    s_mov_b32 m0, 84992
    s_nop 0
    buffer_load_dwordx4 v50, s[16:19], s44 offen lds
    s_mov_b32 m0, 86016
    s_nop 0
    buffer_load_dwordx4 v51, s[16:19], s44 offen lds
    s_mov_b32 m0, 87040
    s_nop 0
    buffer_load_dwordx4 v52, s[16:19], s44 offen lds
    s_mov_b32 m0, 88064
    s_nop 0
    buffer_load_dwordx4 v53, s[16:19], s44 offen lds
    s_mov_b32 m0, 89088
    s_nop 0
    buffer_load_dwordx4 v54, s[16:19], s44 offen lds
    s_mov_b32 m0, 90112
    s_nop 0
    buffer_load_dwordx4 v55, s[16:19], s44 offen lds
    s_mov_b32 m0, 91136
    s_nop 0
    buffer_load_dwordx4 v56, s[16:19], s44 offen lds
    s_add_u32 s44, s44, 128
    s_waitcnt vmcnt(54)
    s_mov_b32 m0, 36864
    s_nop 0
    buffer_load_dwordx4 v48, s[16:19], s44 offen lds
    s_mov_b32 m0, 37888
    s_nop 0
    buffer_load_dwordx4 v49, s[16:19], s44 offen lds
    s_mov_b32 m0, 38912
    s_nop 0
    buffer_load_dwordx4 v50, s[16:19], s44 offen lds
    s_mov_b32 m0, 39936
    s_nop 0
    buffer_load_dwordx4 v51, s[16:19], s44 offen lds
    s_mov_b32 m0, 40960
    s_nop 0
    buffer_load_dwordx4 v52, s[16:19], s44 offen lds
    s_mov_b32 m0, 41984
    s_nop 0
    buffer_load_dwordx4 v53, s[16:19], s44 offen lds
    s_mov_b32 m0, 43008
    s_nop 0
    buffer_load_dwordx4 v54, s[16:19], s44 offen lds
    s_mov_b32 m0, 44032
    s_nop 0
    buffer_load_dwordx4 v55, s[16:19], s44 offen lds
    s_mov_b32 m0, 45056
    s_nop 0
    buffer_load_dwordx4 v56, s[16:19], s44 offen lds
    s_add_u32 s44, s44, 128
    s_waitcnt vmcnt(45)
    s_barrier
    s_waitcnt vmcnt(54)
    s_mov_b32 m0, 46080
    s_nop 0
    buffer_load_dwordx4 v48, s[16:19], s44 offen lds
    s_mov_b32 m0, 47104
    s_nop 0
    buffer_load_dwordx4 v49, s[16:19], s44 offen lds
    s_mov_b32 m0, 48128
    s_nop 0
    buffer_load_dwordx4 v50, s[16:19], s44 offen lds
    s_mov_b32 m0, 49152
    s_nop 0
    buffer_load_dwordx4 v51, s[16:19], s44 offen lds
    s_mov_b32 m0, 50176
    s_nop 0
    buffer_load_dwordx4 v52, s[16:19], s44 offen lds
    s_mov_b32 m0, 51200
    s_nop 0
    buffer_load_dwordx4 v53, s[16:19], s44 offen lds
    s_mov_b32 m0, 52224
    s_nop 0
    buffer_load_dwordx4 v54, s[16:19], s44 offen lds
    s_mov_b32 m0, 53248
    s_nop 0
    buffer_load_dwordx4 v55, s[16:19], s44 offen lds
    s_mov_b32 m0, 54272
    s_nop 0
    buffer_load_dwordx4 v56, s[16:19], s44 offen lds
    s_add_u32 s44, s44, 128
    s_waitcnt vmcnt(54)
    s_mov_b32 m0, 55296
    s_nop 0
    buffer_load_dwordx4 v48, s[16:19], s44 offen lds
    s_mov_b32 m0, 56320
    s_nop 0
    buffer_load_dwordx4 v49, s[16:19], s44 offen lds
    s_mov_b32 m0, 57344
    s_nop 0
    buffer_load_dwordx4 v50, s[16:19], s44 offen lds
    s_mov_b32 m0, 58368
    s_nop 0
    buffer_load_dwordx4 v51, s[16:19], s44 offen lds
    s_mov_b32 m0, 59392
    s_nop 0
    buffer_load_dwordx4 v52, s[16:19], s44 offen lds
    s_mov_b32 m0, 60416
    s_nop 0
    buffer_load_dwordx4 v53, s[16:19], s44 offen lds
    s_mov_b32 m0, 61440
    s_nop 0
    buffer_load_dwordx4 v54, s[16:19], s44 offen lds
    s_mov_b32 m0, 62464
    s_nop 0
    buffer_load_dwordx4 v55, s[16:19], s44 offen lds
    s_mov_b32 m0, 63488
    s_nop 0
    buffer_load_dwordx4 v56, s[16:19], s44 offen lds
    s_add_u32 s44, s44, 128
    s_waitcnt vmcnt(45)
    s_barrier
    s_waitcnt vmcnt(54)
    s_mov_b32 m0, 64512
    s_nop 0
    buffer_load_dwordx4 v48, s[16:19], s44 offen lds
    s_mov_b32 m0, 65536
    s_nop 0
    buffer_load_dwordx4 v49, s[16:19], s44 offen lds
    s_mov_b32 m0, 66560
    s_nop 0
    buffer_load_dwordx4 v50, s[16:19], s44 offen lds
    s_mov_b32 m0, 67584
    s_nop 0
    buffer_load_dwordx4 v51, s[16:19], s44 offen lds
    s_mov_b32 m0, 68608
    s_nop 0
    buffer_load_dwordx4 v52, s[16:19], s44 offen lds
    s_mov_b32 m0, 69632
    s_nop 0
    buffer_load_dwordx4 v53, s[16:19], s44 offen lds
    s_mov_b32 m0, 70656
    s_nop 0
    buffer_load_dwordx4 v54, s[16:19], s44 offen lds
    s_mov_b32 m0, 71680
    s_nop 0
    buffer_load_dwordx4 v55, s[16:19], s44 offen lds
    s_mov_b32 m0, 72704
    s_nop 0
    buffer_load_dwordx4 v56, s[16:19], s44 offen lds
    s_add_u32 s44, s44, 128
    s_waitcnt vmcnt(36)
    s_barrier
    s_waitcnt vmcnt(54)
    s_mov_b32 m0, 0
    s_nop 0
    buffer_load_dwordx4 v48, s[16:19], s44 offen lds
    s_mov_b32 m0, 1024
    s_nop 0
    buffer_load_dwordx4 v49, s[16:19], s44 offen lds
    s_mov_b32 m0, 2048
    s_nop 0
    buffer_load_dwordx4 v50, s[16:19], s44 offen lds
    s_mov_b32 m0, 3072
    s_nop 0
    buffer_load_dwordx4 v51, s[16:19], s44 offen lds
    s_mov_b32 m0, 4096
    s_nop 0
    buffer_load_dwordx4 v52, s[16:19], s44 offen lds
    s_mov_b32 m0, 5120
    s_nop 0
    buffer_load_dwordx4 v53, s[16:19], s44 offen lds
    s_mov_b32 m0, 6144
    s_nop 0
    buffer_load_dwordx4 v54, s[16:19], s44 offen lds
    s_mov_b32 m0, 7168
    s_nop 0
    buffer_load_dwordx4 v55, s[16:19], s44 offen lds
    s_mov_b32 m0, 8192
    s_nop 0
    buffer_load_dwordx4 v56, s[16:19], s44 offen lds
    s_add_u32 s44, s44, 128
    s_waitcnt vmcnt(54)
    s_mov_b32 m0, 9216
    s_nop 0
    buffer_load_dwordx4 v48, s[16:19], s44 offen lds
    s_mov_b32 m0, 10240
    s_nop 0
    buffer_load_dwordx4 v49, s[16:19], s44 offen lds
    s_mov_b32 m0, 11264
    s_nop 0
    buffer_load_dwordx4 v50, s[16:19], s44 offen lds
    s_mov_b32 m0, 12288
    s_nop 0
    buffer_load_dwordx4 v51, s[16:19], s44 offen lds
    s_mov_b32 m0, 13312
    s_nop 0
    buffer_load_dwordx4 v52, s[16:19], s44 offen lds
    s_mov_b32 m0, 14336
    s_nop 0
    buffer_load_dwordx4 v53, s[16:19], s44 offen lds
    s_mov_b32 m0, 15360
    s_nop 0
    buffer_load_dwordx4 v54, s[16:19], s44 offen lds
    s_mov_b32 m0, 16384
    s_nop 0
    buffer_load_dwordx4 v55, s[16:19], s44 offen lds
    s_mov_b32 m0, 17408
    s_nop 0
    buffer_load_dwordx4 v56, s[16:19], s44 offen lds
    s_add_u32 s44, s44, 128
    s_waitcnt vmcnt(36)
    s_barrier
    s_waitcnt vmcnt(54)
    s_mov_b32 m0, 73728
    s_nop 0
    buffer_load_dwordx4 v48, s[16:19], s44 offen lds
    s_mov_b32 m0, 74752
    s_nop 0
    buffer_load_dwordx4 v49, s[16:19], s44 offen lds
    s_mov_b32 m0, 75776
    s_nop 0
    buffer_load_dwordx4 v50, s[16:19], s44 offen lds
    s_mov_b32 m0, 76800
    s_nop 0
    buffer_load_dwordx4 v51, s[16:19], s44 offen lds
    s_mov_b32 m0, 77824
    s_nop 0
    buffer_load_dwordx4 v52, s[16:19], s44 offen lds
    s_mov_b32 m0, 78848
    s_nop 0
    buffer_load_dwordx4 v53, s[16:19], s44 offen lds
    s_mov_b32 m0, 79872
    s_nop 0
    buffer_load_dwordx4 v54, s[16:19], s44 offen lds
    s_mov_b32 m0, 80896
    s_nop 0
    buffer_load_dwordx4 v55, s[16:19], s44 offen lds
    s_mov_b32 m0, 81920
    s_nop 0
    buffer_load_dwordx4 v56, s[16:19], s44 offen lds
    s_add_u32 s44, s44, 128
    s_waitcnt vmcnt(54)
    s_mov_b32 m0, 18432
    s_nop 0
    buffer_load_dwordx4 v48, s[16:19], s44 offen lds
    s_mov_b32 m0, 19456
    s_nop 0
    buffer_load_dwordx4 v49, s[16:19], s44 offen lds
    s_mov_b32 m0, 20480
    s_nop 0
    buffer_load_dwordx4 v50, s[16:19], s44 offen lds
    s_mov_b32 m0, 21504
    s_nop 0
    buffer_load_dwordx4 v51, s[16:19], s44 offen lds
    s_mov_b32 m0, 22528
    s_nop 0
    buffer_load_dwordx4 v52, s[16:19], s44 offen lds
    s_mov_b32 m0, 23552
    s_nop 0
    buffer_load_dwordx4 v53, s[16:19], s44 offen lds
    s_mov_b32 m0, 24576
    s_nop 0
    buffer_load_dwordx4 v54, s[16:19], s44 offen lds
    s_mov_b32 m0, 25600
    s_nop 0
    buffer_load_dwordx4 v55, s[16:19], s44 offen lds
    s_mov_b32 m0, 26624
    s_nop 0
    buffer_load_dwordx4 v56, s[16:19], s44 offen lds
    s_add_u32 s44, s44, 128
    s_waitcnt vmcnt(36)
    s_barrier
    s_waitcnt vmcnt(54)
    s_mov_b32 m0, 27648
    s_nop 0
    buffer_load_dwordx4 v48, s[16:19], s44 offen lds
    s_mov_b32 m0, 28672
    s_nop 0
    buffer_load_dwordx4 v49, s[16:19], s44 offen lds
    s_mov_b32 m0, 29696
    s_nop 0
    buffer_load_dwordx4 v50, s[16:19], s44 offen lds
    s_mov_b32 m0, 30720
    s_nop 0
    buffer_load_dwordx4 v51, s[16:19], s44 offen lds
    s_mov_b32 m0, 31744
    s_nop 0
    buffer_load_dwordx4 v52, s[16:19], s44 offen lds
    s_mov_b32 m0, 32768
    s_nop 0
    buffer_load_dwordx4 v53, s[16:19], s44 offen lds
    s_mov_b32 m0, 33792
    s_nop 0
    buffer_load_dwordx4 v54, s[16:19], s44 offen lds
    s_mov_b32 m0, 34816
    s_nop 0
    buffer_load_dwordx4 v55, s[16:19], s44 offen lds
    s_mov_b32 m0, 35840
    s_nop 0
    buffer_load_dwordx4 v56, s[16:19], s44 offen lds
    s_add_u32 s44, s44, 128
    s_waitcnt vmcnt(54)
    s_mov_b32 m0, 82944
    s_nop 0
    buffer_load_dwordx4 v48, s[16:19], s44 offen lds
    s_mov_b32 m0, 83968
    s_nop 0
    buffer_load_dwordx4 v49, s[16:19], s44 offen lds
    s_mov_b32 m0, 84992
    s_nop 0
    buffer_load_dwordx4 v50, s[16:19], s44 offen lds
    s_mov_b32 m0, 86016
    s_nop 0
    buffer_load_dwordx4 v51, s[16:19], s44 offen lds
    s_mov_b32 m0, 87040
    s_nop 0
    buffer_load_dwordx4 v52, s[16:19], s44 offen lds
    s_mov_b32 m0, 88064
    s_nop 0
    buffer_load_dwordx4 v53, s[16:19], s44 offen lds
    s_mov_b32 m0, 89088
    s_nop 0
    buffer_load_dwordx4 v54, s[16:19], s44 offen lds
    s_mov_b32 m0, 90112
    s_nop 0
    buffer_load_dwordx4 v55, s[16:19], s44 offen lds
    s_mov_b32 m0, 91136
    s_nop 0
    buffer_load_dwordx4 v56, s[16:19], s44 offen lds
    s_add_u32 s44, s44, 128
    s_waitcnt vmcnt(36)
    s_barrier
    s_waitcnt vmcnt(54)
    s_mov_b32 m0, 36864
    s_nop 0
    buffer_load_dwordx4 v48, s[16:19], s44 offen lds
    s_mov_b32 m0, 37888
    s_nop 0
    buffer_load_dwordx4 v49, s[16:19], s44 offen lds
    s_mov_b32 m0, 38912
    s_nop 0
    buffer_load_dwordx4 v50, s[16:19], s44 offen lds
    s_mov_b32 m0, 39936
    s_nop 0
    buffer_load_dwordx4 v51, s[16:19], s44 offen lds
    s_mov_b32 m0, 40960
    s_nop 0
    buffer_load_dwordx4 v52, s[16:19], s44 offen lds
    s_mov_b32 m0, 41984
    s_nop 0
    buffer_load_dwordx4 v53, s[16:19], s44 offen lds
    s_mov_b32 m0, 43008
    s_nop 0
    buffer_load_dwordx4 v54, s[16:19], s44 offen lds
    s_mov_b32 m0, 44032
    s_nop 0
    buffer_load_dwordx4 v55, s[16:19], s44 offen lds
    s_mov_b32 m0, 45056
    s_nop 0
    buffer_load_dwordx4 v56, s[16:19], s44 offen lds
    s_add_u32 s44, s44, 128
    s_waitcnt vmcnt(27)
    s_barrier
    s_waitcnt vmcnt(54)
    s_mov_b32 m0, 46080
    s_nop 0
    buffer_load_dwordx4 v48, s[16:19], s44 offen lds
    s_mov_b32 m0, 47104
    s_nop 0
    buffer_load_dwordx4 v49, s[16:19], s44 offen lds
    s_mov_b32 m0, 48128
    s_nop 0
    buffer_load_dwordx4 v50, s[16:19], s44 offen lds
    s_mov_b32 m0, 49152
    s_nop 0
    buffer_load_dwordx4 v51, s[16:19], s44 offen lds
    s_mov_b32 m0, 50176
    s_nop 0
    buffer_load_dwordx4 v52, s[16:19], s44 offen lds
    s_mov_b32 m0, 51200
    s_nop 0
    buffer_load_dwordx4 v53, s[16:19], s44 offen lds
    s_mov_b32 m0, 52224
    s_nop 0
    buffer_load_dwordx4 v54, s[16:19], s44 offen lds
    s_mov_b32 m0, 53248
    s_nop 0
    buffer_load_dwordx4 v55, s[16:19], s44 offen lds
    s_mov_b32 m0, 54272
    s_nop 0
    buffer_load_dwordx4 v56, s[16:19], s44 offen lds
    s_add_u32 s44, s44, 128
    s_waitcnt vmcnt(54)
    s_mov_b32 m0, 55296
    s_nop 0
    buffer_load_dwordx4 v48, s[16:19], s44 offen lds
    s_mov_b32 m0, 56320
    s_nop 0
    buffer_load_dwordx4 v49, s[16:19], s44 offen lds
    s_mov_b32 m0, 57344
    s_nop 0
    buffer_load_dwordx4 v50, s[16:19], s44 offen lds
    s_mov_b32 m0, 58368
    s_nop 0
    buffer_load_dwordx4 v51, s[16:19], s44 offen lds
    s_mov_b32 m0, 59392
    s_nop 0
    buffer_load_dwordx4 v52, s[16:19], s44 offen lds
    s_mov_b32 m0, 60416
    s_nop 0
    buffer_load_dwordx4 v53, s[16:19], s44 offen lds
    s_mov_b32 m0, 61440
    s_nop 0
    buffer_load_dwordx4 v54, s[16:19], s44 offen lds
    s_mov_b32 m0, 62464
    s_nop 0
    buffer_load_dwordx4 v55, s[16:19], s44 offen lds
    s_mov_b32 m0, 63488
    s_nop 0
    buffer_load_dwordx4 v56, s[16:19], s44 offen lds
    s_add_u32 s44, s44, 128
    s_waitcnt vmcnt(27)
    s_barrier
    s_waitcnt vmcnt(54)
    s_mov_b32 m0, 64512
    s_nop 0
    buffer_load_dwordx4 v48, s[16:19], s44 offen lds
    s_mov_b32 m0, 65536
    s_nop 0
    buffer_load_dwordx4 v49, s[16:19], s44 offen lds
    s_mov_b32 m0, 66560
    s_nop 0
    buffer_load_dwordx4 v50, s[16:19], s44 offen lds
    s_mov_b32 m0, 67584
    s_nop 0
    buffer_load_dwordx4 v51, s[16:19], s44 offen lds
    s_mov_b32 m0, 68608
    s_nop 0
    buffer_load_dwordx4 v52, s[16:19], s44 offen lds
    s_mov_b32 m0, 69632
    s_nop 0
    buffer_load_dwordx4 v53, s[16:19], s44 offen lds
    s_mov_b32 m0, 70656
    s_nop 0
    buffer_load_dwordx4 v54, s[16:19], s44 offen lds
    s_mov_b32 m0, 71680
    s_nop 0
    buffer_load_dwordx4 v55, s[16:19], s44 offen lds
    s_mov_b32 m0, 72704
    s_nop 0
    buffer_load_dwordx4 v56, s[16:19], s44 offen lds
    s_add_u32 s44, s44, 128
    s_waitcnt vmcnt(54)
    s_mov_b32 m0, 0
    s_nop 0
    buffer_load_dwordx4 v48, s[16:19], s44 offen lds
    s_mov_b32 m0, 1024
    s_nop 0
    buffer_load_dwordx4 v49, s[16:19], s44 offen lds
    s_mov_b32 m0, 2048
    s_nop 0
    buffer_load_dwordx4 v50, s[16:19], s44 offen lds
    s_mov_b32 m0, 3072
    s_nop 0
    buffer_load_dwordx4 v51, s[16:19], s44 offen lds
    s_mov_b32 m0, 4096
    s_nop 0
    buffer_load_dwordx4 v52, s[16:19], s44 offen lds
    s_mov_b32 m0, 5120
    s_nop 0
    buffer_load_dwordx4 v53, s[16:19], s44 offen lds
    s_mov_b32 m0, 6144
    s_nop 0
    buffer_load_dwordx4 v54, s[16:19], s44 offen lds
    s_mov_b32 m0, 7168
    s_nop 0
    buffer_load_dwordx4 v55, s[16:19], s44 offen lds
    s_mov_b32 m0, 8192
    s_nop 0
    buffer_load_dwordx4 v56, s[16:19], s44 offen lds
    s_add_u32 s44, s44, 128
    s_waitcnt vmcnt(27)
    s_barrier
    s_waitcnt vmcnt(54)
    s_mov_b32 m0, 9216
    s_nop 0
    buffer_load_dwordx4 v48, s[16:19], s44 offen lds
    s_mov_b32 m0, 10240
    s_nop 0
    buffer_load_dwordx4 v49, s[16:19], s44 offen lds
    s_mov_b32 m0, 11264
    s_nop 0
    buffer_load_dwordx4 v50, s[16:19], s44 offen lds
    s_mov_b32 m0, 12288
    s_nop 0
    buffer_load_dwordx4 v51, s[16:19], s44 offen lds
    s_mov_b32 m0, 13312
    s_nop 0
    buffer_load_dwordx4 v52, s[16:19], s44 offen lds
    s_mov_b32 m0, 14336
    s_nop 0
    buffer_load_dwordx4 v53, s[16:19], s44 offen lds
    s_mov_b32 m0, 15360
    s_nop 0
    buffer_load_dwordx4 v54, s[16:19], s44 offen lds
    s_mov_b32 m0, 16384
    s_nop 0
    buffer_load_dwordx4 v55, s[16:19], s44 offen lds
    s_mov_b32 m0, 17408
    s_nop 0
    buffer_load_dwordx4 v56, s[16:19], s44 offen lds
    s_add_u32 s44, s44, 128
    s_waitcnt vmcnt(18)
    s_barrier
    s_waitcnt vmcnt(0)
    s_barrier
    s_endpgm
ldQ_mega_kernel_3:
    s_setprio 3
    s_lshl_b32 s45, s13, 1
    s_lshr_b32 s46, s10, 1
    s_lshl_b32 s44, s46, 18
    s_add_u32 s44, s44, s45
    v_lshrrev_b32 v3, 4, v2
    v_and_b32 v4, 15, v2
    v_lshlrev_b32 v5, 1, v3
    v_xor_b32 v4, v4, v5
    v_lshlrev_b32 v4, 4, v4
    v_lshl_add_u32 v4, v3, 12, v4
    v_xor_b32 v5, 128, v4
    v_add_u32 v16, 0, v4
    v_add_u32 v17, 16384, v4
    v_add_u32 v18, 32768, v5
    v_add_u32 v19, 49152, v5
    v_add_u32 v20, 65536, v4
    v_add_u32 v21, 81920, v4
    v_add_u32 v22, 98304, v5
    v_add_u32 v23, 114688, v5
    v_add_u32 v24, 131072, v4
    v_add_u32 v25, 147456, v4
    v_add_u32 v26, 163840, v5
    v_add_u32 v27, 180224, v5
    v_add_u32 v28, 196608, v4
    v_add_u32 v29, 212992, v4
    v_add_u32 v30, 229376, v5
    v_add_u32 v31, 245760, v5
    s_waitcnt lgkmcnt(0)
    s_add_u32 s16, s6, 0x4800000
    s_addc_u32 s17, s7, 0
    s_mov_b32 s18, 0x240000
    s_mov_b32 s19, 0x00020000
    s_mov_b32 m0, 73728
    s_nop 0
    buffer_load_dwordx4 v16, s[16:19], s44 offen  lds
    s_mov_b32 m0, 74752
    s_nop 0
    buffer_load_dwordx4 v17, s[16:19], s44 offen  lds
    s_mov_b32 m0, 75776
    s_nop 0
    buffer_load_dwordx4 v18, s[16:19], s44 offen  lds
    s_mov_b32 m0, 76800
    s_nop 0
    buffer_load_dwordx4 v19, s[16:19], s44 offen  lds
    s_mov_b32 m0, 77824
    s_nop 0
    buffer_load_dwordx4 v20, s[16:19], s44 offen  lds
    s_mov_b32 m0, 78848
    s_nop 0
    buffer_load_dwordx4 v21, s[16:19], s44 offen  lds
    s_mov_b32 m0, 79872
    s_nop 0
    buffer_load_dwordx4 v22, s[16:19], s44 offen  lds
    s_mov_b32 m0, 80896
    s_nop 0
    buffer_load_dwordx4 v23, s[16:19], s44 offen  lds
    s_mov_b32 m0, 81920
    s_nop 0
    buffer_load_dwordx4 v24, s[16:19], s44 offen  lds
    s_mov_b32 m0, 82944
    s_nop 0
    buffer_load_dwordx4 v25, s[16:19], s44 offen  lds
    s_mov_b32 m0, 83968
    s_nop 0
    buffer_load_dwordx4 v26, s[16:19], s44 offen  lds
    s_mov_b32 m0, 84992
    s_nop 0
    buffer_load_dwordx4 v27, s[16:19], s44 offen  lds
    s_mov_b32 m0, 86016
    s_nop 0
    buffer_load_dwordx4 v28, s[16:19], s44 offen  lds
    s_mov_b32 m0, 87040
    s_nop 0
    buffer_load_dwordx4 v29, s[16:19], s44 offen  lds
    s_mov_b32 m0, 88064
    s_nop 0
    buffer_load_dwordx4 v30, s[16:19], s44 offen  lds
    s_mov_b32 m0, 89088
    s_nop 0
    buffer_load_dwordx4 v31, s[16:19], s44 offen  lds
    s_add_u32 s46, s46, 1
    s_cmp_eq_u32 s46, 9
    s_cselect_b32 s46, 0, s46
    s_mul_i32 s44, s46, 262144
    s_add_u32 s44, s44, s45
    s_mov_b32 m0, 90112
    s_nop 0
    buffer_load_dwordx4 v16, s[16:19], s44 offen  lds
    s_mov_b32 m0, 91136
    s_nop 0
    buffer_load_dwordx4 v17, s[16:19], s44 offen  lds
    s_mov_b32 m0, 92160
    s_nop 0
    buffer_load_dwordx4 v18, s[16:19], s44 offen  lds
    s_mov_b32 m0, 93184
    s_nop 0
    buffer_load_dwordx4 v19, s[16:19], s44 offen  lds
    s_mov_b32 m0, 94208
    s_nop 0
    buffer_load_dwordx4 v20, s[16:19], s44 offen  lds
    s_mov_b32 m0, 95232
    s_nop 0
    buffer_load_dwordx4 v21, s[16:19], s44 offen  lds
    s_mov_b32 m0, 96256
    s_nop 0
    buffer_load_dwordx4 v22, s[16:19], s44 offen  lds
    s_mov_b32 m0, 97280
    s_nop 0
    buffer_load_dwordx4 v23, s[16:19], s44 offen  lds
    s_mov_b32 m0, 98304
    s_nop 0
    buffer_load_dwordx4 v24, s[16:19], s44 offen  lds
    s_mov_b32 m0, 99328
    s_nop 0
    buffer_load_dwordx4 v25, s[16:19], s44 offen  lds
    s_mov_b32 m0, 100352
    s_nop 0
    buffer_load_dwordx4 v26, s[16:19], s44 offen  lds
    s_mov_b32 m0, 101376
    s_nop 0
    buffer_load_dwordx4 v27, s[16:19], s44 offen  lds
    s_mov_b32 m0, 102400
    s_nop 0
    buffer_load_dwordx4 v28, s[16:19], s44 offen  lds
    s_mov_b32 m0, 103424
    s_nop 0
    buffer_load_dwordx4 v29, s[16:19], s44 offen  lds
    s_mov_b32 m0, 104448
    s_nop 0
    buffer_load_dwordx4 v30, s[16:19], s44 offen  lds
    s_mov_b32 m0, 105472
    s_nop 0
    buffer_load_dwordx4 v31, s[16:19], s44 offen  lds
    s_add_u32 s46, s46, 1
    s_cmp_eq_u32 s46, 9
    s_cselect_b32 s46, 0, s46
    s_mul_i32 s44, s46, 262144
    s_add_u32 s44, s44, s45
    v_lshrrev_b32 v3, 3, v2
    v_and_b32 v4, 7, v2
    v_lshrrev_b32 v5, 4, v2
    v_xor_b32 v4, v4, v5
    v_lshlrev_b32 v4, 4, v4
    v_xor_b32 v5, 64, v4
    v_lshrrev_b32 v6, 2, v3
    v_lshlrev_b32 v6, 3, v6
    v_and_b32 v7, 3, v3
    v_add_u32 v6, v6, v7
    v_mul_u32_u24 v6, 4096, v6
    v_mul_u32_u24 v3, 4096, v3
    v_add_u32 v8, v6, v4
    v_add_u32 v9, v6, v5
    v_add_u32 v10, v3, v4
    v_add_u32 v11, v3, v5
    v_mov_b32 v48, v10
    v_add_u32 v49, 0x8000, v11
    v_add_u32 v50, 0x10000, v10
    v_add_u32 v51, 0x18000, v11
    v_add_u32 v52, 0x20000, v10
    v_add_u32 v53, 0x28000, v11
    v_add_u32 v54, 0x30000, v10
    v_add_u32 v55, 0x38000, v11
    v_add_u32 v56, 0x40000, v10
    v_add_u32 v57, 0x48000, v11
    v_add_u32 v58, 0x50000, v10
    v_add_u32 v59, 0x58000, v11
    v_add_u32 v60, 0x60000, v10
    v_add_u32 v61, 0x68000, v11
    v_add_u32 v62, 0x70000, v10
    v_add_u32 v63, 0x78000, v11
    s_waitcnt vmcnt(16)
    s_barrier
    s_mov_b32 m0, 106496
    s_nop 0
    buffer_load_dwordx4 v16, s[16:19], s44 offen  lds
    s_mov_b32 m0, 107520
    s_nop 0
    buffer_load_dwordx4 v17, s[16:19], s44 offen  lds
    s_mov_b32 m0, 108544
    s_nop 0
    buffer_load_dwordx4 v18, s[16:19], s44 offen  lds
    s_mov_b32 m0, 109568
    s_nop 0
    buffer_load_dwordx4 v19, s[16:19], s44 offen  lds
    s_mov_b32 m0, 110592
    s_nop 0
    buffer_load_dwordx4 v20, s[16:19], s44 offen  lds
    s_mov_b32 m0, 111616
    s_nop 0
    buffer_load_dwordx4 v21, s[16:19], s44 offen  lds
    s_mov_b32 m0, 112640
    s_nop 0
    buffer_load_dwordx4 v22, s[16:19], s44 offen  lds
    s_mov_b32 m0, 113664
    s_nop 0
    buffer_load_dwordx4 v23, s[16:19], s44 offen  lds
    s_mov_b32 m0, 114688
    s_nop 0
    buffer_load_dwordx4 v24, s[16:19], s44 offen  lds
    s_mov_b32 m0, 115712
    s_nop 0
    buffer_load_dwordx4 v25, s[16:19], s44 offen  lds
    s_mov_b32 m0, 116736
    s_nop 0
    buffer_load_dwordx4 v26, s[16:19], s44 offen  lds
    s_mov_b32 m0, 117760
    s_nop 0
    buffer_load_dwordx4 v27, s[16:19], s44 offen  lds
    s_mov_b32 m0, 118784
    s_nop 0
    buffer_load_dwordx4 v28, s[16:19], s44 offen  lds
    s_mov_b32 m0, 119808
    s_nop 0
    buffer_load_dwordx4 v29, s[16:19], s44 offen  lds
    s_mov_b32 m0, 120832
    s_nop 0
    buffer_load_dwordx4 v30, s[16:19], s44 offen  lds
    s_mov_b32 m0, 121856
    s_nop 0
    buffer_load_dwordx4 v31, s[16:19], s44 offen  lds
    s_add_u32 s46, s46, 1
    s_cmp_eq_u32 s46, 9
    s_cselect_b32 s46, 0, s46
    s_mul_i32 s44, s46, 262144
    s_add_u32 s44, s44, s45
    s_waitcnt vmcnt(16)
    s_barrier
    s_mov_b32 m0, 122880
    s_nop 0
    buffer_load_dwordx4 v16, s[16:19], s44 offen  lds
    s_mov_b32 m0, 123904
    s_nop 0
    buffer_load_dwordx4 v17, s[16:19], s44 offen  lds
    s_mov_b32 m0, 124928
    s_nop 0
    buffer_load_dwordx4 v18, s[16:19], s44 offen  lds
    s_mov_b32 m0, 125952
    s_nop 0
    buffer_load_dwordx4 v19, s[16:19], s44 offen  lds
    s_mov_b32 m0, 126976
    s_nop 0
    buffer_load_dwordx4 v20, s[16:19], s44 offen  lds
    s_mov_b32 m0, 128000
    s_nop 0
    buffer_load_dwordx4 v21, s[16:19], s44 offen  lds
    s_mov_b32 m0, 129024
    s_nop 0
    buffer_load_dwordx4 v22, s[16:19], s44 offen  lds
    s_mov_b32 m0, 130048
    s_nop 0
    buffer_load_dwordx4 v23, s[16:19], s44 offen  lds
    s_mov_b32 m0, 131072
    s_nop 0
    buffer_load_dwordx4 v24, s[16:19], s44 offen  lds
    s_mov_b32 m0, 132096
    s_nop 0
    buffer_load_dwordx4 v25, s[16:19], s44 offen  lds
    s_mov_b32 m0, 133120
    s_nop 0
    buffer_load_dwordx4 v26, s[16:19], s44 offen  lds
    s_mov_b32 m0, 134144
    s_nop 0
    buffer_load_dwordx4 v27, s[16:19], s44 offen  lds
    s_mov_b32 m0, 135168
    s_nop 0
    buffer_load_dwordx4 v28, s[16:19], s44 offen  lds
    s_mov_b32 m0, 136192
    s_nop 0
    buffer_load_dwordx4 v29, s[16:19], s44 offen  lds
    s_mov_b32 m0, 137216
    s_nop 0
    buffer_load_dwordx4 v30, s[16:19], s44 offen  lds
    s_mov_b32 m0, 138240
    s_nop 0
    buffer_load_dwordx4 v31, s[16:19], s44 offen  lds
    s_add_u32 s46, s46, 1
    s_cmp_eq_u32 s46, 9
    s_cselect_b32 s46, 0, s46
    s_mul_i32 s44, s46, 262144
    s_add_u32 s44, s44, s45
    s_waitcnt vmcnt(16)
    s_barrier
    s_mov_b32 m0, 73728
    s_nop 0
    buffer_load_dwordx4 v16, s[16:19], s44 offen  lds
    s_mov_b32 m0, 74752
    s_nop 0
    buffer_load_dwordx4 v17, s[16:19], s44 offen  lds
    s_mov_b32 m0, 75776
    s_nop 0
    buffer_load_dwordx4 v18, s[16:19], s44 offen  lds
    s_mov_b32 m0, 76800
    s_nop 0
    buffer_load_dwordx4 v19, s[16:19], s44 offen  lds
    s_mov_b32 m0, 77824
    s_nop 0
    buffer_load_dwordx4 v20, s[16:19], s44 offen  lds
    s_mov_b32 m0, 78848
    s_nop 0
    buffer_load_dwordx4 v21, s[16:19], s44 offen  lds
    s_mov_b32 m0, 79872
    s_nop 0
    buffer_load_dwordx4 v22, s[16:19], s44 offen  lds
    s_mov_b32 m0, 80896
    s_nop 0
    buffer_load_dwordx4 v23, s[16:19], s44 offen  lds
    s_mov_b32 m0, 81920
    s_nop 0
    buffer_load_dwordx4 v24, s[16:19], s44 offen  lds
    s_mov_b32 m0, 82944
    s_nop 0
    buffer_load_dwordx4 v25, s[16:19], s44 offen  lds
    s_mov_b32 m0, 83968
    s_nop 0
    buffer_load_dwordx4 v26, s[16:19], s44 offen  lds
    s_mov_b32 m0, 84992
    s_nop 0
    buffer_load_dwordx4 v27, s[16:19], s44 offen  lds
    s_mov_b32 m0, 86016
    s_nop 0
    buffer_load_dwordx4 v28, s[16:19], s44 offen  lds
    s_mov_b32 m0, 87040
    s_nop 0
    buffer_load_dwordx4 v29, s[16:19], s44 offen  lds
    s_mov_b32 m0, 88064
    s_nop 0
    buffer_load_dwordx4 v30, s[16:19], s44 offen  lds
    s_mov_b32 m0, 89088
    s_nop 0
    buffer_load_dwordx4 v31, s[16:19], s44 offen  lds
    s_add_u32 s46, s46, 1
    s_cmp_eq_u32 s46, 9
    s_cselect_b32 s46, 0, s46
    s_mul_i32 s44, s46, 262144
    s_add_u32 s44, s44, s45
    s_waitcnt vmcnt(16)
    s_barrier
    s_mov_b32 m0, 90112
    s_nop 0
    buffer_load_dwordx4 v16, s[16:19], s44 offen  lds
    s_mov_b32 m0, 91136
    s_nop 0
    buffer_load_dwordx4 v17, s[16:19], s44 offen  lds
    s_mov_b32 m0, 92160
    s_nop 0
    buffer_load_dwordx4 v18, s[16:19], s44 offen  lds
    s_mov_b32 m0, 93184
    s_nop 0
    buffer_load_dwordx4 v19, s[16:19], s44 offen  lds
    s_mov_b32 m0, 94208
    s_nop 0
    buffer_load_dwordx4 v20, s[16:19], s44 offen  lds
    s_mov_b32 m0, 95232
    s_nop 0
    buffer_load_dwordx4 v21, s[16:19], s44 offen  lds
    s_mov_b32 m0, 96256
    s_nop 0
    buffer_load_dwordx4 v22, s[16:19], s44 offen  lds
    s_mov_b32 m0, 97280
    s_nop 0
    buffer_load_dwordx4 v23, s[16:19], s44 offen  lds
    s_mov_b32 m0, 98304
    s_nop 0
    buffer_load_dwordx4 v24, s[16:19], s44 offen  lds
    s_mov_b32 m0, 99328
    s_nop 0
    buffer_load_dwordx4 v25, s[16:19], s44 offen  lds
    s_mov_b32 m0, 100352
    s_nop 0
    buffer_load_dwordx4 v26, s[16:19], s44 offen  lds
    s_mov_b32 m0, 101376
    s_nop 0
    buffer_load_dwordx4 v27, s[16:19], s44 offen  lds
    s_mov_b32 m0, 102400
    s_nop 0
    buffer_load_dwordx4 v28, s[16:19], s44 offen  lds
    s_mov_b32 m0, 103424
    s_nop 0
    buffer_load_dwordx4 v29, s[16:19], s44 offen  lds
    s_mov_b32 m0, 104448
    s_nop 0
    buffer_load_dwordx4 v30, s[16:19], s44 offen  lds
    s_mov_b32 m0, 105472
    s_nop 0
    buffer_load_dwordx4 v31, s[16:19], s44 offen  lds
    s_add_u32 s46, s46, 1
    s_cmp_eq_u32 s46, 9
    s_cselect_b32 s46, 0, s46
    s_mul_i32 s44, s46, 262144
    s_add_u32 s44, s44, s45
    s_waitcnt vmcnt(16)
    s_barrier
    s_mov_b32 m0, 106496
    s_nop 0
    buffer_load_dwordx4 v16, s[16:19], s44 offen  lds
    s_mov_b32 m0, 107520
    s_nop 0
    buffer_load_dwordx4 v17, s[16:19], s44 offen  lds
    s_mov_b32 m0, 108544
    s_nop 0
    buffer_load_dwordx4 v18, s[16:19], s44 offen  lds
    s_mov_b32 m0, 109568
    s_nop 0
    buffer_load_dwordx4 v19, s[16:19], s44 offen  lds
    s_mov_b32 m0, 110592
    s_nop 0
    buffer_load_dwordx4 v20, s[16:19], s44 offen  lds
    s_mov_b32 m0, 111616
    s_nop 0
    buffer_load_dwordx4 v21, s[16:19], s44 offen  lds
    s_mov_b32 m0, 112640
    s_nop 0
    buffer_load_dwordx4 v22, s[16:19], s44 offen  lds
    s_mov_b32 m0, 113664
    s_nop 0
    buffer_load_dwordx4 v23, s[16:19], s44 offen  lds
    s_mov_b32 m0, 114688
    s_nop 0
    buffer_load_dwordx4 v24, s[16:19], s44 offen  lds
    s_mov_b32 m0, 115712
    s_nop 0
    buffer_load_dwordx4 v25, s[16:19], s44 offen  lds
    s_mov_b32 m0, 116736
    s_nop 0
    buffer_load_dwordx4 v26, s[16:19], s44 offen  lds
    s_mov_b32 m0, 117760
    s_nop 0
    buffer_load_dwordx4 v27, s[16:19], s44 offen  lds
    s_mov_b32 m0, 118784
    s_nop 0
    buffer_load_dwordx4 v28, s[16:19], s44 offen  lds
    s_mov_b32 m0, 119808
    s_nop 0
    buffer_load_dwordx4 v29, s[16:19], s44 offen  lds
    s_mov_b32 m0, 120832
    s_nop 0
    buffer_load_dwordx4 v30, s[16:19], s44 offen  lds
    s_mov_b32 m0, 121856
    s_nop 0
    buffer_load_dwordx4 v31, s[16:19], s44 offen  lds
    s_add_u32 s46, s46, 1
    s_cmp_eq_u32 s46, 9
    s_cselect_b32 s46, 0, s46
    s_mul_i32 s44, s46, 262144
    s_add_u32 s44, s44, s45
    s_waitcnt vmcnt(16)
    s_barrier
    s_mov_b32 m0, 122880
    s_nop 0
    buffer_load_dwordx4 v16, s[16:19], s44 offen  lds
    s_mov_b32 m0, 123904
    s_nop 0
    buffer_load_dwordx4 v17, s[16:19], s44 offen  lds
    s_mov_b32 m0, 124928
    s_nop 0
    buffer_load_dwordx4 v18, s[16:19], s44 offen  lds
    s_mov_b32 m0, 125952
    s_nop 0
    buffer_load_dwordx4 v19, s[16:19], s44 offen  lds
    s_mov_b32 m0, 126976
    s_nop 0
    buffer_load_dwordx4 v20, s[16:19], s44 offen  lds
    s_mov_b32 m0, 128000
    s_nop 0
    buffer_load_dwordx4 v21, s[16:19], s44 offen  lds
    s_mov_b32 m0, 129024
    s_nop 0
    buffer_load_dwordx4 v22, s[16:19], s44 offen  lds
    s_mov_b32 m0, 130048
    s_nop 0
    buffer_load_dwordx4 v23, s[16:19], s44 offen  lds
    s_mov_b32 m0, 131072
    s_nop 0
    buffer_load_dwordx4 v24, s[16:19], s44 offen  lds
    s_mov_b32 m0, 132096
    s_nop 0
    buffer_load_dwordx4 v25, s[16:19], s44 offen  lds
    s_mov_b32 m0, 133120
    s_nop 0
    buffer_load_dwordx4 v26, s[16:19], s44 offen  lds
    s_mov_b32 m0, 134144
    s_nop 0
    buffer_load_dwordx4 v27, s[16:19], s44 offen  lds
    s_mov_b32 m0, 135168
    s_nop 0
    buffer_load_dwordx4 v28, s[16:19], s44 offen  lds
    s_mov_b32 m0, 136192
    s_nop 0
    buffer_load_dwordx4 v29, s[16:19], s44 offen  lds
    s_mov_b32 m0, 137216
    s_nop 0
    buffer_load_dwordx4 v30, s[16:19], s44 offen  lds
    s_mov_b32 m0, 138240
    s_nop 0
    buffer_load_dwordx4 v31, s[16:19], s44 offen  lds
    s_add_u32 s46, s46, 1
    s_cmp_eq_u32 s46, 9
    s_cselect_b32 s46, 0, s46
    s_mul_i32 s44, s46, 262144
    s_add_u32 s44, s44, s45
    s_waitcnt vmcnt(16)
    s_barrier
    s_mov_b32 m0, 73728
    s_nop 0
    buffer_load_dwordx4 v16, s[16:19], s44 offen  lds
    s_mov_b32 m0, 74752
    s_nop 0
    buffer_load_dwordx4 v17, s[16:19], s44 offen  lds
    s_mov_b32 m0, 75776
    s_nop 0
    buffer_load_dwordx4 v18, s[16:19], s44 offen  lds
    s_mov_b32 m0, 76800
    s_nop 0
    buffer_load_dwordx4 v19, s[16:19], s44 offen  lds
    s_mov_b32 m0, 77824
    s_nop 0
    buffer_load_dwordx4 v20, s[16:19], s44 offen  lds
    s_mov_b32 m0, 78848
    s_nop 0
    buffer_load_dwordx4 v21, s[16:19], s44 offen  lds
    s_mov_b32 m0, 79872
    s_nop 0
    buffer_load_dwordx4 v22, s[16:19], s44 offen  lds
    s_mov_b32 m0, 80896
    s_nop 0
    buffer_load_dwordx4 v23, s[16:19], s44 offen  lds
    s_mov_b32 m0, 81920
    s_nop 0
    buffer_load_dwordx4 v24, s[16:19], s44 offen  lds
    s_mov_b32 m0, 82944
    s_nop 0
    buffer_load_dwordx4 v25, s[16:19], s44 offen  lds
    s_mov_b32 m0, 83968
    s_nop 0
    buffer_load_dwordx4 v26, s[16:19], s44 offen  lds
    s_mov_b32 m0, 84992
    s_nop 0
    buffer_load_dwordx4 v27, s[16:19], s44 offen  lds
    s_mov_b32 m0, 86016
    s_nop 0
    buffer_load_dwordx4 v28, s[16:19], s44 offen  lds
    s_mov_b32 m0, 87040
    s_nop 0
    buffer_load_dwordx4 v29, s[16:19], s44 offen  lds
    s_mov_b32 m0, 88064
    s_nop 0
    buffer_load_dwordx4 v30, s[16:19], s44 offen  lds
    s_mov_b32 m0, 89088
    s_nop 0
    buffer_load_dwordx4 v31, s[16:19], s44 offen  lds
    s_add_u32 s46, s46, 1
    s_cmp_eq_u32 s46, 9
    s_cselect_b32 s46, 0, s46
    s_mul_i32 s44, s46, 262144
    s_add_u32 s44, s44, s45
    s_waitcnt vmcnt(16)
    s_barrier
    s_mov_b32 m0, 90112
    s_nop 0
    buffer_load_dwordx4 v16, s[16:19], s44 offen  lds
    s_mov_b32 m0, 91136
    s_nop 0
    buffer_load_dwordx4 v17, s[16:19], s44 offen  lds
    s_mov_b32 m0, 92160
    s_nop 0
    buffer_load_dwordx4 v18, s[16:19], s44 offen  lds
    s_mov_b32 m0, 93184
    s_nop 0
    buffer_load_dwordx4 v19, s[16:19], s44 offen  lds
    s_mov_b32 m0, 94208
    s_nop 0
    buffer_load_dwordx4 v20, s[16:19], s44 offen  lds
    s_mov_b32 m0, 95232
    s_nop 0
    buffer_load_dwordx4 v21, s[16:19], s44 offen  lds
    s_mov_b32 m0, 96256
    s_nop 0
    buffer_load_dwordx4 v22, s[16:19], s44 offen  lds
    s_mov_b32 m0, 97280
    s_nop 0
    buffer_load_dwordx4 v23, s[16:19], s44 offen  lds
    s_mov_b32 m0, 98304
    s_nop 0
    buffer_load_dwordx4 v24, s[16:19], s44 offen  lds
    s_mov_b32 m0, 99328
    s_nop 0
    buffer_load_dwordx4 v25, s[16:19], s44 offen  lds
    s_mov_b32 m0, 100352
    s_nop 0
    buffer_load_dwordx4 v26, s[16:19], s44 offen  lds
    s_mov_b32 m0, 101376
    s_nop 0
    buffer_load_dwordx4 v27, s[16:19], s44 offen  lds
    s_mov_b32 m0, 102400
    s_nop 0
    buffer_load_dwordx4 v28, s[16:19], s44 offen  lds
    s_mov_b32 m0, 103424
    s_nop 0
    buffer_load_dwordx4 v29, s[16:19], s44 offen  lds
    s_mov_b32 m0, 104448
    s_nop 0
    buffer_load_dwordx4 v30, s[16:19], s44 offen  lds
    s_mov_b32 m0, 105472
    s_nop 0
    buffer_load_dwordx4 v31, s[16:19], s44 offen  lds
    s_add_u32 s46, s46, 1
    s_cmp_eq_u32 s46, 9
    s_cselect_b32 s46, 0, s46
    s_mul_i32 s44, s46, 262144
    s_add_u32 s44, s44, s45
    s_waitcnt vmcnt(16)
    s_barrier
    s_mov_b32 m0, 106496
    s_nop 0
    buffer_load_dwordx4 v16, s[16:19], s44 offen  lds
    s_mov_b32 m0, 107520
    s_nop 0
    buffer_load_dwordx4 v17, s[16:19], s44 offen  lds
    s_mov_b32 m0, 108544
    s_nop 0
    buffer_load_dwordx4 v18, s[16:19], s44 offen  lds
    s_mov_b32 m0, 109568
    s_nop 0
    buffer_load_dwordx4 v19, s[16:19], s44 offen  lds
    s_mov_b32 m0, 110592
    s_nop 0
    buffer_load_dwordx4 v20, s[16:19], s44 offen  lds
    s_mov_b32 m0, 111616
    s_nop 0
    buffer_load_dwordx4 v21, s[16:19], s44 offen  lds
    s_mov_b32 m0, 112640
    s_nop 0
    buffer_load_dwordx4 v22, s[16:19], s44 offen  lds
    s_mov_b32 m0, 113664
    s_nop 0
    buffer_load_dwordx4 v23, s[16:19], s44 offen  lds
    s_mov_b32 m0, 114688
    s_nop 0
    buffer_load_dwordx4 v24, s[16:19], s44 offen  lds
    s_mov_b32 m0, 115712
    s_nop 0
    buffer_load_dwordx4 v25, s[16:19], s44 offen  lds
    s_mov_b32 m0, 116736
    s_nop 0
    buffer_load_dwordx4 v26, s[16:19], s44 offen  lds
    s_mov_b32 m0, 117760
    s_nop 0
    buffer_load_dwordx4 v27, s[16:19], s44 offen  lds
    s_mov_b32 m0, 118784
    s_nop 0
    buffer_load_dwordx4 v28, s[16:19], s44 offen  lds
    s_mov_b32 m0, 119808
    s_nop 0
    buffer_load_dwordx4 v29, s[16:19], s44 offen  lds
    s_mov_b32 m0, 120832
    s_nop 0
    buffer_load_dwordx4 v30, s[16:19], s44 offen  lds
    s_mov_b32 m0, 121856
    s_nop 0
    buffer_load_dwordx4 v31, s[16:19], s44 offen  lds
    s_add_u32 s46, s46, 1
    s_cmp_eq_u32 s46, 9
    s_cselect_b32 s46, 0, s46
    s_mul_i32 s44, s46, 262144
    s_add_u32 s44, s44, s45
    s_waitcnt vmcnt(16)
    s_barrier
    s_mov_b32 m0, 122880
    s_nop 0
    buffer_load_dwordx4 v16, s[16:19], s44 offen  lds
    s_mov_b32 m0, 123904
    s_nop 0
    buffer_load_dwordx4 v17, s[16:19], s44 offen  lds
    s_mov_b32 m0, 124928
    s_nop 0
    buffer_load_dwordx4 v18, s[16:19], s44 offen  lds
    s_mov_b32 m0, 125952
    s_nop 0
    buffer_load_dwordx4 v19, s[16:19], s44 offen  lds
    s_mov_b32 m0, 126976
    s_nop 0
    buffer_load_dwordx4 v20, s[16:19], s44 offen  lds
    s_mov_b32 m0, 128000
    s_nop 0
    buffer_load_dwordx4 v21, s[16:19], s44 offen  lds
    s_mov_b32 m0, 129024
    s_nop 0
    buffer_load_dwordx4 v22, s[16:19], s44 offen  lds
    s_mov_b32 m0, 130048
    s_nop 0
    buffer_load_dwordx4 v23, s[16:19], s44 offen  lds
    s_mov_b32 m0, 131072
    s_nop 0
    buffer_load_dwordx4 v24, s[16:19], s44 offen  lds
    s_mov_b32 m0, 132096
    s_nop 0
    buffer_load_dwordx4 v25, s[16:19], s44 offen  lds
    s_mov_b32 m0, 133120
    s_nop 0
    buffer_load_dwordx4 v26, s[16:19], s44 offen  lds
    s_mov_b32 m0, 134144
    s_nop 0
    buffer_load_dwordx4 v27, s[16:19], s44 offen  lds
    s_mov_b32 m0, 135168
    s_nop 0
    buffer_load_dwordx4 v28, s[16:19], s44 offen  lds
    s_mov_b32 m0, 136192
    s_nop 0
    buffer_load_dwordx4 v29, s[16:19], s44 offen  lds
    s_mov_b32 m0, 137216
    s_nop 0
    buffer_load_dwordx4 v30, s[16:19], s44 offen  lds
    s_mov_b32 m0, 138240
    s_nop 0
    buffer_load_dwordx4 v31, s[16:19], s44 offen  lds
    s_add_u32 s46, s46, 1
    s_cmp_eq_u32 s46, 9
    s_cselect_b32 s46, 0, s46
    s_mul_i32 s44, s46, 262144
    s_add_u32 s44, s44, s45
    s_waitcnt vmcnt(32)
    s_mov_b32 m0, 73728
    s_nop 0
    buffer_load_dwordx4 v16, s[16:19], s44 offen  lds
    s_mov_b32 m0, 74752
    s_nop 0
    buffer_load_dwordx4 v17, s[16:19], s44 offen  lds
    s_mov_b32 m0, 75776
    s_nop 0
    buffer_load_dwordx4 v18, s[16:19], s44 offen  lds
    s_mov_b32 m0, 76800
    s_nop 0
    buffer_load_dwordx4 v19, s[16:19], s44 offen  lds
    s_mov_b32 m0, 77824
    s_nop 0
    buffer_load_dwordx4 v20, s[16:19], s44 offen  lds
    s_mov_b32 m0, 78848
    s_nop 0
    buffer_load_dwordx4 v21, s[16:19], s44 offen  lds
    s_mov_b32 m0, 79872
    s_nop 0
    buffer_load_dwordx4 v22, s[16:19], s44 offen  lds
    s_mov_b32 m0, 80896
    s_nop 0
    buffer_load_dwordx4 v23, s[16:19], s44 offen  lds
    s_mov_b32 m0, 81920
    s_nop 0
    buffer_load_dwordx4 v24, s[16:19], s44 offen  lds
    s_mov_b32 m0, 82944
    s_nop 0
    buffer_load_dwordx4 v25, s[16:19], s44 offen  lds
    s_mov_b32 m0, 83968
    s_nop 0
    buffer_load_dwordx4 v26, s[16:19], s44 offen  lds
    s_mov_b32 m0, 84992
    s_nop 0
    buffer_load_dwordx4 v27, s[16:19], s44 offen  lds
    s_mov_b32 m0, 86016
    s_nop 0
    buffer_load_dwordx4 v28, s[16:19], s44 offen  lds
    s_mov_b32 m0, 87040
    s_nop 0
    buffer_load_dwordx4 v29, s[16:19], s44 offen  lds
    s_mov_b32 m0, 88064
    s_nop 0
    buffer_load_dwordx4 v30, s[16:19], s44 offen  lds
    s_mov_b32 m0, 89088
    s_nop 0
    buffer_load_dwordx4 v31, s[16:19], s44 offen  lds
    s_add_u32 s46, s46, 1
    s_cmp_eq_u32 s46, 9
    s_cselect_b32 s46, 0, s46
    s_mul_i32 s44, s46, 262144
    s_add_u32 s44, s44, s45
    v_lshrrev_b32 v3, 3, v2
    v_and_b32 v4, 7, v2
    v_lshrrev_b32 v5, 4, v2
    v_xor_b32 v4, v4, v5
    v_xor_b32 v6, 0, v4
    v_add_u32 v7, 0, v3
    v_lshrrev_b32 v8, 2, v6
    v_lshlrev_b32 v8, 10, v8
    v_lshl_add_u32 v8, v7, 6, v8
    v_and_b32 v9, 3, v6
    v_lshl_add_u32 v80, v9, 4, v8
    v_lshrrev_b32 v8, 1, v6
    v_mul_u32_u24 v8, 4608, v8
    v_lshl_add_u32 v8, v7, 5, v8
    v_and_b32 v9, 1, v6
    v_lshl_add_u32 v8, v9, 4, v8
    v_add_u32 v82, 4096, v8
    v_xor_b32 v6, 4, v4
    v_add_u32 v7, 8, v3
    v_lshrrev_b32 v8, 2, v6
    v_lshlrev_b32 v8, 10, v8
    v_lshl_add_u32 v8, v7, 6, v8
    v_and_b32 v9, 3, v6
    v_lshl_add_u32 v81, v9, 4, v8
    v_lshrrev_b32 v8, 1, v6
    v_mul_u32_u24 v8, 4608, v8
    v_lshl_add_u32 v8, v7, 5, v8
    v_and_b32 v9, 1, v6
    v_lshl_add_u32 v8, v9, 4, v8
    v_add_u32 v83, 4096, v8
    s_barrier
    s_waitcnt vmcnt(32)
    s_barrier
    s_mov_b32 m0, 90112
    s_nop 0
    buffer_load_dwordx4 v16, s[16:19], s44 offen  lds
    s_mov_b32 m0, 91136
    s_nop 0
    buffer_load_dwordx4 v17, s[16:19], s44 offen  lds
    s_mov_b32 m0, 92160
    s_nop 0
    buffer_load_dwordx4 v18, s[16:19], s44 offen  lds
    s_mov_b32 m0, 93184
    s_nop 0
    buffer_load_dwordx4 v19, s[16:19], s44 offen  lds
    s_mov_b32 m0, 94208
    s_nop 0
    buffer_load_dwordx4 v20, s[16:19], s44 offen  lds
    s_mov_b32 m0, 95232
    s_nop 0
    buffer_load_dwordx4 v21, s[16:19], s44 offen  lds
    s_mov_b32 m0, 96256
    s_nop 0
    buffer_load_dwordx4 v22, s[16:19], s44 offen  lds
    s_mov_b32 m0, 97280
    s_nop 0
    buffer_load_dwordx4 v23, s[16:19], s44 offen  lds
    s_mov_b32 m0, 98304
    s_nop 0
    buffer_load_dwordx4 v24, s[16:19], s44 offen  lds
    s_mov_b32 m0, 99328
    s_nop 0
    buffer_load_dwordx4 v25, s[16:19], s44 offen  lds
    s_mov_b32 m0, 100352
    s_nop 0
    buffer_load_dwordx4 v26, s[16:19], s44 offen  lds
    s_mov_b32 m0, 101376
    s_nop 0
    buffer_load_dwordx4 v27, s[16:19], s44 offen  lds
    s_mov_b32 m0, 102400
    s_nop 0
    buffer_load_dwordx4 v28, s[16:19], s44 offen  lds
    s_mov_b32 m0, 103424
    s_nop 0
    buffer_load_dwordx4 v29, s[16:19], s44 offen  lds
    s_mov_b32 m0, 104448
    s_nop 0
    buffer_load_dwordx4 v30, s[16:19], s44 offen  lds
    s_mov_b32 m0, 105472
    s_nop 0
    buffer_load_dwordx4 v31, s[16:19], s44 offen  lds
    s_add_u32 s46, s46, 1
    s_cmp_eq_u32 s46, 9
    s_cselect_b32 s46, 0, s46
    s_mul_i32 s44, s46, 262144
    s_add_u32 s44, s44, s45
    s_waitcnt vmcnt(32)
    s_barrier
    s_mov_b32 m0, 106496
    s_nop 0
    buffer_load_dwordx4 v16, s[16:19], s44 offen  lds
    s_mov_b32 m0, 107520
    s_nop 0
    buffer_load_dwordx4 v17, s[16:19], s44 offen  lds
    s_mov_b32 m0, 108544
    s_nop 0
    buffer_load_dwordx4 v18, s[16:19], s44 offen  lds
    s_mov_b32 m0, 109568
    s_nop 0
    buffer_load_dwordx4 v19, s[16:19], s44 offen  lds
    s_mov_b32 m0, 110592
    s_nop 0
    buffer_load_dwordx4 v20, s[16:19], s44 offen  lds
    s_mov_b32 m0, 111616
    s_nop 0
    buffer_load_dwordx4 v21, s[16:19], s44 offen  lds
    s_mov_b32 m0, 112640
    s_nop 0
    buffer_load_dwordx4 v22, s[16:19], s44 offen  lds
    s_mov_b32 m0, 113664
    s_nop 0
    buffer_load_dwordx4 v23, s[16:19], s44 offen  lds
    s_mov_b32 m0, 114688
    s_nop 0
    buffer_load_dwordx4 v24, s[16:19], s44 offen  lds
    s_mov_b32 m0, 115712
    s_nop 0
    buffer_load_dwordx4 v25, s[16:19], s44 offen  lds
    s_mov_b32 m0, 116736
    s_nop 0
    buffer_load_dwordx4 v26, s[16:19], s44 offen  lds
    s_mov_b32 m0, 117760
    s_nop 0
    buffer_load_dwordx4 v27, s[16:19], s44 offen  lds
    s_mov_b32 m0, 118784
    s_nop 0
    buffer_load_dwordx4 v28, s[16:19], s44 offen  lds
    s_mov_b32 m0, 119808
    s_nop 0
    buffer_load_dwordx4 v29, s[16:19], s44 offen  lds
    s_mov_b32 m0, 120832
    s_nop 0
    buffer_load_dwordx4 v30, s[16:19], s44 offen  lds
    s_mov_b32 m0, 121856
    s_nop 0
    buffer_load_dwordx4 v31, s[16:19], s44 offen  lds
    s_add_u32 s46, s46, 1
    s_cmp_eq_u32 s46, 9
    s_cselect_b32 s46, 0, s46
    s_mul_i32 s44, s46, 262144
    s_add_u32 s44, s44, s45
    s_waitcnt vmcnt(32)
    s_barrier
    s_mov_b32 m0, 122880
    s_nop 0
    buffer_load_dwordx4 v16, s[16:19], s44 offen  lds
    s_mov_b32 m0, 123904
    s_nop 0
    buffer_load_dwordx4 v17, s[16:19], s44 offen  lds
    s_mov_b32 m0, 124928
    s_nop 0
    buffer_load_dwordx4 v18, s[16:19], s44 offen  lds
    s_mov_b32 m0, 125952
    s_nop 0
    buffer_load_dwordx4 v19, s[16:19], s44 offen  lds
    s_mov_b32 m0, 126976
    s_nop 0
    buffer_load_dwordx4 v20, s[16:19], s44 offen  lds
    s_mov_b32 m0, 128000
    s_nop 0
    buffer_load_dwordx4 v21, s[16:19], s44 offen  lds
    s_mov_b32 m0, 129024
    s_nop 0
    buffer_load_dwordx4 v22, s[16:19], s44 offen  lds
    s_mov_b32 m0, 130048
    s_nop 0
    buffer_load_dwordx4 v23, s[16:19], s44 offen  lds
    s_mov_b32 m0, 131072
    s_nop 0
    buffer_load_dwordx4 v24, s[16:19], s44 offen  lds
    s_mov_b32 m0, 132096
    s_nop 0
    buffer_load_dwordx4 v25, s[16:19], s44 offen  lds
    s_mov_b32 m0, 133120
    s_nop 0
    buffer_load_dwordx4 v26, s[16:19], s44 offen  lds
    s_mov_b32 m0, 134144
    s_nop 0
    buffer_load_dwordx4 v27, s[16:19], s44 offen  lds
    s_mov_b32 m0, 135168
    s_nop 0
    buffer_load_dwordx4 v28, s[16:19], s44 offen  lds
    s_mov_b32 m0, 136192
    s_nop 0
    buffer_load_dwordx4 v29, s[16:19], s44 offen  lds
    s_mov_b32 m0, 137216
    s_nop 0
    buffer_load_dwordx4 v30, s[16:19], s44 offen  lds
    s_mov_b32 m0, 138240
    s_nop 0
    buffer_load_dwordx4 v31, s[16:19], s44 offen  lds
    s_add_u32 s46, s46, 1
    s_cmp_eq_u32 s46, 9
    s_cselect_b32 s46, 0, s46
    s_mul_i32 s44, s46, 262144
    s_add_u32 s44, s44, s45
    s_waitcnt vmcnt(32)
    s_barrier
    s_mov_b32 m0, 73728
    s_nop 0
    buffer_load_dwordx4 v16, s[16:19], s44 offen  lds
    s_mov_b32 m0, 74752
    s_nop 0
    buffer_load_dwordx4 v17, s[16:19], s44 offen  lds
    s_mov_b32 m0, 75776
    s_nop 0
    buffer_load_dwordx4 v18, s[16:19], s44 offen  lds
    s_mov_b32 m0, 76800
    s_nop 0
    buffer_load_dwordx4 v19, s[16:19], s44 offen  lds
    s_mov_b32 m0, 77824
    s_nop 0
    buffer_load_dwordx4 v20, s[16:19], s44 offen  lds
    s_mov_b32 m0, 78848
    s_nop 0
    buffer_load_dwordx4 v21, s[16:19], s44 offen  lds
    s_mov_b32 m0, 79872
    s_nop 0
    buffer_load_dwordx4 v22, s[16:19], s44 offen  lds
    s_mov_b32 m0, 80896
    s_nop 0
    buffer_load_dwordx4 v23, s[16:19], s44 offen  lds
    s_mov_b32 m0, 81920
    s_nop 0
    buffer_load_dwordx4 v24, s[16:19], s44 offen  lds
    s_mov_b32 m0, 82944
    s_nop 0
    buffer_load_dwordx4 v25, s[16:19], s44 offen  lds
    s_mov_b32 m0, 83968
    s_nop 0
    buffer_load_dwordx4 v26, s[16:19], s44 offen  lds
    s_mov_b32 m0, 84992
    s_nop 0
    buffer_load_dwordx4 v27, s[16:19], s44 offen  lds
    s_mov_b32 m0, 86016
    s_nop 0
    buffer_load_dwordx4 v28, s[16:19], s44 offen  lds
    s_mov_b32 m0, 87040
    s_nop 0
    buffer_load_dwordx4 v29, s[16:19], s44 offen  lds
    s_mov_b32 m0, 88064
    s_nop 0
    buffer_load_dwordx4 v30, s[16:19], s44 offen  lds
    s_mov_b32 m0, 89088
    s_nop 0
    buffer_load_dwordx4 v31, s[16:19], s44 offen  lds
    s_add_u32 s46, s46, 1
    s_cmp_eq_u32 s46, 9
    s_cselect_b32 s46, 0, s46
    s_mul_i32 s44, s46, 262144
    s_add_u32 s44, s44, s45
    s_waitcnt vmcnt(32)
    s_barrier
    s_mov_b32 m0, 90112
    s_nop 0
    buffer_load_dwordx4 v16, s[16:19], s44 offen  lds
    s_mov_b32 m0, 91136
    s_nop 0
    buffer_load_dwordx4 v17, s[16:19], s44 offen  lds
    s_mov_b32 m0, 92160
    s_nop 0
    buffer_load_dwordx4 v18, s[16:19], s44 offen  lds
    s_mov_b32 m0, 93184
    s_nop 0
    buffer_load_dwordx4 v19, s[16:19], s44 offen  lds
    s_mov_b32 m0, 94208
    s_nop 0
    buffer_load_dwordx4 v20, s[16:19], s44 offen  lds
    s_mov_b32 m0, 95232
    s_nop 0
    buffer_load_dwordx4 v21, s[16:19], s44 offen  lds
    s_mov_b32 m0, 96256
    s_nop 0
    buffer_load_dwordx4 v22, s[16:19], s44 offen  lds
    s_mov_b32 m0, 97280
    s_nop 0
    buffer_load_dwordx4 v23, s[16:19], s44 offen  lds
    s_mov_b32 m0, 98304
    s_nop 0
    buffer_load_dwordx4 v24, s[16:19], s44 offen  lds
    s_mov_b32 m0, 99328
    s_nop 0
    buffer_load_dwordx4 v25, s[16:19], s44 offen  lds
    s_mov_b32 m0, 100352
    s_nop 0
    buffer_load_dwordx4 v26, s[16:19], s44 offen  lds
    s_mov_b32 m0, 101376
    s_nop 0
    buffer_load_dwordx4 v27, s[16:19], s44 offen  lds
    s_mov_b32 m0, 102400
    s_nop 0
    buffer_load_dwordx4 v28, s[16:19], s44 offen  lds
    s_mov_b32 m0, 103424
    s_nop 0
    buffer_load_dwordx4 v29, s[16:19], s44 offen  lds
    s_mov_b32 m0, 104448
    s_nop 0
    buffer_load_dwordx4 v30, s[16:19], s44 offen  lds
    s_mov_b32 m0, 105472
    s_nop 0
    buffer_load_dwordx4 v31, s[16:19], s44 offen  lds
    s_add_u32 s46, s46, 1
    s_cmp_eq_u32 s46, 9
    s_cselect_b32 s46, 0, s46
    s_mul_i32 s44, s46, 262144
    s_add_u32 s44, s44, s45
    s_mov_b32 s16, s72
    s_mov_b32 s17, s73
    s_mov_b32 s18, 0x800000
    s_mov_b32 s19, 0x00020000
    s_lshl_b32 s45, s13, 12
    s_lshl_b32 s46, s11, 8
    s_add_u32 s44, s45, s46
    s_waitcnt vmcnt(32)
    s_barrier
    s_mov_b32 m0, 106496
    s_nop 0
    buffer_load_dwordx4 v48, s[16:19], s44 offen  lds
    s_mov_b32 m0, 107520
    s_nop 0
    buffer_load_dwordx4 v49, s[16:19], s44 offen  lds
    s_mov_b32 m0, 108544
    s_nop 0
    buffer_load_dwordx4 v50, s[16:19], s44 offen  lds
    s_mov_b32 m0, 109568
    s_nop 0
    buffer_load_dwordx4 v51, s[16:19], s44 offen  lds
    s_mov_b32 m0, 110592
    s_nop 0
    buffer_load_dwordx4 v52, s[16:19], s44 offen  lds
    s_mov_b32 m0, 111616
    s_nop 0
    buffer_load_dwordx4 v53, s[16:19], s44 offen  lds
    s_mov_b32 m0, 112640
    s_nop 0
    buffer_load_dwordx4 v54, s[16:19], s44 offen  lds
    s_mov_b32 m0, 113664
    s_nop 0
    buffer_load_dwordx4 v55, s[16:19], s44 offen  lds
    s_mov_b32 m0, 114688
    s_nop 0
    buffer_load_dwordx4 v56, s[16:19], s44 offen  lds
    s_mov_b32 m0, 115712
    s_nop 0
    buffer_load_dwordx4 v57, s[16:19], s44 offen  lds
    s_mov_b32 m0, 116736
    s_nop 0
    buffer_load_dwordx4 v58, s[16:19], s44 offen  lds
    s_mov_b32 m0, 117760
    s_nop 0
    buffer_load_dwordx4 v59, s[16:19], s44 offen  lds
    s_mov_b32 m0, 118784
    s_nop 0
    buffer_load_dwordx4 v60, s[16:19], s44 offen  lds
    s_mov_b32 m0, 119808
    s_nop 0
    buffer_load_dwordx4 v61, s[16:19], s44 offen  lds
    s_mov_b32 m0, 120832
    s_nop 0
    buffer_load_dwordx4 v62, s[16:19], s44 offen  lds
    s_mov_b32 m0, 121856
    s_nop 0
    buffer_load_dwordx4 v63, s[16:19], s44 offen  lds
    s_add_u32 s46, s46, 128
    s_and_b32 s46, s46, 4095
    s_add_u32 s44, s45, s46
    s_waitcnt vmcnt(32)
    s_barrier
    s_mov_b32 m0, 122880
    s_nop 0
    buffer_load_dwordx4 v48, s[16:19], s44 offen  lds
    s_mov_b32 m0, 123904
    s_nop 0
    buffer_load_dwordx4 v49, s[16:19], s44 offen  lds
    s_mov_b32 m0, 124928
    s_nop 0
    buffer_load_dwordx4 v50, s[16:19], s44 offen  lds
    s_mov_b32 m0, 125952
    s_nop 0
    buffer_load_dwordx4 v51, s[16:19], s44 offen  lds
    s_mov_b32 m0, 126976
    s_nop 0
    buffer_load_dwordx4 v52, s[16:19], s44 offen  lds
    s_mov_b32 m0, 128000
    s_nop 0
    buffer_load_dwordx4 v53, s[16:19], s44 offen  lds
    s_mov_b32 m0, 129024
    s_nop 0
    buffer_load_dwordx4 v54, s[16:19], s44 offen  lds
    s_mov_b32 m0, 130048
    s_nop 0
    buffer_load_dwordx4 v55, s[16:19], s44 offen  lds
    s_mov_b32 m0, 131072
    s_nop 0
    buffer_load_dwordx4 v56, s[16:19], s44 offen  lds
    s_mov_b32 m0, 132096
    s_nop 0
    buffer_load_dwordx4 v57, s[16:19], s44 offen  lds
    s_mov_b32 m0, 133120
    s_nop 0
    buffer_load_dwordx4 v58, s[16:19], s44 offen  lds
    s_mov_b32 m0, 134144
    s_nop 0
    buffer_load_dwordx4 v59, s[16:19], s44 offen  lds
    s_mov_b32 m0, 135168
    s_nop 0
    buffer_load_dwordx4 v60, s[16:19], s44 offen  lds
    s_mov_b32 m0, 136192
    s_nop 0
    buffer_load_dwordx4 v61, s[16:19], s44 offen  lds
    s_mov_b32 m0, 137216
    s_nop 0
    buffer_load_dwordx4 v62, s[16:19], s44 offen  lds
    s_mov_b32 m0, 138240
    s_nop 0
    buffer_load_dwordx4 v63, s[16:19], s44 offen  lds
    s_add_u32 s46, s46, 128
    s_and_b32 s46, s46, 4095
    s_add_u32 s44, s45, s46
    s_waitcnt vmcnt(32)
    s_barrier
    s_mov_b32 m0, 73728
    s_nop 0
    buffer_load_dwordx4 v48, s[16:19], s44 offen  lds
    s_mov_b32 m0, 74752
    s_nop 0
    buffer_load_dwordx4 v49, s[16:19], s44 offen  lds
    s_mov_b32 m0, 75776
    s_nop 0
    buffer_load_dwordx4 v50, s[16:19], s44 offen  lds
    s_mov_b32 m0, 76800
    s_nop 0
    buffer_load_dwordx4 v51, s[16:19], s44 offen  lds
    s_mov_b32 m0, 77824
    s_nop 0
    buffer_load_dwordx4 v52, s[16:19], s44 offen  lds
    s_mov_b32 m0, 78848
    s_nop 0
    buffer_load_dwordx4 v53, s[16:19], s44 offen  lds
    s_mov_b32 m0, 79872
    s_nop 0
    buffer_load_dwordx4 v54, s[16:19], s44 offen  lds
    s_mov_b32 m0, 80896
    s_nop 0
    buffer_load_dwordx4 v55, s[16:19], s44 offen  lds
    s_mov_b32 m0, 81920
    s_nop 0
    buffer_load_dwordx4 v56, s[16:19], s44 offen  lds
    s_mov_b32 m0, 82944
    s_nop 0
    buffer_load_dwordx4 v57, s[16:19], s44 offen  lds
    s_mov_b32 m0, 83968
    s_nop 0
    buffer_load_dwordx4 v58, s[16:19], s44 offen  lds
    s_mov_b32 m0, 84992
    s_nop 0
    buffer_load_dwordx4 v59, s[16:19], s44 offen  lds
    s_mov_b32 m0, 86016
    s_nop 0
    buffer_load_dwordx4 v60, s[16:19], s44 offen  lds
    s_mov_b32 m0, 87040
    s_nop 0
    buffer_load_dwordx4 v61, s[16:19], s44 offen  lds
    s_mov_b32 m0, 88064
    s_nop 0
    buffer_load_dwordx4 v62, s[16:19], s44 offen  lds
    s_mov_b32 m0, 89088
    s_nop 0
    buffer_load_dwordx4 v63, s[16:19], s44 offen  lds
    s_add_u32 s46, s46, 128
    s_and_b32 s46, s46, 4095
    s_add_u32 s44, s45, s46
    s_barrier
    s_waitcnt vmcnt(32)
    s_mov_b32 m0, 90112
    s_nop 0
    buffer_load_dwordx4 v48, s[16:19], s44 offen  lds
    s_mov_b32 m0, 91136
    s_nop 0
    buffer_load_dwordx4 v49, s[16:19], s44 offen  lds
    s_mov_b32 m0, 92160
    s_nop 0
    buffer_load_dwordx4 v50, s[16:19], s44 offen  lds
    s_mov_b32 m0, 93184
    s_nop 0
    buffer_load_dwordx4 v51, s[16:19], s44 offen  lds
    s_mov_b32 m0, 94208
    s_nop 0
    buffer_load_dwordx4 v52, s[16:19], s44 offen  lds
    s_mov_b32 m0, 95232
    s_nop 0
    buffer_load_dwordx4 v53, s[16:19], s44 offen  lds
    s_mov_b32 m0, 96256
    s_nop 0
    buffer_load_dwordx4 v54, s[16:19], s44 offen  lds
    s_mov_b32 m0, 97280
    s_nop 0
    buffer_load_dwordx4 v55, s[16:19], s44 offen  lds
    s_mov_b32 m0, 98304
    s_nop 0
    buffer_load_dwordx4 v56, s[16:19], s44 offen  lds
    s_mov_b32 m0, 99328
    s_nop 0
    buffer_load_dwordx4 v57, s[16:19], s44 offen  lds
    s_mov_b32 m0, 100352
    s_nop 0
    buffer_load_dwordx4 v58, s[16:19], s44 offen  lds
    s_mov_b32 m0, 101376
    s_nop 0
    buffer_load_dwordx4 v59, s[16:19], s44 offen  lds
    s_mov_b32 m0, 102400
    s_nop 0
    buffer_load_dwordx4 v60, s[16:19], s44 offen  lds
    s_mov_b32 m0, 103424
    s_nop 0
    buffer_load_dwordx4 v61, s[16:19], s44 offen  lds
    s_mov_b32 m0, 104448
    s_nop 0
    buffer_load_dwordx4 v62, s[16:19], s44 offen  lds
    s_mov_b32 m0, 105472
    s_nop 0
    buffer_load_dwordx4 v63, s[16:19], s44 offen  lds
    s_add_u32 s46, s46, 128
    s_and_b32 s46, s46, 4095
    s_add_u32 s44, s45, s46
    s_barrier
    s_mov_b32 s43, 7
lpl_mega_kernel_11:
    s_waitcnt vmcnt(32)
    s_barrier
    s_mov_b32 m0, 106496
    s_nop 0
    buffer_load_dwordx4 v48, s[16:19], s44 offen  lds
    s_mov_b32 m0, 107520
    s_nop 0
    buffer_load_dwordx4 v49, s[16:19], s44 offen  lds
    s_mov_b32 m0, 108544
    s_nop 0
    buffer_load_dwordx4 v50, s[16:19], s44 offen  lds
    s_mov_b32 m0, 109568
    s_nop 0
    buffer_load_dwordx4 v51, s[16:19], s44 offen  lds
    s_mov_b32 m0, 110592
    s_nop 0
    buffer_load_dwordx4 v52, s[16:19], s44 offen  lds
    s_mov_b32 m0, 111616
    s_nop 0
    buffer_load_dwordx4 v53, s[16:19], s44 offen  lds
    s_mov_b32 m0, 112640
    s_nop 0
    buffer_load_dwordx4 v54, s[16:19], s44 offen  lds
    s_mov_b32 m0, 113664
    s_nop 0
    buffer_load_dwordx4 v55, s[16:19], s44 offen  lds
    s_mov_b32 m0, 114688
    s_nop 0
    buffer_load_dwordx4 v56, s[16:19], s44 offen  lds
    s_mov_b32 m0, 115712
    s_nop 0
    buffer_load_dwordx4 v57, s[16:19], s44 offen  lds
    s_mov_b32 m0, 116736
    s_nop 0
    buffer_load_dwordx4 v58, s[16:19], s44 offen  lds
    s_mov_b32 m0, 117760
    s_nop 0
    buffer_load_dwordx4 v59, s[16:19], s44 offen  lds
    s_mov_b32 m0, 118784
    s_nop 0
    buffer_load_dwordx4 v60, s[16:19], s44 offen  lds
    s_mov_b32 m0, 119808
    s_nop 0
    buffer_load_dwordx4 v61, s[16:19], s44 offen  lds
    s_mov_b32 m0, 120832
    s_nop 0
    buffer_load_dwordx4 v62, s[16:19], s44 offen  lds
    s_mov_b32 m0, 121856
    s_nop 0
    buffer_load_dwordx4 v63, s[16:19], s44 offen  lds
    s_add_u32 s46, s46, 128
    s_and_b32 s46, s46, 4095
    s_add_u32 s44, s45, s46
    s_waitcnt vmcnt(32)
    s_barrier
    s_mov_b32 m0, 122880
    s_nop 0
    buffer_load_dwordx4 v48, s[16:19], s44 offen  lds
    s_mov_b32 m0, 123904
    s_nop 0
    buffer_load_dwordx4 v49, s[16:19], s44 offen  lds
    s_mov_b32 m0, 124928
    s_nop 0
    buffer_load_dwordx4 v50, s[16:19], s44 offen  lds
    s_mov_b32 m0, 125952
    s_nop 0
    buffer_load_dwordx4 v51, s[16:19], s44 offen  lds
    s_mov_b32 m0, 126976
    s_nop 0
    buffer_load_dwordx4 v52, s[16:19], s44 offen  lds
    s_mov_b32 m0, 128000
    s_nop 0
    buffer_load_dwordx4 v53, s[16:19], s44 offen  lds
    s_mov_b32 m0, 129024
    s_nop 0
    buffer_load_dwordx4 v54, s[16:19], s44 offen  lds
    s_mov_b32 m0, 130048
    s_nop 0
    buffer_load_dwordx4 v55, s[16:19], s44 offen  lds
    s_mov_b32 m0, 131072
    s_nop 0
    buffer_load_dwordx4 v56, s[16:19], s44 offen  lds
    s_mov_b32 m0, 132096
    s_nop 0
    buffer_load_dwordx4 v57, s[16:19], s44 offen  lds
    s_mov_b32 m0, 133120
    s_nop 0
    buffer_load_dwordx4 v58, s[16:19], s44 offen  lds
    s_mov_b32 m0, 134144
    s_nop 0
    buffer_load_dwordx4 v59, s[16:19], s44 offen  lds
    s_mov_b32 m0, 135168
    s_nop 0
    buffer_load_dwordx4 v60, s[16:19], s44 offen  lds
    s_mov_b32 m0, 136192
    s_nop 0
    buffer_load_dwordx4 v61, s[16:19], s44 offen  lds
    s_mov_b32 m0, 137216
    s_nop 0
    buffer_load_dwordx4 v62, s[16:19], s44 offen  lds
    s_mov_b32 m0, 138240
    s_nop 0
    buffer_load_dwordx4 v63, s[16:19], s44 offen  lds
    s_add_u32 s46, s46, 128
    s_and_b32 s46, s46, 4095
    s_add_u32 s44, s45, s46
    s_waitcnt vmcnt(32)
    s_barrier
    s_mov_b32 m0, 73728
    s_nop 0
    buffer_load_dwordx4 v48, s[16:19], s44 offen  lds
    s_mov_b32 m0, 74752
    s_nop 0
    buffer_load_dwordx4 v49, s[16:19], s44 offen  lds
    s_mov_b32 m0, 75776
    s_nop 0
    buffer_load_dwordx4 v50, s[16:19], s44 offen  lds
    s_mov_b32 m0, 76800
    s_nop 0
    buffer_load_dwordx4 v51, s[16:19], s44 offen  lds
    s_mov_b32 m0, 77824
    s_nop 0
    buffer_load_dwordx4 v52, s[16:19], s44 offen  lds
    s_mov_b32 m0, 78848
    s_nop 0
    buffer_load_dwordx4 v53, s[16:19], s44 offen  lds
    s_mov_b32 m0, 79872
    s_nop 0
    buffer_load_dwordx4 v54, s[16:19], s44 offen  lds
    s_mov_b32 m0, 80896
    s_nop 0
    buffer_load_dwordx4 v55, s[16:19], s44 offen  lds
    s_mov_b32 m0, 81920
    s_nop 0
    buffer_load_dwordx4 v56, s[16:19], s44 offen  lds
    s_mov_b32 m0, 82944
    s_nop 0
    buffer_load_dwordx4 v57, s[16:19], s44 offen  lds
    s_mov_b32 m0, 83968
    s_nop 0
    buffer_load_dwordx4 v58, s[16:19], s44 offen  lds
    s_mov_b32 m0, 84992
    s_nop 0
    buffer_load_dwordx4 v59, s[16:19], s44 offen  lds
    s_mov_b32 m0, 86016
    s_nop 0
    buffer_load_dwordx4 v60, s[16:19], s44 offen  lds
    s_mov_b32 m0, 87040
    s_nop 0
    buffer_load_dwordx4 v61, s[16:19], s44 offen  lds
    s_mov_b32 m0, 88064
    s_nop 0
    buffer_load_dwordx4 v62, s[16:19], s44 offen  lds
    s_mov_b32 m0, 89088
    s_nop 0
    buffer_load_dwordx4 v63, s[16:19], s44 offen  lds
    s_add_u32 s46, s46, 128
    s_and_b32 s46, s46, 4095
    s_add_u32 s44, s45, s46
    s_waitcnt vmcnt(32)
    s_barrier
    s_mov_b32 m0, 90112
    s_nop 0
    buffer_load_dwordx4 v48, s[16:19], s44 offen  lds
    s_mov_b32 m0, 91136
    s_nop 0
    buffer_load_dwordx4 v49, s[16:19], s44 offen  lds
    s_mov_b32 m0, 92160
    s_nop 0
    buffer_load_dwordx4 v50, s[16:19], s44 offen  lds
    s_mov_b32 m0, 93184
    s_nop 0
    buffer_load_dwordx4 v51, s[16:19], s44 offen  lds
    s_mov_b32 m0, 94208
    s_nop 0
    buffer_load_dwordx4 v52, s[16:19], s44 offen  lds
    s_mov_b32 m0, 95232
    s_nop 0
    buffer_load_dwordx4 v53, s[16:19], s44 offen  lds
    s_mov_b32 m0, 96256
    s_nop 0
    buffer_load_dwordx4 v54, s[16:19], s44 offen  lds
    s_mov_b32 m0, 97280
    s_nop 0
    buffer_load_dwordx4 v55, s[16:19], s44 offen  lds
    s_mov_b32 m0, 98304
    s_nop 0
    buffer_load_dwordx4 v56, s[16:19], s44 offen  lds
    s_mov_b32 m0, 99328
    s_nop 0
    buffer_load_dwordx4 v57, s[16:19], s44 offen  lds
    s_mov_b32 m0, 100352
    s_nop 0
    buffer_load_dwordx4 v58, s[16:19], s44 offen  lds
    s_mov_b32 m0, 101376
    s_nop 0
    buffer_load_dwordx4 v59, s[16:19], s44 offen  lds
    s_mov_b32 m0, 102400
    s_nop 0
    buffer_load_dwordx4 v60, s[16:19], s44 offen  lds
    s_mov_b32 m0, 103424
    s_nop 0
    buffer_load_dwordx4 v61, s[16:19], s44 offen  lds
    s_mov_b32 m0, 104448
    s_nop 0
    buffer_load_dwordx4 v62, s[16:19], s44 offen  lds
    s_mov_b32 m0, 105472
    s_nop 0
    buffer_load_dwordx4 v63, s[16:19], s44 offen  lds
    s_add_u32 s46, s46, 128
    s_and_b32 s46, s46, 4095
    s_add_u32 s44, s45, s46
    s_sub_u32 s43, s43, 1
    s_cmp_lg_u32 s43, 0
    s_cbranch_scc1 lpl_mega_kernel_11
    s_waitcnt vmcnt(32)
    s_barrier
    s_waitcnt vmcnt(16)
    s_barrier
    s_waitcnt vmcnt(0)
    s_barrier
    s_waitcnt vmcnt(0)
    s_barrier
    s_lshr_b32 s60, s77, 4
    s_mul_i32 s60, s60, 73728
    s_add_u32 s61, s60, 73728
    s_add_u32 s62, s60, 147456
    s_add_u32 s63, s60, 221184
    s_mov_b32 s56, 0
    s_and_b32 s56, s56, 3
    s_mul_i32 s56, s56, 18432
    s_mov_b32 s57, 1
    s_and_b32 s57, s57, 3
    s_mul_i32 s57, s57, 18432
    s_mov_b32 s58, 2
    s_and_b32 s58, s58, 3
    s_mul_i32 s58, s58, 18432
    s_mov_b32 s59, 3
    s_and_b32 s59, s59, 3
    s_mul_i32 s59, s59, 18432
    s_barrier
    s_add_u32 s84, s6, 0x1e00000
    s_addc_u32 s85, s7, 0
    s_mov_b32 s86, 0x74000
    s_mov_b32 s87, 0x00020000
    s_lshl_b32 s45, s11, 4
    s_add_u32 s45, s45, s10
    s_lshl_b32 s45, s45, 7
    s_add_u32 s45, s45, 442368
    v_and_b32 v12, 15, v2
    v_lshlrev_b32 v12, 2, v12
    s_mov_b32 s47, 1048576
poll_mega_kernel_12:
    buffer_load_dword v13, v12, s[84:87], s45 offen sc1
    s_waitcnt vmcnt(0)
    v_and_b32 v13, 1, v13
    v_cmp_ne_u32 vcc, 0, v13
    s_sub_u32 s47, s47, 1
    s_cmp_eq_u32 s47, 0
    s_cbranch_scc1 pd_mega_kernel_13
    s_nop 3
    s_cbranch_vccz pd_mega_kernel_13
    s_sleep 1
    s_branch poll_mega_kernel_12
pd_mega_kernel_13:
    s_add_u32 s16, s6, 0x3400000
    s_addc_u32 s17, s7, 0
    s_mov_b32 s18, 0x900000
    s_mov_b32 s19, 0x00020000
    s_add_u32 s43, s56, 0
    s_add_u32 s44, s60, s43
    s_mov_b32 m0, 92160
    s_nop 0
    buffer_load_dwordx4 v80, s[16:19], s44 offen sc1 lds
    s_mov_b32 m0, 93184
    s_nop 0
    buffer_load_dwordx4 v81, s[16:19], s44 offen sc1 lds
    s_add_u32 s44, s61, s43
    s_mov_b32 m0, 94208
    s_nop 0
    buffer_load_dwordx4 v80, s[16:19], s44 offen sc1 lds
    s_mov_b32 m0, 95232
    s_nop 0
    buffer_load_dwordx4 v81, s[16:19], s44 offen sc1 lds
    s_add_u32 s44, s62, s43
    s_mov_b32 m0, 96256
    s_nop 0
    buffer_load_dwordx4 v80, s[16:19], s44 offen sc1 lds
    s_mov_b32 m0, 97280
    s_nop 0
    buffer_load_dwordx4 v81, s[16:19], s44 offen sc1 lds
    s_add_u32 s44, s63, s43
    s_mov_b32 m0, 98304
    s_nop 0
    buffer_load_dwordx4 v80, s[16:19], s44 offen sc1 lds
    s_mov_b32 m0, 99328
    s_nop 0
    buffer_load_dwordx4 v81, s[16:19], s44 offen sc1 lds
    s_add_u32 s43, s56, 2048
    s_add_u32 s44, s60, s43
    s_mov_b32 m0, 100352
    s_nop 0
    buffer_load_dwordx4 v80, s[16:19], s44 offen sc1 lds
    s_mov_b32 m0, 101376
    s_nop 0
    buffer_load_dwordx4 v81, s[16:19], s44 offen sc1 lds
    s_add_u32 s44, s61, s43
    s_mov_b32 m0, 102400
    s_nop 0
    buffer_load_dwordx4 v80, s[16:19], s44 offen sc1 lds
    s_mov_b32 m0, 103424
    s_nop 0
    buffer_load_dwordx4 v81, s[16:19], s44 offen sc1 lds
    s_add_u32 s44, s62, s43
    s_mov_b32 m0, 104448
    s_nop 0
    buffer_load_dwordx4 v80, s[16:19], s44 offen sc1 lds
    s_mov_b32 m0, 105472
    s_nop 0
    buffer_load_dwordx4 v81, s[16:19], s44 offen sc1 lds
    s_add_u32 s44, s63, s43
    s_mov_b32 m0, 106496
    s_nop 0
    buffer_load_dwordx4 v80, s[16:19], s44 offen sc1 lds
    s_mov_b32 m0, 107520
    s_nop 0
    buffer_load_dwordx4 v81, s[16:19], s44 offen sc1 lds
    s_add_u32 s43, s56, 4608
    s_add_u32 s44, s60, s43
    s_mov_b32 m0, 108544
    s_nop 0
    buffer_load_dwordx4 v80, s[16:19], s44 offen sc1 lds
    s_mov_b32 m0, 109568
    s_nop 0
    buffer_load_dwordx4 v81, s[16:19], s44 offen sc1 lds
    s_add_u32 s44, s61, s43
    s_mov_b32 m0, 110592
    s_nop 0
    buffer_load_dwordx4 v80, s[16:19], s44 offen sc1 lds
    s_mov_b32 m0, 111616
    s_nop 0
    buffer_load_dwordx4 v81, s[16:19], s44 offen sc1 lds
    s_add_u32 s44, s62, s43
    s_mov_b32 m0, 112640
    s_nop 0
    buffer_load_dwordx4 v80, s[16:19], s44 offen sc1 lds
    s_mov_b32 m0, 113664
    s_nop 0
    buffer_load_dwordx4 v81, s[16:19], s44 offen sc1 lds
    s_add_u32 s44, s63, s43
    s_mov_b32 m0, 114688
    s_nop 0
    buffer_load_dwordx4 v80, s[16:19], s44 offen sc1 lds
    s_mov_b32 m0, 115712
    s_nop 0
    buffer_load_dwordx4 v81, s[16:19], s44 offen sc1 lds
    s_add_u32 s43, s56, 6656
    s_add_u32 s44, s60, s43
    s_mov_b32 m0, 116736
    s_nop 0
    buffer_load_dwordx4 v80, s[16:19], s44 offen sc1 lds
    s_mov_b32 m0, 117760
    s_nop 0
    buffer_load_dwordx4 v81, s[16:19], s44 offen sc1 lds
    s_add_u32 s44, s61, s43
    s_mov_b32 m0, 118784
    s_nop 0
    buffer_load_dwordx4 v80, s[16:19], s44 offen sc1 lds
    s_mov_b32 m0, 119808
    s_nop 0
    buffer_load_dwordx4 v81, s[16:19], s44 offen sc1 lds
    s_add_u32 s44, s62, s43
    s_mov_b32 m0, 120832
    s_nop 0
    buffer_load_dwordx4 v80, s[16:19], s44 offen sc1 lds
    s_mov_b32 m0, 121856
    s_nop 0
    buffer_load_dwordx4 v81, s[16:19], s44 offen sc1 lds
    s_add_u32 s44, s63, s43
    s_mov_b32 m0, 122880
    s_nop 0
    buffer_load_dwordx4 v80, s[16:19], s44 offen sc1 lds
    s_mov_b32 m0, 123904
    s_nop 0
    buffer_load_dwordx4 v81, s[16:19], s44 offen sc1 lds
    s_waitcnt vmcnt(16)
    s_barrier
    s_waitcnt vmcnt(47)
    s_add_u32 s43, s56, 9216
    s_add_u32 s44, s60, s43
    s_mov_b32 m0, 124928
    s_nop 0
    buffer_load_dwordx4 v80, s[16:19], s44 offen sc1 lds
    s_mov_b32 m0, 125952
    s_nop 0
    buffer_load_dwordx4 v81, s[16:19], s44 offen sc1 lds
    s_add_u32 s44, s61, s43
    s_mov_b32 m0, 126976
    s_nop 0
    buffer_load_dwordx4 v80, s[16:19], s44 offen sc1 lds
    s_mov_b32 m0, 128000
    s_nop 0
    buffer_load_dwordx4 v81, s[16:19], s44 offen sc1 lds
    s_add_u32 s44, s62, s43
    s_mov_b32 m0, 129024
    s_nop 0
    buffer_load_dwordx4 v80, s[16:19], s44 offen sc1 lds
    s_mov_b32 m0, 130048
    s_nop 0
    buffer_load_dwordx4 v81, s[16:19], s44 offen sc1 lds
    s_add_u32 s44, s63, s43
    s_mov_b32 m0, 131072
    s_nop 0
    buffer_load_dwordx4 v80, s[16:19], s44 offen sc1 lds
    s_mov_b32 m0, 132096
    s_nop 0
    buffer_load_dwordx4 v81, s[16:19], s44 offen sc1 lds
    s_add_u32 s43, s56, 11264
    s_add_u32 s44, s60, s43
    s_mov_b32 m0, 133120
    s_nop 0
    buffer_load_dwordx4 v80, s[16:19], s44 offen sc1 lds
    s_mov_b32 m0, 134144
    s_nop 0
    buffer_load_dwordx4 v81, s[16:19], s44 offen sc1 lds
    s_add_u32 s44, s61, s43
    s_mov_b32 m0, 135168
    s_nop 0
    buffer_load_dwordx4 v80, s[16:19], s44 offen sc1 lds
    s_mov_b32 m0, 136192
    s_nop 0
    buffer_load_dwordx4 v81, s[16:19], s44 offen sc1 lds
    s_add_u32 s44, s62, s43
    s_mov_b32 m0, 137216
    s_nop 0
    buffer_load_dwordx4 v80, s[16:19], s44 offen sc1 lds
    s_mov_b32 m0, 138240
    s_nop 0
    buffer_load_dwordx4 v81, s[16:19], s44 offen sc1 lds
    s_add_u32 s44, s63, s43
    s_mov_b32 m0, 139264
    s_nop 0
    buffer_load_dwordx4 v80, s[16:19], s44 offen sc1 lds
    s_mov_b32 m0, 140288
    s_nop 0
    buffer_load_dwordx4 v81, s[16:19], s44 offen sc1 lds
    s_waitcnt vmcnt(47)
    s_add_u32 s43, s56, 13824
    s_add_u32 s44, s60, s43
    s_mov_b32 m0, 141312
    s_nop 0
    buffer_load_dwordx4 v80, s[16:19], s44 offen sc1 lds
    s_mov_b32 m0, 142336
    s_nop 0
    buffer_load_dwordx4 v81, s[16:19], s44 offen sc1 lds
    s_add_u32 s44, s61, s43
    s_mov_b32 m0, 143360
    s_nop 0
    buffer_load_dwordx4 v80, s[16:19], s44 offen sc1 lds
    s_mov_b32 m0, 144384
    s_nop 0
    buffer_load_dwordx4 v81, s[16:19], s44 offen sc1 lds
    s_add_u32 s44, s62, s43
    s_mov_b32 m0, 145408
    s_nop 0
    buffer_load_dwordx4 v80, s[16:19], s44 offen sc1 lds
    s_mov_b32 m0, 146432
    s_nop 0
    buffer_load_dwordx4 v81, s[16:19], s44 offen sc1 lds
    s_add_u32 s44, s63, s43
    s_mov_b32 m0, 147456
    s_nop 0
    buffer_load_dwordx4 v80, s[16:19], s44 offen sc1 lds
    s_mov_b32 m0, 148480
    s_nop 0
    buffer_load_dwordx4 v81, s[16:19], s44 offen sc1 lds
    s_add_u32 s43, s56, 15872
    s_add_u32 s44, s60, s43
    s_mov_b32 m0, 149504
    s_nop 0
    buffer_load_dwordx4 v80, s[16:19], s44 offen sc1 lds
    s_mov_b32 m0, 150528
    s_nop 0
    buffer_load_dwordx4 v81, s[16:19], s44 offen sc1 lds
    s_add_u32 s44, s61, s43
    s_mov_b32 m0, 151552
    s_nop 0
    buffer_load_dwordx4 v80, s[16:19], s44 offen sc1 lds
    s_mov_b32 m0, 152576
    s_nop 0
    buffer_load_dwordx4 v81, s[16:19], s44 offen sc1 lds
    s_add_u32 s44, s62, s43
    s_mov_b32 m0, 153600
    s_nop 0
    buffer_load_dwordx4 v80, s[16:19], s44 offen sc1 lds
    s_mov_b32 m0, 154624
    s_nop 0
    buffer_load_dwordx4 v81, s[16:19], s44 offen sc1 lds
    s_add_u32 s44, s63, s43
    s_mov_b32 m0, 155648
    s_nop 0
    buffer_load_dwordx4 v80, s[16:19], s44 offen sc1 lds
    s_mov_b32 m0, 156672
    s_nop 0
    buffer_load_dwordx4 v81, s[16:19], s44 offen sc1 lds
    s_waitcnt vmcnt(32)
    s_barrier
    s_waitcnt vmcnt(47)
    s_add_u32 s43, s56, 0
    s_add_u32 s44, s60, s43
    s_mov_b32 m0, 92160
    s_nop 0
    buffer_load_dwordx4 v82, s[16:19], s44 offen sc1 lds
    s_mov_b32 m0, 93184
    s_nop 0
    buffer_load_dwordx4 v83, s[16:19], s44 offen sc1 lds
    s_add_u32 s44, s61, s43
    s_mov_b32 m0, 94208
    s_nop 0
    buffer_load_dwordx4 v82, s[16:19], s44 offen sc1 lds
    s_mov_b32 m0, 95232
    s_nop 0
    buffer_load_dwordx4 v83, s[16:19], s44 offen sc1 lds
    s_add_u32 s44, s62, s43
    s_mov_b32 m0, 96256
    s_nop 0
    buffer_load_dwordx4 v82, s[16:19], s44 offen sc1 lds
    s_mov_b32 m0, 97280
    s_nop 0
    buffer_load_dwordx4 v83, s[16:19], s44 offen sc1 lds
    s_add_u32 s44, s63, s43
    s_mov_b32 m0, 98304
    s_nop 0
    buffer_load_dwordx4 v82, s[16:19], s44 offen sc1 lds
    s_mov_b32 m0, 99328
    s_nop 0
    buffer_load_dwordx4 v83, s[16:19], s44 offen sc1 lds
    s_add_u32 s43, s57, 0
    s_add_u32 s44, s60, s43
    s_mov_b32 m0, 100352
    s_nop 0
    buffer_load_dwordx4 v80, s[16:19], s44 offen sc1 lds
    s_mov_b32 m0, 101376
    s_nop 0
    buffer_load_dwordx4 v81, s[16:19], s44 offen sc1 lds
    s_add_u32 s44, s61, s43
    s_mov_b32 m0, 102400
    s_nop 0
    buffer_load_dwordx4 v80, s[16:19], s44 offen sc1 lds
    s_mov_b32 m0, 103424
    s_nop 0
    buffer_load_dwordx4 v81, s[16:19], s44 offen sc1 lds
    s_add_u32 s44, s62, s43
    s_mov_b32 m0, 104448
    s_nop 0
    buffer_load_dwordx4 v80, s[16:19], s44 offen sc1 lds
    s_mov_b32 m0, 105472
    s_nop 0
    buffer_load_dwordx4 v81, s[16:19], s44 offen sc1 lds
    s_add_u32 s44, s63, s43
    s_mov_b32 m0, 106496
    s_nop 0
    buffer_load_dwordx4 v80, s[16:19], s44 offen sc1 lds
    s_mov_b32 m0, 107520
    s_nop 0
    buffer_load_dwordx4 v81, s[16:19], s44 offen sc1 lds
    s_waitcnt vmcnt(32)
    s_barrier
    s_waitcnt vmcnt(47)
    s_add_u32 s43, s57, 2048
    s_add_u32 s44, s60, s43
    s_mov_b32 m0, 108544
    s_nop 0
    buffer_load_dwordx4 v80, s[16:19], s44 offen sc1 lds
    s_mov_b32 m0, 109568
    s_nop 0
    buffer_load_dwordx4 v81, s[16:19], s44 offen sc1 lds
    s_add_u32 s44, s61, s43
    s_mov_b32 m0, 110592
    s_nop 0
    buffer_load_dwordx4 v80, s[16:19], s44 offen sc1 lds
    s_mov_b32 m0, 111616
    s_nop 0
    buffer_load_dwordx4 v81, s[16:19], s44 offen sc1 lds
    s_add_u32 s44, s62, s43
    s_mov_b32 m0, 112640
    s_nop 0
    buffer_load_dwordx4 v80, s[16:19], s44 offen sc1 lds
    s_mov_b32 m0, 113664
    s_nop 0
    buffer_load_dwordx4 v81, s[16:19], s44 offen sc1 lds
    s_add_u32 s44, s63, s43
    s_mov_b32 m0, 114688
    s_nop 0
    buffer_load_dwordx4 v80, s[16:19], s44 offen sc1 lds
    s_mov_b32 m0, 115712
    s_nop 0
    buffer_load_dwordx4 v81, s[16:19], s44 offen sc1 lds
    s_add_u32 s43, s57, 4608
    s_add_u32 s44, s60, s43
    s_mov_b32 m0, 116736
    s_nop 0
    buffer_load_dwordx4 v80, s[16:19], s44 offen sc1 lds
    s_mov_b32 m0, 117760
    s_nop 0
    buffer_load_dwordx4 v81, s[16:19], s44 offen sc1 lds
    s_add_u32 s44, s61, s43
    s_mov_b32 m0, 118784
    s_nop 0
    buffer_load_dwordx4 v80, s[16:19], s44 offen sc1 lds
    s_mov_b32 m0, 119808
    s_nop 0
    buffer_load_dwordx4 v81, s[16:19], s44 offen sc1 lds
    s_add_u32 s44, s62, s43
    s_mov_b32 m0, 120832
    s_nop 0
    buffer_load_dwordx4 v80, s[16:19], s44 offen sc1 lds
    s_mov_b32 m0, 121856
    s_nop 0
    buffer_load_dwordx4 v81, s[16:19], s44 offen sc1 lds
    s_add_u32 s44, s63, s43
    s_mov_b32 m0, 122880
    s_nop 0
    buffer_load_dwordx4 v80, s[16:19], s44 offen sc1 lds
    s_mov_b32 m0, 123904
    s_nop 0
    buffer_load_dwordx4 v81, s[16:19], s44 offen sc1 lds
    s_waitcnt vmcnt(32)
    s_barrier
    s_waitcnt vmcnt(47)
    s_add_u32 s43, s57, 6656
    s_add_u32 s44, s60, s43
    s_mov_b32 m0, 124928
    s_nop 0
    buffer_load_dwordx4 v80, s[16:19], s44 offen sc1 lds
    s_mov_b32 m0, 125952
    s_nop 0
    buffer_load_dwordx4 v81, s[16:19], s44 offen sc1 lds
    s_add_u32 s44, s61, s43
    s_mov_b32 m0, 126976
    s_nop 0
    buffer_load_dwordx4 v80, s[16:19], s44 offen sc1 lds
    s_mov_b32 m0, 128000
    s_nop 0
    buffer_load_dwordx4 v81, s[16:19], s44 offen sc1 lds
    s_add_u32 s44, s62, s43
    s_mov_b32 m0, 129024
    s_nop 0
    buffer_load_dwordx4 v80, s[16:19], s44 offen sc1 lds
    s_mov_b32 m0, 130048
    s_nop 0
    buffer_load_dwordx4 v81, s[16:19], s44 offen sc1 lds
    s_add_u32 s44, s63, s43
    s_mov_b32 m0, 131072
    s_nop 0
    buffer_load_dwordx4 v80, s[16:19], s44 offen sc1 lds
    s_mov_b32 m0, 132096
    s_nop 0
    buffer_load_dwordx4 v81, s[16:19], s44 offen sc1 lds
    s_add_u32 s43, s57, 9216
    s_add_u32 s44, s60, s43
    s_mov_b32 m0, 133120
    s_nop 0
    buffer_load_dwordx4 v80, s[16:19], s44 offen sc1 lds
    s_mov_b32 m0, 134144
    s_nop 0
    buffer_load_dwordx4 v81, s[16:19], s44 offen sc1 lds
    s_add_u32 s44, s61, s43
    s_mov_b32 m0, 135168
    s_nop 0
    buffer_load_dwordx4 v80, s[16:19], s44 offen sc1 lds
    s_mov_b32 m0, 136192
    s_nop 0
    buffer_load_dwordx4 v81, s[16:19], s44 offen sc1 lds
    s_add_u32 s44, s62, s43
    s_mov_b32 m0, 137216
    s_nop 0
    buffer_load_dwordx4 v80, s[16:19], s44 offen sc1 lds
    s_mov_b32 m0, 138240
    s_nop 0
    buffer_load_dwordx4 v81, s[16:19], s44 offen sc1 lds
    s_add_u32 s44, s63, s43
    s_mov_b32 m0, 139264
    s_nop 0
    buffer_load_dwordx4 v80, s[16:19], s44 offen sc1 lds
    s_mov_b32 m0, 140288
    s_nop 0
    buffer_load_dwordx4 v81, s[16:19], s44 offen sc1 lds
    s_waitcnt vmcnt(32)
    s_barrier
    s_waitcnt vmcnt(47)
    s_add_u32 s43, s57, 11264
    s_add_u32 s44, s60, s43
    s_mov_b32 m0, 141312
    s_nop 0
    buffer_load_dwordx4 v80, s[16:19], s44 offen sc1 lds
    s_mov_b32 m0, 142336
    s_nop 0
    buffer_load_dwordx4 v81, s[16:19], s44 offen sc1 lds
    s_add_u32 s44, s61, s43
    s_mov_b32 m0, 143360
    s_nop 0
    buffer_load_dwordx4 v80, s[16:19], s44 offen sc1 lds
    s_mov_b32 m0, 144384
    s_nop 0
    buffer_load_dwordx4 v81, s[16:19], s44 offen sc1 lds
    s_add_u32 s44, s62, s43
    s_mov_b32 m0, 145408
    s_nop 0
    buffer_load_dwordx4 v80, s[16:19], s44 offen sc1 lds
    s_mov_b32 m0, 146432
    s_nop 0
    buffer_load_dwordx4 v81, s[16:19], s44 offen sc1 lds
    s_add_u32 s44, s63, s43
    s_mov_b32 m0, 147456
    s_nop 0
    buffer_load_dwordx4 v80, s[16:19], s44 offen sc1 lds
    s_mov_b32 m0, 148480
    s_nop 0
    buffer_load_dwordx4 v81, s[16:19], s44 offen sc1 lds
    s_add_u32 s43, s57, 13824
    s_add_u32 s44, s60, s43
    s_mov_b32 m0, 149504
    s_nop 0
    buffer_load_dwordx4 v80, s[16:19], s44 offen sc1 lds
    s_mov_b32 m0, 150528
    s_nop 0
    buffer_load_dwordx4 v81, s[16:19], s44 offen sc1 lds
    s_add_u32 s44, s61, s43
    s_mov_b32 m0, 151552
    s_nop 0
    buffer_load_dwordx4 v80, s[16:19], s44 offen sc1 lds
    s_mov_b32 m0, 152576
    s_nop 0
    buffer_load_dwordx4 v81, s[16:19], s44 offen sc1 lds
    s_add_u32 s44, s62, s43
    s_mov_b32 m0, 153600
    s_nop 0
    buffer_load_dwordx4 v80, s[16:19], s44 offen sc1 lds
    s_mov_b32 m0, 154624
    s_nop 0
    buffer_load_dwordx4 v81, s[16:19], s44 offen sc1 lds
    s_add_u32 s44, s63, s43
    s_mov_b32 m0, 155648
    s_nop 0
    buffer_load_dwordx4 v80, s[16:19], s44 offen sc1 lds
    s_mov_b32 m0, 156672
    s_nop 0
    buffer_load_dwordx4 v81, s[16:19], s44 offen sc1 lds
    s_waitcnt vmcnt(32)
    s_barrier
    s_waitcnt vmcnt(47)
    s_add_u32 s43, s57, 15872
    s_add_u32 s44, s60, s43
    s_mov_b32 m0, 92160
    s_nop 0
    buffer_load_dwordx4 v80, s[16:19], s44 offen sc1 lds
    s_mov_b32 m0, 93184
    s_nop 0
    buffer_load_dwordx4 v81, s[16:19], s44 offen sc1 lds
    s_add_u32 s44, s61, s43
    s_mov_b32 m0, 94208
    s_nop 0
    buffer_load_dwordx4 v80, s[16:19], s44 offen sc1 lds
    s_mov_b32 m0, 95232
    s_nop 0
    buffer_load_dwordx4 v81, s[16:19], s44 offen sc1 lds
    s_add_u32 s44, s62, s43
    s_mov_b32 m0, 96256
    s_nop 0
    buffer_load_dwordx4 v80, s[16:19], s44 offen sc1 lds
    s_mov_b32 m0, 97280
    s_nop 0
    buffer_load_dwordx4 v81, s[16:19], s44 offen sc1 lds
    s_add_u32 s44, s63, s43
    s_mov_b32 m0, 98304
    s_nop 0
    buffer_load_dwordx4 v80, s[16:19], s44 offen sc1 lds
    s_mov_b32 m0, 99328
    s_nop 0
    buffer_load_dwordx4 v81, s[16:19], s44 offen sc1 lds
    s_add_u32 s43, s57, 0
    s_add_u32 s44, s60, s43
    s_mov_b32 m0, 100352
    s_nop 0
    buffer_load_dwordx4 v82, s[16:19], s44 offen sc1 lds
    s_mov_b32 m0, 101376
    s_nop 0
    buffer_load_dwordx4 v83, s[16:19], s44 offen sc1 lds
    s_add_u32 s44, s61, s43
    s_mov_b32 m0, 102400
    s_nop 0
    buffer_load_dwordx4 v82, s[16:19], s44 offen sc1 lds
    s_mov_b32 m0, 103424
    s_nop 0
    buffer_load_dwordx4 v83, s[16:19], s44 offen sc1 lds
    s_add_u32 s44, s62, s43
    s_mov_b32 m0, 104448
    s_nop 0
    buffer_load_dwordx4 v82, s[16:19], s44 offen sc1 lds
    s_mov_b32 m0, 105472
    s_nop 0
    buffer_load_dwordx4 v83, s[16:19], s44 offen sc1 lds
    s_add_u32 s44, s63, s43
    s_mov_b32 m0, 106496
    s_nop 0
    buffer_load_dwordx4 v82, s[16:19], s44 offen sc1 lds
    s_mov_b32 m0, 107520
    s_nop 0
    buffer_load_dwordx4 v83, s[16:19], s44 offen sc1 lds
    s_waitcnt vmcnt(32)
    s_barrier
    s_waitcnt vmcnt(47)
    s_add_u32 s43, s58, 0
    s_add_u32 s44, s60, s43
    s_mov_b32 m0, 108544
    s_nop 0
    buffer_load_dwordx4 v80, s[16:19], s44 offen sc1 lds
    s_mov_b32 m0, 109568
    s_nop 0
    buffer_load_dwordx4 v81, s[16:19], s44 offen sc1 lds
    s_add_u32 s44, s61, s43
    s_mov_b32 m0, 110592
    s_nop 0
    buffer_load_dwordx4 v80, s[16:19], s44 offen sc1 lds
    s_mov_b32 m0, 111616
    s_nop 0
    buffer_load_dwordx4 v81, s[16:19], s44 offen sc1 lds
    s_add_u32 s44, s62, s43
    s_mov_b32 m0, 112640
    s_nop 0
    buffer_load_dwordx4 v80, s[16:19], s44 offen sc1 lds
    s_mov_b32 m0, 113664
    s_nop 0
    buffer_load_dwordx4 v81, s[16:19], s44 offen sc1 lds
    s_add_u32 s44, s63, s43
    s_mov_b32 m0, 114688
    s_nop 0
    buffer_load_dwordx4 v80, s[16:19], s44 offen sc1 lds
    s_mov_b32 m0, 115712
    s_nop 0
    buffer_load_dwordx4 v81, s[16:19], s44 offen sc1 lds
    s_add_u32 s43, s58, 2048
    s_add_u32 s44, s60, s43
    s_mov_b32 m0, 116736
    s_nop 0
    buffer_load_dwordx4 v80, s[16:19], s44 offen sc1 lds
    s_mov_b32 m0, 117760
    s_nop 0
    buffer_load_dwordx4 v81, s[16:19], s44 offen sc1 lds
    s_add_u32 s44, s61, s43
    s_mov_b32 m0, 118784
    s_nop 0
    buffer_load_dwordx4 v80, s[16:19], s44 offen sc1 lds
    s_mov_b32 m0, 119808
    s_nop 0
    buffer_load_dwordx4 v81, s[16:19], s44 offen sc1 lds
    s_add_u32 s44, s62, s43
    s_mov_b32 m0, 120832
    s_nop 0
    buffer_load_dwordx4 v80, s[16:19], s44 offen sc1 lds
    s_mov_b32 m0, 121856
    s_nop 0
    buffer_load_dwordx4 v81, s[16:19], s44 offen sc1 lds
    s_add_u32 s44, s63, s43
    s_mov_b32 m0, 122880
    s_nop 0
    buffer_load_dwordx4 v80, s[16:19], s44 offen sc1 lds
    s_mov_b32 m0, 123904
    s_nop 0
    buffer_load_dwordx4 v81, s[16:19], s44 offen sc1 lds
    s_waitcnt vmcnt(32)
    s_barrier
    s_waitcnt vmcnt(47)
    s_add_u32 s43, s58, 4608
    s_add_u32 s44, s60, s43
    s_mov_b32 m0, 124928
    s_nop 0
    buffer_load_dwordx4 v80, s[16:19], s44 offen sc1 lds
    s_mov_b32 m0, 125952
    s_nop 0
    buffer_load_dwordx4 v81, s[16:19], s44 offen sc1 lds
    s_add_u32 s44, s61, s43
    s_mov_b32 m0, 126976
    s_nop 0
    buffer_load_dwordx4 v80, s[16:19], s44 offen sc1 lds
    s_mov_b32 m0, 128000
    s_nop 0
    buffer_load_dwordx4 v81, s[16:19], s44 offen sc1 lds
    s_add_u32 s44, s62, s43
    s_mov_b32 m0, 129024
    s_nop 0
    buffer_load_dwordx4 v80, s[16:19], s44 offen sc1 lds
    s_mov_b32 m0, 130048
    s_nop 0
    buffer_load_dwordx4 v81, s[16:19], s44 offen sc1 lds
    s_add_u32 s44, s63, s43
    s_mov_b32 m0, 131072
    s_nop 0
    buffer_load_dwordx4 v80, s[16:19], s44 offen sc1 lds
    s_mov_b32 m0, 132096
    s_nop 0
    buffer_load_dwordx4 v81, s[16:19], s44 offen sc1 lds
    s_add_u32 s43, s58, 6656
    s_add_u32 s44, s60, s43
    s_mov_b32 m0, 133120
    s_nop 0
    buffer_load_dwordx4 v80, s[16:19], s44 offen sc1 lds
    s_mov_b32 m0, 134144
    s_nop 0
    buffer_load_dwordx4 v81, s[16:19], s44 offen sc1 lds
    s_add_u32 s44, s61, s43
    s_mov_b32 m0, 135168
    s_nop 0
    buffer_load_dwordx4 v80, s[16:19], s44 offen sc1 lds
    s_mov_b32 m0, 136192
    s_nop 0
    buffer_load_dwordx4 v81, s[16:19], s44 offen sc1 lds
    s_add_u32 s44, s62, s43
    s_mov_b32 m0, 137216
    s_nop 0
    buffer_load_dwordx4 v80, s[16:19], s44 offen sc1 lds
    s_mov_b32 m0, 138240
    s_nop 0
    buffer_load_dwordx4 v81, s[16:19], s44 offen sc1 lds
    s_add_u32 s44, s63, s43
    s_mov_b32 m0, 139264
    s_nop 0
    buffer_load_dwordx4 v80, s[16:19], s44 offen sc1 lds
    s_mov_b32 m0, 140288
    s_nop 0
    buffer_load_dwordx4 v81, s[16:19], s44 offen sc1 lds
    s_waitcnt vmcnt(32)
    s_barrier
    s_waitcnt vmcnt(47)
    s_add_u32 s43, s58, 9216
    s_add_u32 s44, s60, s43
    s_mov_b32 m0, 141312
    s_nop 0
    buffer_load_dwordx4 v80, s[16:19], s44 offen sc1 lds
    s_mov_b32 m0, 142336
    s_nop 0
    buffer_load_dwordx4 v81, s[16:19], s44 offen sc1 lds
    s_add_u32 s44, s61, s43
    s_mov_b32 m0, 143360
    s_nop 0
    buffer_load_dwordx4 v80, s[16:19], s44 offen sc1 lds
    s_mov_b32 m0, 144384
    s_nop 0
    buffer_load_dwordx4 v81, s[16:19], s44 offen sc1 lds
    s_add_u32 s44, s62, s43
    s_mov_b32 m0, 145408
    s_nop 0
    buffer_load_dwordx4 v80, s[16:19], s44 offen sc1 lds
    s_mov_b32 m0, 146432
    s_nop 0
    buffer_load_dwordx4 v81, s[16:19], s44 offen sc1 lds
    s_add_u32 s44, s63, s43
    s_mov_b32 m0, 147456
    s_nop 0
    buffer_load_dwordx4 v80, s[16:19], s44 offen sc1 lds
    s_mov_b32 m0, 148480
    s_nop 0
    buffer_load_dwordx4 v81, s[16:19], s44 offen sc1 lds
    s_add_u32 s43, s58, 11264
    s_add_u32 s44, s60, s43
    s_mov_b32 m0, 149504
    s_nop 0
    buffer_load_dwordx4 v80, s[16:19], s44 offen sc1 lds
    s_mov_b32 m0, 150528
    s_nop 0
    buffer_load_dwordx4 v81, s[16:19], s44 offen sc1 lds
    s_add_u32 s44, s61, s43
    s_mov_b32 m0, 151552
    s_nop 0
    buffer_load_dwordx4 v80, s[16:19], s44 offen sc1 lds
    s_mov_b32 m0, 152576
    s_nop 0
    buffer_load_dwordx4 v81, s[16:19], s44 offen sc1 lds
    s_add_u32 s44, s62, s43
    s_mov_b32 m0, 153600
    s_nop 0
    buffer_load_dwordx4 v80, s[16:19], s44 offen sc1 lds
    s_mov_b32 m0, 154624
    s_nop 0
    buffer_load_dwordx4 v81, s[16:19], s44 offen sc1 lds
    s_add_u32 s44, s63, s43
    s_mov_b32 m0, 155648
    s_nop 0
    buffer_load_dwordx4 v80, s[16:19], s44 offen sc1 lds
    s_mov_b32 m0, 156672
    s_nop 0
    buffer_load_dwordx4 v81, s[16:19], s44 offen sc1 lds
    s_waitcnt vmcnt(32)
    s_barrier
    s_waitcnt vmcnt(47)
    s_add_u32 s43, s58, 13824
    s_add_u32 s44, s60, s43
    s_mov_b32 m0, 92160
    s_nop 0
    buffer_load_dwordx4 v80, s[16:19], s44 offen sc1 lds
    s_mov_b32 m0, 93184
    s_nop 0
    buffer_load_dwordx4 v81, s[16:19], s44 offen sc1 lds
    s_add_u32 s44, s61, s43
    s_mov_b32 m0, 94208
    s_nop 0
    buffer_load_dwordx4 v80, s[16:19], s44 offen sc1 lds
    s_mov_b32 m0, 95232
    s_nop 0
    buffer_load_dwordx4 v81, s[16:19], s44 offen sc1 lds
    s_add_u32 s44, s62, s43
    s_mov_b32 m0, 96256
    s_nop 0
    buffer_load_dwordx4 v80, s[16:19], s44 offen sc1 lds
    s_mov_b32 m0, 97280
    s_nop 0
    buffer_load_dwordx4 v81, s[16:19], s44 offen sc1 lds
    s_add_u32 s44, s63, s43
    s_mov_b32 m0, 98304
    s_nop 0
    buffer_load_dwordx4 v80, s[16:19], s44 offen sc1 lds
    s_mov_b32 m0, 99328
    s_nop 0
    buffer_load_dwordx4 v81, s[16:19], s44 offen sc1 lds
    s_add_u32 s43, s58, 15872
    s_add_u32 s44, s60, s43
    s_mov_b32 m0, 100352
    s_nop 0
    buffer_load_dwordx4 v80, s[16:19], s44 offen sc1 lds
    s_mov_b32 m0, 101376
    s_nop 0
    buffer_load_dwordx4 v81, s[16:19], s44 offen sc1 lds
    s_add_u32 s44, s61, s43
    s_mov_b32 m0, 102400
    s_nop 0
    buffer_load_dwordx4 v80, s[16:19], s44 offen sc1 lds
    s_mov_b32 m0, 103424
    s_nop 0
    buffer_load_dwordx4 v81, s[16:19], s44 offen sc1 lds
    s_add_u32 s44, s62, s43
    s_mov_b32 m0, 104448
    s_nop 0
    buffer_load_dwordx4 v80, s[16:19], s44 offen sc1 lds
    s_mov_b32 m0, 105472
    s_nop 0
    buffer_load_dwordx4 v81, s[16:19], s44 offen sc1 lds
    s_add_u32 s44, s63, s43
    s_mov_b32 m0, 106496
    s_nop 0
    buffer_load_dwordx4 v80, s[16:19], s44 offen sc1 lds
    s_mov_b32 m0, 107520
    s_nop 0
    buffer_load_dwordx4 v81, s[16:19], s44 offen sc1 lds
    s_waitcnt vmcnt(32)
    s_barrier
    s_waitcnt vmcnt(47)
    s_add_u32 s43, s58, 0
    s_add_u32 s44, s60, s43
    s_mov_b32 m0, 108544
    s_nop 0
    buffer_load_dwordx4 v82, s[16:19], s44 offen sc1 lds
    s_mov_b32 m0, 109568
    s_nop 0
    buffer_load_dwordx4 v83, s[16:19], s44 offen sc1 lds
    s_add_u32 s44, s61, s43
    s_mov_b32 m0, 110592
    s_nop 0
    buffer_load_dwordx4 v82, s[16:19], s44 offen sc1 lds
    s_mov_b32 m0, 111616
    s_nop 0
    buffer_load_dwordx4 v83, s[16:19], s44 offen sc1 lds
    s_add_u32 s44, s62, s43
    s_mov_b32 m0, 112640
    s_nop 0
    buffer_load_dwordx4 v82, s[16:19], s44 offen sc1 lds
    s_mov_b32 m0, 113664
    s_nop 0
    buffer_load_dwordx4 v83, s[16:19], s44 offen sc1 lds
    s_add_u32 s44, s63, s43
    s_mov_b32 m0, 114688
    s_nop 0
    buffer_load_dwordx4 v82, s[16:19], s44 offen sc1 lds
    s_mov_b32 m0, 115712
    s_nop 0
    buffer_load_dwordx4 v83, s[16:19], s44 offen sc1 lds
    s_add_u32 s43, s59, 0
    s_add_u32 s44, s60, s43
    s_mov_b32 m0, 116736
    s_nop 0
    buffer_load_dwordx4 v80, s[16:19], s44 offen sc1 lds
    s_mov_b32 m0, 117760
    s_nop 0
    buffer_load_dwordx4 v81, s[16:19], s44 offen sc1 lds
    s_add_u32 s44, s61, s43
    s_mov_b32 m0, 118784
    s_nop 0
    buffer_load_dwordx4 v80, s[16:19], s44 offen sc1 lds
    s_mov_b32 m0, 119808
    s_nop 0
    buffer_load_dwordx4 v81, s[16:19], s44 offen sc1 lds
    s_add_u32 s44, s62, s43
    s_mov_b32 m0, 120832
    s_nop 0
    buffer_load_dwordx4 v80, s[16:19], s44 offen sc1 lds
    s_mov_b32 m0, 121856
    s_nop 0
    buffer_load_dwordx4 v81, s[16:19], s44 offen sc1 lds
    s_add_u32 s44, s63, s43
    s_mov_b32 m0, 122880
    s_nop 0
    buffer_load_dwordx4 v80, s[16:19], s44 offen sc1 lds
    s_mov_b32 m0, 123904
    s_nop 0
    buffer_load_dwordx4 v81, s[16:19], s44 offen sc1 lds
    s_waitcnt vmcnt(32)
    s_barrier
    s_waitcnt vmcnt(47)
    s_add_u32 s43, s59, 2048
    s_add_u32 s44, s60, s43
    s_mov_b32 m0, 124928
    s_nop 0
    buffer_load_dwordx4 v80, s[16:19], s44 offen sc1 lds
    s_mov_b32 m0, 125952
    s_nop 0
    buffer_load_dwordx4 v81, s[16:19], s44 offen sc1 lds
    s_add_u32 s44, s61, s43
    s_mov_b32 m0, 126976
    s_nop 0
    buffer_load_dwordx4 v80, s[16:19], s44 offen sc1 lds
    s_mov_b32 m0, 128000
    s_nop 0
    buffer_load_dwordx4 v81, s[16:19], s44 offen sc1 lds
    s_add_u32 s44, s62, s43
    s_mov_b32 m0, 129024
    s_nop 0
    buffer_load_dwordx4 v80, s[16:19], s44 offen sc1 lds
    s_mov_b32 m0, 130048
    s_nop 0
    buffer_load_dwordx4 v81, s[16:19], s44 offen sc1 lds
    s_add_u32 s44, s63, s43
    s_mov_b32 m0, 131072
    s_nop 0
    buffer_load_dwordx4 v80, s[16:19], s44 offen sc1 lds
    s_mov_b32 m0, 132096
    s_nop 0
    buffer_load_dwordx4 v81, s[16:19], s44 offen sc1 lds
    s_add_u32 s43, s59, 4608
    s_add_u32 s44, s60, s43
    s_mov_b32 m0, 133120
    s_nop 0
    buffer_load_dwordx4 v80, s[16:19], s44 offen sc1 lds
    s_mov_b32 m0, 134144
    s_nop 0
    buffer_load_dwordx4 v81, s[16:19], s44 offen sc1 lds
    s_add_u32 s44, s61, s43
    s_mov_b32 m0, 135168
    s_nop 0
    buffer_load_dwordx4 v80, s[16:19], s44 offen sc1 lds
    s_mov_b32 m0, 136192
    s_nop 0
    buffer_load_dwordx4 v81, s[16:19], s44 offen sc1 lds
    s_add_u32 s44, s62, s43
    s_mov_b32 m0, 137216
    s_nop 0
    buffer_load_dwordx4 v80, s[16:19], s44 offen sc1 lds
    s_mov_b32 m0, 138240
    s_nop 0
    buffer_load_dwordx4 v81, s[16:19], s44 offen sc1 lds
    s_add_u32 s44, s63, s43
    s_mov_b32 m0, 139264
    s_nop 0
    buffer_load_dwordx4 v80, s[16:19], s44 offen sc1 lds
    s_mov_b32 m0, 140288
    s_nop 0
    buffer_load_dwordx4 v81, s[16:19], s44 offen sc1 lds
    s_waitcnt vmcnt(32)
    s_barrier
    s_waitcnt vmcnt(47)
    s_add_u32 s43, s59, 6656
    s_add_u32 s44, s60, s43
    s_mov_b32 m0, 141312
    s_nop 0
    buffer_load_dwordx4 v80, s[16:19], s44 offen sc1 lds
    s_mov_b32 m0, 142336
    s_nop 0
    buffer_load_dwordx4 v81, s[16:19], s44 offen sc1 lds
    s_add_u32 s44, s61, s43
    s_mov_b32 m0, 143360
    s_nop 0
    buffer_load_dwordx4 v80, s[16:19], s44 offen sc1 lds
    s_mov_b32 m0, 144384
    s_nop 0
    buffer_load_dwordx4 v81, s[16:19], s44 offen sc1 lds
    s_add_u32 s44, s62, s43
    s_mov_b32 m0, 145408
    s_nop 0
    buffer_load_dwordx4 v80, s[16:19], s44 offen sc1 lds
    s_mov_b32 m0, 146432
    s_nop 0
    buffer_load_dwordx4 v81, s[16:19], s44 offen sc1 lds
    s_add_u32 s44, s63, s43
    s_mov_b32 m0, 147456
    s_nop 0
    buffer_load_dwordx4 v80, s[16:19], s44 offen sc1 lds
    s_mov_b32 m0, 148480
    s_nop 0
    buffer_load_dwordx4 v81, s[16:19], s44 offen sc1 lds
    s_add_u32 s43, s59, 9216
    s_add_u32 s44, s60, s43
    s_mov_b32 m0, 149504
    s_nop 0
    buffer_load_dwordx4 v80, s[16:19], s44 offen sc1 lds
    s_mov_b32 m0, 150528
    s_nop 0
    buffer_load_dwordx4 v81, s[16:19], s44 offen sc1 lds
    s_add_u32 s44, s61, s43
    s_mov_b32 m0, 151552
    s_nop 0
    buffer_load_dwordx4 v80, s[16:19], s44 offen sc1 lds
    s_mov_b32 m0, 152576
    s_nop 0
    buffer_load_dwordx4 v81, s[16:19], s44 offen sc1 lds
    s_add_u32 s44, s62, s43
    s_mov_b32 m0, 153600
    s_nop 0
    buffer_load_dwordx4 v80, s[16:19], s44 offen sc1 lds
    s_mov_b32 m0, 154624
    s_nop 0
    buffer_load_dwordx4 v81, s[16:19], s44 offen sc1 lds
    s_add_u32 s44, s63, s43
    s_mov_b32 m0, 155648
    s_nop 0
    buffer_load_dwordx4 v80, s[16:19], s44 offen sc1 lds
    s_mov_b32 m0, 156672
    s_nop 0
    buffer_load_dwordx4 v81, s[16:19], s44 offen sc1 lds
    s_waitcnt vmcnt(32)
    s_barrier
    s_waitcnt vmcnt(47)
    s_add_u32 s43, s59, 11264
    s_add_u32 s44, s60, s43
    s_mov_b32 m0, 92160
    s_nop 0
    buffer_load_dwordx4 v80, s[16:19], s44 offen sc1 lds
    s_mov_b32 m0, 93184
    s_nop 0
    buffer_load_dwordx4 v81, s[16:19], s44 offen sc1 lds
    s_add_u32 s44, s61, s43
    s_mov_b32 m0, 94208
    s_nop 0
    buffer_load_dwordx4 v80, s[16:19], s44 offen sc1 lds
    s_mov_b32 m0, 95232
    s_nop 0
    buffer_load_dwordx4 v81, s[16:19], s44 offen sc1 lds
    s_add_u32 s44, s62, s43
    s_mov_b32 m0, 96256
    s_nop 0
    buffer_load_dwordx4 v80, s[16:19], s44 offen sc1 lds
    s_mov_b32 m0, 97280
    s_nop 0
    buffer_load_dwordx4 v81, s[16:19], s44 offen sc1 lds
    s_add_u32 s44, s63, s43
    s_mov_b32 m0, 98304
    s_nop 0
    buffer_load_dwordx4 v80, s[16:19], s44 offen sc1 lds
    s_mov_b32 m0, 99328
    s_nop 0
    buffer_load_dwordx4 v81, s[16:19], s44 offen sc1 lds
    s_add_u32 s43, s59, 13824
    s_add_u32 s44, s60, s43
    s_mov_b32 m0, 100352
    s_nop 0
    buffer_load_dwordx4 v80, s[16:19], s44 offen sc1 lds
    s_mov_b32 m0, 101376
    s_nop 0
    buffer_load_dwordx4 v81, s[16:19], s44 offen sc1 lds
    s_add_u32 s44, s61, s43
    s_mov_b32 m0, 102400
    s_nop 0
    buffer_load_dwordx4 v80, s[16:19], s44 offen sc1 lds
    s_mov_b32 m0, 103424
    s_nop 0
    buffer_load_dwordx4 v81, s[16:19], s44 offen sc1 lds
    s_add_u32 s44, s62, s43
    s_mov_b32 m0, 104448
    s_nop 0
    buffer_load_dwordx4 v80, s[16:19], s44 offen sc1 lds
    s_mov_b32 m0, 105472
    s_nop 0
    buffer_load_dwordx4 v81, s[16:19], s44 offen sc1 lds
    s_add_u32 s44, s63, s43
    s_mov_b32 m0, 106496
    s_nop 0
    buffer_load_dwordx4 v80, s[16:19], s44 offen sc1 lds
    s_mov_b32 m0, 107520
    s_nop 0
    buffer_load_dwordx4 v81, s[16:19], s44 offen sc1 lds
    s_waitcnt vmcnt(32)
    s_barrier
    s_waitcnt vmcnt(47)
    s_add_u32 s43, s59, 15872
    s_add_u32 s44, s60, s43
    s_mov_b32 m0, 108544
    s_nop 0
    buffer_load_dwordx4 v80, s[16:19], s44 offen sc1 lds
    s_mov_b32 m0, 109568
    s_nop 0
    buffer_load_dwordx4 v81, s[16:19], s44 offen sc1 lds
    s_add_u32 s44, s61, s43
    s_mov_b32 m0, 110592
    s_nop 0
    buffer_load_dwordx4 v80, s[16:19], s44 offen sc1 lds
    s_mov_b32 m0, 111616
    s_nop 0
    buffer_load_dwordx4 v81, s[16:19], s44 offen sc1 lds
    s_add_u32 s44, s62, s43
    s_mov_b32 m0, 112640
    s_nop 0
    buffer_load_dwordx4 v80, s[16:19], s44 offen sc1 lds
    s_mov_b32 m0, 113664
    s_nop 0
    buffer_load_dwordx4 v81, s[16:19], s44 offen sc1 lds
    s_add_u32 s44, s63, s43
    s_mov_b32 m0, 114688
    s_nop 0
    buffer_load_dwordx4 v80, s[16:19], s44 offen sc1 lds
    s_mov_b32 m0, 115712
    s_nop 0
    buffer_load_dwordx4 v81, s[16:19], s44 offen sc1 lds
    s_add_u32 s43, s59, 0
    s_add_u32 s44, s60, s43
    s_mov_b32 m0, 116736
    s_nop 0
    buffer_load_dwordx4 v82, s[16:19], s44 offen sc1 lds
    s_mov_b32 m0, 117760
    s_nop 0
    buffer_load_dwordx4 v83, s[16:19], s44 offen sc1 lds
    s_add_u32 s44, s61, s43
    s_mov_b32 m0, 118784
    s_nop 0
    buffer_load_dwordx4 v82, s[16:19], s44 offen sc1 lds
    s_mov_b32 m0, 119808
    s_nop 0
    buffer_load_dwordx4 v83, s[16:19], s44 offen sc1 lds
    s_add_u32 s44, s62, s43
    s_mov_b32 m0, 120832
    s_nop 0
    buffer_load_dwordx4 v82, s[16:19], s44 offen sc1 lds
    s_mov_b32 m0, 121856
    s_nop 0
    buffer_load_dwordx4 v83, s[16:19], s44 offen sc1 lds
    s_add_u32 s44, s63, s43
    s_mov_b32 m0, 122880
    s_nop 0
    buffer_load_dwordx4 v82, s[16:19], s44 offen sc1 lds
    s_mov_b32 m0, 123904
    s_nop 0
    buffer_load_dwordx4 v83, s[16:19], s44 offen sc1 lds
    s_waitcnt vmcnt(32)
    s_barrier
    s_waitcnt vmcnt(16)
    s_barrier
    s_waitcnt vmcnt(0)
    s_barrier
    s_endpgm
aux_mega_kernel_4:
    s_setprio 3
    v_and_b32 v3, 15, v2
    v_lshrrev_b32 v4, 4, v2
    v_add_u32 v5, s12, v2
    v_lshlrev_b32 v5, 2, v5
    v_lshrrev_b32 v12, 2, v3
    v_and_b32 v13, 3, v3
    v_and_b32 v14, 1, v4
    v_lshl_or_b32 v14, v14, 2, v12
    v_lshlrev_b32 v14, 1, v14
    v_lshrrev_b32 v15, 1, v13
    s_and_b32 s43, s10, 1
    s_lshl_b32 s43, s43, 3
    v_add_u32 v15, s43, v15
    v_xor_b32 v15, v15, v14
    v_lshlrev_b32 v15, 4, v15
    v_and_b32 v13, 1, v13
    v_lshl_add_u32 v15, v13, 3, v15
    v_lshl_add_u32 v14, v4, 3, v12
    v_lshl_add_u32 v8, v14, 8, v15
    v_add_u32 v8, 73728, v8
    v_xor_b32 v9, 32, v8
    v_xor_b32 v10, 64, v8
    v_xor_b32 v11, 96, v8
    v_cmp_eq_u32 s[62:63], v12, v4
    v_and_b32 v12, 8, v3
    v_cmp_ne_u32 s[64:65], 0, v12
    v_and_b32 v12, 4, v3
    v_cmp_ne_u32 s[66:67], 0, v12
    v_and_b32 v12, 2, v3
    v_cmp_ne_u32 s[68:69], 0, v12
    v_and_b32 v12, 1, v3
    v_cmp_ne_u32 s[70:71], 0, v12
    v_mov_b32 v36, 0x3f803f80
    v_mov_b32 v37, 0x3f803f80
    v_mov_b32 v38, 0x3f803f80
    v_mov_b32 v39, 0x3f803f80
    v_lshlrev_b32 v14, 3, v3
    s_waitcnt lgkmcnt(0)
    s_add_u32 s36, s6, 0x2000000
    s_addc_u32 s37, s7, 0
    s_mov_b32 s38, 0xd800
    s_mov_b32 s39, 0x00020000
    s_add_u32 s84, s6, 0x1e00000
    s_addc_u32 s85, s7, 0
    s_mov_b32 s86, 0x74000
    s_mov_b32 s87, 0x00020000
    s_barrier
    ds_read_b64_tr_b16 v[40:41], v8 offset:0
    ds_read_b64_tr_b16 v[42:43], v8 offset:1024
    ds_read_b64_tr_b16 v[44:45], v8 offset:8192
    ds_read_b64_tr_b16 v[46:47], v8 offset:9216
    ds_read_b64_tr_b16 v[48:49], v9 offset:0
    ds_read_b64_tr_b16 v[50:51], v9 offset:1024
    ds_read_b64_tr_b16 v[52:53], v9 offset:8192
    ds_read_b64_tr_b16 v[54:55], v9 offset:9216
    ds_read_b64_tr_b16 v[56:57], v10 offset:0
    ds_read_b64_tr_b16 v[58:59], v10 offset:1024
    ds_read_b64_tr_b16 v[60:61], v10 offset:8192
    ds_read_b64_tr_b16 v[62:63], v10 offset:9216
    ds_read_b64_tr_b16 v[64:65], v11 offset:0
    ds_read_b64_tr_b16 v[66:67], v11 offset:1024
    ds_read_b64_tr_b16 v[68:69], v11 offset:8192
    ds_read_b64_tr_b16 v[70:71], v11 offset:9216
    s_mov_b32 s42, 0
    buffer_load_dword v16, v5, s[36:39], s42 offen offset:0
    buffer_load_dword v17, v5, s[36:39], s42 offen offset:256
    buffer_load_dword v18, v5, s[36:39], s42 offen offset:512
    s_mov_b32 s42, 18432
    buffer_load_dword v19, v5, s[36:39], s42 offen offset:0
    buffer_load_dword v20, v5, s[36:39], s42 offen offset:256
    buffer_load_dword v21, v5, s[36:39], s42 offen offset:512
    s_mov_b32 s42, 36864
    buffer_load_dword v22, v5, s[36:39], s42 offen offset:0
    buffer_load_dword v23, v5, s[36:39], s42 offen offset:256
    buffer_load_dword v24, v5, s[36:39], s42 offen offset:512
    s_mov_b32 s42, 9216
    buffer_load_dword v25, v5, s[36:39], s42 offen offset:0
    buffer_load_dword v26, v5, s[36:39], s42 offen offset:256
    buffer_load_dword v27, v5, s[36:39], s42 offen offset:512
    s_mov_b32 s42, 27648
    buffer_load_dword v28, v5, s[36:39], s42 offen offset:0
    buffer_load_dword v29, v5, s[36:39], s42 offen offset:256
    buffer_load_dword v30, v5, s[36:39], s42 offen offset:512
    s_mov_b32 s42, 46080
    buffer_load_dword v31, v5, s[36:39], s42 offen offset:0
    buffer_load_dword v32, v5, s[36:39], s42 offen offset:256
    buffer_load_dword v33, v5, s[36:39], s42 offen offset:512
    v_lshlrev_b32 v6, 2, v2
    v_add_u32 v6, 143360, v6
    s_waitcnt lgkmcnt(0)
    s_barrier
    s_cmp_lt_u32 s10, 14
    s_cbranch_scc1 sk_mega_kernel_14
    ds_read_b64_tr_b16 v[104:105], v8 offset:16384
    ds_read_b64_tr_b16 v[106:107], v8 offset:17408
    ds_read_b64_tr_b16 v[108:109], v8 offset:24576
    ds_read_b64_tr_b16 v[110:111], v8 offset:25600
    ds_read_b64_tr_b16 v[112:113], v9 offset:16384
    ds_read_b64_tr_b16 v[114:115], v9 offset:17408
    ds_read_b64_tr_b16 v[116:117], v9 offset:24576
    ds_read_b64_tr_b16 v[118:119], v9 offset:25600
    ds_read_b64_tr_b16 v[120:121], v10 offset:16384
    ds_read_b64_tr_b16 v[122:123], v10 offset:17408
    ds_read_b64_tr_b16 v[124:125], v10 offset:24576
    ds_read_b64_tr_b16 v[126:127], v10 offset:25600
    ds_read_b64_tr_b16 v[128:129], v11 offset:16384
    ds_read_b64_tr_b16 v[130:131], v11 offset:17408
    ds_read_b64_tr_b16 v[132:133], v11 offset:24576
    ds_read_b64_tr_b16 v[134:135], v11 offset:25600
sk_mega_kernel_14:
    v_mfma_f32_16x16x32_bf16 v[72:75], v[36:39], v[40:43], 0
    v_mfma_f32_16x16x32_bf16 v[76:79], v[40:43], v[40:43], 0
    v_mfma_f32_16x16x32_bf16 v[80:83], v[36:39], v[48:51], 0
    v_mfma_f32_16x16x32_bf16 v[84:87], v[48:51], v[48:51], 0
    v_mfma_f32_16x16x32_bf16 v[88:91], v[36:39], v[56:59], 0
    v_mfma_f32_16x16x32_bf16 v[92:95], v[56:59], v[56:59], 0
    v_mfma_f32_16x16x32_bf16 v[96:99], v[36:39], v[64:67], 0
    v_mfma_f32_16x16x32_bf16 v[100:103], v[64:67], v[64:67], 0
    v_mfma_f32_16x16x32_bf16 v[72:75], v[36:39], v[44:47], v[72:75]
    v_mfma_f32_16x16x32_bf16 v[76:79], v[44:47], v[44:47], v[76:79]
    v_mfma_f32_16x16x32_bf16 v[80:83], v[36:39], v[52:55], v[80:83]
    v_mfma_f32_16x16x32_bf16 v[84:87], v[52:55], v[52:55], v[84:87]
    v_mfma_f32_16x16x32_bf16 v[88:91], v[36:39], v[60:63], v[88:91]
    v_mfma_f32_16x16x32_bf16 v[92:95], v[60:63], v[60:63], v[92:95]
    v_mfma_f32_16x16x32_bf16 v[96:99], v[36:39], v[68:71], v[96:99]
    v_mfma_f32_16x16x32_bf16 v[100:103], v[68:71], v[68:71], v[100:103]
    s_lshr_b32 s42, s10, 1
    s_lshl_b32 s42, s42, 14
    s_and_b32 s43, s10, 1
    s_lshl_b32 s43, s43, 6
    s_add_u32 s43, s43, s13
    s_lshl_b32 s43, s43, 3
    s_add_u32 s42, s42, s43
    s_add_u32 s42, s42, 262144
    s_nop 1
    v_cndmask_b32 v76, v76, v77, s[70:71]
    v_cndmask_b32 v78, v78, v79, s[70:71]
    v_cndmask_b32 v73, v76, v78, s[68:69]
    v_and_b32 v72, 0xfffffffe, v72
    v_and_b32 v73, 0xfffffffe, v73
    v_cndmask_b32 v84, v84, v85, s[70:71]
    v_cndmask_b32 v86, v86, v87, s[70:71]
    v_cndmask_b32 v81, v84, v86, s[68:69]
    v_and_b32 v80, 0xfffffffe, v80
    v_and_b32 v81, 0xfffffffe, v81
    v_cndmask_b32 v92, v92, v93, s[70:71]
    v_cndmask_b32 v94, v94, v95, s[70:71]
    v_cndmask_b32 v89, v92, v94, s[68:69]
    v_and_b32 v88, 0xfffffffe, v88
    v_and_b32 v89, 0xfffffffe, v89
    v_cndmask_b32 v100, v100, v101, s[70:71]
    v_cndmask_b32 v102, v102, v103, s[70:71]
    v_cndmask_b32 v97, v100, v102, s[68:69]
    v_and_b32 v96, 0xfffffffe, v96
    v_and_b32 v97, 0xfffffffe, v97
    s_mov_b64 exec, s[62:63]
    buffer_store_dwordx2 v[72:73], v14, s[84:87], s42 offen offset:0 sc1
    buffer_store_dwordx2 v[80:81], v14, s[84:87], s42 offen offset:128 sc1
    buffer_store_dwordx2 v[88:89], v14, s[84:87], s42 offen offset:256 sc1
    buffer_store_dwordx2 v[96:97], v14, s[84:87], s42 offen offset:384 sc1
    s_mov_b64 exec, -1
    s_waitcnt lgkmcnt(0)
    s_barrier
    s_cmp_lt_u32 s10, 14
    s_cbranch_scc1 sk_mega_kernel_15
    v_mfma_f32_16x16x32_bf16 v[72:75], v[36:39], v[104:107], 0
    v_mfma_f32_16x16x32_bf16 v[76:79], v[104:107], v[104:107], 0
    v_mfma_f32_16x16x32_bf16 v[80:83], v[36:39], v[112:115], 0
    v_mfma_f32_16x16x32_bf16 v[84:87], v[112:115], v[112:115], 0
    v_mfma_f32_16x16x32_bf16 v[88:91], v[36:39], v[120:123], 0
    v_mfma_f32_16x16x32_bf16 v[92:95], v[120:123], v[120:123], 0
    v_mfma_f32_16x16x32_bf16 v[96:99], v[36:39], v[128:131], 0
    v_mfma_f32_16x16x32_bf16 v[100:103], v[128:131], v[128:131], 0
    v_mfma_f32_16x16x32_bf16 v[72:75], v[36:39], v[108:111], v[72:75]
    v_mfma_f32_16x16x32_bf16 v[76:79], v[108:111], v[108:111], v[76:79]
    v_mfma_f32_16x16x32_bf16 v[80:83], v[36:39], v[116:119], v[80:83]
    v_mfma_f32_16x16x32_bf16 v[84:87], v[116:119], v[116:119], v[84:87]
    v_mfma_f32_16x16x32_bf16 v[88:91], v[36:39], v[124:127], v[88:91]
    v_mfma_f32_16x16x32_bf16 v[92:95], v[124:127], v[124:127], v[92:95]
    v_mfma_f32_16x16x32_bf16 v[96:99], v[36:39], v[132:135], v[96:99]
    v_mfma_f32_16x16x32_bf16 v[100:103], v[132:135], v[132:135], v[100:103]
    s_mov_b32 s42, 8
    s_lshl_b32 s42, s42, 14
    s_and_b32 s43, s10, 1
    s_lshl_b32 s43, s43, 6
    s_add_u32 s43, s43, s13
    s_lshl_b32 s43, s43, 3
    s_add_u32 s42, s42, s43
    s_add_u32 s42, s42, 262144
    s_nop 1
    v_cndmask_b32 v76, v76, v77, s[70:71]
    v_cndmask_b32 v78, v78, v79, s[70:71]
    v_cndmask_b32 v73, v76, v78, s[68:69]
    v_and_b32 v72, 0xfffffffe, v72
    v_and_b32 v73, 0xfffffffe, v73
    v_cndmask_b32 v84, v84, v85, s[70:71]
    v_cndmask_b32 v86, v86, v87, s[70:71]
    v_cndmask_b32 v81, v84, v86, s[68:69]
    v_and_b32 v80, 0xfffffffe, v80
    v_and_b32 v81, 0xfffffffe, v81
    v_cndmask_b32 v92, v92, v93, s[70:71]
    v_cndmask_b32 v94, v94, v95, s[70:71]
    v_cndmask_b32 v89, v92, v94, s[68:69]
    v_and_b32 v88, 0xfffffffe, v88
    v_and_b32 v89, 0xfffffffe, v89
    v_cndmask_b32 v100, v100, v101, s[70:71]
    v_cndmask_b32 v102, v102, v103, s[70:71]
    v_cndmask_b32 v97, v100, v102, s[68:69]
    v_and_b32 v96, 0xfffffffe, v96
    v_and_b32 v97, 0xfffffffe, v97
    s_mov_b64 exec, s[62:63]
    buffer_store_dwordx2 v[72:73], v14, s[84:87], s42 offen offset:0 sc1
    buffer_store_dwordx2 v[80:81], v14, s[84:87], s42 offen offset:128 sc1
    buffer_store_dwordx2 v[88:89], v14, s[84:87], s42 offen offset:256 sc1
    buffer_store_dwordx2 v[96:97], v14, s[84:87], s42 offen offset:384 sc1
    s_mov_b64 exec, -1
sk_mega_kernel_15:
    s_barrier
    s_barrier
    s_barrier
    s_waitcnt vmcnt(0)
    v_add_f32 v16, v16, v19
    v_add_f32 v16, v16, v22
    v_cvt_pk_bf16_f32 v7, v16, v16
    v_lshlrev_b32 v7, 16, v7
    v_sub_f32 v7, v16, v7
    v_cvt_pk_bf16_f32 v16, v16, v7
    ds_write_b32 v6, v16 offset:0
    v_add_f32 v17, v17, v20
    v_add_f32 v17, v17, v23
    v_cvt_pk_bf16_f32 v7, v17, v17
    v_lshlrev_b32 v7, 16, v7
    v_sub_f32 v7, v17, v7
    v_cvt_pk_bf16_f32 v17, v17, v7
    ds_write_b32 v6, v17 offset:256
    v_add_f32 v18, v18, v21
    v_add_f32 v18, v18, v24
    v_cvt_pk_bf16_f32 v7, v18, v18
    v_lshlrev_b32 v7, 16, v7
    v_sub_f32 v7, v18, v7
    v_cvt_pk_bf16_f32 v18, v18, v7
    ds_write_b32 v6, v18 offset:512
    v_add_f32 v25, v25, v28
    v_add_f32 v25, v25, v31
    v_cvt_pk_bf16_f32 v7, v25, v25
    v_lshlrev_b32 v7, 16, v7
    v_sub_f32 v7, v25, v7
    v_cvt_pk_bf16_f32 v25, v25, v7
    ds_write_b32 v6, v25 offset:768
    v_add_f32 v26, v26, v29
    v_add_f32 v26, v26, v32
    v_cvt_pk_bf16_f32 v7, v26, v26
    v_lshlrev_b32 v7, 16, v7
    v_sub_f32 v7, v26, v7
    v_cvt_pk_bf16_f32 v26, v26, v7
    ds_write_b32 v6, v26 offset:1024
    v_add_f32 v27, v27, v30
    v_add_f32 v27, v27, v33
    v_cvt_pk_bf16_f32 v7, v27, v27
    v_lshlrev_b32 v7, 16, v7
    v_sub_f32 v7, v27, v7
    v_cvt_pk_bf16_f32 v27, v27, v7
    ds_write_b32 v6, v27 offset:1280
    s_barrier
    v_lshlrev_b32 v5, 4, v2
    s_lshl_b32 s42, s13, 3
    s_add_u32 s42, s42, 262144
    s_mov_b32 s47, 1048576
    s_add_u32 s43, s42, 0
    buffer_load_dwordx4 v[40:43], v5, s[84:87], s43 offen sc1
    s_add_u32 s43, s42, 16384
    buffer_load_dwordx4 v[44:47], v5, s[84:87], s43 offen sc1
    s_add_u32 s43, s42, 32768
    buffer_load_dwordx4 v[48:51], v5, s[84:87], s43 offen sc1
    s_add_u32 s43, s42, 49152
    buffer_load_dwordx4 v[52:55], v5, s[84:87], s43 offen sc1
    s_add_u32 s43, s42, 65536
    buffer_load_dwordx4 v[56:59], v5, s[84:87], s43 offen sc1
    s_add_u32 s43, s42, 81920
    buffer_load_dwordx4 v[60:63], v5, s[84:87], s43 offen sc1
    s_add_u32 s43, s42, 98304
    buffer_load_dwordx4 v[64:67], v5, s[84:87], s43 offen sc1
    s_add_u32 s43, s42, 114688
    buffer_load_dwordx4 v[68:71], v5, s[84:87], s43 offen sc1
    s_add_u32 s43, s42, 131072
    buffer_load_dwordx4 v[72:75], v5, s[84:87], s43 offen sc1
    s_barrier
    s_branch pc_mega_kernel_18
poll_mega_kernel_16:
    s_sleep 1
    s_add_u32 s43, s42, 0
    buffer_load_dwordx4 v[40:43], v5, s[84:87], s43 offen sc1
    s_add_u32 s43, s42, 16384
    buffer_load_dwordx4 v[44:47], v5, s[84:87], s43 offen sc1
    s_add_u32 s43, s42, 32768
    buffer_load_dwordx4 v[48:51], v5, s[84:87], s43 offen sc1
    s_add_u32 s43, s42, 49152
    buffer_load_dwordx4 v[52:55], v5, s[84:87], s43 offen sc1
    s_add_u32 s43, s42, 65536
    buffer_load_dwordx4 v[56:59], v5, s[84:87], s43 offen sc1
    s_add_u32 s43, s42, 81920
    buffer_load_dwordx4 v[60:63], v5, s[84:87], s43 offen sc1
    s_add_u32 s43, s42, 98304
    buffer_load_dwordx4 v[64:67], v5, s[84:87], s43 offen sc1
    s_add_u32 s43, s42, 114688
    buffer_load_dwordx4 v[68:71], v5, s[84:87], s43 offen sc1
    s_add_u32 s43, s42, 131072
    buffer_load_dwordx4 v[72:75], v5, s[84:87], s43 offen sc1
pc_mega_kernel_18:
    s_waitcnt vmcnt(0)
    v_add_f32 v24, v40, v44
    v_add_f32 v25, v41, v45
    v_add_f32 v26, v42, v46
    v_add_f32 v27, v43, v47
    v_add_f32 v24, v24, v48
    v_add_f32 v25, v25, v49
    v_add_f32 v26, v26, v50
    v_add_f32 v27, v27, v51
    v_add_f32 v24, v24, v52
    v_add_f32 v25, v25, v53
    v_add_f32 v26, v26, v54
    v_add_f32 v27, v27, v55
    v_add_f32 v24, v24, v56
    v_add_f32 v25, v25, v57
    v_add_f32 v26, v26, v58
    v_add_f32 v27, v27, v59
    v_add_f32 v24, v24, v60
    v_add_f32 v25, v25, v61
    v_add_f32 v26, v26, v62
    v_add_f32 v27, v27, v63
    v_add_f32 v24, v24, v64
    v_add_f32 v25, v25, v65
    v_add_f32 v26, v26, v66
    v_add_f32 v27, v27, v67
    v_add_f32 v24, v24, v68
    v_add_f32 v25, v25, v69
    v_add_f32 v26, v26, v70
    v_add_f32 v27, v27, v71
    v_add_f32 v24, v24, v72
    v_add_f32 v25, v25, v73
    v_add_f32 v26, v26, v74
    v_add_f32 v27, v27, v75
    v_add_f32 v12, v24, v25
    v_add_f32 v13, v26, v27
    v_cmp_u_f32 vcc, v12, v13
    s_nop 4
    s_cbranch_vccz pd_mega_kernel_17
    v_or_b32 v13, v40, v41
    v_or3_b32 v13, v13, v42, v43
    v_or3_b32 v13, v13, v44, v45
    v_or3_b32 v13, v13, v46, v47
    v_or3_b32 v13, v13, v48, v49
    v_or3_b32 v13, v13, v50, v51
    v_or3_b32 v13, v13, v52, v53
    v_or3_b32 v13, v13, v54, v55
    v_or3_b32 v13, v13, v56, v57
    v_or3_b32 v13, v13, v58, v59
    v_or3_b32 v13, v13, v60, v61
    v_or3_b32 v13, v13, v62, v63
    v_or3_b32 v13, v13, v64, v65
    v_or3_b32 v13, v13, v66, v67
    v_or3_b32 v13, v13, v68, v69
    v_or3_b32 v13, v13, v70, v71
    v_or3_b32 v13, v13, v72, v73
    v_or3_b32 v13, v13, v74, v75
    v_and_b32 v13, 1, v13
    v_cmp_ne_u32 vcc, 0, v13
    s_sub_u32 s47, s47, 1
    s_cmp_eq_u32 s47, 0
    s_cbranch_scc1 pd_mega_kernel_17
    s_nop 3
    s_cbranch_vccnz poll_mega_kernel_16
pd_mega_kernel_17:
    s_barrier
    v_mul_f32 v24, 0x3ae38e39, v24
    v_mul_f32 v25, 0x3ae38e39, v25
    v_fma_f32 v25, -v24, v24, v25
    v_max_f32 v25, 0, v25
    v_cvt_pk_bf16_f32 v24, v24, v24
    v_lshlrev_b32 v24, 16, v24
    v_cvt_pk_bf16_f32 v25, v25, v25
    v_lshlrev_b32 v25, 16, v25
    v_add_f32 v25, 0x3727c5ac, v25
    v_cvt_pk_bf16_f32 v25, v25, v25
    v_lshlrev_b32 v25, 16, v25
    v_sqrt_f32 v25, v25
    s_nop 0
    v_cvt_pk_bf16_f32 v25, v25, v25
    v_lshlrev_b32 v25, 16, v25
    v_rcp_f32 v25, v25
    s_nop 0
    v_mul_f32 v26, 0x3ae38e39, v26
    v_mul_f32 v27, 0x3ae38e39, v27
    v_fma_f32 v27, -v26, v26, v27
    v_max_f32 v27, 0, v27
    v_cvt_pk_bf16_f32 v26, v26, v26
    v_lshlrev_b32 v26, 16, v26
    v_cvt_pk_bf16_f32 v27, v27, v27
    v_lshlrev_b32 v27, 16, v27
    v_add_f32 v27, 0x3727c5ac, v27
    v_cvt_pk_bf16_f32 v27, v27, v27
    v_lshlrev_b32 v27, 16, v27
    v_sqrt_f32 v27, v27
    s_nop 0
    v_cvt_pk_bf16_f32 v27, v27, v27
    v_lshlrev_b32 v27, 16, v27
    v_rcp_f32 v27, v27
    s_nop 0
    v_cvt_pk_bf16_f32 v20, -v24, -v24
    v_cvt_pk_bf16_f32 v21, -v26, -v26
    v_mov_b32 v22, v25
    v_mov_b32 v23, v27
    v_lshlrev_b32 v6, 3, v2
    v_add_u32 v6, 139264, v6
    ds_write_b64 v6, v[22:23]
    ds_write_b64 v6, v[20:21] offset:512
    s_waitcnt lgkmcnt(0)
    s_barrier
    s_mov_b32 s36, s72
    s_mov_b32 s37, s73
    s_mov_b32 s38, 0x800000
    s_mov_b32 s39, 0x00020000
    s_lshl_b32 s46, s2, 15
    buffer_load_dwordx4 v[96:99], v5, s[36:39], s46 offen
    s_add_u32 s46, s46, 1024
    buffer_load_dwordx4 v[100:103], v5, s[36:39], s46 offen
    s_add_u32 s46, s46, 1024
    buffer_load_dwordx4 v[104:107], v5, s[36:39], s46 offen
    s_add_u32 s46, s46, 1024
    buffer_load_dwordx4 v[108:111], v5, s[36:39], s46 offen
    s_add_u32 s46, s46, 1024
    buffer_load_dwordx4 v[112:115], v5, s[36:39], s46 offen
    s_add_u32 s46, s46, 1024
    buffer_load_dwordx4 v[116:119], v5, s[36:39], s46 offen
    s_add_u32 s46, s46, 1024
    buffer_load_dwordx4 v[120:123], v5, s[36:39], s46 offen
    s_add_u32 s46, s46, 1024
    buffer_load_dwordx4 v[124:127], v5, s[36:39], s46 offen
    s_add_u32 s46, s46, 1024
    buffer_load_dwordx4 v[128:131], v5, s[36:39], s46 offen
    s_add_u32 s46, s46, 1024
    buffer_load_dwordx4 v[132:135], v5, s[36:39], s46 offen
    s_add_u32 s46, s46, 1024
    buffer_load_dwordx4 v[136:139], v5, s[36:39], s46 offen
    s_add_u32 s46, s46, 1024
    buffer_load_dwordx4 v[140:143], v5, s[36:39], s46 offen
    s_add_u32 s46, s46, 1024
    buffer_load_dwordx4 v[144:147], v5, s[36:39], s46 offen
    s_add_u32 s46, s46, 1024
    buffer_load_dwordx4 v[148:151], v5, s[36:39], s46 offen
    s_add_u32 s46, s46, 1024
    buffer_load_dwordx4 v[152:155], v5, s[36:39], s46 offen
    s_add_u32 s46, s46, 1024
    buffer_load_dwordx4 v[156:159], v5, s[36:39], s46 offen
    s_add_u32 s46, s46, 1024
    buffer_load_dwordx4 v[96:99], v5, s[36:39], s46 offen
    s_add_u32 s46, s46, 1024
    buffer_load_dwordx4 v[100:103], v5, s[36:39], s46 offen
    s_add_u32 s46, s46, 1024
    buffer_load_dwordx4 v[104:107], v5, s[36:39], s46 offen
    s_add_u32 s46, s46, 1024
    buffer_load_dwordx4 v[108:111], v5, s[36:39], s46 offen
    s_add_u32 s46, s46, 1024
    buffer_load_dwordx4 v[112:115], v5, s[36:39], s46 offen
    s_add_u32 s46, s46, 1024
    buffer_load_dwordx4 v[116:119], v5, s[36:39], s46 offen
    s_add_u32 s46, s46, 1024
    buffer_load_dwordx4 v[120:123], v5, s[36:39], s46 offen
    s_add_u32 s46, s46, 1024
    buffer_load_dwordx4 v[124:127], v5, s[36:39], s46 offen
    s_add_u32 s46, s46, 1024
    buffer_load_dwordx4 v[128:131], v5, s[36:39], s46 offen
    s_add_u32 s46, s46, 1024
    buffer_load_dwordx4 v[132:135], v5, s[36:39], s46 offen
    s_add_u32 s46, s46, 1024
    buffer_load_dwordx4 v[136:139], v5, s[36:39], s46 offen
    s_add_u32 s46, s46, 1024
    buffer_load_dwordx4 v[140:143], v5, s[36:39], s46 offen
    s_add_u32 s46, s46, 1024
    buffer_load_dwordx4 v[144:147], v5, s[36:39], s46 offen
    s_add_u32 s46, s46, 1024
    buffer_load_dwordx4 v[148:151], v5, s[36:39], s46 offen
    s_add_u32 s46, s46, 1024
    buffer_load_dwordx4 v[152:155], v5, s[36:39], s46 offen
    s_add_u32 s46, s46, 1024
    buffer_load_dwordx4 v[156:159], v5, s[36:39], s46 offen
    s_add_u32 s46, s46, 1024
    v_add_u32 v7, 140288, v5
    s_lshl_b32 s42, s13, 3
    s_lshl_b32 s43, s10, 14
    s_add_u32 s43, s43, s42
    s_barrier
    ds_read_b128 v[16:19], v7
    ds_read_b128 v[20:23], v7 offset:1024
    s_waitcnt lgkmcnt(0)
    v_add_f32 v16, v16, v20
    v_and_b32 v16, 0xfffffffe, v16
    v_add_f32 v17, v17, v21
    v_and_b32 v17, 0xfffffffe, v17
    v_add_f32 v18, v18, v22
    v_and_b32 v18, 0xfffffffe, v18
    v_add_f32 v19, v19, v23
    v_and_b32 v19, 0xfffffffe, v19
    buffer_store_dwordx4 v[16:19], v5, s[84:87], s43 offen sc1
    s_barrier
    s_barrier
    s_barrier
    s_mov_b32 s47, 1048576
    s_add_u32 s43, s42, 0
    buffer_load_dwordx4 v[32:35], v5, s[84:87], s43 offen sc1
    s_add_u32 s43, s42, 16384
    buffer_load_dwordx4 v[36:39], v5, s[84:87], s43 offen sc1
    s_add_u32 s43, s42, 32768
    buffer_load_dwordx4 v[40:43], v5, s[84:87], s43 offen sc1
    s_add_u32 s43, s42, 49152
    buffer_load_dwordx4 v[44:47], v5, s[84:87], s43 offen sc1
    s_add_u32 s43, s42, 65536
    buffer_load_dwordx4 v[48:51], v5, s[84:87], s43 offen sc1
    s_add_u32 s43, s42, 81920
    buffer_load_dwordx4 v[52:55], v5, s[84:87], s43 offen sc1
    s_add_u32 s43, s42, 98304
    buffer_load_dwordx4 v[56:59], v5, s[84:87], s43 offen sc1
    s_add_u32 s43, s42, 114688
    buffer_load_dwordx4 v[60:63], v5, s[84:87], s43 offen sc1
    s_add_u32 s43, s42, 131072
    buffer_load_dwordx4 v[64:67], v5, s[84:87], s43 offen sc1
    s_add_u32 s43, s42, 147456
    buffer_load_dwordx4 v[68:71], v5, s[84:87], s43 offen sc1
    s_add_u32 s43, s42, 163840
    buffer_load_dwordx4 v[72:75], v5, s[84:87], s43 offen sc1
    s_add_u32 s43, s42, 180224
    buffer_load_dwordx4 v[76:79], v5, s[84:87], s43 offen sc1
    s_add_u32 s43, s42, 196608
    buffer_load_dwordx4 v[80:83], v5, s[84:87], s43 offen sc1
    s_add_u32 s43, s42, 212992
    buffer_load_dwordx4 v[84:87], v5, s[84:87], s43 offen sc1
    s_add_u32 s43, s42, 229376
    buffer_load_dwordx4 v[88:91], v5, s[84:87], s43 offen sc1
    s_add_u32 s43, s42, 245760
    buffer_load_dwordx4 v[92:95], v5, s[84:87], s43 offen sc1
    s_barrier
    s_branch pc_mega_kernel_21
poll_mega_kernel_19:
    s_sleep 1
    s_add_u32 s43, s42, 0
    buffer_load_dwordx4 v[32:35], v5, s[84:87], s43 offen sc1
    s_add_u32 s43, s42, 16384
    buffer_load_dwordx4 v[36:39], v5, s[84:87], s43 offen sc1
    s_add_u32 s43, s42, 32768
    buffer_load_dwordx4 v[40:43], v5, s[84:87], s43 offen sc1
    s_add_u32 s43, s42, 49152
    buffer_load_dwordx4 v[44:47], v5, s[84:87], s43 offen sc1
    s_add_u32 s43, s42, 65536
    buffer_load_dwordx4 v[48:51], v5, s[84:87], s43 offen sc1
    s_add_u32 s43, s42, 81920
    buffer_load_dwordx4 v[52:55], v5, s[84:87], s43 offen sc1
    s_add_u32 s43, s42, 98304
    buffer_load_dwordx4 v[56:59], v5, s[84:87], s43 offen sc1
    s_add_u32 s43, s42, 114688
    buffer_load_dwordx4 v[60:63], v5, s[84:87], s43 offen sc1
    s_add_u32 s43, s42, 131072
    buffer_load_dwordx4 v[64:67], v5, s[84:87], s43 offen sc1
    s_add_u32 s43, s42, 147456
    buffer_load_dwordx4 v[68:71], v5, s[84:87], s43 offen sc1
    s_add_u32 s43, s42, 163840
    buffer_load_dwordx4 v[72:75], v5, s[84:87], s43 offen sc1
    s_add_u32 s43, s42, 180224
    buffer_load_dwordx4 v[76:79], v5, s[84:87], s43 offen sc1
    s_add_u32 s43, s42, 196608
    buffer_load_dwordx4 v[80:83], v5, s[84:87], s43 offen sc1
    s_add_u32 s43, s42, 212992
    buffer_load_dwordx4 v[84:87], v5, s[84:87], s43 offen sc1
    s_add_u32 s43, s42, 229376
    buffer_load_dwordx4 v[88:91], v5, s[84:87], s43 offen sc1
    s_add_u32 s43, s42, 245760
    buffer_load_dwordx4 v[92:95], v5, s[84:87], s43 offen sc1
pc_mega_kernel_21:
    s_waitcnt vmcnt(0)
    v_add_f32 v24, v32, v36
    v_add_f32 v25, v33, v37
    v_add_f32 v26, v34, v38
    v_add_f32 v27, v35, v39
    v_add_f32 v24, v24, v40
    v_add_f32 v25, v25, v41
    v_add_f32 v26, v26, v42
    v_add_f32 v27, v27, v43
    v_add_f32 v24, v24, v44
    v_add_f32 v25, v25, v45
    v_add_f32 v26, v26, v46
    v_add_f32 v27, v27, v47
    v_add_f32 v24, v24, v48
    v_add_f32 v25, v25, v49
    v_add_f32 v26, v26, v50
    v_add_f32 v27, v27, v51
    v_add_f32 v24, v24, v52
    v_add_f32 v25, v25, v53
    v_add_f32 v26, v26, v54
    v_add_f32 v27, v27, v55
    v_add_f32 v24, v24, v56
    v_add_f32 v25, v25, v57
    v_add_f32 v26, v26, v58
    v_add_f32 v27, v27, v59
    v_add_f32 v24, v24, v60
    v_add_f32 v25, v25, v61
    v_add_f32 v26, v26, v62
    v_add_f32 v27, v27, v63
    v_add_f32 v24, v24, v64
    v_add_f32 v25, v25, v65
    v_add_f32 v26, v26, v66
    v_add_f32 v27, v27, v67
    v_add_f32 v24, v24, v68
    v_add_f32 v25, v25, v69
    v_add_f32 v26, v26, v70
    v_add_f32 v27, v27, v71
    v_add_f32 v24, v24, v72
    v_add_f32 v25, v25, v73
    v_add_f32 v26, v26, v74
    v_add_f32 v27, v27, v75
    v_add_f32 v24, v24, v76
    v_add_f32 v25, v25, v77
    v_add_f32 v26, v26, v78
    v_add_f32 v27, v27, v79
    v_add_f32 v24, v24, v80
    v_add_f32 v25, v25, v81
    v_add_f32 v26, v26, v82
    v_add_f32 v27, v27, v83
    v_add_f32 v24, v24, v84
    v_add_f32 v25, v25, v85
    v_add_f32 v26, v26, v86
    v_add_f32 v27, v27, v87
    v_add_f32 v24, v24, v88
    v_add_f32 v25, v25, v89
    v_add_f32 v26, v26, v90
    v_add_f32 v27, v27, v91
    v_add_f32 v24, v24, v92
    v_add_f32 v25, v25, v93
    v_add_f32 v26, v26, v94
    v_add_f32 v27, v27, v95
    v_add_f32 v12, v24, v25
    v_add_f32 v13, v26, v27
    v_cmp_u_f32 vcc, v12, v13
    s_nop 4
    s_cbranch_vccz pd_mega_kernel_20
    v_or_b32 v13, v32, v33
    v_or3_b32 v13, v13, v34, v35
    v_or3_b32 v13, v13, v36, v37
    v_or3_b32 v13, v13, v38, v39
    v_or3_b32 v13, v13, v40, v41
    v_or3_b32 v13, v13, v42, v43
    v_or3_b32 v13, v13, v44, v45
    v_or3_b32 v13, v13, v46, v47
    v_or3_b32 v13, v13, v48, v49
    v_or3_b32 v13, v13, v50, v51
    v_or3_b32 v13, v13, v52, v53
    v_or3_b32 v13, v13, v54, v55
    v_or3_b32 v13, v13, v56, v57
    v_or3_b32 v13, v13, v58, v59
    v_or3_b32 v13, v13, v60, v61
    v_or3_b32 v13, v13, v62, v63
    v_or3_b32 v13, v13, v64, v65
    v_or3_b32 v13, v13, v66, v67
    v_or3_b32 v13, v13, v68, v69
    v_or3_b32 v13, v13, v70, v71
    v_or3_b32 v13, v13, v72, v73
    v_or3_b32 v13, v13, v74, v75
    v_or3_b32 v13, v13, v76, v77
    v_or3_b32 v13, v13, v78, v79
    v_or3_b32 v13, v13, v80, v81
    v_or3_b32 v13, v13, v82, v83
    v_or3_b32 v13, v13, v84, v85
    v_or3_b32 v13, v13, v86, v87
    v_or3_b32 v13, v13, v88, v89
    v_or3_b32 v13, v13, v90, v91
    v_or3_b32 v13, v13, v92, v93
    v_or3_b32 v13, v13, v94, v95
    v_and_b32 v13, 1, v13
    v_cmp_ne_u32 vcc, 0, v13
    s_sub_u32 s47, s47, 1
    s_cmp_eq_u32 s47, 0
    s_cbranch_scc1 pd_mega_kernel_20
    s_nop 3
    s_cbranch_vccnz poll_mega_kernel_19
pd_mega_kernel_20:
    v_mul_f32 v24, 0x39e38e39, v24
    v_mul_f32 v25, 0x39e38e39, v25
    v_fma_f32 v25, -v24, v24, v25
    v_max_f32 v25, 0, v25
    v_cvt_pk_bf16_f32 v24, v24, v24
    v_lshlrev_b32 v24, 16, v24
    v_cvt_pk_bf16_f32 v25, v25, v25
    v_lshlrev_b32 v25, 16, v25
    v_add_f32 v25, 0x3727c5ac, v25
    v_cvt_pk_bf16_f32 v25, v25, v25
    v_lshlrev_b32 v25, 16, v25
    v_sqrt_f32 v25, v25
    s_nop 0
    v_cvt_pk_bf16_f32 v25, v25, v25
    v_lshlrev_b32 v25, 16, v25
    v_rcp_f32 v25, v25
    s_nop 0
    v_mul_f32 v24, v24, v25
    v_mul_f32 v26, 0x39e38e39, v26
    v_mul_f32 v27, 0x39e38e39, v27
    v_fma_f32 v27, -v26, v26, v27
    v_max_f32 v27, 0, v27
    v_cvt_pk_bf16_f32 v26, v26, v26
    v_lshlrev_b32 v26, 16, v26
    v_cvt_pk_bf16_f32 v27, v27, v27
    v_lshlrev_b32 v27, 16, v27
    v_add_f32 v27, 0x3727c5ac, v27
    v_cvt_pk_bf16_f32 v27, v27, v27
    v_lshlrev_b32 v27, 16, v27
    v_sqrt_f32 v27, v27
    s_nop 0
    v_cvt_pk_bf16_f32 v27, v27, v27
    v_lshlrev_b32 v27, 16, v27
    v_rcp_f32 v27, v27
    s_nop 0
    v_mul_f32 v26, v26, v27
    v_mov_b32 v16, v25
    v_mov_b32 v17, v27
    v_mov_b32 v18, v24
    v_mov_b32 v19, v26
    v_lshlrev_b32 v6, 3, v2
    v_add_u32 v6, 142336, v6
    ds_write_b64 v6, v[16:17]
    ds_write_b64 v6, v[18:19] offset:512
    s_waitcnt lgkmcnt(0)
    v_mov_b32 v16, 0
    v_lshlrev_b32 v5, 7, v2
    s_lshl_b32 s42, s10, 11
    s_lshl_b32 s43, s11, 2
    s_add_u32 s42, s42, s43
    s_add_u32 s42, s42, 409600
    s_barrier
    s_barrier
    s_barrier
    s_mov_b64 exec, 65535
    buffer_store_dword v16, v5, s[84:87], s42 offen sc1
    s_mov_b64 exec, -1
    s_barrier
    s_barrier
    s_add_u32 s84, s6, 0x1e00000
    s_addc_u32 s85, s7, 0
    s_mov_b32 s86, 0x74000
    s_mov_b32 s87, 0x00020000
    s_lshl_b32 s45, s10, 4
    s_add_u32 s45, s45, s11
    s_lshl_b32 s45, s45, 7
    s_add_u32 s45, s45, 409600
    v_and_b32 v12, 15, v2
    v_lshlrev_b32 v12, 2, v12
    s_mov_b32 s47, 1048576
poll_mega_kernel_22:
    buffer_load_dword v13, v12, s[84:87], s45 offen sc1
    s_waitcnt vmcnt(0)
    v_and_b32 v13, 1, v13
    v_cmp_ne_u32 vcc, 0, v13
    s_sub_u32 s47, s47, 1
    s_cmp_eq_u32 s47, 0
    s_cbranch_scc1 pd_mega_kernel_23
    s_nop 3
    s_cbranch_vccz pd_mega_kernel_23
    s_sleep 1
    s_branch poll_mega_kernel_22
pd_mega_kernel_23:
    s_barrier
    s_mov_b32 s43, 7
lp_mega_kernel_24:
    s_barrier
    s_barrier
    s_barrier
    s_barrier
    s_sub_u32 s43, s43, 1
    s_cmp_lg_u32 s43, 0
    s_cbranch_scc1 lp_mega_kernel_24
    s_barrier
    s_barrier
    s_barrier
    s_barrier
    s_lshl_b32 s42, s11, 11
    s_lshl_b32 s43, s10, 2
    s_add_u32 s42, s42, s43
    s_add_u32 s42, s42, 442368
    s_mov_b64 exec, 65535
    s_barrier
    buffer_store_dword v16, v5, s[84:87], s42 offen sc1
    s_endpgm
done_mega_kernel_1:
    s_endpgm
all_code_end:
.section .rodata,"a"
.p2align 6
.amdhsa_kernel k1_kernel
  .amdhsa_next_free_vgpr 72
  .amdhsa_next_free_sgpr 80
  .amdhsa_accum_offset 72
  .amdhsa_group_segment_fixed_size 0
  .amdhsa_kernarg_size 136
  .amdhsa_user_sgpr_count 2
  .amdhsa_user_sgpr_kernarg_segment_ptr 1
  .amdhsa_system_sgpr_workgroup_id_x 1
  .amdhsa_float_denorm_mode_32 3
.end_amdhsa_kernel
.p2align 6
.amdhsa_kernel k2_kernel
  .amdhsa_next_free_vgpr 112
  .amdhsa_next_free_sgpr 80
  .amdhsa_accum_offset 112
  .amdhsa_group_segment_fixed_size 0
  .amdhsa_kernarg_size 136
  .amdhsa_user_sgpr_count 2
  .amdhsa_user_sgpr_kernarg_segment_ptr 1
  .amdhsa_system_sgpr_workgroup_id_x 1
  .amdhsa_float_denorm_mode_32 3
.end_amdhsa_kernel
.p2align 6
.amdhsa_kernel mega_kernel
  .amdhsa_next_free_vgpr 164
  .amdhsa_next_free_sgpr 96
  .amdhsa_accum_offset 164
  .amdhsa_group_segment_fixed_size 0
  .amdhsa_kernarg_size 136
  .amdhsa_user_sgpr_count 2
  .amdhsa_user_sgpr_kernarg_segment_ptr 1
  .amdhsa_system_sgpr_workgroup_id_x 1
  .amdhsa_float_denorm_mode_32 3
.end_amdhsa_kernel
```
